```python
import torch

def _softmax(x, axis=-1):
    return torch.softmax(x, dim=axis)
def _gelu(x):
    return torch.nn.functional.gelu(x, approximate="tanh")
def _silu(x):
    return torch.nn.functional.silu(x)
def _sigmoid(x):
    return torch.sigmoid(x)
def _layernorm(x, axis=-1, eps=1e-5):
    m = x.mean(dim=axis, keepdim=True)
    v = x.var(dim=axis, keepdim=True, unbiased=False)
    return (x - m) / torch.sqrt(v + eps)
def _scatter_add(tgt, idx, src, axis=0):
    return tgt.clone().index_add_(axis, idx, src)
def _segment_sum(src, seg, n):
    out = torch.zeros((n,) + src.shape[1:], dtype=src.dtype)
    return out.index_add_(0, seg, src)
def _pad(x, pw):
    flat = tuple(v for pair in reversed(pw) for v in pair)
    return torch.nn.functional.pad(x, flat)

kernel_name = 'standalone__gqa_softmax__near_ridge'

def setup_inputs():

    _w = (lambda a: (lambda t: t.to(torch.bfloat16) if t.is_floating_point() else t)(torch.as_tensor(a)))
    B, Hq, Hkv, Sq, Sk, D = 16, 32, 32, 736, 512, 128
    return {
        "q": _w((lambda *s: torch.randn(*s, dtype=torch.bfloat16) * 0.8)(B, Hq, Sq, D)),
        "k": _w((lambda *s: torch.randn(*s, dtype=torch.bfloat16) * 0.8)(B, Hkv, Sk, D)),
        "v": _w((lambda *s: torch.randn(*s, dtype=torch.bfloat16) * 0.05)(B, Hkv, Sk, D)),
    }

def reference(q, k, v):
    B, Hq, Sq, D = q.shape
    Hkv = k.shape[1]
    rep = Hq // Hkv
    k = (lambda x, n, axis: torch.repeat_interleave(x, n, dim=axis))(k, rep, axis=1)
    v = (lambda x, n, axis: torch.repeat_interleave(x, n, dim=axis))(v, rep, axis=1)
    scale = D ** -0.5
    scores = torch.einsum("bhqd,bhkd->bhqk", q, k) * scale
    p = _softmax(scores, axis=-1)
    return torch.einsum("bhqk,bhkd->bhqd", p, v)
```

```asm
; @launch grid=(256,1,1) block=(256,1,1) lds=163840
.amdgcn_target "amdgcn-amd-amdhsa--gfx950"
.text
.globl standalone__gqa_softmax__near_ridge_kernel
.p2align 8
.type standalone__gqa_softmax__near_ridge_kernel,@function
standalone__gqa_softmax__near_ridge_kernel:
  s_cmp_ge_u32 s2, 256
  s_cbranch_scc1 L_end
  s_load_dwordx8 s[4:11], s[0:1], 0
  s_getpc_b64 s[74:75]
L_pc:
  s_bfe_u32 s48, s2, 0x30003
  s_lshl_b32 s48, s48, 15
  v_lshl_add_u32 v246, v0, 7, s48
  v_min_u32 v246, L_end-L_pc, v246
  v_mov_b32 v247, 0
  v_lshl_add_u64 v[246:247], v[246:247], 0, s[74:75]
  global_load_dword v236, v[246:247], off
  v_lshrrev_b32 v250, 6, v0
  v_and_b32 v248, 63, v0
  v_readfirstlane_b32 s52, v250
  s_and_b32 s48, s2, 7
  s_lshr_b32 s49, s2, 4
  s_lshl_b32 s49, s49, 3
  s_add_u32 s48, s48, s49
  s_lshl_b32 s53, s48, 19
  s_mul_i32 s51, s48, 753664
  s_bfe_u32 s49, s2, 0x10003
  s_mul_i32 s49, s49, 94208
  s_add_u32 s51, s51, s49
  s_mul_i32 s49, s52, 24576
  s_add_u32 s51, s51, s49
  s_add_u32 s50, s49, 65536
  s_and_b32 s48, s52, 1
  s_lshl_b32 s48, s48, 12
  s_lshr_b32 s49, s52, 1
  s_lshl_b32 s54, s49, 11
  s_add_u32 s39, s48, s54
  s_lshl_b32 s54, s49, 10
  s_add_u32 s40, s48, s54
  s_add_u32 s37, s53, s39
  s_add_u32 s38, s53, s40
  s_add_u32 s40, s40, 8192
  s_lshl_b32 s49, s49, 5
  v_bfe_u32 v250, v248, 2, 2
  v_lshrrev_b32 v251, 4, v248
  v_and_b32 v252, 3, v248
  v_lshlrev_b32 v229, 8, v250
  v_lshl_add_u32 v229, v251, 6, v229
  v_lshl_add_u32 v229, v252, 4, v229
  v_xor_b32 v230, 32, v229
  v_xor_b32 v228, s49, v229
  v_xor_b32 v241, v251, v248
  v_lshlrev_b32 v241, 4, v241
  s_nop 0
  s_waitcnt lgkmcnt(0)
  s_mov_b32 s16, s4
  s_and_b32 s17, s5, 0xffff
  s_mov_b32 s18, 96468992
  s_mov_b32 s19, 0x20000
  s_mov_b32 s20, s6
  s_and_b32 s21, s7, 0xffff
  s_add_u32 s22, s53, 524288
  s_mov_b32 s23, 0x20000
  s_mov_b32 s24, s8
  s_and_b32 s25, s9, 0xffff
  s_add_u32 s26, s53, 524288
  s_mov_b32 s27, 0x20000
  s_mov_b32 s28, s10
  s_and_b32 s29, s11, 0xffff
  s_mov_b32 s30, 96468992
  s_mov_b32 s31, 0x20000
  s_cmp_eq_u32 s52, 3
  s_cbranch_scc1 L_pro5
L_pro6:
  s_add_u32 m0, s39, 0
  s_nop 0
  buffer_load_dwordx4 v228, s[20:23], s37 offen offset:0 lds
  buffer_load_dwordx4 v228, s[20:23], s37 offen offset:1024 lds
  s_add_u32 s37, s37, 8192
  s_add_u32 m0, s40, 0
  s_nop 0
  buffer_load_dwordx4 v241, s[24:27], s38 offen offset:0 lds
  buffer_load_dwordx4 v241, s[24:27], s38 offen offset:2048 lds
  s_add_u32 s38, s38, 8192
  s_add_u32 m0, s39, 16384
  s_nop 0
  buffer_load_dwordx4 v228, s[20:23], s37 offen offset:0 lds
  buffer_load_dwordx4 v228, s[20:23], s37 offen offset:1024 lds
  s_add_u32 s37, s37, 8192
  s_add_u32 m0, s40, 16384
  s_nop 0
  buffer_load_dwordx4 v241, s[24:27], s38 offen offset:0 lds
  buffer_load_dwordx4 v241, s[24:27], s38 offen offset:2048 lds
  s_add_u32 s38, s38, 8192
  s_mov_b32 s41, s51
  s_add_u32 m0, s50, 0
  s_nop 0
  buffer_load_dwordx4 v229, s[16:19], s41 offen offset:0 nt lds
  buffer_load_dwordx4 v229, s[16:19], s41 offen offset:1024 nt lds
  buffer_load_dwordx4 v230, s[16:19], s41 offen offset:2048 nt lds
  buffer_load_dwordx4 v230, s[16:19], s41 offen offset:3072 nt lds
  s_add_u32 s41, s41, 4096
  s_add_u32 m0, s50, 4096
  s_nop 0
  buffer_load_dwordx4 v229, s[16:19], s41 offen offset:0 nt lds
  buffer_load_dwordx4 v229, s[16:19], s41 offen offset:1024 nt lds
  buffer_load_dwordx4 v230, s[16:19], s41 offen offset:2048 nt lds
  buffer_load_dwordx4 v230, s[16:19], s41 offen offset:3072 nt lds
  s_add_u32 s41, s41, 4096
  v_and_b32 v253, 2, v250
  v_xor_b32 v253, v253, v251
  v_lshlrev_b32 v224, 10, v250
  v_lshl_add_u32 v224, v252, 6, v224
  v_lshl_add_u32 v224, v253, 4, v224
  v_add_u32 v225, s50, v224
  v_lshlrev_b32 v253, 4, v250
  v_lshl_add_u32 v253, v252, 6, v253
  v_lshl_add_u32 v226, v250, 8, v253
  v_lshl_add_u32 v226, v251, 10, v226
  v_xor_b32 v237, 16, v226
  v_xor_b32 v234, 32, v226
  v_xor_b32 v228, 48, v226
  v_lshl_add_u32 v231, v251, 8, v253
  v_lshrrev_b32 v231, 0, v231
  v_add_u32 v231, s50, v231
  v_lshl_add_u32 v233, v248, 4, s50
  v_and_b32 v253, 15, v248
  v_lshlrev_b32 v232, 10, v251
  v_lshl_add_u32 v232, v253, 4, v232
  s_nop 0
  s_nop 0
  v_mov_b32 v250, 0x3f803f80
  v_bfe_u32 v253, v248, 1, 3
  v_lshrrev_b32 v254, 5, v248
  v_cmp_eq_u32 vcc, v253, v254
  v_and_b32 v253, 1, v248
  v_mul_u32_u24 v227, 0xaaaa, v253
  v_cndmask_b32 v250, 0, v250, vcc
  v_add_u32 v227, 0x4444, v227
  v_accvgpr_write_b32 a224, 0
  v_accvgpr_write_b32 a225, 0
  v_accvgpr_write_b32 a226, 0
  v_accvgpr_write_b32 a227, 0
  v_accvgpr_write_b32 a228, 0
  v_accvgpr_write_b32 a229, 0
  v_accvgpr_write_b32 a230, 0
  v_accvgpr_write_b32 a231, 0
  v_accvgpr_write_b32 a232, 0
  v_accvgpr_write_b32 a233, 0
  v_accvgpr_write_b32 a234, 0
  v_accvgpr_write_b32 a235, 0
  v_accvgpr_write_b32 a248, v250
  v_accvgpr_write_b32 a249, v250
  v_accvgpr_write_b32 a250, v250
  v_accvgpr_write_b32 a251, v250
  s_mov_b32 s36, 0x3e0293ee
  s_mov_b32 s45, 0
  s_mov_b32 s46, 0
  s_lshl_b32 s48, s52, 7
  s_add_u32 s48, s48, 162816
  v_lshlrev_b32 v250, 2, v248
  v_add_u32 v251, s48, v250
  v_add_u32 v250, 163200, v250
  v_cmp_gt_u32 vcc, 32, v248
  s_nop 1
  v_cndmask_b32 v242, v250, v251, vcc
  v_cndmask_b32 v243, 0, 1, vcc
  s_mov_b32 s58, 3
  v_add_u32 v231, 24576, v231
  v_xor_b32 v250, 0, v248
  v_lshl_add_u32 v250, v250, 2, s50
  v_and_b32 v251, 48, v248
  v_add_u32 v251, s50, v251
  v_mov_b32 v252, 0x42b00000
  v_mov_b32 v253, 0x42b00000
  v_mov_b32 v254, 0x42b00000
  v_mov_b32 v255, 0x42b00000
  s_waitcnt vmcnt(8)
  s_barrier
  s_add_u32 m0, s50, 8192
  s_nop 0
  buffer_load_dwordx4 v229, s[16:19], s41 offen offset:0 nt lds
  buffer_load_dwordx4 v229, s[16:19], s41 offen offset:1024 nt lds
  buffer_load_dwordx4 v230, s[16:19], s41 offen offset:2048 nt lds
  buffer_load_dwordx4 v230, s[16:19], s41 offen offset:3072 nt lds
  s_add_u32 s41, s41, 4096
  s_add_u32 m0, s50, 12288
  s_nop 0
  buffer_load_dwordx4 v229, s[16:19], s41 offen offset:0 nt lds
  buffer_load_dwordx4 v229, s[16:19], s41 offen offset:1024 nt lds
  buffer_load_dwordx4 v230, s[16:19], s41 offen offset:2048 nt lds
  buffer_load_dwordx4 v230, s[16:19], s41 offen offset:3072 nt lds
  s_add_u32 s41, s41, 4096
  ds_read_b128 a[96:99], v224 offset:0
  ds_read_b128 a[100:103], v224 offset:256
  ds_read_b128 a[104:107], v224 offset:512
  ds_read_b128 a[108:111], v224 offset:768
  ds_read_b128 a[112:115], v224 offset:4096
  ds_read_b128 a[116:119], v224 offset:4352
  ds_read_b128 a[120:123], v224 offset:4608
  ds_read_b128 a[124:127], v224 offset:4864
  ds_read_b128 a[128:131], v224 offset:16384
  ds_read_b128 a[132:135], v224 offset:16640
  ds_read_b128 a[136:139], v224 offset:16896
  ds_read_b128 a[140:143], v224 offset:17152
  ds_read_b128 a[144:147], v224 offset:20480
  ds_read_b128 a[148:151], v224 offset:20736
  ds_read_b128 a[152:155], v224 offset:20992
  ds_read_b128 a[156:159], v224 offset:21248
  ds_read_b64_tr_b16 a[160:161], v226 offset:8192
  ds_read_b64_tr_b16 a[162:163], v226 offset:12288
  ds_read_b64_tr_b16 a[164:165], v237 offset:8192
  ds_read_b64_tr_b16 a[166:167], v237 offset:12288
  ds_read_b64_tr_b16 a[168:169], v234 offset:8192
  ds_read_b64_tr_b16 a[170:171], v234 offset:12288
  ds_read_b64_tr_b16 a[172:173], v228 offset:8192
  ds_read_b64_tr_b16 a[174:175], v228 offset:12288
  ds_read_b64_tr_b16 a[176:177], v226 offset:8200
  ds_read_b64_tr_b16 a[178:179], v226 offset:12296
  ds_read_b64_tr_b16 a[180:181], v237 offset:8200
  ds_read_b64_tr_b16 a[182:183], v237 offset:12296
  ds_read_b64_tr_b16 a[184:185], v234 offset:8200
  ds_read_b64_tr_b16 a[186:187], v234 offset:12296
  ds_read_b64_tr_b16 a[188:189], v228 offset:8200
  ds_read_b64_tr_b16 a[190:191], v228 offset:12296
  s_waitcnt vmcnt(12)
  ds_read_b128 a[0:3], v225 offset:0
  ds_read_b128 a[4:7], v225 offset:256
  ds_read_b128 a[8:11], v225 offset:512
  ds_read_b128 a[12:15], v225 offset:768
  ds_read_b64_tr_b16 a[192:193], v226 offset:24576
  ds_read_b64_tr_b16 a[194:195], v226 offset:28672
  ds_read_b64_tr_b16 a[196:197], v237 offset:24576
  ds_read_b64_tr_b16 a[198:199], v237 offset:28672
  ds_read_b64_tr_b16 a[200:201], v234 offset:24576
  ds_read_b64_tr_b16 a[202:203], v234 offset:28672
  ds_read_b64_tr_b16 a[204:205], v228 offset:24576
  ds_read_b64_tr_b16 a[206:207], v228 offset:28672
  ds_read_b64_tr_b16 a[208:209], v226 offset:24584
  ds_read_b64_tr_b16 a[210:211], v226 offset:28680
  ds_read_b64_tr_b16 a[212:213], v237 offset:24584
  ds_read_b64_tr_b16 a[214:215], v237 offset:28680
  ds_read_b64_tr_b16 a[216:217], v234 offset:24584
  ds_read_b64_tr_b16 a[218:219], v234 offset:28680
  ds_read_b64_tr_b16 a[220:221], v228 offset:24584
  ds_read_b64_tr_b16 a[222:223], v228 offset:28680
  ds_add_u32 v242, v243
  ds_add_u32 v242, v243
  s_waitcnt lgkmcnt(15)
  v_mfma_f32_16x16x32_bf16 v[192:195], a[96:99], a[0:3], v[252:255]
  s_add_u32 m0, s50, 16384
  v_mfma_f32_16x16x32_bf16 v[192:195], a[100:103], a[4:7], v[192:195]
  buffer_load_dwordx4 v229, s[16:19], s41 offen offset:0 nt lds
  v_mfma_f32_16x16x32_bf16 v[192:195], a[104:107], a[8:11], v[192:195]
  buffer_load_dwordx4 v229, s[16:19], s41 offen offset:1024 nt lds
  v_mfma_f32_16x16x32_bf16 v[192:195], a[108:111], a[12:15], v[192:195]
  buffer_load_dwordx4 v230, s[16:19], s41 offen offset:2048 nt lds
  v_mfma_f32_16x16x32_bf16 v[196:199], a[112:115], a[0:3], v[252:255]
  v_mfma_f32_16x16x32_bf16 v[196:199], a[116:119], a[4:7], v[196:199]
  v_mfma_f32_16x16x32_bf16 v[196:199], a[120:123], a[8:11], v[196:199]
  s_waitcnt vmcnt(11)
  buffer_load_dwordx4 v230, s[16:19], s41 offen offset:3072 nt lds
  v_mfma_f32_16x16x32_bf16 v[196:199], a[124:127], a[12:15], v[196:199]
  s_add_u32 s41, s41, 4096
  ds_read_b128 a[16:19], v225 offset:4096
  ds_read_b128 a[20:23], v225 offset:4352
  ds_read_b128 a[24:27], v225 offset:4608
  ds_read_b128 a[28:31], v225 offset:4864
  s_nop 3
  v_mul_f32 v192, s36, v192
  v_mul_f32 v193, s36, v193
  s_nop 1
  s_waitcnt lgkmcnt(6)
  v_exp_f32 v192, v192
  s_nop 1
  v_mul_f32 v194, s36, v194
  v_mul_f32 v195, s36, v195
  s_nop 1
  v_exp_f32 v193, v193
  s_nop 1
  s_nop 1
  v_exp_f32 v194, v194
  s_nop 1
  v_cvt_pk_bf16_f32 v208, v192, v193
  v_mul_f32 v196, s36, v196
  s_nop 1
  v_exp_f32 v195, v195
  s_nop 1
  s_waitcnt lgkmcnt(0)
  v_mul_f32 v197, s36, v197
  v_mul_f32 v198, s36, v198
  v_mfma_f32_16x16x32_bf16 v[200:203], a[96:99], a[16:19], v[252:255]
  s_add_u32 m0, s50, 20480
  v_exp_f32 v196, v196
  v_mfma_f32_16x16x32_bf16 v[200:203], a[100:103], a[20:23], v[200:203]
  buffer_load_dwordx4 v229, s[16:19], s41 offen offset:0 nt lds
  v_cvt_pk_bf16_f32 v209, v194, v195
  v_mul_f32 v199, s36, v199
  v_mfma_f32_16x16x32_bf16 v[200:203], a[104:107], a[24:27], v[200:203]
  buffer_load_dwordx4 v229, s[16:19], s41 offen offset:1024 nt lds
  v_exp_f32 v197, v197
  v_mfma_f32_16x16x32_bf16 v[200:203], a[108:111], a[28:31], v[200:203]
  buffer_load_dwordx4 v230, s[16:19], s41 offen offset:2048 nt lds
  v_exp_f32 v198, v198
  v_mfma_f32_16x16x32_bf16 v[204:207], a[112:115], a[16:19], v[252:255]
  v_mfma_f32_16x16x32_bf16 v[204:207], a[116:119], a[20:23], v[204:207]
  buffer_load_dwordx4 v230, s[16:19], s41 offen offset:3072 nt lds
  v_exp_f32 v199, v199
  v_mfma_f32_16x16x32_bf16 v[204:207], a[120:123], a[24:27], v[204:207]
  s_add_u32 s41, s41, 4096
  v_cvt_pk_bf16_f32 v210, v196, v197
  v_cvt_pk_bf16_f32 v211, v198, v199
  v_mfma_f32_16x16x32_bf16 v[204:207], a[124:127], a[28:31], v[204:207]
  v_mul_f32 v200, s36, v200
  v_mul_f32 v201, s36, v201
  v_mfma_f32_16x16x32_bf16 v[0:3], v[208:211], a[160:163], 0
  v_exp_f32 v200, v200
  v_mfma_f32_16x16x32_bf16 v[4:7], v[208:211], a[164:167], 0
  v_mul_f32 v202, s36, v202
  v_mul_f32 v203, s36, v203
  v_mfma_f32_16x16x32_bf16 v[8:11], v[208:211], a[168:171], 0
  v_exp_f32 v201, v201
  v_mfma_f32_16x16x32_bf16 v[12:15], v[208:211], a[172:175], 0
  v_mfma_f32_16x16x32_bf16 v[16:19], v[208:211], a[176:179], 0
  v_exp_f32 v202, v202
  v_mfma_f32_16x16x32_bf16 v[20:23], v[208:211], a[180:183], 0
  v_cvt_pk_bf16_f32 v212, v200, v201
  v_mul_f32 v204, s36, v204
  v_mfma_f32_16x16x32_bf16 v[24:27], v[208:211], a[184:187], 0
  v_exp_f32 v203, v203
  v_mfma_f32_16x16x32_bf16 v[28:31], v[208:211], a[188:191], 0
  v_mul_f32 v205, s36, v205
  v_mul_f32 v206, s36, v206
  v_mfma_f32_16x16x32_bf16 v[192:195], a[128:131], a[0:3], v[252:255]
  v_exp_f32 v204, v204
  v_mfma_f32_16x16x32_bf16 v[192:195], a[132:135], a[4:7], v[192:195]
  v_cvt_pk_bf16_f32 v213, v202, v203
  v_mul_f32 v207, s36, v207
  v_mfma_f32_16x16x32_bf16 v[192:195], a[136:139], a[8:11], v[192:195]
  v_exp_f32 v205, v205
  v_mfma_f32_16x16x32_bf16 v[192:195], a[140:143], a[12:15], v[192:195]
  v_exp_f32 v206, v206
  v_mfma_f32_16x16x32_bf16 v[196:199], a[144:147], a[0:3], v[252:255]
  v_mfma_f32_16x16x32_bf16 v[196:199], a[148:151], a[4:7], v[196:199]
  v_exp_f32 v207, v207
  v_mfma_f32_16x16x32_bf16 v[196:199], a[152:155], a[8:11], v[196:199]
  v_cvt_pk_bf16_f32 v214, v204, v205
  v_cvt_pk_bf16_f32 v215, v206, v207
  v_mfma_f32_16x16x32_bf16 v[196:199], a[156:159], a[12:15], v[196:199]
  s_nop 0
  v_smfmac_f32_16x16x64_bf16 a[224:227], a[248:251], v[208:215], v227
  v_mul_f32 v192, s36, v192
  v_mul_f32 v193, s36, v193
  v_mfma_f32_16x16x32_bf16 v[32:35], v[212:215], a[160:163], 0
  v_exp_f32 v192, v192
  v_mfma_f32_16x16x32_bf16 v[36:39], v[212:215], a[164:167], 0
  v_mul_f32 v194, s36, v194
  v_mul_f32 v195, s36, v195
  v_mfma_f32_16x16x32_bf16 v[40:43], v[212:215], a[168:171], 0
  v_exp_f32 v193, v193
  v_mfma_f32_16x16x32_bf16 v[44:47], v[212:215], a[172:175], 0
  v_mfma_f32_16x16x32_bf16 v[48:51], v[212:215], a[176:179], 0
  v_exp_f32 v194, v194
  v_mfma_f32_16x16x32_bf16 v[52:55], v[212:215], a[180:183], 0
  v_cvt_pk_bf16_f32 v208, v192, v193
  v_mul_f32 v196, s36, v196
  v_mfma_f32_16x16x32_bf16 v[56:59], v[212:215], a[184:187], 0
  v_exp_f32 v195, v195
  v_mfma_f32_16x16x32_bf16 v[60:63], v[212:215], a[188:191], 0
  v_mul_f32 v197, s36, v197
  v_mul_f32 v198, s36, v198
  v_mfma_f32_16x16x32_bf16 v[200:203], a[128:131], a[16:19], v[252:255]
  v_exp_f32 v196, v196
  v_mfma_f32_16x16x32_bf16 v[200:203], a[132:135], a[20:23], v[200:203]
  v_cvt_pk_bf16_f32 v209, v194, v195
  v_mul_f32 v199, s36, v199
  v_mfma_f32_16x16x32_bf16 v[200:203], a[136:139], a[24:27], v[200:203]
  v_exp_f32 v197, v197
  v_mfma_f32_16x16x32_bf16 v[200:203], a[140:143], a[28:31], v[200:203]
  v_exp_f32 v198, v198
  v_mfma_f32_16x16x32_bf16 v[204:207], a[144:147], a[16:19], v[252:255]
  v_mfma_f32_16x16x32_bf16 v[204:207], a[148:151], a[20:23], v[204:207]
  v_exp_f32 v199, v199
  v_mfma_f32_16x16x32_bf16 v[204:207], a[152:155], a[24:27], v[204:207]
  s_waitcnt vmcnt(12)
  v_cvt_pk_bf16_f32 v210, v196, v197
  v_cvt_pk_bf16_f32 v211, v198, v199
  v_mfma_f32_16x16x32_bf16 v[204:207], a[156:159], a[28:31], v[204:207]
  ds_read_b128 a[32:35], v225 offset:8192
  ds_read_b128 a[36:39], v225 offset:8448
  ds_read_b128 a[40:43], v225 offset:8704
  ds_read_b128 a[44:47], v225 offset:8960
  v_mul_f32 v200, s36, v200
  v_mul_f32 v201, s36, v201
  v_mfma_f32_16x16x32_bf16 v[0:3], v[208:211], a[192:195], v[0:3]
  v_exp_f32 v200, v200
  v_mfma_f32_16x16x32_bf16 v[4:7], v[208:211], a[196:199], v[4:7]
  v_mul_f32 v202, s36, v202
  v_mul_f32 v203, s36, v203
  v_mfma_f32_16x16x32_bf16 v[8:11], v[208:211], a[200:203], v[8:11]
  v_exp_f32 v201, v201
  v_mfma_f32_16x16x32_bf16 v[12:15], v[208:211], a[204:207], v[12:15]
  v_mfma_f32_16x16x32_bf16 v[16:19], v[208:211], a[208:211], v[16:19]
  v_exp_f32 v202, v202
  v_mfma_f32_16x16x32_bf16 v[20:23], v[208:211], a[212:215], v[20:23]
  v_cvt_pk_bf16_f32 v212, v200, v201
  v_mul_f32 v204, s36, v204
  v_mfma_f32_16x16x32_bf16 v[24:27], v[208:211], a[216:219], v[24:27]
  v_exp_f32 v203, v203
  v_mfma_f32_16x16x32_bf16 v[28:31], v[208:211], a[220:223], v[28:31]
  s_waitcnt lgkmcnt(0)
  v_mul_f32 v205, s36, v205
  v_mul_f32 v206, s36, v206
  v_mfma_f32_16x16x32_bf16 v[192:195], a[96:99], a[32:35], v[252:255]
  v_exp_f32 v204, v204
  v_mfma_f32_16x16x32_bf16 v[192:195], a[100:103], a[36:39], v[192:195]
  v_cvt_pk_bf16_f32 v213, v202, v203
  v_mul_f32 v207, s36, v207
  v_mfma_f32_16x16x32_bf16 v[192:195], a[104:107], a[40:43], v[192:195]
  v_exp_f32 v205, v205
  v_mfma_f32_16x16x32_bf16 v[192:195], a[108:111], a[44:47], v[192:195]
  v_exp_f32 v206, v206
  v_mfma_f32_16x16x32_bf16 v[196:199], a[112:115], a[32:35], v[252:255]
  v_mfma_f32_16x16x32_bf16 v[196:199], a[116:119], a[36:39], v[196:199]
  v_exp_f32 v207, v207
  v_mfma_f32_16x16x32_bf16 v[196:199], a[120:123], a[40:43], v[196:199]
  s_waitcnt vmcnt(8)
  v_cvt_pk_bf16_f32 v214, v204, v205
  v_cvt_pk_bf16_f32 v215, v206, v207
  v_mfma_f32_16x16x32_bf16 v[196:199], a[124:127], a[44:47], v[196:199]
  ds_read_b128 a[48:51], v225 offset:12288
  ds_read_b128 a[52:55], v225 offset:12544
  ds_read_b128 a[56:59], v225 offset:12800
  ds_read_b128 a[60:63], v225 offset:13056
  v_smfmac_f32_16x16x64_bf16 a[224:227], a[248:251], v[208:215], v227
  v_mul_f32 v192, s36, v192
  v_mul_f32 v193, s36, v193
  v_mfma_f32_16x16x32_bf16 v[32:35], v[212:215], a[192:195], v[32:35]
  v_exp_f32 v192, v192
  v_mfma_f32_16x16x32_bf16 v[36:39], v[212:215], a[196:199], v[36:39]
  v_mul_f32 v194, s36, v194
  v_mul_f32 v195, s36, v195
  v_mfma_f32_16x16x32_bf16 v[40:43], v[212:215], a[200:203], v[40:43]
  v_exp_f32 v193, v193
  v_mfma_f32_16x16x32_bf16 v[44:47], v[212:215], a[204:207], v[44:47]
  v_mfma_f32_16x16x32_bf16 v[48:51], v[212:215], a[208:211], v[48:51]
  v_exp_f32 v194, v194
  v_mfma_f32_16x16x32_bf16 v[52:55], v[212:215], a[212:215], v[52:55]
  v_cvt_pk_bf16_f32 v208, v192, v193
  v_mul_f32 v196, s36, v196
  v_mfma_f32_16x16x32_bf16 v[56:59], v[212:215], a[216:219], v[56:59]
  v_exp_f32 v195, v195
  v_mfma_f32_16x16x32_bf16 v[60:63], v[212:215], a[220:223], v[60:63]
  s_waitcnt lgkmcnt(0)
  v_mul_f32 v197, s36, v197
  v_mul_f32 v198, s36, v198
  v_mfma_f32_16x16x32_bf16 v[200:203], a[96:99], a[48:51], v[252:255]
  v_exp_f32 v196, v196
  v_mfma_f32_16x16x32_bf16 v[200:203], a[100:103], a[52:55], v[200:203]
  v_cvt_pk_bf16_f32 v209, v194, v195
  v_mul_f32 v199, s36, v199
  v_mfma_f32_16x16x32_bf16 v[200:203], a[104:107], a[56:59], v[200:203]
  v_exp_f32 v197, v197
  v_mfma_f32_16x16x32_bf16 v[200:203], a[108:111], a[60:63], v[200:203]
  v_exp_f32 v198, v198
  v_mfma_f32_16x16x32_bf16 v[204:207], a[112:115], a[48:51], v[252:255]
  v_mfma_f32_16x16x32_bf16 v[204:207], a[116:119], a[52:55], v[204:207]
  v_exp_f32 v199, v199
  v_mfma_f32_16x16x32_bf16 v[204:207], a[120:123], a[56:59], v[204:207]
  v_cvt_pk_bf16_f32 v210, v196, v197
  v_cvt_pk_bf16_f32 v211, v198, v199
  v_mfma_f32_16x16x32_bf16 v[204:207], a[124:127], a[60:63], v[204:207]
  v_mul_f32 v200, s36, v200
  v_mul_f32 v201, s36, v201
  v_mfma_f32_16x16x32_bf16 v[64:67], v[208:211], a[160:163], 0
  v_exp_f32 v200, v200
  v_mfma_f32_16x16x32_bf16 v[68:71], v[208:211], a[164:167], 0
  v_mul_f32 v202, s36, v202
  v_mul_f32 v203, s36, v203
  v_mfma_f32_16x16x32_bf16 v[72:75], v[208:211], a[168:171], 0
  v_exp_f32 v201, v201
  v_mfma_f32_16x16x32_bf16 v[76:79], v[208:211], a[172:175], 0
  v_mfma_f32_16x16x32_bf16 v[80:83], v[208:211], a[176:179], 0
  v_exp_f32 v202, v202
  v_mfma_f32_16x16x32_bf16 v[84:87], v[208:211], a[180:183], 0
  v_cvt_pk_bf16_f32 v212, v200, v201
  v_mul_f32 v204, s36, v204
  v_mfma_f32_16x16x32_bf16 v[88:91], v[208:211], a[184:187], 0
  v_exp_f32 v203, v203
  v_mfma_f32_16x16x32_bf16 v[92:95], v[208:211], a[188:191], 0
  v_mul_f32 v205, s36, v205
  v_mul_f32 v206, s36, v206
  v_mfma_f32_16x16x32_bf16 v[192:195], a[128:131], a[32:35], v[252:255]
  v_exp_f32 v204, v204
  v_mfma_f32_16x16x32_bf16 v[192:195], a[132:135], a[36:39], v[192:195]
  v_cvt_pk_bf16_f32 v213, v202, v203
  v_mul_f32 v207, s36, v207
  v_mfma_f32_16x16x32_bf16 v[192:195], a[136:139], a[40:43], v[192:195]
  v_exp_f32 v205, v205
  v_mfma_f32_16x16x32_bf16 v[192:195], a[140:143], a[44:47], v[192:195]
  v_exp_f32 v206, v206
  v_mfma_f32_16x16x32_bf16 v[196:199], a[144:147], a[32:35], v[252:255]
  v_mfma_f32_16x16x32_bf16 v[196:199], a[148:151], a[36:39], v[196:199]
  v_exp_f32 v207, v207
  v_mfma_f32_16x16x32_bf16 v[196:199], a[152:155], a[40:43], v[196:199]
  v_cvt_pk_bf16_f32 v214, v204, v205
  v_cvt_pk_bf16_f32 v215, v206, v207
  v_mfma_f32_16x16x32_bf16 v[196:199], a[156:159], a[44:47], v[196:199]
  s_nop 0
  v_smfmac_f32_16x16x64_bf16 a[228:231], a[248:251], v[208:215], v227
  v_mul_f32 v192, s36, v192
  v_mul_f32 v193, s36, v193
  v_mfma_f32_16x16x32_bf16 v[96:99], v[212:215], a[160:163], 0
  v_exp_f32 v192, v192
  v_mfma_f32_16x16x32_bf16 v[100:103], v[212:215], a[164:167], 0
  v_mul_f32 v194, s36, v194
  v_mul_f32 v195, s36, v195
  v_mfma_f32_16x16x32_bf16 v[104:107], v[212:215], a[168:171], 0
  v_exp_f32 v193, v193
  v_mfma_f32_16x16x32_bf16 v[108:111], v[212:215], a[172:175], 0
  v_mfma_f32_16x16x32_bf16 v[112:115], v[212:215], a[176:179], 0
  v_exp_f32 v194, v194
  v_mfma_f32_16x16x32_bf16 v[116:119], v[212:215], a[180:183], 0
  v_cvt_pk_bf16_f32 v208, v192, v193
  v_mul_f32 v196, s36, v196
  v_mfma_f32_16x16x32_bf16 v[120:123], v[212:215], a[184:187], 0
  v_exp_f32 v195, v195
  v_mfma_f32_16x16x32_bf16 v[124:127], v[212:215], a[188:191], 0
  v_mul_f32 v197, s36, v197
  v_mul_f32 v198, s36, v198
  v_mfma_f32_16x16x32_bf16 v[200:203], a[128:131], a[48:51], v[252:255]
  v_exp_f32 v196, v196
  v_mfma_f32_16x16x32_bf16 v[200:203], a[132:135], a[52:55], v[200:203]
  v_cvt_pk_bf16_f32 v209, v194, v195
  v_mul_f32 v199, s36, v199
  v_mfma_f32_16x16x32_bf16 v[200:203], a[136:139], a[56:59], v[200:203]
  v_exp_f32 v197, v197
  v_mfma_f32_16x16x32_bf16 v[200:203], a[140:143], a[60:63], v[200:203]
  v_exp_f32 v198, v198
  v_mfma_f32_16x16x32_bf16 v[204:207], a[144:147], a[48:51], v[252:255]
  v_mfma_f32_16x16x32_bf16 v[204:207], a[148:151], a[52:55], v[204:207]
  v_exp_f32 v199, v199
  v_mfma_f32_16x16x32_bf16 v[204:207], a[152:155], a[56:59], v[204:207]
  s_waitcnt vmcnt(4)
  v_cvt_pk_bf16_f32 v210, v196, v197
  v_cvt_pk_bf16_f32 v211, v198, v199
  v_mfma_f32_16x16x32_bf16 v[204:207], a[156:159], a[60:63], v[204:207]
  ds_read_b128 a[64:67], v225 offset:16384
  ds_read_b128 a[68:71], v225 offset:16640
  ds_read_b128 a[72:75], v225 offset:16896
  ds_read_b128 a[76:79], v225 offset:17152
  v_mul_f32 v200, s36, v200
  v_mul_f32 v201, s36, v201
  v_mfma_f32_16x16x32_bf16 v[64:67], v[208:211], a[192:195], v[64:67]
  v_exp_f32 v200, v200
  v_mfma_f32_16x16x32_bf16 v[68:71], v[208:211], a[196:199], v[68:71]
  v_mul_f32 v202, s36, v202
  v_mul_f32 v203, s36, v203
  v_mfma_f32_16x16x32_bf16 v[72:75], v[208:211], a[200:203], v[72:75]
  v_exp_f32 v201, v201
  v_mfma_f32_16x16x32_bf16 v[76:79], v[208:211], a[204:207], v[76:79]
  v_mfma_f32_16x16x32_bf16 v[80:83], v[208:211], a[208:211], v[80:83]
  v_exp_f32 v202, v202
  v_mfma_f32_16x16x32_bf16 v[84:87], v[208:211], a[212:215], v[84:87]
  v_cvt_pk_bf16_f32 v212, v200, v201
  v_mul_f32 v204, s36, v204
  v_mfma_f32_16x16x32_bf16 v[88:91], v[208:211], a[216:219], v[88:91]
  v_exp_f32 v203, v203
  v_mfma_f32_16x16x32_bf16 v[92:95], v[208:211], a[220:223], v[92:95]
  s_waitcnt lgkmcnt(0)
  v_mul_f32 v205, s36, v205
  v_mul_f32 v206, s36, v206
  v_mfma_f32_16x16x32_bf16 v[192:195], a[96:99], a[64:67], v[252:255]
  v_exp_f32 v204, v204
  v_mfma_f32_16x16x32_bf16 v[192:195], a[100:103], a[68:71], v[192:195]
  v_cvt_pk_bf16_f32 v213, v202, v203
  v_mul_f32 v207, s36, v207
  v_mfma_f32_16x16x32_bf16 v[192:195], a[104:107], a[72:75], v[192:195]
  v_exp_f32 v205, v205
  v_mfma_f32_16x16x32_bf16 v[192:195], a[108:111], a[76:79], v[192:195]
  v_exp_f32 v206, v206
  v_mfma_f32_16x16x32_bf16 v[196:199], a[112:115], a[64:67], v[252:255]
  v_mfma_f32_16x16x32_bf16 v[196:199], a[116:119], a[68:71], v[196:199]
  v_exp_f32 v207, v207
  v_mfma_f32_16x16x32_bf16 v[196:199], a[120:123], a[72:75], v[196:199]
  s_waitcnt vmcnt(0)
  v_cvt_pk_bf16_f32 v214, v204, v205
  v_cvt_pk_bf16_f32 v215, v206, v207
  v_mfma_f32_16x16x32_bf16 v[196:199], a[124:127], a[76:79], v[196:199]
  ds_read_b128 a[80:83], v225 offset:20480
  ds_read_b128 a[84:87], v225 offset:20736
  ds_read_b128 a[88:91], v225 offset:20992
  ds_read_b128 a[92:95], v225 offset:21248
  v_smfmac_f32_16x16x64_bf16 a[228:231], a[248:251], v[208:215], v227
  v_mul_f32 v192, s36, v192
  v_mul_f32 v193, s36, v193
  v_mfma_f32_16x16x32_bf16 v[96:99], v[212:215], a[192:195], v[96:99]
  v_exp_f32 v192, v192
  v_mfma_f32_16x16x32_bf16 v[100:103], v[212:215], a[196:199], v[100:103]
  v_mul_f32 v194, s36, v194
  v_mul_f32 v195, s36, v195
  v_mfma_f32_16x16x32_bf16 v[104:107], v[212:215], a[200:203], v[104:107]
  v_exp_f32 v193, v193
  v_mfma_f32_16x16x32_bf16 v[108:111], v[212:215], a[204:207], v[108:111]
  v_mfma_f32_16x16x32_bf16 v[112:115], v[212:215], a[208:211], v[112:115]
  v_exp_f32 v194, v194
  v_mfma_f32_16x16x32_bf16 v[116:119], v[212:215], a[212:215], v[116:119]
  v_cvt_pk_bf16_f32 v208, v192, v193
  v_mul_f32 v196, s36, v196
  v_mfma_f32_16x16x32_bf16 v[120:123], v[212:215], a[216:219], v[120:123]
  v_exp_f32 v195, v195
  v_mfma_f32_16x16x32_bf16 v[124:127], v[212:215], a[220:223], v[124:127]
  s_waitcnt lgkmcnt(0)
  v_mul_f32 v197, s36, v197
  v_mul_f32 v198, s36, v198
  v_mfma_f32_16x16x32_bf16 v[200:203], a[96:99], a[80:83], v[252:255]
  v_exp_f32 v196, v196
  v_mfma_f32_16x16x32_bf16 v[200:203], a[100:103], a[84:87], v[200:203]
  v_cvt_pk_bf16_f32 v209, v194, v195
  v_mul_f32 v199, s36, v199
  v_mfma_f32_16x16x32_bf16 v[200:203], a[104:107], a[88:91], v[200:203]
  v_exp_f32 v197, v197
  v_mfma_f32_16x16x32_bf16 v[200:203], a[108:111], a[92:95], v[200:203]
  v_exp_f32 v198, v198
  v_mfma_f32_16x16x32_bf16 v[204:207], a[112:115], a[80:83], v[252:255]
  ds_read_b32 v244, v242
  v_mfma_f32_16x16x32_bf16 v[204:207], a[116:119], a[84:87], v[204:207]
  v_exp_f32 v199, v199
  v_mfma_f32_16x16x32_bf16 v[204:207], a[120:123], a[88:91], v[204:207]
  v_cvt_pk_bf16_f32 v210, v196, v197
  v_cvt_pk_bf16_f32 v211, v198, v199
  v_mfma_f32_16x16x32_bf16 v[204:207], a[124:127], a[92:95], v[204:207]
  v_mul_f32 v200, s36, v200
  v_mul_f32 v201, s36, v201
  v_mfma_f32_16x16x32_bf16 v[128:131], v[208:211], a[160:163], 0
  v_exp_f32 v200, v200
  v_mfma_f32_16x16x32_bf16 v[132:135], v[208:211], a[164:167], 0
  v_mul_f32 v202, s36, v202
  v_mul_f32 v203, s36, v203
  v_mfma_f32_16x16x32_bf16 v[136:139], v[208:211], a[168:171], 0
  v_exp_f32 v201, v201
  v_mfma_f32_16x16x32_bf16 v[140:143], v[208:211], a[172:175], 0
  s_waitcnt lgkmcnt(0)
  v_cmp_gt_u32 vcc, s58, v244
  v_mfma_f32_16x16x32_bf16 v[144:147], v[208:211], a[176:179], 0
  v_exp_f32 v202, v202
  v_mfma_f32_16x16x32_bf16 v[148:151], v[208:211], a[180:183], 0
  s_cbranch_vccnz L_s6_a
L_r6_a:
  v_cvt_pk_bf16_f32 v212, v200, v201
  v_mul_f32 v204, s36, v204
  v_mfma_f32_16x16x32_bf16 v[152:155], v[208:211], a[184:187], 0
  s_add_u32 s58, s58, 1
  v_exp_f32 v203, v203
  v_mfma_f32_16x16x32_bf16 v[156:159], v[208:211], a[188:191], 0
  v_mul_f32 v205, s36, v205
  v_mul_f32 v206, s36, v206
  v_mfma_f32_16x16x32_bf16 v[192:195], a[128:131], a[64:67], v[252:255]
  ds_read_b128 a[96:99], v224 offset:32768
  ds_read_b128 a[100:103], v224 offset:33024
  v_exp_f32 v204, v204
  v_mfma_f32_16x16x32_bf16 v[192:195], a[132:135], a[68:71], v[192:195]
  v_cvt_pk_bf16_f32 v213, v202, v203
  v_mul_f32 v207, s36, v207
  v_mfma_f32_16x16x32_bf16 v[192:195], a[136:139], a[72:75], v[192:195]
  v_exp_f32 v205, v205
  v_mfma_f32_16x16x32_bf16 v[192:195], a[140:143], a[76:79], v[192:195]
  v_exp_f32 v206, v206
  v_mfma_f32_16x16x32_bf16 v[196:199], a[144:147], a[64:67], v[252:255]
  ds_read_b128 a[104:107], v224 offset:33280
  ds_read_b128 a[108:111], v224 offset:33536
  v_mfma_f32_16x16x32_bf16 v[196:199], a[148:151], a[68:71], v[196:199]
  v_exp_f32 v207, v207
  v_mfma_f32_16x16x32_bf16 v[196:199], a[152:155], a[72:75], v[196:199]
  v_cvt_pk_bf16_f32 v214, v204, v205
  v_cvt_pk_bf16_f32 v215, v206, v207
  v_mfma_f32_16x16x32_bf16 v[196:199], a[156:159], a[76:79], v[196:199]
  ds_read_b128 a[112:115], v224 offset:36864
  ds_read_b128 a[116:119], v224 offset:37120
  v_smfmac_f32_16x16x64_bf16 a[232:235], a[248:251], v[208:215], v227
  v_mul_f32 v192, s36, v192
  v_mul_f32 v193, s36, v193
  v_mfma_f32_16x16x32_bf16 v[160:163], v[212:215], a[160:163], 0
  v_exp_f32 v192, v192
  v_mfma_f32_16x16x32_bf16 v[164:167], v[212:215], a[164:167], 0
  v_mul_f32 v194, s36, v194
  v_mul_f32 v195, s36, v195
  v_mfma_f32_16x16x32_bf16 v[168:171], v[212:215], a[168:171], 0
  v_exp_f32 v193, v193
  v_mfma_f32_16x16x32_bf16 v[172:175], v[212:215], a[172:175], 0
  ds_read_b128 a[120:123], v224 offset:37376
  ds_read_b128 a[124:127], v224 offset:37632
  v_mfma_f32_16x16x32_bf16 v[176:179], v[212:215], a[176:179], 0
  v_exp_f32 v194, v194
  v_mfma_f32_16x16x32_bf16 v[180:183], v[212:215], a[180:183], 0
  v_cvt_pk_bf16_f32 v208, v192, v193
  v_mul_f32 v196, s36, v196
  v_mfma_f32_16x16x32_bf16 v[184:187], v[212:215], a[184:187], 0
  v_exp_f32 v195, v195
  v_mfma_f32_16x16x32_bf16 v[188:191], v[212:215], a[188:191], 0
  v_mul_f32 v197, s36, v197
  v_mul_f32 v198, s36, v198
  v_mfma_f32_16x16x32_bf16 v[200:203], a[128:131], a[80:83], v[252:255]
  ds_read_b64_tr_b16 a[160:161], v226 offset:40960
  ds_read_b64_tr_b16 a[162:163], v226 offset:45056
  v_exp_f32 v196, v196
  v_mfma_f32_16x16x32_bf16 v[200:203], a[132:135], a[84:87], v[200:203]
  v_cvt_pk_bf16_f32 v209, v194, v195
  v_mul_f32 v199, s36, v199
  v_mfma_f32_16x16x32_bf16 v[200:203], a[136:139], a[88:91], v[200:203]
  ds_read_b64_tr_b16 a[164:165], v237 offset:40960
  ds_read_b64_tr_b16 a[166:167], v237 offset:45056
  v_exp_f32 v197, v197
  v_mfma_f32_16x16x32_bf16 v[200:203], a[140:143], a[92:95], v[200:203]
  s_waitcnt lgkmcnt(4)
  v_exp_f32 v198, v198
  v_mfma_f32_16x16x32_bf16 v[204:207], a[144:147], a[80:83], v[252:255]
  ds_read_b64_tr_b16 a[168:169], v234 offset:40960
  ds_read_b64_tr_b16 a[170:171], v234 offset:45056
  ds_read_b64_tr_b16 a[172:173], v228 offset:40960
  ds_read_b64_tr_b16 a[174:175], v228 offset:45056
  v_mfma_f32_16x16x32_bf16 v[204:207], a[148:151], a[84:87], v[204:207]
  v_exp_f32 v199, v199
  v_mfma_f32_16x16x32_bf16 v[204:207], a[152:155], a[88:91], v[204:207]
  v_cvt_pk_bf16_f32 v210, v196, v197
  v_cvt_pk_bf16_f32 v211, v198, v199
  v_mfma_f32_16x16x32_bf16 v[204:207], a[156:159], a[92:95], v[204:207]
  v_mul_f32 v200, s36, v200
  v_mul_f32 v201, s36, v201
  v_mfma_f32_16x16x32_bf16 v[128:131], v[208:211], a[192:195], v[128:131]
  ds_read_b64_tr_b16 a[176:177], v226 offset:40968
  ds_read_b64_tr_b16 a[178:179], v226 offset:45064
  v_exp_f32 v200, v200
  v_mfma_f32_16x16x32_bf16 v[132:135], v[208:211], a[196:199], v[132:135]
  v_mul_f32 v202, s36, v202
  v_mul_f32 v203, s36, v203
  v_mfma_f32_16x16x32_bf16 v[136:139], v[208:211], a[200:203], v[136:139]
  v_exp_f32 v201, v201
  v_mfma_f32_16x16x32_bf16 v[140:143], v[208:211], a[204:207], v[140:143]
  ds_read_b64_tr_b16 a[180:181], v237 offset:40968
  ds_read_b64_tr_b16 a[182:183], v237 offset:45064
  ds_read_b64_tr_b16 a[184:185], v234 offset:40968
  ds_read_b64_tr_b16 a[186:187], v234 offset:45064
  v_mfma_f32_16x16x32_bf16 v[144:147], v[208:211], a[208:211], v[144:147]
  v_exp_f32 v202, v202
  v_mfma_f32_16x16x32_bf16 v[148:151], v[208:211], a[212:215], v[148:151]
  v_cvt_pk_bf16_f32 v212, v200, v201
  v_mul_f32 v204, s36, v204
  v_mfma_f32_16x16x32_bf16 v[152:155], v[208:211], a[216:219], v[152:155]
  v_exp_f32 v203, v203
  v_mfma_f32_16x16x32_bf16 v[156:159], v[208:211], a[220:223], v[156:159]
  v_mul_f32 v205, s36, v205
  v_mul_f32 v206, s36, v206
  s_mov_b32 s42, 0
  s_mov_b32 s30, 0
  s_add_u32 s41, s51, 188416
  s_mov_b32 s44, 0
  s_branch L_D6
.p2align 6
L_A6:
  v_mfma_f32_16x16x32_bf16 v[192:195], a[128:131], a[0:3], v[252:255]
  v_exp_f32 v204, v204
  v_mfma_f32_16x16x32_bf16 v[192:195], a[132:135], a[4:7], v[192:195]
  v_cvt_pk_bf16_f32 v213, v202, v203
  v_mul_f32 v207, s36, v207
  v_mfma_f32_16x16x32_bf16 v[192:195], a[136:139], a[8:11], v[192:195]
  v_exp_f32 v205, v205
  v_mfma_f32_16x16x32_bf16 v[192:195], a[140:143], a[12:15], v[192:195]
  v_exp_f32 v206, v206
  v_mfma_f32_16x16x32_bf16 v[196:199], a[144:147], a[0:3], v[252:255]
  ds_read_b64_tr_b16 a[220:221], v228 offset:57352
  ds_read_b64_tr_b16 a[222:223], v228 offset:61448
  v_mfma_f32_16x16x32_bf16 v[196:199], a[148:151], a[4:7], v[196:199]
  v_exp_f32 v207, v207
  v_mfma_f32_16x16x32_bf16 v[196:199], a[152:155], a[8:11], v[196:199]
  s_waitcnt vmcnt(32)
  v_cvt_pk_bf16_f32 v214, v204, v205
  v_cvt_pk_bf16_f32 v215, v206, v207
  v_mfma_f32_16x16x32_bf16 v[196:199], a[156:159], a[12:15], v[196:199]
  ds_add_rtn_u32 v244, v242, v243
  ds_read_b128 a[0:3], v225 offset:0
  ds_read_b128 a[4:7], v225 offset:256
  v_smfmac_f32_16x16x64_bf16 a[232:235], a[248:251], v[208:215], v227
  ds_read_b128 a[8:11], v225 offset:512
  ds_read_b128 a[12:15], v225 offset:768
  v_mul_f32 v192, s36, v192
  v_mul_f32 v193, s36, v193
  v_mfma_f32_16x16x32_bf16 v[160:163], v[212:215], a[160:163], v[160:163]
  v_exp_f32 v192, v192
  v_mfma_f32_16x16x32_bf16 v[164:167], v[212:215], a[164:167], v[164:167]
  v_mul_f32 v194, s36, v194
  v_mul_f32 v195, s36, v195
  v_mfma_f32_16x16x32_bf16 v[168:171], v[212:215], a[168:171], v[168:171]
  v_exp_f32 v193, v193
  v_mfma_f32_16x16x32_bf16 v[172:175], v[212:215], a[172:175], v[172:175]
  ds_read_b128 a[96:99], v224 offset:0
  ds_read_b128 a[100:103], v224 offset:256
  v_mfma_f32_16x16x32_bf16 v[176:179], v[212:215], a[176:179], v[176:179]
  v_exp_f32 v194, v194
  v_mfma_f32_16x16x32_bf16 v[180:183], v[212:215], a[180:183], v[180:183]
  v_cvt_pk_bf16_f32 v208, v192, v193
  v_mul_f32 v196, s36, v196
  v_mfma_f32_16x16x32_bf16 v[184:187], v[212:215], a[184:187], v[184:187]
  v_exp_f32 v195, v195
  v_mfma_f32_16x16x32_bf16 v[188:191], v[212:215], a[188:191], v[188:191]
  v_mul_f32 v197, s36, v197
  v_mul_f32 v198, s36, v198
  v_mfma_f32_16x16x32_bf16 v[200:203], a[128:131], a[16:19], v[252:255]
  v_exp_f32 v196, v196
  v_mfma_f32_16x16x32_bf16 v[200:203], a[132:135], a[20:23], v[200:203]
  v_cvt_pk_bf16_f32 v209, v194, v195
  v_mul_f32 v199, s36, v199
  v_mfma_f32_16x16x32_bf16 v[200:203], a[136:139], a[24:27], v[200:203]
  v_exp_f32 v197, v197
  v_mfma_f32_16x16x32_bf16 v[200:203], a[140:143], a[28:31], v[200:203]
  v_exp_f32 v198, v198
  v_mfma_f32_16x16x32_bf16 v[204:207], a[144:147], a[16:19], v[252:255]
  ds_read_b128 a[104:107], v224 offset:512
  ds_read_b128 a[108:111], v224 offset:768
  v_mfma_f32_16x16x32_bf16 v[204:207], a[148:151], a[20:23], v[204:207]
  v_exp_f32 v199, v199
  v_mfma_f32_16x16x32_bf16 v[204:207], a[152:155], a[24:27], v[204:207]
  v_cvt_pk_bf16_f32 v210, v196, v197
  v_cvt_pk_bf16_f32 v211, v198, v199
  v_mfma_f32_16x16x32_bf16 v[204:207], a[156:159], a[28:31], v[204:207]
  s_waitcnt lgkmcnt(8)
  ds_read_b128 a[16:19], v225 offset:4096
  ds_read_b128 a[20:23], v225 offset:4352
  v_mul_f32 v200, s36, v200
  v_mul_f32 v201, s36, v201
  v_mfma_f32_16x16x32_bf16 v[0:3], v[208:211], a[192:195], v[0:3]
  v_exp_f32 v200, v200
  v_mfma_f32_16x16x32_bf16 v[4:7], v[208:211], a[196:199], v[4:7]
  ds_read_b128 a[24:27], v225 offset:4608
  ds_read_b128 a[28:31], v225 offset:4864
  v_mul_f32 v202, s36, v202
  v_mul_f32 v203, s36, v203
  v_mfma_f32_16x16x32_bf16 v[8:11], v[208:211], a[200:203], v[8:11]
  v_exp_f32 v201, v201
  v_mfma_f32_16x16x32_bf16 v[12:15], v[208:211], a[204:207], v[12:15]
  ds_read_b128 a[112:115], v224 offset:4096
  ds_read_b128 a[116:119], v224 offset:4352
  v_mfma_f32_16x16x32_bf16 v[16:19], v[208:211], a[208:211], v[16:19]
  v_exp_f32 v202, v202
  v_mfma_f32_16x16x32_bf16 v[20:23], v[208:211], a[212:215], v[20:23]
  v_cvt_pk_bf16_f32 v212, v200, v201
  v_mul_f32 v204, s36, v204
  v_mfma_f32_16x16x32_bf16 v[24:27], v[208:211], a[216:219], v[24:27]
  v_exp_f32 v203, v203
  v_mfma_f32_16x16x32_bf16 v[28:31], v[208:211], a[220:223], v[28:31]
  v_mul_f32 v205, s36, v205
  v_mul_f32 v206, s36, v206
  v_mfma_f32_16x16x32_bf16 v[192:195], a[128:131], a[32:35], v[252:255]
  v_exp_f32 v204, v204
  v_mfma_f32_16x16x32_bf16 v[192:195], a[132:135], a[36:39], v[192:195]
  v_cvt_pk_bf16_f32 v213, v202, v203
  v_mul_f32 v207, s36, v207
  v_mfma_f32_16x16x32_bf16 v[192:195], a[136:139], a[40:43], v[192:195]
  v_exp_f32 v205, v205
  v_mfma_f32_16x16x32_bf16 v[192:195], a[140:143], a[44:47], v[192:195]
  v_exp_f32 v206, v206
  v_mfma_f32_16x16x32_bf16 v[196:199], a[144:147], a[32:35], v[252:255]
  ds_read_b128 a[120:123], v224 offset:4608
  ds_read_b128 a[124:127], v224 offset:4864
  v_mfma_f32_16x16x32_bf16 v[196:199], a[148:151], a[36:39], v[196:199]
  v_exp_f32 v207, v207
  v_mfma_f32_16x16x32_bf16 v[196:199], a[152:155], a[40:43], v[196:199]
  v_cvt_pk_bf16_f32 v214, v204, v205
  v_cvt_pk_bf16_f32 v215, v206, v207
  v_mfma_f32_16x16x32_bf16 v[196:199], a[156:159], a[44:47], v[196:199]
  ds_read_b128 a[32:35], v225 offset:8192
  ds_read_b128 a[36:39], v225 offset:8448
  v_cmp_gt_u32 vcc, s58, v244
  v_smfmac_f32_16x16x64_bf16 a[224:227], a[248:251], v[208:215], v227
  ds_read_b128 a[40:43], v225 offset:8704
  ds_read_b128 a[44:47], v225 offset:8960
  v_mul_f32 v192, s36, v192
  v_mul_f32 v193, s36, v193
  v_mfma_f32_16x16x32_bf16 v[32:35], v[212:215], a[192:195], v[32:35]
  s_cbranch_vccnz L_s6_1515
L_r6_1515:
  v_exp_f32 v192, v192
  v_mfma_f32_16x16x32_bf16 v[36:39], v[212:215], a[196:199], v[36:39]
  s_add_u32 s58, s58, 1
  v_mul_f32 v194, s36, v194
  v_mul_f32 v195, s36, v195
  v_mfma_f32_16x16x32_bf16 v[40:43], v[212:215], a[200:203], v[40:43]
  v_exp_f32 v193, v193
  v_accvgpr_read_b32 v238, a224
  v_accvgpr_read_b32 v216, a225
  v_accvgpr_read_b32 v239, a226
  v_accvgpr_read_b32 v220, a227
  v_add_f32 v238, v238, v216
  v_add_f32 v239, v239, v220
  v_rcp_f32 v216, v238
  v_rcp_f32 v220, v239
  v_add_u32 v238, 0xd5800000, v238
  v_add_u32 v239, 0xd5800000, v239
  ds_write2st64_b32 v250, v216, v220 offset0:0 offset1:1
  ds_read_b128 v[216:219], v251 offset:0
  ds_read_b128 v[220:223], v251 offset:256
  v_accvgpr_write_b32 a224, 0
  v_accvgpr_write_b32 a225, 0
  v_accvgpr_write_b32 a226, 0
  v_accvgpr_write_b32 a227, 0
  v_mfma_f32_16x16x32_bf16 v[44:47], v[212:215], a[204:207], v[44:47]
  ds_read_b64_tr_b16 a[160:161], v226 offset:8192
  ds_read_b64_tr_b16 a[162:163], v226 offset:12288
  v_mfma_f32_16x16x32_bf16 v[48:51], v[212:215], a[208:211], v[48:51]
  v_exp_f32 v194, v194
  v_mfma_f32_16x16x32_bf16 v[52:55], v[212:215], a[212:215], v[52:55]
  v_cvt_pk_bf16_f32 v208, v192, v193
  v_mul_f32 v196, s36, v196
  v_mfma_f32_16x16x32_bf16 v[56:59], v[212:215], a[216:219], v[56:59]
  v_exp_f32 v195, v195
  v_mfma_f32_16x16x32_bf16 v[60:63], v[212:215], a[220:223], v[60:63]
  v_mul_f32 v197, s36, v197
  v_mul_f32 v198, s36, v198
  v_mfma_f32_16x16x32_bf16 v[200:203], a[128:131], a[48:51], v[252:255]
  v_exp_f32 v196, v196
  v_mfma_f32_16x16x32_bf16 v[200:203], a[132:135], a[52:55], v[200:203]
  v_cvt_pk_bf16_f32 v209, v194, v195
  v_mul_f32 v199, s36, v199
  v_mfma_f32_16x16x32_bf16 v[200:203], a[136:139], a[56:59], v[200:203]
  v_exp_f32 v197, v197
  v_mfma_f32_16x16x32_bf16 v[200:203], a[140:143], a[60:63], v[200:203]
  v_exp_f32 v198, v198
  v_mfma_f32_16x16x32_bf16 v[204:207], a[144:147], a[48:51], v[252:255]
  s_waitcnt lgkmcnt(2)
  ds_read_b64_tr_b16 a[164:165], v237 offset:8192
  ds_read_b64_tr_b16 a[166:167], v237 offset:12288
  v_cmp_le_u32 vcc, 0x34000000, v238
  v_pk_mul_f32 v[0:1], v[0:1], v[216:217]
  v_pk_mul_f32 v[2:3], v[2:3], v[218:219]
  v_pk_mul_f32 v[4:5], v[4:5], v[216:217]
  v_pk_mul_f32 v[6:7], v[6:7], v[218:219]
  v_pk_mul_f32 v[8:9], v[8:9], v[216:217]
  v_pk_mul_f32 v[10:11], v[10:11], v[218:219]
  v_pk_mul_f32 v[12:13], v[12:13], v[216:217]
  v_pk_mul_f32 v[14:15], v[14:15], v[218:219]
  v_cvt_pk_bf16_f32 v0, v0, v4
  v_cvt_pk_bf16_f32 v4, v1, v5
  v_cvt_pk_bf16_f32 v1, v8, v12
  v_cvt_pk_bf16_f32 v5, v9, v13
  v_cvt_pk_bf16_f32 v8, v2, v6
  v_cvt_pk_bf16_f32 v12, v3, v7
  v_pk_mul_f32 v[16:17], v[16:17], v[216:217]
  v_pk_mul_f32 v[20:21], v[20:21], v[216:217]
  v_pk_mul_f32 v[24:25], v[24:25], v[216:217]
  v_pk_mul_f32 v[28:29], v[28:29], v[216:217]
  v_cvt_pk_bf16_f32 v2, v16, v20
  v_cvt_pk_bf16_f32 v3, v24, v28
  ds_write_b128 v233, v[0:3] offset:0
  v_cvt_pk_bf16_f32 v6, v17, v21
  v_cvt_pk_bf16_f32 v7, v25, v29
  v_cvt_pk_bf16_f32 v9, v10, v14
  v_cvt_pk_bf16_f32 v13, v11, v15
  v_pk_mul_f32 v[18:19], v[18:19], v[218:219]
  v_pk_mul_f32 v[22:23], v[22:23], v[218:219]
  v_pk_mul_f32 v[26:27], v[26:27], v[218:219]
  v_pk_mul_f32 v[30:31], v[30:31], v[218:219]
  v_cvt_pk_bf16_f32 v10, v18, v22
  v_cvt_pk_bf16_f32 v11, v26, v30
  v_cvt_pk_bf16_f32 v14, v19, v23
  v_cvt_pk_bf16_f32 v15, v27, v31
  v_mfma_f32_16x16x32_bf16 v[204:207], a[148:151], a[52:55], v[204:207]
  s_and_b32 vcc_lo, vcc_lo, 0xffff
  v_exp_f32 v199, v199
  v_mfma_f32_16x16x32_bf16 v[204:207], a[152:155], a[56:59], v[204:207]
  s_addc_u32 s46, s46, s46
  v_cvt_pk_bf16_f32 v210, v196, v197
  v_cvt_pk_bf16_f32 v211, v198, v199
  v_mfma_f32_16x16x32_bf16 v[204:207], a[156:159], a[60:63], v[204:207]
  ds_read_b128 a[48:51], v225 offset:12288
  ds_read_b128 a[52:55], v225 offset:12544
  v_mul_f32 v200, s36, v200
  v_mul_f32 v201, s36, v201
  v_mfma_f32_16x16x32_bf16 v[64:67], v[208:211], a[192:195], v[64:67]
  ds_write_b128 v233, v[4:7] offset:1024
  v_exp_f32 v200, v200
  v_mfma_f32_16x16x32_bf16 v[68:71], v[208:211], a[196:199], v[68:71]
  ds_read_b128 a[56:59], v225 offset:12800
  ds_read_b128 a[60:63], v225 offset:13056
  v_mul_f32 v202, s36, v202
  v_mul_f32 v203, s36, v203
  v_mfma_f32_16x16x32_bf16 v[72:75], v[208:211], a[200:203], v[72:75]
  v_exp_f32 v201, v201
  v_mfma_f32_16x16x32_bf16 v[76:79], v[208:211], a[204:207], v[76:79]
  ds_read_b64_tr_b16 a[168:169], v234 offset:8192
  ds_read_b64_tr_b16 a[170:171], v234 offset:12288
  v_mfma_f32_16x16x32_bf16 v[80:83], v[208:211], a[208:211], v[80:83]
  ds_write_b128 v233, v[8:11] offset:2048
  v_exp_f32 v202, v202
  v_mfma_f32_16x16x32_bf16 v[84:87], v[208:211], a[212:215], v[84:87]
  v_cvt_pk_bf16_f32 v212, v200, v201
  v_mul_f32 v204, s36, v204
  v_mfma_f32_16x16x32_bf16 v[88:91], v[208:211], a[216:219], v[88:91]
  ds_write_b128 v233, v[12:15] offset:3072
  v_exp_f32 v203, v203
  v_mfma_f32_16x16x32_bf16 v[92:95], v[208:211], a[220:223], v[92:95]
  v_mul_f32 v205, s36, v205
  v_mul_f32 v206, s36, v206
  v_mfma_f32_16x16x32_bf16 v[192:195], a[128:131], a[64:67], v[252:255]
  v_exp_f32 v204, v204
  v_mfma_f32_16x16x32_bf16 v[192:195], a[132:135], a[68:71], v[192:195]
  v_cvt_pk_bf16_f32 v213, v202, v203
  v_mul_f32 v207, s36, v207
  v_mfma_f32_16x16x32_bf16 v[192:195], a[136:139], a[72:75], v[192:195]
  v_exp_f32 v205, v205
  v_mfma_f32_16x16x32_bf16 v[192:195], a[140:143], a[76:79], v[192:195]
  v_exp_f32 v206, v206
  v_mfma_f32_16x16x32_bf16 v[196:199], a[144:147], a[64:67], v[252:255]
  ds_read_b64_tr_b16 a[172:173], v228 offset:8192
  ds_read_b64_tr_b16 a[174:175], v228 offset:12288
  v_cmp_le_u32 vcc, 0x34000000, v239
  v_pk_mul_f32 v[32:33], v[32:33], v[220:221]
  v_pk_mul_f32 v[36:37], v[36:37], v[220:221]
  v_pk_mul_f32 v[40:41], v[40:41], v[220:221]
  v_pk_mul_f32 v[44:45], v[44:45], v[220:221]
  v_pk_mul_f32 v[48:49], v[48:49], v[220:221]
  v_pk_mul_f32 v[52:53], v[52:53], v[220:221]
  v_pk_mul_f32 v[56:57], v[56:57], v[220:221]
  v_pk_mul_f32 v[60:61], v[60:61], v[220:221]
  v_cvt_pk_bf16_f32 v0, v32, v36
  v_cvt_pk_bf16_f32 v1, v40, v44
  v_cvt_pk_bf16_f32 v2, v48, v52
  v_cvt_pk_bf16_f32 v3, v56, v60
  ds_write_b128 v233, v[0:3] offset:4096
  v_cvt_pk_bf16_f32 v4, v33, v37
  v_cvt_pk_bf16_f32 v5, v41, v45
  v_cvt_pk_bf16_f32 v6, v49, v53
  v_cvt_pk_bf16_f32 v7, v57, v61
  v_pk_mul_f32 v[34:35], v[34:35], v[222:223]
  v_pk_mul_f32 v[38:39], v[38:39], v[222:223]
  v_pk_mul_f32 v[42:43], v[42:43], v[222:223]
  v_pk_mul_f32 v[46:47], v[46:47], v[222:223]
  ds_write_b128 v233, v[4:7] offset:5120
  v_pk_mul_f32 v[50:51], v[50:51], v[222:223]
  v_pk_mul_f32 v[54:55], v[54:55], v[222:223]
  v_pk_mul_f32 v[58:59], v[58:59], v[222:223]
  v_pk_mul_f32 v[62:63], v[62:63], v[222:223]
  v_cvt_pk_bf16_f32 v8, v34, v38
  v_cvt_pk_bf16_f32 v9, v42, v46
  v_cvt_pk_bf16_f32 v10, v50, v54
  v_cvt_pk_bf16_f32 v11, v58, v62
  v_cvt_pk_bf16_f32 v12, v35, v39
  v_cvt_pk_bf16_f32 v13, v43, v47
  v_cvt_pk_bf16_f32 v14, v51, v55
  v_cvt_pk_bf16_f32 v15, v59, v63
  v_mfma_f32_16x16x32_bf16 v[196:199], a[148:151], a[68:71], v[196:199]
  s_and_b32 vcc_lo, vcc_lo, 0xffff
  v_exp_f32 v207, v207
  v_mfma_f32_16x16x32_bf16 v[196:199], a[152:155], a[72:75], v[196:199]
  s_addc_u32 s46, s46, s46
  v_cvt_pk_bf16_f32 v214, v204, v205
  v_cvt_pk_bf16_f32 v215, v206, v207
  v_mfma_f32_16x16x32_bf16 v[196:199], a[156:159], a[76:79], v[196:199]
  ds_read_b128 a[64:67], v225 offset:16384
  ds_read_b128 a[68:71], v225 offset:16640
  v_smfmac_f32_16x16x64_bf16 a[228:231], a[248:251], v[208:215], v227
  ds_read_b128 a[72:75], v225 offset:16896
  ds_read_b128 a[76:79], v225 offset:17152
  v_mul_f32 v192, s36, v192
  v_mul_f32 v193, s36, v193
  v_mfma_f32_16x16x32_bf16 v[96:99], v[212:215], a[192:195], v[96:99]
  ds_write_b128 v233, v[8:11] offset:6144
  v_exp_f32 v192, v192
  v_mfma_f32_16x16x32_bf16 v[100:103], v[212:215], a[196:199], v[100:103]
  v_mul_f32 v194, s36, v194
  v_mul_f32 v195, s36, v195
  v_mfma_f32_16x16x32_bf16 v[104:107], v[212:215], a[200:203], v[104:107]
  v_exp_f32 v193, v193
  v_accvgpr_read_b32 v238, a228
  v_accvgpr_read_b32 v216, a229
  v_accvgpr_read_b32 v239, a230
  v_accvgpr_read_b32 v220, a231
  v_add_f32 v238, v238, v216
  v_add_f32 v239, v239, v220
  v_rcp_f32 v216, v238
  v_rcp_f32 v220, v239
  v_add_u32 v238, 0xd5800000, v238
  v_add_u32 v239, 0xd5800000, v239
  ds_write2st64_b32 v250, v216, v220 offset0:32 offset1:33
  ds_read_b128 v[216:219], v251 offset:8192
  ds_read_b128 v[220:223], v251 offset:8448
  v_accvgpr_write_b32 a228, 0
  v_accvgpr_write_b32 a229, 0
  v_accvgpr_write_b32 a230, 0
  v_accvgpr_write_b32 a231, 0
  v_mfma_f32_16x16x32_bf16 v[108:111], v[212:215], a[204:207], v[108:111]
  ds_read_b64_tr_b16 a[176:177], v226 offset:8200
  ds_read_b64_tr_b16 a[178:179], v226 offset:12296
  v_mfma_f32_16x16x32_bf16 v[112:115], v[212:215], a[208:211], v[112:115]
  ds_write_b128 v233, v[12:15] offset:7168
  v_exp_f32 v194, v194
  v_mfma_f32_16x16x32_bf16 v[116:119], v[212:215], a[212:215], v[116:119]
  v_cvt_pk_bf16_f32 v208, v192, v193
  v_mul_f32 v196, s36, v196
  v_mfma_f32_16x16x32_bf16 v[120:123], v[212:215], a[216:219], v[120:123]
  v_exp_f32 v195, v195
  v_mfma_f32_16x16x32_bf16 v[124:127], v[212:215], a[220:223], v[124:127]
  v_mul_f32 v197, s36, v197
  v_mul_f32 v198, s36, v198
  v_mfma_f32_16x16x32_bf16 v[200:203], a[128:131], a[80:83], v[252:255]
  v_exp_f32 v196, v196
  v_mfma_f32_16x16x32_bf16 v[200:203], a[132:135], a[84:87], v[200:203]
  v_cvt_pk_bf16_f32 v209, v194, v195
  v_mul_f32 v199, s36, v199
  v_mfma_f32_16x16x32_bf16 v[200:203], a[136:139], a[88:91], v[200:203]
  v_exp_f32 v197, v197
  v_mfma_f32_16x16x32_bf16 v[200:203], a[140:143], a[92:95], v[200:203]
  s_waitcnt lgkmcnt(15)
  v_exp_f32 v198, v198
  v_mfma_f32_16x16x32_bf16 v[204:207], a[144:147], a[80:83], v[252:255]
  s_waitcnt lgkmcnt(3)
  ds_read_b64_tr_b16 a[180:181], v237 offset:8200
  ds_read_b64_tr_b16 a[182:183], v237 offset:12296
  v_cmp_le_u32 vcc, 0x34000000, v238
  v_pk_mul_f32 v[64:65], v[64:65], v[216:217]
  v_pk_mul_f32 v[68:69], v[68:69], v[216:217]
  v_pk_mul_f32 v[72:73], v[72:73], v[216:217]
  v_pk_mul_f32 v[76:77], v[76:77], v[216:217]
  v_pk_mul_f32 v[80:81], v[80:81], v[216:217]
  v_pk_mul_f32 v[84:85], v[84:85], v[216:217]
  v_pk_mul_f32 v[88:89], v[88:89], v[216:217]
  v_pk_mul_f32 v[92:93], v[92:93], v[216:217]
  v_cvt_pk_bf16_f32 v32, v64, v68
  v_cvt_pk_bf16_f32 v33, v72, v76
  v_cvt_pk_bf16_f32 v34, v80, v84
  v_cvt_pk_bf16_f32 v35, v88, v92
  ds_write_b128 v233, v[32:35] offset:8192
  v_cvt_pk_bf16_f32 v36, v65, v69
  v_cvt_pk_bf16_f32 v37, v73, v77
  v_cvt_pk_bf16_f32 v38, v81, v85
  v_cvt_pk_bf16_f32 v39, v89, v93
  v_pk_mul_f32 v[66:67], v[66:67], v[218:219]
  v_pk_mul_f32 v[70:71], v[70:71], v[218:219]
  v_pk_mul_f32 v[74:75], v[74:75], v[218:219]
  v_pk_mul_f32 v[78:79], v[78:79], v[218:219]
  ds_write_b128 v233, v[36:39] offset:9216
  v_pk_mul_f32 v[82:83], v[82:83], v[218:219]
  v_pk_mul_f32 v[86:87], v[86:87], v[218:219]
  v_pk_mul_f32 v[90:91], v[90:91], v[218:219]
  v_pk_mul_f32 v[94:95], v[94:95], v[218:219]
  v_cvt_pk_bf16_f32 v40, v66, v70
  v_cvt_pk_bf16_f32 v41, v74, v78
  v_cvt_pk_bf16_f32 v42, v82, v86
  v_cvt_pk_bf16_f32 v43, v90, v94
  v_cvt_pk_bf16_f32 v44, v67, v71
  v_cvt_pk_bf16_f32 v45, v75, v79
  v_cvt_pk_bf16_f32 v46, v83, v87
  v_cvt_pk_bf16_f32 v47, v91, v95
  v_mfma_f32_16x16x32_bf16 v[204:207], a[148:151], a[84:87], v[204:207]
  s_and_b32 vcc_lo, vcc_lo, 0xffff
  v_exp_f32 v199, v199
  v_mfma_f32_16x16x32_bf16 v[204:207], a[152:155], a[88:91], v[204:207]
  s_addc_u32 s46, s46, s46
  v_cvt_pk_bf16_f32 v210, v196, v197
  v_cvt_pk_bf16_f32 v211, v198, v199
  v_mfma_f32_16x16x32_bf16 v[204:207], a[156:159], a[92:95], v[204:207]
  ds_read_b128 a[80:83], v225 offset:20480
  ds_read_b128 a[84:87], v225 offset:20736
  v_mul_f32 v200, s36, v200
  v_mul_f32 v201, s36, v201
  v_mfma_f32_16x16x32_bf16 v[128:131], v[208:211], a[192:195], v[128:131]
  ds_write_b128 v233, v[40:43] offset:10240
  v_exp_f32 v200, v200
  v_mfma_f32_16x16x32_bf16 v[132:135], v[208:211], a[196:199], v[132:135]
  ds_read_b128 a[88:91], v225 offset:20992
  ds_read_b128 a[92:95], v225 offset:21248
  v_mul_f32 v202, s36, v202
  v_mul_f32 v203, s36, v203
  v_mfma_f32_16x16x32_bf16 v[136:139], v[208:211], a[200:203], v[136:139]
  v_exp_f32 v201, v201
  v_mfma_f32_16x16x32_bf16 v[140:143], v[208:211], a[204:207], v[140:143]
  ds_read_b64_tr_b16 a[184:185], v234 offset:8200
  ds_read_b64_tr_b16 a[186:187], v234 offset:12296
  v_mfma_f32_16x16x32_bf16 v[144:147], v[208:211], a[208:211], v[144:147]
  ds_write_b128 v233, v[44:47] offset:11264
  v_exp_f32 v202, v202
  v_mfma_f32_16x16x32_bf16 v[148:151], v[208:211], a[212:215], v[148:151]
  v_cvt_pk_bf16_f32 v212, v200, v201
  v_mul_f32 v204, s36, v204
  v_mfma_f32_16x16x32_bf16 v[152:155], v[208:211], a[216:219], v[152:155]
  v_exp_f32 v203, v203
  v_mfma_f32_16x16x32_bf16 v[156:159], v[208:211], a[220:223], v[156:159]
  v_mul_f32 v205, s36, v205
  v_mul_f32 v206, s36, v206
  v_mfma_f32_16x16x32_bf16 v[192:195], a[96:99], a[0:3], v[252:255]
  v_exp_f32 v204, v204
  v_mfma_f32_16x16x32_bf16 v[192:195], a[100:103], a[4:7], v[192:195]
  v_cvt_pk_bf16_f32 v213, v202, v203
  v_mul_f32 v207, s36, v207
  v_mfma_f32_16x16x32_bf16 v[192:195], a[104:107], a[8:11], v[192:195]
  v_exp_f32 v205, v205
  v_mfma_f32_16x16x32_bf16 v[192:195], a[108:111], a[12:15], v[192:195]
  v_exp_f32 v206, v206
  v_mfma_f32_16x16x32_bf16 v[196:199], a[112:115], a[0:3], v[252:255]
  ds_read_b64_tr_b16 a[188:189], v228 offset:8200
  ds_read_b64_tr_b16 a[190:191], v228 offset:12296
  v_cmp_le_u32 vcc, 0x34000000, v239
  v_pk_mul_f32 v[96:97], v[96:97], v[220:221]
  v_pk_mul_f32 v[100:101], v[100:101], v[220:221]
  v_pk_mul_f32 v[104:105], v[104:105], v[220:221]
  v_pk_mul_f32 v[108:109], v[108:109], v[220:221]
  v_pk_mul_f32 v[112:113], v[112:113], v[220:221]
  v_pk_mul_f32 v[116:117], v[116:117], v[220:221]
  v_pk_mul_f32 v[120:121], v[120:121], v[220:221]
  v_pk_mul_f32 v[124:125], v[124:125], v[220:221]
  v_cvt_pk_bf16_f32 v64, v96, v100
  v_cvt_pk_bf16_f32 v65, v104, v108
  v_cvt_pk_bf16_f32 v66, v112, v116
  v_cvt_pk_bf16_f32 v67, v120, v124
  ds_write_b128 v233, v[64:67] offset:12288
  v_cvt_pk_bf16_f32 v68, v97, v101
  v_cvt_pk_bf16_f32 v69, v105, v109
  v_cvt_pk_bf16_f32 v70, v113, v117
  v_cvt_pk_bf16_f32 v71, v121, v125
  v_pk_mul_f32 v[98:99], v[98:99], v[222:223]
  v_pk_mul_f32 v[102:103], v[102:103], v[222:223]
  v_pk_mul_f32 v[106:107], v[106:107], v[222:223]
  v_pk_mul_f32 v[110:111], v[110:111], v[222:223]
  ds_write_b128 v233, v[68:71] offset:13312
  v_pk_mul_f32 v[114:115], v[114:115], v[222:223]
  v_pk_mul_f32 v[118:119], v[118:119], v[222:223]
  v_pk_mul_f32 v[122:123], v[122:123], v[222:223]
  v_pk_mul_f32 v[126:127], v[126:127], v[222:223]
  v_cvt_pk_bf16_f32 v72, v98, v102
  v_cvt_pk_bf16_f32 v73, v106, v110
  v_cvt_pk_bf16_f32 v74, v114, v118
  v_cvt_pk_bf16_f32 v75, v122, v126
  v_cvt_pk_bf16_f32 v76, v99, v103
  v_cvt_pk_bf16_f32 v77, v107, v111
  v_cvt_pk_bf16_f32 v78, v115, v119
  v_cvt_pk_bf16_f32 v79, v123, v127
  v_mfma_f32_16x16x32_bf16 v[196:199], a[116:119], a[4:7], v[196:199]
  s_and_b32 vcc_lo, vcc_lo, 0xffff
  v_exp_f32 v207, v207
  v_mfma_f32_16x16x32_bf16 v[196:199], a[120:123], a[8:11], v[196:199]
  s_addc_u32 s46, s46, s46
  v_cvt_pk_bf16_f32 v214, v204, v205
  v_cvt_pk_bf16_f32 v215, v206, v207
  v_mfma_f32_16x16x32_bf16 v[196:199], a[124:127], a[12:15], v[196:199]
  ds_add_rtn_u32 v244, v242, v243
  v_smfmac_f32_16x16x64_bf16 a[232:235], a[248:251], v[208:215], v227
  v_mul_f32 v192, s36, v192
  v_mul_f32 v193, s36, v193
  v_mfma_f32_16x16x32_bf16 v[160:163], v[212:215], a[192:195], v[160:163]
  ds_write_b128 v233, v[72:75] offset:14336
  v_exp_f32 v192, v192
  v_mfma_f32_16x16x32_bf16 v[164:167], v[212:215], a[196:199], v[164:167]
  v_mul_f32 v194, s36, v194
  v_mul_f32 v195, s36, v195
  v_mfma_f32_16x16x32_bf16 v[168:171], v[212:215], a[200:203], v[168:171]
  v_exp_f32 v193, v193
  v_accvgpr_read_b32 v238, a232
  v_accvgpr_read_b32 v216, a233
  v_accvgpr_read_b32 v239, a234
  v_accvgpr_read_b32 v220, a235
  v_add_f32 v238, v238, v216
  v_add_f32 v239, v239, v220
  v_rcp_f32 v216, v238
  v_rcp_f32 v220, v239
  v_add_u32 v238, 0xd5800000, v238
  v_add_u32 v239, 0xd5800000, v239
  ds_write2st64_b32 v250, v216, v220 offset0:64 offset1:65
  ds_read_b128 v[216:219], v251 offset:16384
  ds_read_b128 v[220:223], v251 offset:16640
  v_accvgpr_write_b32 a232, 0
  v_accvgpr_write_b32 a233, 0
  v_accvgpr_write_b32 a234, 0
  v_accvgpr_write_b32 a235, 0
  v_mfma_f32_16x16x32_bf16 v[172:175], v[212:215], a[204:207], v[172:175]
  ds_read_b128 a[128:131], v224 offset:16384
  ds_read_b128 a[132:135], v224 offset:16640
  v_mfma_f32_16x16x32_bf16 v[176:179], v[212:215], a[208:211], v[176:179]
  ds_write_b128 v233, v[76:79] offset:15360
  v_exp_f32 v194, v194
  v_mfma_f32_16x16x32_bf16 v[180:183], v[212:215], a[212:215], v[180:183]
  v_cvt_pk_bf16_f32 v208, v192, v193
  v_mul_f32 v196, s36, v196
  v_mfma_f32_16x16x32_bf16 v[184:187], v[212:215], a[216:219], v[184:187]
  v_exp_f32 v195, v195
  v_mfma_f32_16x16x32_bf16 v[188:191], v[212:215], a[220:223], v[188:191]
  v_mul_f32 v197, s36, v197
  v_mul_f32 v198, s36, v198
  v_mfma_f32_16x16x32_bf16 v[200:203], a[96:99], a[16:19], v[252:255]
  v_exp_f32 v196, v196
  v_mfma_f32_16x16x32_bf16 v[200:203], a[100:103], a[20:23], v[200:203]
  v_cvt_pk_bf16_f32 v209, v194, v195
  v_mul_f32 v199, s36, v199
  v_mfma_f32_16x16x32_bf16 v[200:203], a[104:107], a[24:27], v[200:203]
  v_exp_f32 v197, v197
  v_mfma_f32_16x16x32_bf16 v[200:203], a[108:111], a[28:31], v[200:203]
  v_exp_f32 v198, v198
  v_mfma_f32_16x16x32_bf16 v[204:207], a[112:115], a[16:19], v[252:255]
  s_waitcnt lgkmcnt(3)
  ds_read_b128 a[136:139], v224 offset:16896
  ds_read_b128 a[140:143], v224 offset:17152
  v_cmp_le_u32 vcc, 0x34000000, v238
  v_pk_mul_f32 v[128:129], v[128:129], v[216:217]
  v_pk_mul_f32 v[132:133], v[132:133], v[216:217]
  v_pk_mul_f32 v[136:137], v[136:137], v[216:217]
  v_pk_mul_f32 v[140:141], v[140:141], v[216:217]
  v_pk_mul_f32 v[144:145], v[144:145], v[216:217]
  v_pk_mul_f32 v[148:149], v[148:149], v[216:217]
  v_pk_mul_f32 v[152:153], v[152:153], v[216:217]
  v_pk_mul_f32 v[156:157], v[156:157], v[216:217]
  v_cvt_pk_bf16_f32 v96, v128, v132
  v_cvt_pk_bf16_f32 v97, v136, v140
  v_cvt_pk_bf16_f32 v98, v144, v148
  v_cvt_pk_bf16_f32 v99, v152, v156
  ds_write_b128 v233, v[96:99] offset:16384
  v_cvt_pk_bf16_f32 v100, v129, v133
  v_cvt_pk_bf16_f32 v101, v137, v141
  v_cvt_pk_bf16_f32 v102, v145, v149
  v_cvt_pk_bf16_f32 v103, v153, v157
  v_pk_mul_f32 v[130:131], v[130:131], v[218:219]
  v_pk_mul_f32 v[134:135], v[134:135], v[218:219]
  v_pk_mul_f32 v[138:139], v[138:139], v[218:219]
  v_pk_mul_f32 v[142:143], v[142:143], v[218:219]
  ds_write_b128 v233, v[100:103] offset:17408
  v_pk_mul_f32 v[146:147], v[146:147], v[218:219]
  v_pk_mul_f32 v[150:151], v[150:151], v[218:219]
  v_pk_mul_f32 v[154:155], v[154:155], v[218:219]
  v_pk_mul_f32 v[158:159], v[158:159], v[218:219]
  v_cvt_pk_bf16_f32 v104, v130, v134
  v_cvt_pk_bf16_f32 v105, v138, v142
  v_cvt_pk_bf16_f32 v106, v146, v150
  v_cvt_pk_bf16_f32 v107, v154, v158
  v_cvt_pk_bf16_f32 v108, v131, v135
  v_cvt_pk_bf16_f32 v109, v139, v143
  v_cvt_pk_bf16_f32 v110, v147, v151
  v_cvt_pk_bf16_f32 v111, v155, v159
  v_mfma_f32_16x16x32_bf16 v[204:207], a[116:119], a[20:23], v[204:207]
  s_and_b32 vcc_lo, vcc_lo, 0xffff
  v_exp_f32 v199, v199
  v_mfma_f32_16x16x32_bf16 v[204:207], a[120:123], a[24:27], v[204:207]
  s_addc_u32 s46, s46, s46
  v_cvt_pk_bf16_f32 v210, v196, v197
  v_cvt_pk_bf16_f32 v211, v198, v199
  v_mfma_f32_16x16x32_bf16 v[204:207], a[124:127], a[28:31], v[204:207]
  s_waitcnt lgkmcnt(11)
  v_mul_f32 v200, s36, v200
  v_mul_f32 v201, s36, v201
  v_mfma_f32_16x16x32_bf16 v[0:3], v[208:211], a[160:163], 0
  ds_write_b128 v233, v[104:107] offset:18432
  v_exp_f32 v200, v200
  v_mfma_f32_16x16x32_bf16 v[4:7], v[208:211], a[164:167], 0
  v_mul_f32 v202, s36, v202
  v_mul_f32 v203, s36, v203
  v_mfma_f32_16x16x32_bf16 v[8:11], v[208:211], a[168:171], 0
  v_exp_f32 v201, v201
  v_mfma_f32_16x16x32_bf16 v[12:15], v[208:211], a[172:175], 0
  ds_read_b128 a[144:147], v224 offset:20480
  ds_read_b128 a[148:151], v224 offset:20736
  v_mfma_f32_16x16x32_bf16 v[16:19], v[208:211], a[176:179], 0
  ds_write_b128 v233, v[108:111] offset:19456
  v_exp_f32 v202, v202
  v_mfma_f32_16x16x32_bf16 v[20:23], v[208:211], a[180:183], 0
  v_cvt_pk_bf16_f32 v212, v200, v201
  v_mul_f32 v204, s36, v204
  v_mfma_f32_16x16x32_bf16 v[24:27], v[208:211], a[184:187], 0
  v_exp_f32 v203, v203
  v_mfma_f32_16x16x32_bf16 v[28:31], v[208:211], a[188:191], 0
  v_mul_f32 v205, s36, v205
  v_mul_f32 v206, s36, v206
  v_mfma_f32_16x16x32_bf16 v[192:195], a[96:99], a[32:35], v[252:255]
  v_exp_f32 v204, v204
  v_mfma_f32_16x16x32_bf16 v[192:195], a[100:103], a[36:39], v[192:195]
  v_cvt_pk_bf16_f32 v213, v202, v203
  v_mul_f32 v207, s36, v207
  v_mfma_f32_16x16x32_bf16 v[192:195], a[104:107], a[40:43], v[192:195]
  v_exp_f32 v205, v205
  v_mfma_f32_16x16x32_bf16 v[192:195], a[108:111], a[44:47], v[192:195]
  v_exp_f32 v206, v206
  v_mfma_f32_16x16x32_bf16 v[196:199], a[112:115], a[32:35], v[252:255]
  ds_read_b128 a[152:155], v224 offset:20992
  ds_read_b128 a[156:159], v224 offset:21248
  v_cmp_le_u32 vcc, 0x34000000, v239
  v_pk_mul_f32 v[160:161], v[160:161], v[220:221]
  v_pk_mul_f32 v[164:165], v[164:165], v[220:221]
  v_pk_mul_f32 v[168:169], v[168:169], v[220:221]
  v_pk_mul_f32 v[172:173], v[172:173], v[220:221]
  v_pk_mul_f32 v[176:177], v[176:177], v[220:221]
  v_pk_mul_f32 v[180:181], v[180:181], v[220:221]
  v_pk_mul_f32 v[184:185], v[184:185], v[220:221]
  v_pk_mul_f32 v[188:189], v[188:189], v[220:221]
  v_cvt_pk_bf16_f32 v128, v160, v164
  v_cvt_pk_bf16_f32 v129, v168, v172
  v_cvt_pk_bf16_f32 v130, v176, v180
  v_cvt_pk_bf16_f32 v131, v184, v188
  ds_write_b128 v233, v[128:131] offset:20480
  v_cvt_pk_bf16_f32 v132, v161, v165
  v_cvt_pk_bf16_f32 v133, v169, v173
  v_cvt_pk_bf16_f32 v134, v177, v181
  v_cvt_pk_bf16_f32 v135, v185, v189
  v_pk_mul_f32 v[162:163], v[162:163], v[222:223]
  v_pk_mul_f32 v[166:167], v[166:167], v[222:223]
  v_pk_mul_f32 v[170:171], v[170:171], v[222:223]
  v_pk_mul_f32 v[174:175], v[174:175], v[222:223]
  ds_write_b128 v233, v[132:135] offset:21504
  v_pk_mul_f32 v[178:179], v[178:179], v[222:223]
  v_pk_mul_f32 v[182:183], v[182:183], v[222:223]
  v_pk_mul_f32 v[186:187], v[186:187], v[222:223]
  v_pk_mul_f32 v[190:191], v[190:191], v[222:223]
  v_cvt_pk_bf16_f32 v136, v162, v166
  v_cvt_pk_bf16_f32 v137, v170, v174
  v_cvt_pk_bf16_f32 v138, v178, v182
  v_cvt_pk_bf16_f32 v139, v186, v190
  v_cvt_pk_bf16_f32 v140, v163, v167
  v_cvt_pk_bf16_f32 v141, v171, v175
  v_cvt_pk_bf16_f32 v142, v179, v183
  v_cvt_pk_bf16_f32 v143, v187, v191
  v_mfma_f32_16x16x32_bf16 v[196:199], a[116:119], a[36:39], v[196:199]
  s_and_b32 vcc_lo, vcc_lo, 0xffff
  v_exp_f32 v207, v207
  v_mfma_f32_16x16x32_bf16 v[196:199], a[120:123], a[40:43], v[196:199]
  s_addc_u32 s46, s46, s46
  v_cvt_pk_bf16_f32 v214, v204, v205
  v_cvt_pk_bf16_f32 v215, v206, v207
  v_mfma_f32_16x16x32_bf16 v[196:199], a[124:127], a[44:47], v[196:199]
  v_cmp_gt_u32 vcc, s58, v244
  v_smfmac_f32_16x16x64_bf16 a[224:227], a[248:251], v[208:215], v227
  v_mul_f32 v192, s36, v192
  v_mul_f32 v193, s36, v193
  v_mfma_f32_16x16x32_bf16 v[32:35], v[212:215], a[160:163], 0
  s_cbranch_vccnz L_s6_00
L_r6_00:
  ds_write_b128 v233, v[136:139] offset:22528
  v_exp_f32 v192, v192
  v_mfma_f32_16x16x32_bf16 v[36:39], v[212:215], a[164:167], 0
  s_add_u32 s58, s58, 1
  v_mul_f32 v194, s36, v194
  v_mul_f32 v195, s36, v195
  v_mfma_f32_16x16x32_bf16 v[40:43], v[212:215], a[168:171], 0
  v_exp_f32 v193, v193
  v_mfma_f32_16x16x32_bf16 v[44:47], v[212:215], a[172:175], 0
  ds_read_b64_tr_b16 a[192:193], v226 offset:24576
  ds_read_b64_tr_b16 a[194:195], v226 offset:28672
  v_mfma_f32_16x16x32_bf16 v[48:51], v[212:215], a[176:179], 0
  ds_write_b128 v233, v[140:143] offset:23552
  v_exp_f32 v194, v194
  v_mfma_f32_16x16x32_bf16 v[52:55], v[212:215], a[180:183], 0
  v_cvt_pk_bf16_f32 v208, v192, v193
  v_mul_f32 v196, s36, v196
  v_mfma_f32_16x16x32_bf16 v[56:59], v[212:215], a[184:187], 0
  v_exp_f32 v195, v195
  v_mfma_f32_16x16x32_bf16 v[60:63], v[212:215], a[188:191], 0
  v_mul_f32 v197, s36, v197
  v_mul_f32 v198, s36, v198
  v_mfma_f32_16x16x32_bf16 v[200:203], a[96:99], a[48:51], v[252:255]
  v_exp_f32 v196, v196
  v_mfma_f32_16x16x32_bf16 v[200:203], a[100:103], a[52:55], v[200:203]
  v_cvt_pk_bf16_f32 v209, v194, v195
  v_mul_f32 v199, s36, v199
  v_mfma_f32_16x16x32_bf16 v[200:203], a[104:107], a[56:59], v[200:203]
  v_exp_f32 v197, v197
  v_mfma_f32_16x16x32_bf16 v[200:203], a[108:111], a[60:63], v[200:203]
  v_exp_f32 v198, v198
  v_mfma_f32_16x16x32_bf16 v[204:207], a[112:115], a[48:51], v[252:255]
  ds_read_b64_tr_b16 a[196:197], v237 offset:24576
  ds_read_b64_tr_b16 a[198:199], v237 offset:28672
  v_mfma_f32_16x16x32_bf16 v[204:207], a[116:119], a[52:55], v[204:207]
  v_exp_f32 v199, v199
  v_mfma_f32_16x16x32_bf16 v[204:207], a[120:123], a[56:59], v[204:207]
  v_cvt_pk_bf16_f32 v210, v196, v197
  v_cvt_pk_bf16_f32 v211, v198, v199
  v_mfma_f32_16x16x32_bf16 v[204:207], a[124:127], a[60:63], v[204:207]
  v_mul_f32 v200, s36, v200
  v_mul_f32 v201, s36, v201
  v_mfma_f32_16x16x32_bf16 v[64:67], v[208:211], a[160:163], 0
  v_exp_f32 v200, v200
  v_mfma_f32_16x16x32_bf16 v[68:71], v[208:211], a[164:167], 0
  v_mul_f32 v202, s36, v202
  v_mul_f32 v203, s36, v203
  v_mfma_f32_16x16x32_bf16 v[72:75], v[208:211], a[168:171], 0
  v_exp_f32 v201, v201
  v_mfma_f32_16x16x32_bf16 v[76:79], v[208:211], a[172:175], 0
  ds_read_b64_tr_b16 a[200:201], v234 offset:24576
  ds_read_b64_tr_b16 a[202:203], v234 offset:28672
  v_mfma_f32_16x16x32_bf16 v[80:83], v[208:211], a[176:179], 0
  v_exp_f32 v202, v202
  v_mfma_f32_16x16x32_bf16 v[84:87], v[208:211], a[180:183], 0
  v_cvt_pk_bf16_f32 v212, v200, v201
  v_mul_f32 v204, s36, v204
  v_mfma_f32_16x16x32_bf16 v[88:91], v[208:211], a[184:187], 0
  v_exp_f32 v203, v203
  v_mfma_f32_16x16x32_bf16 v[92:95], v[208:211], a[188:191], 0
  v_mul_f32 v205, s36, v205
  v_mul_f32 v206, s36, v206
  v_mfma_f32_16x16x32_bf16 v[192:195], a[96:99], a[64:67], v[252:255]
  v_exp_f32 v204, v204
  v_mfma_f32_16x16x32_bf16 v[192:195], a[100:103], a[68:71], v[192:195]
  v_cvt_pk_bf16_f32 v213, v202, v203
  v_mul_f32 v207, s36, v207
  v_mfma_f32_16x16x32_bf16 v[192:195], a[104:107], a[72:75], v[192:195]
  v_exp_f32 v205, v205
  v_mfma_f32_16x16x32_bf16 v[192:195], a[108:111], a[76:79], v[192:195]
  v_exp_f32 v206, v206
  v_mfma_f32_16x16x32_bf16 v[196:199], a[112:115], a[64:67], v[252:255]
  ds_read_b64_tr_b16 a[204:205], v228 offset:24576
  ds_read_b64_tr_b16 a[206:207], v228 offset:28672
  v_mfma_f32_16x16x32_bf16 v[196:199], a[116:119], a[68:71], v[196:199]
  v_exp_f32 v207, v207
  v_mfma_f32_16x16x32_bf16 v[196:199], a[120:123], a[72:75], v[196:199]
  v_cvt_pk_bf16_f32 v214, v204, v205
  v_cvt_pk_bf16_f32 v215, v206, v207
  v_mfma_f32_16x16x32_bf16 v[196:199], a[124:127], a[76:79], v[196:199]
  s_nop 0
  v_smfmac_f32_16x16x64_bf16 a[228:231], a[248:251], v[208:215], v227
  v_mul_f32 v192, s36, v192
  v_mul_f32 v193, s36, v193
  v_mfma_f32_16x16x32_bf16 v[96:99], v[212:215], a[160:163], 0
  v_exp_f32 v192, v192
  v_mfma_f32_16x16x32_bf16 v[100:103], v[212:215], a[164:167], 0
  v_mul_f32 v194, s36, v194
  v_mul_f32 v195, s36, v195
  v_mfma_f32_16x16x32_bf16 v[104:107], v[212:215], a[168:171], 0
  v_exp_f32 v193, v193
  v_mfma_f32_16x16x32_bf16 v[108:111], v[212:215], a[172:175], 0
  ds_read_b64_tr_b16 a[208:209], v226 offset:24584
  ds_read_b64_tr_b16 a[210:211], v226 offset:28680
  v_mfma_f32_16x16x32_bf16 v[112:115], v[212:215], a[176:179], 0
  v_exp_f32 v194, v194
  v_mfma_f32_16x16x32_bf16 v[116:119], v[212:215], a[180:183], 0
  v_cvt_pk_bf16_f32 v208, v192, v193
  v_mul_f32 v196, s36, v196
  v_mfma_f32_16x16x32_bf16 v[120:123], v[212:215], a[184:187], 0
  v_exp_f32 v195, v195
  v_mfma_f32_16x16x32_bf16 v[124:127], v[212:215], a[188:191], 0
  v_mul_f32 v197, s36, v197
  v_mul_f32 v198, s36, v198
  v_mfma_f32_16x16x32_bf16 v[200:203], a[96:99], a[80:83], v[252:255]
  v_exp_f32 v196, v196
  v_mfma_f32_16x16x32_bf16 v[200:203], a[100:103], a[84:87], v[200:203]
  v_cvt_pk_bf16_f32 v209, v194, v195
  v_mul_f32 v199, s36, v199
  v_mfma_f32_16x16x32_bf16 v[200:203], a[104:107], a[88:91], v[200:203]
  v_exp_f32 v197, v197
  v_mfma_f32_16x16x32_bf16 v[200:203], a[108:111], a[92:95], v[200:203]
  s_waitcnt lgkmcnt(14)
  v_exp_f32 v198, v198
  v_mfma_f32_16x16x32_bf16 v[204:207], a[112:115], a[80:83], v[252:255]
  ds_read_b64_tr_b16 a[212:213], v237 offset:24584
  ds_read_b64_tr_b16 a[214:215], v237 offset:28680
  v_mfma_f32_16x16x32_bf16 v[204:207], a[116:119], a[84:87], v[204:207]
  v_exp_f32 v199, v199
  v_mfma_f32_16x16x32_bf16 v[204:207], a[120:123], a[88:91], v[204:207]
  v_cvt_pk_bf16_f32 v210, v196, v197
  v_cvt_pk_bf16_f32 v211, v198, v199
  v_mfma_f32_16x16x32_bf16 v[204:207], a[124:127], a[92:95], v[204:207]
  v_mul_f32 v200, s36, v200
  v_mul_f32 v201, s36, v201
  v_mfma_f32_16x16x32_bf16 v[128:131], v[208:211], a[160:163], 0
  v_exp_f32 v200, v200
  v_mfma_f32_16x16x32_bf16 v[132:135], v[208:211], a[164:167], 0
  v_mul_f32 v202, s36, v202
  v_mul_f32 v203, s36, v203
  v_mfma_f32_16x16x32_bf16 v[136:139], v[208:211], a[168:171], 0
  v_exp_f32 v201, v201
  v_mfma_f32_16x16x32_bf16 v[140:143], v[208:211], a[172:175], 0
  ds_read_b64_tr_b16 a[216:217], v234 offset:24584
  ds_read_b64_tr_b16 a[218:219], v234 offset:28680
  v_mfma_f32_16x16x32_bf16 v[144:147], v[208:211], a[176:179], 0
  v_exp_f32 v202, v202
  v_mfma_f32_16x16x32_bf16 v[148:151], v[208:211], a[180:183], 0
  v_cvt_pk_bf16_f32 v212, v200, v201
  v_mul_f32 v204, s36, v204
  v_mfma_f32_16x16x32_bf16 v[152:155], v[208:211], a[184:187], 0
  v_exp_f32 v203, v203
  v_mfma_f32_16x16x32_bf16 v[156:159], v[208:211], a[188:191], 0
  v_mul_f32 v205, s36, v205
  v_mul_f32 v206, s36, v206
  v_mfma_f32_16x16x32_bf16 v[192:195], a[128:131], a[0:3], v[252:255]
  v_exp_f32 v204, v204
  v_mfma_f32_16x16x32_bf16 v[192:195], a[132:135], a[4:7], v[192:195]
  v_cvt_pk_bf16_f32 v213, v202, v203
  v_mul_f32 v207, s36, v207
  v_mfma_f32_16x16x32_bf16 v[192:195], a[136:139], a[8:11], v[192:195]
  v_exp_f32 v205, v205
  v_mfma_f32_16x16x32_bf16 v[192:195], a[140:143], a[12:15], v[192:195]
  v_exp_f32 v206, v206
  v_mfma_f32_16x16x32_bf16 v[196:199], a[144:147], a[0:3], v[252:255]
  ds_read_b64_tr_b16 a[220:221], v228 offset:24584
  ds_read_b64_tr_b16 a[222:223], v228 offset:28680
  v_mfma_f32_16x16x32_bf16 v[196:199], a[148:151], a[4:7], v[196:199]
  v_exp_f32 v207, v207
  v_mfma_f32_16x16x32_bf16 v[196:199], a[152:155], a[8:11], v[196:199]
  v_cvt_pk_bf16_f32 v214, v204, v205
  v_cvt_pk_bf16_f32 v215, v206, v207
  v_mfma_f32_16x16x32_bf16 v[196:199], a[156:159], a[12:15], v[196:199]
  ds_add_rtn_u32 v244, v242, v243
  v_smfmac_f32_16x16x64_bf16 a[232:235], a[248:251], v[208:215], v227
  v_mul_f32 v192, s36, v192
  v_mul_f32 v193, s36, v193
  v_mfma_f32_16x16x32_bf16 v[160:163], v[212:215], a[160:163], 0
  v_exp_f32 v192, v192
  v_mfma_f32_16x16x32_bf16 v[164:167], v[212:215], a[164:167], 0
  v_mul_f32 v194, s36, v194
  v_mul_f32 v195, s36, v195
  v_mfma_f32_16x16x32_bf16 v[168:171], v[212:215], a[168:171], 0
  v_exp_f32 v193, v193
  v_mfma_f32_16x16x32_bf16 v[172:175], v[212:215], a[172:175], 0
  ds_read_b128 a[96:99], v224 offset:32768
  ds_read_b128 a[100:103], v224 offset:33024
  v_mfma_f32_16x16x32_bf16 v[176:179], v[212:215], a[176:179], 0
  v_exp_f32 v194, v194
  v_mfma_f32_16x16x32_bf16 v[180:183], v[212:215], a[180:183], 0
  v_cvt_pk_bf16_f32 v208, v192, v193
  v_mul_f32 v196, s36, v196
  v_mfma_f32_16x16x32_bf16 v[184:187], v[212:215], a[184:187], 0
  v_exp_f32 v195, v195
  v_mfma_f32_16x16x32_bf16 v[188:191], v[212:215], a[188:191], 0
  v_mul_f32 v197, s36, v197
  v_mul_f32 v198, s36, v198
  v_mfma_f32_16x16x32_bf16 v[200:203], a[128:131], a[16:19], v[252:255]
  v_exp_f32 v196, v196
  v_mfma_f32_16x16x32_bf16 v[200:203], a[132:135], a[20:23], v[200:203]
  v_cvt_pk_bf16_f32 v209, v194, v195
  v_mul_f32 v199, s36, v199
  v_mfma_f32_16x16x32_bf16 v[200:203], a[136:139], a[24:27], v[200:203]
  v_exp_f32 v197, v197
  v_mfma_f32_16x16x32_bf16 v[200:203], a[140:143], a[28:31], v[200:203]
  v_exp_f32 v198, v198
  v_mfma_f32_16x16x32_bf16 v[204:207], a[144:147], a[16:19], v[252:255]
  ds_read_b128 a[104:107], v224 offset:33280
  ds_read_b128 a[108:111], v224 offset:33536
  v_mfma_f32_16x16x32_bf16 v[204:207], a[148:151], a[20:23], v[204:207]
  v_exp_f32 v199, v199
  v_mfma_f32_16x16x32_bf16 v[204:207], a[152:155], a[24:27], v[204:207]
  v_cvt_pk_bf16_f32 v210, v196, v197
  v_cvt_pk_bf16_f32 v211, v198, v199
  v_mfma_f32_16x16x32_bf16 v[204:207], a[156:159], a[28:31], v[204:207]
  s_waitcnt lgkmcnt(4)
  v_mul_f32 v200, s36, v200
  v_mul_f32 v201, s36, v201
  v_mfma_f32_16x16x32_bf16 v[0:3], v[208:211], a[192:195], v[0:3]
  v_exp_f32 v200, v200
  v_mfma_f32_16x16x32_bf16 v[4:7], v[208:211], a[196:199], v[4:7]
  v_mul_f32 v202, s36, v202
  v_mul_f32 v203, s36, v203
  v_mfma_f32_16x16x32_bf16 v[8:11], v[208:211], a[200:203], v[8:11]
  v_exp_f32 v201, v201
  v_mfma_f32_16x16x32_bf16 v[12:15], v[208:211], a[204:207], v[12:15]
  ds_read_b128 a[112:115], v224 offset:36864
  ds_read_b128 a[116:119], v224 offset:37120
  v_mfma_f32_16x16x32_bf16 v[16:19], v[208:211], a[208:211], v[16:19]
  v_exp_f32 v202, v202
  v_mfma_f32_16x16x32_bf16 v[20:23], v[208:211], a[212:215], v[20:23]
  v_cvt_pk_bf16_f32 v212, v200, v201
  v_mul_f32 v204, s36, v204
  v_mfma_f32_16x16x32_bf16 v[24:27], v[208:211], a[216:219], v[24:27]
  v_exp_f32 v203, v203
  v_mfma_f32_16x16x32_bf16 v[28:31], v[208:211], a[220:223], v[28:31]
  v_mul_f32 v205, s36, v205
  v_mul_f32 v206, s36, v206
  v_mfma_f32_16x16x32_bf16 v[192:195], a[128:131], a[32:35], v[252:255]
  v_exp_f32 v204, v204
  v_mfma_f32_16x16x32_bf16 v[192:195], a[132:135], a[36:39], v[192:195]
  v_cvt_pk_bf16_f32 v213, v202, v203
  v_mul_f32 v207, s36, v207
  v_mfma_f32_16x16x32_bf16 v[192:195], a[136:139], a[40:43], v[192:195]
  v_exp_f32 v205, v205
  v_mfma_f32_16x16x32_bf16 v[192:195], a[140:143], a[44:47], v[192:195]
  v_exp_f32 v206, v206
  v_mfma_f32_16x16x32_bf16 v[196:199], a[144:147], a[32:35], v[252:255]
  ds_read_b128 a[120:123], v224 offset:37376
  ds_read_b128 a[124:127], v224 offset:37632
  v_mfma_f32_16x16x32_bf16 v[196:199], a[148:151], a[36:39], v[196:199]
  v_exp_f32 v207, v207
  v_mfma_f32_16x16x32_bf16 v[196:199], a[152:155], a[40:43], v[196:199]
  v_cvt_pk_bf16_f32 v214, v204, v205
  v_cvt_pk_bf16_f32 v215, v206, v207
  v_mfma_f32_16x16x32_bf16 v[196:199], a[156:159], a[44:47], v[196:199]
  v_cmp_gt_u32 vcc, s58, v244
  v_smfmac_f32_16x16x64_bf16 a[224:227], a[248:251], v[208:215], v227
  v_mul_f32 v192, s36, v192
  v_mul_f32 v193, s36, v193
  v_mfma_f32_16x16x32_bf16 v[32:35], v[212:215], a[192:195], v[32:35]
  s_cbranch_vccnz L_s6_11
L_r6_11:
  v_exp_f32 v192, v192
  v_mfma_f32_16x16x32_bf16 v[36:39], v[212:215], a[196:199], v[36:39]
  s_add_u32 s58, s58, 1
  v_mul_f32 v194, s36, v194
  v_mul_f32 v195, s36, v195
  v_mfma_f32_16x16x32_bf16 v[40:43], v[212:215], a[200:203], v[40:43]
  v_exp_f32 v193, v193
  v_mfma_f32_16x16x32_bf16 v[44:47], v[212:215], a[204:207], v[44:47]
  ds_read_b64_tr_b16 a[160:161], v226 offset:40960
  ds_read_b64_tr_b16 a[162:163], v226 offset:45056
  v_mfma_f32_16x16x32_bf16 v[48:51], v[212:215], a[208:211], v[48:51]
  v_exp_f32 v194, v194
  v_mfma_f32_16x16x32_bf16 v[52:55], v[212:215], a[212:215], v[52:55]
  v_cvt_pk_bf16_f32 v208, v192, v193
  v_mul_f32 v196, s36, v196
  v_mfma_f32_16x16x32_bf16 v[56:59], v[212:215], a[216:219], v[56:59]
  v_exp_f32 v195, v195
  v_mfma_f32_16x16x32_bf16 v[60:63], v[212:215], a[220:223], v[60:63]
  v_mul_f32 v197, s36, v197
  v_mul_f32 v198, s36, v198
  v_mfma_f32_16x16x32_bf16 v[200:203], a[128:131], a[48:51], v[252:255]
  v_exp_f32 v196, v196
  v_mfma_f32_16x16x32_bf16 v[200:203], a[132:135], a[52:55], v[200:203]
  v_cvt_pk_bf16_f32 v209, v194, v195
  v_mul_f32 v199, s36, v199
  v_mfma_f32_16x16x32_bf16 v[200:203], a[136:139], a[56:59], v[200:203]
  v_exp_f32 v197, v197
  v_mfma_f32_16x16x32_bf16 v[200:203], a[140:143], a[60:63], v[200:203]
  v_exp_f32 v198, v198
  v_mfma_f32_16x16x32_bf16 v[204:207], a[144:147], a[48:51], v[252:255]
  ds_read_b64_tr_b16 a[164:165], v237 offset:40960
  ds_read_b64_tr_b16 a[166:167], v237 offset:45056
  v_mfma_f32_16x16x32_bf16 v[204:207], a[148:151], a[52:55], v[204:207]
  v_exp_f32 v199, v199
  v_mfma_f32_16x16x32_bf16 v[204:207], a[152:155], a[56:59], v[204:207]
  v_cvt_pk_bf16_f32 v210, v196, v197
  v_cvt_pk_bf16_f32 v211, v198, v199
  v_mfma_f32_16x16x32_bf16 v[204:207], a[156:159], a[60:63], v[204:207]
  v_mul_f32 v200, s36, v200
  v_mul_f32 v201, s36, v201
  v_mfma_f32_16x16x32_bf16 v[64:67], v[208:211], a[192:195], v[64:67]
  v_exp_f32 v200, v200
  v_mfma_f32_16x16x32_bf16 v[68:71], v[208:211], a[196:199], v[68:71]
  v_mul_f32 v202, s36, v202
  v_mul_f32 v203, s36, v203
  v_mfma_f32_16x16x32_bf16 v[72:75], v[208:211], a[200:203], v[72:75]
  v_exp_f32 v201, v201
  v_mfma_f32_16x16x32_bf16 v[76:79], v[208:211], a[204:207], v[76:79]
  ds_read_b64_tr_b16 a[168:169], v234 offset:40960
  ds_read_b64_tr_b16 a[170:171], v234 offset:45056
  v_mfma_f32_16x16x32_bf16 v[80:83], v[208:211], a[208:211], v[80:83]
  v_exp_f32 v202, v202
  v_mfma_f32_16x16x32_bf16 v[84:87], v[208:211], a[212:215], v[84:87]
  v_cvt_pk_bf16_f32 v212, v200, v201
  v_mul_f32 v204, s36, v204
  v_mfma_f32_16x16x32_bf16 v[88:91], v[208:211], a[216:219], v[88:91]
  v_exp_f32 v203, v203
  v_mfma_f32_16x16x32_bf16 v[92:95], v[208:211], a[220:223], v[92:95]
  v_mul_f32 v205, s36, v205
  v_mul_f32 v206, s36, v206
  v_mfma_f32_16x16x32_bf16 v[192:195], a[128:131], a[64:67], v[252:255]
  s_mul_i32 s49, s45, 188416
  v_exp_f32 v204, v204
  v_mfma_f32_16x16x32_bf16 v[192:195], a[132:135], a[68:71], v[192:195]
  s_add_u32 s49, s49, s51
  v_cvt_pk_bf16_f32 v213, v202, v203
  v_mul_f32 v207, s36, v207
  v_mfma_f32_16x16x32_bf16 v[192:195], a[136:139], a[72:75], v[192:195]
  s_sub_u32 s42, s49, 188416
  v_exp_f32 v205, v205
  v_mfma_f32_16x16x32_bf16 v[192:195], a[140:143], a[76:79], v[192:195]
  s_add_u32 s30, s42, 24576
  v_exp_f32 v206, v206
  v_mfma_f32_16x16x32_bf16 v[196:199], a[144:147], a[64:67], v[252:255]
  s_mov_b32 s44, 0
  ds_read_b64_tr_b16 a[172:173], v228 offset:40960
  ds_read_b64_tr_b16 a[174:175], v228 offset:45056
  v_mfma_f32_16x16x32_bf16 v[196:199], a[148:151], a[68:71], v[196:199]
  v_exp_f32 v207, v207
  v_mfma_f32_16x16x32_bf16 v[196:199], a[152:155], a[72:75], v[196:199]
  v_cvt_pk_bf16_f32 v214, v204, v205
  v_cvt_pk_bf16_f32 v215, v206, v207
  v_mfma_f32_16x16x32_bf16 v[196:199], a[156:159], a[76:79], v[196:199]
  s_nop 0
  v_smfmac_f32_16x16x64_bf16 a[228:231], a[248:251], v[208:215], v227
  v_mul_f32 v192, s36, v192
  v_mul_f32 v193, s36, v193
  v_mfma_f32_16x16x32_bf16 v[96:99], v[212:215], a[192:195], v[96:99]
  v_exp_f32 v192, v192
  v_mfma_f32_16x16x32_bf16 v[100:103], v[212:215], a[196:199], v[100:103]
  v_mul_f32 v194, s36, v194
  v_mul_f32 v195, s36, v195
  v_mfma_f32_16x16x32_bf16 v[104:107], v[212:215], a[200:203], v[104:107]
  v_exp_f32 v193, v193
  v_mfma_f32_16x16x32_bf16 v[108:111], v[212:215], a[204:207], v[108:111]
  ds_read_b64_tr_b16 a[176:177], v226 offset:40968
  ds_read_b64_tr_b16 a[178:179], v226 offset:45064
  v_mfma_f32_16x16x32_bf16 v[112:115], v[212:215], a[208:211], v[112:115]
  v_exp_f32 v194, v194
  v_mfma_f32_16x16x32_bf16 v[116:119], v[212:215], a[212:215], v[116:119]
  v_cvt_pk_bf16_f32 v208, v192, v193
  v_mul_f32 v196, s36, v196
  v_mfma_f32_16x16x32_bf16 v[120:123], v[212:215], a[216:219], v[120:123]
  v_exp_f32 v195, v195
  v_mfma_f32_16x16x32_bf16 v[124:127], v[212:215], a[220:223], v[124:127]
  v_mul_f32 v197, s36, v197
  v_mul_f32 v198, s36, v198
  v_mfma_f32_16x16x32_bf16 v[200:203], a[128:131], a[80:83], v[252:255]
  v_exp_f32 v196, v196
  v_mfma_f32_16x16x32_bf16 v[200:203], a[132:135], a[84:87], v[200:203]
  v_cvt_pk_bf16_f32 v209, v194, v195
  v_mul_f32 v199, s36, v199
  v_mfma_f32_16x16x32_bf16 v[200:203], a[136:139], a[88:91], v[200:203]
  v_exp_f32 v197, v197
  v_mfma_f32_16x16x32_bf16 v[200:203], a[140:143], a[92:95], v[200:203]
  s_waitcnt lgkmcnt(10)
  v_exp_f32 v198, v198
  v_mfma_f32_16x16x32_bf16 v[204:207], a[144:147], a[80:83], v[252:255]
  ds_read_b64_tr_b16 a[180:181], v237 offset:40968
  ds_read_b64_tr_b16 a[182:183], v237 offset:45064
  v_mfma_f32_16x16x32_bf16 v[204:207], a[148:151], a[84:87], v[204:207]
  v_exp_f32 v199, v199
  v_mfma_f32_16x16x32_bf16 v[204:207], a[152:155], a[88:91], v[204:207]
  v_cvt_pk_bf16_f32 v210, v196, v197
  v_cvt_pk_bf16_f32 v211, v198, v199
  v_mfma_f32_16x16x32_bf16 v[204:207], a[156:159], a[92:95], v[204:207]
  v_mul_f32 v200, s36, v200
  v_mul_f32 v201, s36, v201
  v_mfma_f32_16x16x32_bf16 v[128:131], v[208:211], a[192:195], v[128:131]
  v_exp_f32 v200, v200
  v_mfma_f32_16x16x32_bf16 v[132:135], v[208:211], a[196:199], v[132:135]
  v_mul_f32 v202, s36, v202
  v_mul_f32 v203, s36, v203
  v_mfma_f32_16x16x32_bf16 v[136:139], v[208:211], a[200:203], v[136:139]
  v_exp_f32 v201, v201
  v_mfma_f32_16x16x32_bf16 v[140:143], v[208:211], a[204:207], v[140:143]
  ds_read_b64_tr_b16 a[184:185], v234 offset:40968
  ds_read_b64_tr_b16 a[186:187], v234 offset:45064
  v_mfma_f32_16x16x32_bf16 v[144:147], v[208:211], a[208:211], v[144:147]
  v_exp_f32 v202, v202
  v_mfma_f32_16x16x32_bf16 v[148:151], v[208:211], a[212:215], v[148:151]
  v_cvt_pk_bf16_f32 v212, v200, v201
  v_mul_f32 v204, s36, v204
  v_mfma_f32_16x16x32_bf16 v[152:155], v[208:211], a[216:219], v[152:155]
  v_exp_f32 v203, v203
  v_mfma_f32_16x16x32_bf16 v[156:159], v[208:211], a[220:223], v[156:159]
  s_cmp_eq_u32 s45, 3
  v_mul_f32 v205, s36, v205
  v_mul_f32 v206, s36, v206
  s_cbranch_scc1 L_C6
L_B6:
  v_mfma_f32_16x16x32_bf16 v[192:195], a[96:99], a[0:3], v[252:255]
  v_exp_f32 v204, v204
  v_mfma_f32_16x16x32_bf16 v[192:195], a[100:103], a[4:7], v[192:195]
  v_cvt_pk_bf16_f32 v213, v202, v203
  v_mul_f32 v207, s36, v207
  v_mfma_f32_16x16x32_bf16 v[192:195], a[104:107], a[8:11], v[192:195]
  v_exp_f32 v205, v205
  v_mfma_f32_16x16x32_bf16 v[192:195], a[108:111], a[12:15], v[192:195]
  v_exp_f32 v206, v206
  v_mfma_f32_16x16x32_bf16 v[196:199], a[112:115], a[0:3], v[252:255]
  ds_read_b64_tr_b16 a[188:189], v228 offset:40968
  ds_read_b64_tr_b16 a[190:191], v228 offset:45064
  v_mfma_f32_16x16x32_bf16 v[196:199], a[116:119], a[4:7], v[196:199]
  v_exp_f32 v207, v207
  v_mfma_f32_16x16x32_bf16 v[196:199], a[120:123], a[8:11], v[196:199]
  v_cvt_pk_bf16_f32 v214, v204, v205
  v_cvt_pk_bf16_f32 v215, v206, v207
  v_mfma_f32_16x16x32_bf16 v[196:199], a[124:127], a[12:15], v[196:199]
  ds_read_b64_tr_b16 v[216:217], v231 offset:0
  ds_read_b64_tr_b16 v[218:219], v231 offset:8
  ds_read_b64_tr_b16 v[220:221], v231 offset:1024
  ds_read_b64_tr_b16 v[222:223], v231 offset:1032
  ds_add_rtn_u32 v244, v242, v243
  v_smfmac_f32_16x16x64_bf16 a[232:235], a[248:251], v[208:215], v227
  v_mul_f32 v192, s36, v192
  v_mul_f32 v193, s36, v193
  v_mfma_f32_16x16x32_bf16 v[160:163], v[212:215], a[192:195], v[160:163]
  v_exp_f32 v192, v192
  v_mfma_f32_16x16x32_bf16 v[164:167], v[212:215], a[196:199], v[164:167]
  v_mul_f32 v194, s36, v194
  v_mul_f32 v195, s36, v195
  v_mfma_f32_16x16x32_bf16 v[168:171], v[212:215], a[200:203], v[168:171]
  v_exp_f32 v193, v193
  v_mfma_f32_16x16x32_bf16 v[172:175], v[212:215], a[204:207], v[172:175]
  ds_read_b128 a[128:131], v224 offset:49152
  ds_read_b128 a[132:135], v224 offset:49408
  v_mfma_f32_16x16x32_bf16 v[176:179], v[212:215], a[208:211], v[176:179]
  v_exp_f32 v194, v194
  v_mfma_f32_16x16x32_bf16 v[180:183], v[212:215], a[212:215], v[180:183]
  v_cvt_pk_bf16_f32 v208, v192, v193
  v_mul_f32 v196, s36, v196
  v_mfma_f32_16x16x32_bf16 v[184:187], v[212:215], a[216:219], v[184:187]
  v_exp_f32 v195, v195
  v_mfma_f32_16x16x32_bf16 v[188:191], v[212:215], a[220:223], v[188:191]
  v_mul_f32 v197, s36, v197
  v_mul_f32 v198, s36, v198
  v_mfma_f32_16x16x32_bf16 v[200:203], a[96:99], a[16:19], v[252:255]
  v_exp_f32 v196, v196
  v_mfma_f32_16x16x32_bf16 v[200:203], a[100:103], a[20:23], v[200:203]
  v_cvt_pk_bf16_f32 v209, v194, v195
  v_mul_f32 v199, s36, v199
  v_mfma_f32_16x16x32_bf16 v[200:203], a[104:107], a[24:27], v[200:203]
  v_exp_f32 v197, v197
  v_mfma_f32_16x16x32_bf16 v[200:203], a[108:111], a[28:31], v[200:203]
  v_exp_f32 v198, v198
  v_mfma_f32_16x16x32_bf16 v[204:207], a[112:115], a[16:19], v[252:255]
  ds_read_b128 a[136:139], v224 offset:49664
  ds_read_b128 a[140:143], v224 offset:49920
  v_mfma_f32_16x16x32_bf16 v[204:207], a[116:119], a[20:23], v[204:207]
  v_exp_f32 v199, v199
  v_mfma_f32_16x16x32_bf16 v[204:207], a[120:123], a[24:27], v[204:207]
  v_cvt_pk_bf16_f32 v210, v196, v197
  v_cvt_pk_bf16_f32 v211, v198, v199
  v_mfma_f32_16x16x32_bf16 v[204:207], a[124:127], a[28:31], v[204:207]
  s_waitcnt lgkmcnt(4)
  v_mul_f32 v200, s36, v200
  v_mul_f32 v201, s36, v201
  v_mfma_f32_16x16x32_bf16 v[0:3], v[208:211], a[160:163], v[0:3]
  v_exp_f32 v200, v200
  v_mfma_f32_16x16x32_bf16 v[4:7], v[208:211], a[164:167], v[4:7]
  v_mul_f32 v202, s36, v202
  v_mul_f32 v203, s36, v203
  v_mfma_f32_16x16x32_bf16 v[8:11], v[208:211], a[168:171], v[8:11]
  v_exp_f32 v201, v201
  v_mfma_f32_16x16x32_bf16 v[12:15], v[208:211], a[172:175], v[12:15]
  ds_read_b128 a[144:147], v224 offset:53248
  ds_read_b128 a[148:151], v224 offset:53504
  v_mfma_f32_16x16x32_bf16 v[16:19], v[208:211], a[176:179], v[16:19]
  v_exp_f32 v202, v202
  v_mfma_f32_16x16x32_bf16 v[20:23], v[208:211], a[180:183], v[20:23]
  v_cvt_pk_bf16_f32 v212, v200, v201
  v_mul_f32 v204, s36, v204
  v_mfma_f32_16x16x32_bf16 v[24:27], v[208:211], a[184:187], v[24:27]
  v_exp_f32 v203, v203
  v_mfma_f32_16x16x32_bf16 v[28:31], v[208:211], a[188:191], v[28:31]
  v_mul_f32 v205, s36, v205
  v_mul_f32 v206, s36, v206
  v_mfma_f32_16x16x32_bf16 v[192:195], a[96:99], a[32:35], v[252:255]
  v_exp_f32 v204, v204
  v_mfma_f32_16x16x32_bf16 v[192:195], a[100:103], a[36:39], v[192:195]
  v_cvt_pk_bf16_f32 v213, v202, v203
  v_mul_f32 v207, s36, v207
  v_mfma_f32_16x16x32_bf16 v[192:195], a[104:107], a[40:43], v[192:195]
  v_exp_f32 v205, v205
  v_mfma_f32_16x16x32_bf16 v[192:195], a[108:111], a[44:47], v[192:195]
  v_exp_f32 v206, v206
  v_mfma_f32_16x16x32_bf16 v[196:199], a[112:115], a[32:35], v[252:255]
  ds_read_b128 a[152:155], v224 offset:53760
  ds_read_b128 a[156:159], v224 offset:54016
  v_mfma_f32_16x16x32_bf16 v[196:199], a[116:119], a[36:39], v[196:199]
  v_exp_f32 v207, v207
  v_mfma_f32_16x16x32_bf16 v[196:199], a[120:123], a[40:43], v[196:199]
  v_cvt_pk_bf16_f32 v214, v204, v205
  v_cvt_pk_bf16_f32 v215, v206, v207
  v_mfma_f32_16x16x32_bf16 v[196:199], a[124:127], a[44:47], v[196:199]
  buffer_store_dwordx4 v[216:219], v232, s[28:31], s42 offen offset:0 nt
  v_cmp_gt_u32 vcc, s58, v244
  v_smfmac_f32_16x16x64_bf16 a[224:227], a[248:251], v[208:215], v227
  v_mul_f32 v192, s36, v192
  v_mul_f32 v193, s36, v193
  v_mfma_f32_16x16x32_bf16 v[32:35], v[212:215], a[160:163], v[32:35]
  s_cbranch_vccnz L_s6_B2
L_r6_B2:
  v_exp_f32 v192, v192
  v_mfma_f32_16x16x32_bf16 v[36:39], v[212:215], a[164:167], v[36:39]
  s_add_u32 s58, s58, 1
  v_mul_f32 v194, s36, v194
  v_mul_f32 v195, s36, v195
  v_mfma_f32_16x16x32_bf16 v[40:43], v[212:215], a[168:171], v[40:43]
  v_exp_f32 v193, v193
  v_mfma_f32_16x16x32_bf16 v[44:47], v[212:215], a[172:175], v[44:47]
  ds_read_b64_tr_b16 a[192:193], v226 offset:57344
  ds_read_b64_tr_b16 a[194:195], v226 offset:61440
  v_mfma_f32_16x16x32_bf16 v[48:51], v[212:215], a[176:179], v[48:51]
  v_exp_f32 v194, v194
  v_mfma_f32_16x16x32_bf16 v[52:55], v[212:215], a[180:183], v[52:55]
  v_cvt_pk_bf16_f32 v208, v192, v193
  v_mul_f32 v196, s36, v196
  v_mfma_f32_16x16x32_bf16 v[56:59], v[212:215], a[184:187], v[56:59]
  v_exp_f32 v195, v195
  v_mfma_f32_16x16x32_bf16 v[60:63], v[212:215], a[188:191], v[60:63]
  v_mul_f32 v197, s36, v197
  v_mul_f32 v198, s36, v198
  v_mfma_f32_16x16x32_bf16 v[200:203], a[96:99], a[48:51], v[252:255]
  v_exp_f32 v196, v196
  v_mfma_f32_16x16x32_bf16 v[200:203], a[100:103], a[52:55], v[200:203]
  v_cvt_pk_bf16_f32 v209, v194, v195
  v_mul_f32 v199, s36, v199
  v_mfma_f32_16x16x32_bf16 v[200:203], a[104:107], a[56:59], v[200:203]
  v_exp_f32 v197, v197
  v_mfma_f32_16x16x32_bf16 v[200:203], a[108:111], a[60:63], v[200:203]
  v_exp_f32 v198, v198
  v_mfma_f32_16x16x32_bf16 v[204:207], a[112:115], a[48:51], v[252:255]
  ds_read_b64_tr_b16 a[196:197], v237 offset:57344
  ds_read_b64_tr_b16 a[198:199], v237 offset:61440
  v_mfma_f32_16x16x32_bf16 v[204:207], a[116:119], a[52:55], v[204:207]
  v_exp_f32 v199, v199
  v_mfma_f32_16x16x32_bf16 v[204:207], a[120:123], a[56:59], v[204:207]
  v_cvt_pk_bf16_f32 v210, v196, v197
  v_cvt_pk_bf16_f32 v211, v198, v199
  v_mfma_f32_16x16x32_bf16 v[204:207], a[124:127], a[60:63], v[204:207]
  v_mul_f32 v200, s36, v200
  v_mul_f32 v201, s36, v201
  v_mfma_f32_16x16x32_bf16 v[64:67], v[208:211], a[160:163], v[64:67]
  v_exp_f32 v200, v200
  v_mfma_f32_16x16x32_bf16 v[68:71], v[208:211], a[164:167], v[68:71]
  v_mul_f32 v202, s36, v202
  v_mul_f32 v203, s36, v203
  v_mfma_f32_16x16x32_bf16 v[72:75], v[208:211], a[168:171], v[72:75]
  v_exp_f32 v201, v201
  v_mfma_f32_16x16x32_bf16 v[76:79], v[208:211], a[172:175], v[76:79]
  ds_read_b64_tr_b16 a[200:201], v234 offset:57344
  ds_read_b64_tr_b16 a[202:203], v234 offset:61440
  v_mfma_f32_16x16x32_bf16 v[80:83], v[208:211], a[176:179], v[80:83]
  v_exp_f32 v202, v202
  v_mfma_f32_16x16x32_bf16 v[84:87], v[208:211], a[180:183], v[84:87]
  v_cvt_pk_bf16_f32 v212, v200, v201
  v_mul_f32 v204, s36, v204
  v_mfma_f32_16x16x32_bf16 v[88:91], v[208:211], a[184:187], v[88:91]
  v_exp_f32 v203, v203
  v_mfma_f32_16x16x32_bf16 v[92:95], v[208:211], a[188:191], v[92:95]
  v_mul_f32 v205, s36, v205
  v_mul_f32 v206, s36, v206
  v_mfma_f32_16x16x32_bf16 v[192:195], a[96:99], a[64:67], v[252:255]
  v_exp_f32 v204, v204
  v_mfma_f32_16x16x32_bf16 v[192:195], a[100:103], a[68:71], v[192:195]
  v_cvt_pk_bf16_f32 v213, v202, v203
  v_mul_f32 v207, s36, v207
  v_mfma_f32_16x16x32_bf16 v[192:195], a[104:107], a[72:75], v[192:195]
  v_exp_f32 v205, v205
  v_mfma_f32_16x16x32_bf16 v[192:195], a[108:111], a[76:79], v[192:195]
  v_exp_f32 v206, v206
  v_mfma_f32_16x16x32_bf16 v[196:199], a[112:115], a[64:67], v[252:255]
  ds_read_b64_tr_b16 a[204:205], v228 offset:57344
  ds_read_b64_tr_b16 a[206:207], v228 offset:61440
  v_mfma_f32_16x16x32_bf16 v[196:199], a[116:119], a[68:71], v[196:199]
  v_exp_f32 v207, v207
  v_mfma_f32_16x16x32_bf16 v[196:199], a[120:123], a[72:75], v[196:199]
  v_cvt_pk_bf16_f32 v214, v204, v205
  v_cvt_pk_bf16_f32 v215, v206, v207
  v_mfma_f32_16x16x32_bf16 v[196:199], a[124:127], a[76:79], v[196:199]
  buffer_store_dwordx4 v[220:223], v232, s[28:31], s42 offen offset:256 nt
  v_smfmac_f32_16x16x64_bf16 a[228:231], a[248:251], v[208:215], v227
  v_mul_f32 v192, s36, v192
  v_mul_f32 v193, s36, v193
  v_mfma_f32_16x16x32_bf16 v[96:99], v[212:215], a[160:163], v[96:99]
  v_exp_f32 v192, v192
  v_mfma_f32_16x16x32_bf16 v[100:103], v[212:215], a[164:167], v[100:103]
  v_mul_f32 v194, s36, v194
  v_mul_f32 v195, s36, v195
  v_mfma_f32_16x16x32_bf16 v[104:107], v[212:215], a[168:171], v[104:107]
  v_exp_f32 v193, v193
  v_mfma_f32_16x16x32_bf16 v[108:111], v[212:215], a[172:175], v[108:111]
  ds_read_b64_tr_b16 a[208:209], v226 offset:57352
  ds_read_b64_tr_b16 a[210:211], v226 offset:61448
  v_mfma_f32_16x16x32_bf16 v[112:115], v[212:215], a[176:179], v[112:115]
  v_exp_f32 v194, v194
  v_mfma_f32_16x16x32_bf16 v[116:119], v[212:215], a[180:183], v[116:119]
  v_cvt_pk_bf16_f32 v208, v192, v193
  v_mul_f32 v196, s36, v196
  v_mfma_f32_16x16x32_bf16 v[120:123], v[212:215], a[184:187], v[120:123]
  v_exp_f32 v195, v195
  v_mfma_f32_16x16x32_bf16 v[124:127], v[212:215], a[188:191], v[124:127]
  v_mul_f32 v197, s36, v197
  v_mul_f32 v198, s36, v198
  v_mfma_f32_16x16x32_bf16 v[200:203], a[96:99], a[80:83], v[252:255]
  v_exp_f32 v196, v196
  v_mfma_f32_16x16x32_bf16 v[200:203], a[100:103], a[84:87], v[200:203]
  v_cvt_pk_bf16_f32 v209, v194, v195
  v_mul_f32 v199, s36, v199
  v_mfma_f32_16x16x32_bf16 v[200:203], a[104:107], a[88:91], v[200:203]
  v_exp_f32 v197, v197
  v_mfma_f32_16x16x32_bf16 v[200:203], a[108:111], a[92:95], v[200:203]
  s_waitcnt lgkmcnt(10)
  v_exp_f32 v198, v198
  v_mfma_f32_16x16x32_bf16 v[204:207], a[112:115], a[80:83], v[252:255]
  ds_read_b64_tr_b16 a[212:213], v237 offset:57352
  ds_read_b64_tr_b16 a[214:215], v237 offset:61448
  v_mfma_f32_16x16x32_bf16 v[204:207], a[116:119], a[84:87], v[204:207]
  v_exp_f32 v199, v199
  v_mfma_f32_16x16x32_bf16 v[204:207], a[120:123], a[88:91], v[204:207]
  v_cvt_pk_bf16_f32 v210, v196, v197
  v_cvt_pk_bf16_f32 v211, v198, v199
  v_mfma_f32_16x16x32_bf16 v[204:207], a[124:127], a[92:95], v[204:207]
  v_mul_f32 v200, s36, v200
  v_mul_f32 v201, s36, v201
  v_mfma_f32_16x16x32_bf16 v[128:131], v[208:211], a[160:163], v[128:131]
  v_exp_f32 v200, v200
  v_mfma_f32_16x16x32_bf16 v[132:135], v[208:211], a[164:167], v[132:135]
  v_mul_f32 v202, s36, v202
  v_mul_f32 v203, s36, v203
  v_mfma_f32_16x16x32_bf16 v[136:139], v[208:211], a[168:171], v[136:139]
  v_exp_f32 v201, v201
  v_mfma_f32_16x16x32_bf16 v[140:143], v[208:211], a[172:175], v[140:143]
  ds_read_b64_tr_b16 a[216:217], v234 offset:57352
  ds_read_b64_tr_b16 a[218:219], v234 offset:61448
  v_mfma_f32_16x16x32_bf16 v[144:147], v[208:211], a[176:179], v[144:147]
  v_exp_f32 v202, v202
  v_mfma_f32_16x16x32_bf16 v[148:151], v[208:211], a[180:183], v[148:151]
  v_cvt_pk_bf16_f32 v212, v200, v201
  v_mul_f32 v204, s36, v204
  v_mfma_f32_16x16x32_bf16 v[152:155], v[208:211], a[184:187], v[152:155]
  v_exp_f32 v203, v203
  v_mfma_f32_16x16x32_bf16 v[156:159], v[208:211], a[188:191], v[156:159]
  v_mul_f32 v205, s36, v205
  v_mul_f32 v206, s36, v206
  v_mfma_f32_16x16x32_bf16 v[192:195], a[128:131], a[0:3], v[252:255]
  v_exp_f32 v204, v204
  v_mfma_f32_16x16x32_bf16 v[192:195], a[132:135], a[4:7], v[192:195]
  v_cvt_pk_bf16_f32 v213, v202, v203
  v_mul_f32 v207, s36, v207
  v_mfma_f32_16x16x32_bf16 v[192:195], a[136:139], a[8:11], v[192:195]
  v_exp_f32 v205, v205
  v_mfma_f32_16x16x32_bf16 v[192:195], a[140:143], a[12:15], v[192:195]
  v_exp_f32 v206, v206
  v_mfma_f32_16x16x32_bf16 v[196:199], a[144:147], a[0:3], v[252:255]
  ds_read_b64_tr_b16 a[220:221], v228 offset:57352
  ds_read_b64_tr_b16 a[222:223], v228 offset:61448
  v_mfma_f32_16x16x32_bf16 v[196:199], a[148:151], a[4:7], v[196:199]
  v_exp_f32 v207, v207
  v_mfma_f32_16x16x32_bf16 v[196:199], a[152:155], a[8:11], v[196:199]
  v_cvt_pk_bf16_f32 v214, v204, v205
  v_cvt_pk_bf16_f32 v215, v206, v207
  v_mfma_f32_16x16x32_bf16 v[196:199], a[156:159], a[12:15], v[196:199]
  ds_read_b64_tr_b16 v[216:217], v231 offset:2048
  ds_read_b64_tr_b16 v[218:219], v231 offset:2056
  ds_read_b64_tr_b16 v[220:221], v231 offset:3072
  ds_read_b64_tr_b16 v[222:223], v231 offset:3080
  ds_add_rtn_u32 v244, v242, v243
  v_smfmac_f32_16x16x64_bf16 a[232:235], a[248:251], v[208:215], v227
  v_mul_f32 v192, s36, v192
  v_mul_f32 v193, s36, v193
  v_mfma_f32_16x16x32_bf16 v[160:163], v[212:215], a[160:163], v[160:163]
  v_exp_f32 v192, v192
  v_mfma_f32_16x16x32_bf16 v[164:167], v[212:215], a[164:167], v[164:167]
  v_mul_f32 v194, s36, v194
  v_mul_f32 v195, s36, v195
  v_mfma_f32_16x16x32_bf16 v[168:171], v[212:215], a[168:171], v[168:171]
  v_exp_f32 v193, v193
  v_mfma_f32_16x16x32_bf16 v[172:175], v[212:215], a[172:175], v[172:175]
  ds_read_b128 a[96:99], v224 offset:0
  ds_read_b128 a[100:103], v224 offset:256
  v_mfma_f32_16x16x32_bf16 v[176:179], v[212:215], a[176:179], v[176:179]
  v_exp_f32 v194, v194
  v_mfma_f32_16x16x32_bf16 v[180:183], v[212:215], a[180:183], v[180:183]
  v_cvt_pk_bf16_f32 v208, v192, v193
  v_mul_f32 v196, s36, v196
  v_mfma_f32_16x16x32_bf16 v[184:187], v[212:215], a[184:187], v[184:187]
  v_exp_f32 v195, v195
  v_mfma_f32_16x16x32_bf16 v[188:191], v[212:215], a[188:191], v[188:191]
  v_mul_f32 v197, s36, v197
  v_mul_f32 v198, s36, v198
  v_mfma_f32_16x16x32_bf16 v[200:203], a[128:131], a[16:19], v[252:255]
  v_exp_f32 v196, v196
  v_mfma_f32_16x16x32_bf16 v[200:203], a[132:135], a[20:23], v[200:203]
  v_cvt_pk_bf16_f32 v209, v194, v195
  v_mul_f32 v199, s36, v199
  v_mfma_f32_16x16x32_bf16 v[200:203], a[136:139], a[24:27], v[200:203]
  v_exp_f32 v197, v197
  v_mfma_f32_16x16x32_bf16 v[200:203], a[140:143], a[28:31], v[200:203]
  v_exp_f32 v198, v198
  v_mfma_f32_16x16x32_bf16 v[204:207], a[144:147], a[16:19], v[252:255]
  ds_read_b128 a[104:107], v224 offset:512
  ds_read_b128 a[108:111], v224 offset:768
  v_mfma_f32_16x16x32_bf16 v[204:207], a[148:151], a[20:23], v[204:207]
  v_exp_f32 v199, v199
  v_mfma_f32_16x16x32_bf16 v[204:207], a[152:155], a[24:27], v[204:207]
  v_cvt_pk_bf16_f32 v210, v196, v197
  v_cvt_pk_bf16_f32 v211, v198, v199
  v_mfma_f32_16x16x32_bf16 v[204:207], a[156:159], a[28:31], v[204:207]
  s_waitcnt lgkmcnt(4)
  v_mul_f32 v200, s36, v200
  v_mul_f32 v201, s36, v201
  v_mfma_f32_16x16x32_bf16 v[0:3], v[208:211], a[192:195], v[0:3]
  v_exp_f32 v200, v200
  v_mfma_f32_16x16x32_bf16 v[4:7], v[208:211], a[196:199], v[4:7]
  v_mul_f32 v202, s36, v202
  v_mul_f32 v203, s36, v203
  v_mfma_f32_16x16x32_bf16 v[8:11], v[208:211], a[200:203], v[8:11]
  v_exp_f32 v201, v201
  v_mfma_f32_16x16x32_bf16 v[12:15], v[208:211], a[204:207], v[12:15]
  ds_read_b128 a[112:115], v224 offset:4096
  ds_read_b128 a[116:119], v224 offset:4352
  v_mfma_f32_16x16x32_bf16 v[16:19], v[208:211], a[208:211], v[16:19]
  v_exp_f32 v202, v202
  v_mfma_f32_16x16x32_bf16 v[20:23], v[208:211], a[212:215], v[20:23]
  v_cvt_pk_bf16_f32 v212, v200, v201
  v_mul_f32 v204, s36, v204
  v_mfma_f32_16x16x32_bf16 v[24:27], v[208:211], a[216:219], v[24:27]
  v_exp_f32 v203, v203
  v_mfma_f32_16x16x32_bf16 v[28:31], v[208:211], a[220:223], v[28:31]
  v_mul_f32 v205, s36, v205
  v_mul_f32 v206, s36, v206
  v_mfma_f32_16x16x32_bf16 v[192:195], a[128:131], a[32:35], v[252:255]
  v_exp_f32 v204, v204
  v_mfma_f32_16x16x32_bf16 v[192:195], a[132:135], a[36:39], v[192:195]
  v_cvt_pk_bf16_f32 v213, v202, v203
  v_mul_f32 v207, s36, v207
  v_mfma_f32_16x16x32_bf16 v[192:195], a[136:139], a[40:43], v[192:195]
  v_exp_f32 v205, v205
  v_mfma_f32_16x16x32_bf16 v[192:195], a[140:143], a[44:47], v[192:195]
  v_exp_f32 v206, v206
  v_mfma_f32_16x16x32_bf16 v[196:199], a[144:147], a[32:35], v[252:255]
  ds_read_b128 a[120:123], v224 offset:4608
  ds_read_b128 a[124:127], v224 offset:4864
  v_mfma_f32_16x16x32_bf16 v[196:199], a[148:151], a[36:39], v[196:199]
  v_exp_f32 v207, v207
  v_mfma_f32_16x16x32_bf16 v[196:199], a[152:155], a[40:43], v[196:199]
  v_cvt_pk_bf16_f32 v214, v204, v205
  v_cvt_pk_bf16_f32 v215, v206, v207
  v_mfma_f32_16x16x32_bf16 v[196:199], a[156:159], a[44:47], v[196:199]
  buffer_store_dwordx4 v[216:219], v232, s[28:31], s42 offen offset:512 nt
  v_cmp_gt_u32 vcc, s58, v244
  v_smfmac_f32_16x16x64_bf16 a[224:227], a[248:251], v[208:215], v227
  v_mul_f32 v192, s36, v192
  v_mul_f32 v193, s36, v193
  v_mfma_f32_16x16x32_bf16 v[32:35], v[212:215], a[192:195], v[32:35]
  s_cbranch_vccnz L_s6_B3
L_r6_B3:
  v_exp_f32 v192, v192
  v_mfma_f32_16x16x32_bf16 v[36:39], v[212:215], a[196:199], v[36:39]
  s_add_u32 s58, s58, 1
  v_mul_f32 v194, s36, v194
  v_mul_f32 v195, s36, v195
  v_mfma_f32_16x16x32_bf16 v[40:43], v[212:215], a[200:203], v[40:43]
  v_exp_f32 v193, v193
  v_mfma_f32_16x16x32_bf16 v[44:47], v[212:215], a[204:207], v[44:47]
  ds_read_b64_tr_b16 a[160:161], v226 offset:8192
  ds_read_b64_tr_b16 a[162:163], v226 offset:12288
  v_mfma_f32_16x16x32_bf16 v[48:51], v[212:215], a[208:211], v[48:51]
  v_exp_f32 v194, v194
  v_mfma_f32_16x16x32_bf16 v[52:55], v[212:215], a[212:215], v[52:55]
  v_cvt_pk_bf16_f32 v208, v192, v193
  v_mul_f32 v196, s36, v196
  v_mfma_f32_16x16x32_bf16 v[56:59], v[212:215], a[216:219], v[56:59]
  v_exp_f32 v195, v195
  v_mfma_f32_16x16x32_bf16 v[60:63], v[212:215], a[220:223], v[60:63]
  v_mul_f32 v197, s36, v197
  v_mul_f32 v198, s36, v198
  v_mfma_f32_16x16x32_bf16 v[200:203], a[128:131], a[48:51], v[252:255]
  v_exp_f32 v196, v196
  v_mfma_f32_16x16x32_bf16 v[200:203], a[132:135], a[52:55], v[200:203]
  v_cvt_pk_bf16_f32 v209, v194, v195
  v_mul_f32 v199, s36, v199
  v_mfma_f32_16x16x32_bf16 v[200:203], a[136:139], a[56:59], v[200:203]
  v_exp_f32 v197, v197
  v_mfma_f32_16x16x32_bf16 v[200:203], a[140:143], a[60:63], v[200:203]
  v_exp_f32 v198, v198
  v_mfma_f32_16x16x32_bf16 v[204:207], a[144:147], a[48:51], v[252:255]
  ds_read_b64_tr_b16 a[164:165], v237 offset:8192
  ds_read_b64_tr_b16 a[166:167], v237 offset:12288
  v_mfma_f32_16x16x32_bf16 v[204:207], a[148:151], a[52:55], v[204:207]
  v_exp_f32 v199, v199
  v_mfma_f32_16x16x32_bf16 v[204:207], a[152:155], a[56:59], v[204:207]
  v_cvt_pk_bf16_f32 v210, v196, v197
  v_cvt_pk_bf16_f32 v211, v198, v199
  v_mfma_f32_16x16x32_bf16 v[204:207], a[156:159], a[60:63], v[204:207]
  v_mul_f32 v200, s36, v200
  v_mul_f32 v201, s36, v201
  v_mfma_f32_16x16x32_bf16 v[64:67], v[208:211], a[192:195], v[64:67]
  v_exp_f32 v200, v200
  v_mfma_f32_16x16x32_bf16 v[68:71], v[208:211], a[196:199], v[68:71]
  v_mul_f32 v202, s36, v202
  v_mul_f32 v203, s36, v203
  v_mfma_f32_16x16x32_bf16 v[72:75], v[208:211], a[200:203], v[72:75]
  v_exp_f32 v201, v201
  v_mfma_f32_16x16x32_bf16 v[76:79], v[208:211], a[204:207], v[76:79]
  ds_read_b64_tr_b16 a[168:169], v234 offset:8192
  ds_read_b64_tr_b16 a[170:171], v234 offset:12288
  v_mfma_f32_16x16x32_bf16 v[80:83], v[208:211], a[208:211], v[80:83]
  v_exp_f32 v202, v202
  v_mfma_f32_16x16x32_bf16 v[84:87], v[208:211], a[212:215], v[84:87]
  v_cvt_pk_bf16_f32 v212, v200, v201
  v_mul_f32 v204, s36, v204
  v_mfma_f32_16x16x32_bf16 v[88:91], v[208:211], a[216:219], v[88:91]
  v_exp_f32 v203, v203
  v_mfma_f32_16x16x32_bf16 v[92:95], v[208:211], a[220:223], v[92:95]
  v_mul_f32 v205, s36, v205
  v_mul_f32 v206, s36, v206
  v_mfma_f32_16x16x32_bf16 v[192:195], a[128:131], a[64:67], v[252:255]
  v_exp_f32 v204, v204
  v_mfma_f32_16x16x32_bf16 v[192:195], a[132:135], a[68:71], v[192:195]
  v_cvt_pk_bf16_f32 v213, v202, v203
  v_mul_f32 v207, s36, v207
  v_mfma_f32_16x16x32_bf16 v[192:195], a[136:139], a[72:75], v[192:195]
  v_exp_f32 v205, v205
  v_mfma_f32_16x16x32_bf16 v[192:195], a[140:143], a[76:79], v[192:195]
  v_exp_f32 v206, v206
  v_mfma_f32_16x16x32_bf16 v[196:199], a[144:147], a[64:67], v[252:255]
  ds_read_b64_tr_b16 a[172:173], v228 offset:8192
  ds_read_b64_tr_b16 a[174:175], v228 offset:12288
  v_mfma_f32_16x16x32_bf16 v[196:199], a[148:151], a[68:71], v[196:199]
  v_exp_f32 v207, v207
  v_mfma_f32_16x16x32_bf16 v[196:199], a[152:155], a[72:75], v[196:199]
  v_cvt_pk_bf16_f32 v214, v204, v205
  v_cvt_pk_bf16_f32 v215, v206, v207
  v_mfma_f32_16x16x32_bf16 v[196:199], a[156:159], a[76:79], v[196:199]
  buffer_store_dwordx4 v[220:223], v232, s[28:31], s42 offen offset:768 nt
  v_smfmac_f32_16x16x64_bf16 a[228:231], a[248:251], v[208:215], v227
  s_add_u32 s42, s42, 4096
  v_mul_f32 v192, s36, v192
  v_mul_f32 v193, s36, v193
  v_mfma_f32_16x16x32_bf16 v[96:99], v[212:215], a[192:195], v[96:99]
  v_exp_f32 v192, v192
  v_mfma_f32_16x16x32_bf16 v[100:103], v[212:215], a[196:199], v[100:103]
  v_mul_f32 v194, s36, v194
  v_mul_f32 v195, s36, v195
  v_mfma_f32_16x16x32_bf16 v[104:107], v[212:215], a[200:203], v[104:107]
  v_exp_f32 v193, v193
  v_mfma_f32_16x16x32_bf16 v[108:111], v[212:215], a[204:207], v[108:111]
  ds_read_b64_tr_b16 a[176:177], v226 offset:8200
  ds_read_b64_tr_b16 a[178:179], v226 offset:12296
  v_mfma_f32_16x16x32_bf16 v[112:115], v[212:215], a[208:211], v[112:115]
  v_exp_f32 v194, v194
  v_mfma_f32_16x16x32_bf16 v[116:119], v[212:215], a[212:215], v[116:119]
  v_cvt_pk_bf16_f32 v208, v192, v193
  v_mul_f32 v196, s36, v196
  v_mfma_f32_16x16x32_bf16 v[120:123], v[212:215], a[216:219], v[120:123]
  v_exp_f32 v195, v195
  v_mfma_f32_16x16x32_bf16 v[124:127], v[212:215], a[220:223], v[124:127]
  v_mul_f32 v197, s36, v197
  v_mul_f32 v198, s36, v198
  v_mfma_f32_16x16x32_bf16 v[200:203], a[128:131], a[80:83], v[252:255]
  v_exp_f32 v196, v196
  v_mfma_f32_16x16x32_bf16 v[200:203], a[132:135], a[84:87], v[200:203]
  v_cvt_pk_bf16_f32 v209, v194, v195
  v_mul_f32 v199, s36, v199
  v_mfma_f32_16x16x32_bf16 v[200:203], a[136:139], a[88:91], v[200:203]
  v_exp_f32 v197, v197
  v_mfma_f32_16x16x32_bf16 v[200:203], a[140:143], a[92:95], v[200:203]
  s_waitcnt lgkmcnt(10)
  v_exp_f32 v198, v198
  v_mfma_f32_16x16x32_bf16 v[204:207], a[144:147], a[80:83], v[252:255]
  ds_read_b64_tr_b16 a[180:181], v237 offset:8200
  ds_read_b64_tr_b16 a[182:183], v237 offset:12296
  v_mfma_f32_16x16x32_bf16 v[204:207], a[148:151], a[84:87], v[204:207]
  v_exp_f32 v199, v199
  v_mfma_f32_16x16x32_bf16 v[204:207], a[152:155], a[88:91], v[204:207]
  v_cvt_pk_bf16_f32 v210, v196, v197
  v_cvt_pk_bf16_f32 v211, v198, v199
  v_mfma_f32_16x16x32_bf16 v[204:207], a[156:159], a[92:95], v[204:207]
  v_mul_f32 v200, s36, v200
  v_mul_f32 v201, s36, v201
  v_mfma_f32_16x16x32_bf16 v[128:131], v[208:211], a[192:195], v[128:131]
  v_exp_f32 v200, v200
  v_mfma_f32_16x16x32_bf16 v[132:135], v[208:211], a[196:199], v[132:135]
  v_mul_f32 v202, s36, v202
  v_mul_f32 v203, s36, v203
  v_mfma_f32_16x16x32_bf16 v[136:139], v[208:211], a[200:203], v[136:139]
  v_exp_f32 v201, v201
  v_mfma_f32_16x16x32_bf16 v[140:143], v[208:211], a[204:207], v[140:143]
  ds_read_b64_tr_b16 a[184:185], v234 offset:8200
  ds_read_b64_tr_b16 a[186:187], v234 offset:12296
  v_mfma_f32_16x16x32_bf16 v[144:147], v[208:211], a[208:211], v[144:147]
  v_exp_f32 v202, v202
  v_mfma_f32_16x16x32_bf16 v[148:151], v[208:211], a[212:215], v[148:151]
  v_cvt_pk_bf16_f32 v212, v200, v201
  v_mul_f32 v204, s36, v204
  v_mfma_f32_16x16x32_bf16 v[152:155], v[208:211], a[216:219], v[152:155]
  v_exp_f32 v203, v203
  v_mfma_f32_16x16x32_bf16 v[156:159], v[208:211], a[220:223], v[156:159]
  v_mul_f32 v205, s36, v205
  v_mul_f32 v206, s36, v206
  v_mfma_f32_16x16x32_bf16 v[192:195], a[96:99], a[0:3], v[252:255]
  v_exp_f32 v204, v204
  v_mfma_f32_16x16x32_bf16 v[192:195], a[100:103], a[4:7], v[192:195]
  v_cvt_pk_bf16_f32 v213, v202, v203
  v_mul_f32 v207, s36, v207
  v_mfma_f32_16x16x32_bf16 v[192:195], a[104:107], a[8:11], v[192:195]
  v_exp_f32 v205, v205
  v_mfma_f32_16x16x32_bf16 v[192:195], a[108:111], a[12:15], v[192:195]
  v_exp_f32 v206, v206
  v_mfma_f32_16x16x32_bf16 v[196:199], a[112:115], a[0:3], v[252:255]
  ds_read_b64_tr_b16 a[188:189], v228 offset:8200
  ds_read_b64_tr_b16 a[190:191], v228 offset:12296
  v_mfma_f32_16x16x32_bf16 v[196:199], a[116:119], a[4:7], v[196:199]
  v_exp_f32 v207, v207
  v_mfma_f32_16x16x32_bf16 v[196:199], a[120:123], a[8:11], v[196:199]
  v_cvt_pk_bf16_f32 v214, v204, v205
  v_cvt_pk_bf16_f32 v215, v206, v207
  v_mfma_f32_16x16x32_bf16 v[196:199], a[124:127], a[12:15], v[196:199]
  ds_read_b64_tr_b16 v[216:217], v231 offset:4096
  ds_read_b64_tr_b16 v[218:219], v231 offset:4104
  ds_read_b64_tr_b16 v[220:221], v231 offset:5120
  ds_read_b64_tr_b16 v[222:223], v231 offset:5128
  ds_add_rtn_u32 v244, v242, v243
  v_smfmac_f32_16x16x64_bf16 a[232:235], a[248:251], v[208:215], v227
  v_mul_f32 v192, s36, v192
  v_mul_f32 v193, s36, v193
  v_mfma_f32_16x16x32_bf16 v[160:163], v[212:215], a[192:195], v[160:163]
  v_exp_f32 v192, v192
  v_mfma_f32_16x16x32_bf16 v[164:167], v[212:215], a[196:199], v[164:167]
  v_mul_f32 v194, s36, v194
  v_mul_f32 v195, s36, v195
  v_mfma_f32_16x16x32_bf16 v[168:171], v[212:215], a[200:203], v[168:171]
  v_exp_f32 v193, v193
  v_mfma_f32_16x16x32_bf16 v[172:175], v[212:215], a[204:207], v[172:175]
  ds_read_b128 a[128:131], v224 offset:16384
  ds_read_b128 a[132:135], v224 offset:16640
  v_mfma_f32_16x16x32_bf16 v[176:179], v[212:215], a[208:211], v[176:179]
  v_exp_f32 v194, v194
  v_mfma_f32_16x16x32_bf16 v[180:183], v[212:215], a[212:215], v[180:183]
  v_cvt_pk_bf16_f32 v208, v192, v193
  v_mul_f32 v196, s36, v196
  v_mfma_f32_16x16x32_bf16 v[184:187], v[212:215], a[216:219], v[184:187]
  v_exp_f32 v195, v195
  v_mfma_f32_16x16x32_bf16 v[188:191], v[212:215], a[220:223], v[188:191]
  v_mul_f32 v197, s36, v197
  v_mul_f32 v198, s36, v198
  v_mfma_f32_16x16x32_bf16 v[200:203], a[96:99], a[16:19], v[252:255]
  v_exp_f32 v196, v196
  v_mfma_f32_16x16x32_bf16 v[200:203], a[100:103], a[20:23], v[200:203]
  v_cvt_pk_bf16_f32 v209, v194, v195
  v_mul_f32 v199, s36, v199
  v_mfma_f32_16x16x32_bf16 v[200:203], a[104:107], a[24:27], v[200:203]
  v_exp_f32 v197, v197
  v_mfma_f32_16x16x32_bf16 v[200:203], a[108:111], a[28:31], v[200:203]
  v_exp_f32 v198, v198
  v_mfma_f32_16x16x32_bf16 v[204:207], a[112:115], a[16:19], v[252:255]
  ds_read_b128 a[136:139], v224 offset:16896
  ds_read_b128 a[140:143], v224 offset:17152
  v_mfma_f32_16x16x32_bf16 v[204:207], a[116:119], a[20:23], v[204:207]
  v_exp_f32 v199, v199
  v_mfma_f32_16x16x32_bf16 v[204:207], a[120:123], a[24:27], v[204:207]
  v_cvt_pk_bf16_f32 v210, v196, v197
  v_cvt_pk_bf16_f32 v211, v198, v199
  v_mfma_f32_16x16x32_bf16 v[204:207], a[124:127], a[28:31], v[204:207]
  s_waitcnt lgkmcnt(4)
  v_mul_f32 v200, s36, v200
  v_mul_f32 v201, s36, v201
  v_mfma_f32_16x16x32_bf16 v[0:3], v[208:211], a[160:163], v[0:3]
  v_exp_f32 v200, v200
  v_mfma_f32_16x16x32_bf16 v[4:7], v[208:211], a[164:167], v[4:7]
  v_mul_f32 v202, s36, v202
  v_mul_f32 v203, s36, v203
  v_mfma_f32_16x16x32_bf16 v[8:11], v[208:211], a[168:171], v[8:11]
  v_exp_f32 v201, v201
  v_mfma_f32_16x16x32_bf16 v[12:15], v[208:211], a[172:175], v[12:15]
  ds_read_b128 a[144:147], v224 offset:20480
  ds_read_b128 a[148:151], v224 offset:20736
  v_mfma_f32_16x16x32_bf16 v[16:19], v[208:211], a[176:179], v[16:19]
  v_exp_f32 v202, v202
  v_mfma_f32_16x16x32_bf16 v[20:23], v[208:211], a[180:183], v[20:23]
  v_cvt_pk_bf16_f32 v212, v200, v201
  v_mul_f32 v204, s36, v204
  v_mfma_f32_16x16x32_bf16 v[24:27], v[208:211], a[184:187], v[24:27]
  v_exp_f32 v203, v203
  v_mfma_f32_16x16x32_bf16 v[28:31], v[208:211], a[188:191], v[28:31]
  v_mul_f32 v205, s36, v205
  v_mul_f32 v206, s36, v206
  v_mfma_f32_16x16x32_bf16 v[192:195], a[96:99], a[32:35], v[252:255]
  v_exp_f32 v204, v204
  v_mfma_f32_16x16x32_bf16 v[192:195], a[100:103], a[36:39], v[192:195]
  v_cvt_pk_bf16_f32 v213, v202, v203
  v_mul_f32 v207, s36, v207
  v_mfma_f32_16x16x32_bf16 v[192:195], a[104:107], a[40:43], v[192:195]
  v_exp_f32 v205, v205
  v_mfma_f32_16x16x32_bf16 v[192:195], a[108:111], a[44:47], v[192:195]
  v_exp_f32 v206, v206
  v_mfma_f32_16x16x32_bf16 v[196:199], a[112:115], a[32:35], v[252:255]
  ds_read_b128 a[152:155], v224 offset:20992
  ds_read_b128 a[156:159], v224 offset:21248
  v_mfma_f32_16x16x32_bf16 v[196:199], a[116:119], a[36:39], v[196:199]
  v_exp_f32 v207, v207
  v_mfma_f32_16x16x32_bf16 v[196:199], a[120:123], a[40:43], v[196:199]
  v_cvt_pk_bf16_f32 v214, v204, v205
  v_cvt_pk_bf16_f32 v215, v206, v207
  v_mfma_f32_16x16x32_bf16 v[196:199], a[124:127], a[44:47], v[196:199]
  buffer_store_dwordx4 v[216:219], v232, s[28:31], s42 offen offset:0 nt
  v_cmp_gt_u32 vcc, s58, v244
  v_smfmac_f32_16x16x64_bf16 a[224:227], a[248:251], v[208:215], v227
  v_mul_f32 v192, s36, v192
  v_mul_f32 v193, s36, v193
  v_mfma_f32_16x16x32_bf16 v[32:35], v[212:215], a[160:163], v[32:35]
  s_cbranch_vccnz L_s6_B4
L_r6_B4:
  v_exp_f32 v192, v192
  v_mfma_f32_16x16x32_bf16 v[36:39], v[212:215], a[164:167], v[36:39]
  s_add_u32 s58, s58, 1
  v_mul_f32 v194, s36, v194
  v_mul_f32 v195, s36, v195
  v_mfma_f32_16x16x32_bf16 v[40:43], v[212:215], a[168:171], v[40:43]
  v_exp_f32 v193, v193
  v_mfma_f32_16x16x32_bf16 v[44:47], v[212:215], a[172:175], v[44:47]
  ds_read_b64_tr_b16 a[192:193], v226 offset:24576
  ds_read_b64_tr_b16 a[194:195], v226 offset:28672
  v_mfma_f32_16x16x32_bf16 v[48:51], v[212:215], a[176:179], v[48:51]
  v_exp_f32 v194, v194
  v_mfma_f32_16x16x32_bf16 v[52:55], v[212:215], a[180:183], v[52:55]
  v_cvt_pk_bf16_f32 v208, v192, v193
  v_mul_f32 v196, s36, v196
  v_mfma_f32_16x16x32_bf16 v[56:59], v[212:215], a[184:187], v[56:59]
  v_exp_f32 v195, v195
  v_mfma_f32_16x16x32_bf16 v[60:63], v[212:215], a[188:191], v[60:63]
  v_mul_f32 v197, s36, v197
  v_mul_f32 v198, s36, v198
  v_mfma_f32_16x16x32_bf16 v[200:203], a[96:99], a[48:51], v[252:255]
  v_exp_f32 v196, v196
  v_mfma_f32_16x16x32_bf16 v[200:203], a[100:103], a[52:55], v[200:203]
  v_cvt_pk_bf16_f32 v209, v194, v195
  v_mul_f32 v199, s36, v199
  v_mfma_f32_16x16x32_bf16 v[200:203], a[104:107], a[56:59], v[200:203]
  v_exp_f32 v197, v197
  v_mfma_f32_16x16x32_bf16 v[200:203], a[108:111], a[60:63], v[200:203]
  v_exp_f32 v198, v198
  v_mfma_f32_16x16x32_bf16 v[204:207], a[112:115], a[48:51], v[252:255]
  ds_read_b64_tr_b16 a[196:197], v237 offset:24576
  ds_read_b64_tr_b16 a[198:199], v237 offset:28672
  v_mfma_f32_16x16x32_bf16 v[204:207], a[116:119], a[52:55], v[204:207]
  v_exp_f32 v199, v199
  v_mfma_f32_16x16x32_bf16 v[204:207], a[120:123], a[56:59], v[204:207]
  v_cvt_pk_bf16_f32 v210, v196, v197
  v_cvt_pk_bf16_f32 v211, v198, v199
  v_mfma_f32_16x16x32_bf16 v[204:207], a[124:127], a[60:63], v[204:207]
  v_mul_f32 v200, s36, v200
  v_mul_f32 v201, s36, v201
  v_mfma_f32_16x16x32_bf16 v[64:67], v[208:211], a[160:163], v[64:67]
  v_exp_f32 v200, v200
  v_mfma_f32_16x16x32_bf16 v[68:71], v[208:211], a[164:167], v[68:71]
  v_mul_f32 v202, s36, v202
  v_mul_f32 v203, s36, v203
  v_mfma_f32_16x16x32_bf16 v[72:75], v[208:211], a[168:171], v[72:75]
  v_exp_f32 v201, v201
  v_mfma_f32_16x16x32_bf16 v[76:79], v[208:211], a[172:175], v[76:79]
  ds_read_b64_tr_b16 a[200:201], v234 offset:24576
  ds_read_b64_tr_b16 a[202:203], v234 offset:28672
  v_mfma_f32_16x16x32_bf16 v[80:83], v[208:211], a[176:179], v[80:83]
  v_exp_f32 v202, v202
  v_mfma_f32_16x16x32_bf16 v[84:87], v[208:211], a[180:183], v[84:87]
  v_cvt_pk_bf16_f32 v212, v200, v201
  v_mul_f32 v204, s36, v204
  v_mfma_f32_16x16x32_bf16 v[88:91], v[208:211], a[184:187], v[88:91]
  v_exp_f32 v203, v203
  v_mfma_f32_16x16x32_bf16 v[92:95], v[208:211], a[188:191], v[92:95]
  v_mul_f32 v205, s36, v205
  v_mul_f32 v206, s36, v206
  v_mfma_f32_16x16x32_bf16 v[192:195], a[96:99], a[64:67], v[252:255]
  v_exp_f32 v204, v204
  v_mfma_f32_16x16x32_bf16 v[192:195], a[100:103], a[68:71], v[192:195]
  v_cvt_pk_bf16_f32 v213, v202, v203
  v_mul_f32 v207, s36, v207
  v_mfma_f32_16x16x32_bf16 v[192:195], a[104:107], a[72:75], v[192:195]
  v_exp_f32 v205, v205
  v_mfma_f32_16x16x32_bf16 v[192:195], a[108:111], a[76:79], v[192:195]
  v_exp_f32 v206, v206
  v_mfma_f32_16x16x32_bf16 v[196:199], a[112:115], a[64:67], v[252:255]
  ds_read_b64_tr_b16 a[204:205], v228 offset:24576
  ds_read_b64_tr_b16 a[206:207], v228 offset:28672
  v_mfma_f32_16x16x32_bf16 v[196:199], a[116:119], a[68:71], v[196:199]
  v_exp_f32 v207, v207
  v_mfma_f32_16x16x32_bf16 v[196:199], a[120:123], a[72:75], v[196:199]
  v_cvt_pk_bf16_f32 v214, v204, v205
  v_cvt_pk_bf16_f32 v215, v206, v207
  v_mfma_f32_16x16x32_bf16 v[196:199], a[124:127], a[76:79], v[196:199]
  buffer_store_dwordx4 v[220:223], v232, s[28:31], s42 offen offset:256 nt
  v_smfmac_f32_16x16x64_bf16 a[228:231], a[248:251], v[208:215], v227
  v_mul_f32 v192, s36, v192
  v_mul_f32 v193, s36, v193
  v_mfma_f32_16x16x32_bf16 v[96:99], v[212:215], a[160:163], v[96:99]
  v_exp_f32 v192, v192
  v_mfma_f32_16x16x32_bf16 v[100:103], v[212:215], a[164:167], v[100:103]
  v_mul_f32 v194, s36, v194
  v_mul_f32 v195, s36, v195
  v_mfma_f32_16x16x32_bf16 v[104:107], v[212:215], a[168:171], v[104:107]
  v_exp_f32 v193, v193
  v_mfma_f32_16x16x32_bf16 v[108:111], v[212:215], a[172:175], v[108:111]
  ds_read_b64_tr_b16 a[208:209], v226 offset:24584
  ds_read_b64_tr_b16 a[210:211], v226 offset:28680
  v_mfma_f32_16x16x32_bf16 v[112:115], v[212:215], a[176:179], v[112:115]
  v_exp_f32 v194, v194
  v_mfma_f32_16x16x32_bf16 v[116:119], v[212:215], a[180:183], v[116:119]
  v_cvt_pk_bf16_f32 v208, v192, v193
  v_mul_f32 v196, s36, v196
  v_mfma_f32_16x16x32_bf16 v[120:123], v[212:215], a[184:187], v[120:123]
  v_exp_f32 v195, v195
  v_mfma_f32_16x16x32_bf16 v[124:127], v[212:215], a[188:191], v[124:127]
  v_mul_f32 v197, s36, v197
  v_mul_f32 v198, s36, v198
  v_mfma_f32_16x16x32_bf16 v[200:203], a[96:99], a[80:83], v[252:255]
  v_exp_f32 v196, v196
  v_mfma_f32_16x16x32_bf16 v[200:203], a[100:103], a[84:87], v[200:203]
  v_cvt_pk_bf16_f32 v209, v194, v195
  v_mul_f32 v199, s36, v199
  v_mfma_f32_16x16x32_bf16 v[200:203], a[104:107], a[88:91], v[200:203]
  v_exp_f32 v197, v197
  v_mfma_f32_16x16x32_bf16 v[200:203], a[108:111], a[92:95], v[200:203]
  s_waitcnt lgkmcnt(10)
  v_exp_f32 v198, v198
  v_mfma_f32_16x16x32_bf16 v[204:207], a[112:115], a[80:83], v[252:255]
  ds_read_b64_tr_b16 a[212:213], v237 offset:24584
  ds_read_b64_tr_b16 a[214:215], v237 offset:28680
  v_mfma_f32_16x16x32_bf16 v[204:207], a[116:119], a[84:87], v[204:207]
  v_exp_f32 v199, v199
  v_mfma_f32_16x16x32_bf16 v[204:207], a[120:123], a[88:91], v[204:207]
  v_cvt_pk_bf16_f32 v210, v196, v197
  v_cvt_pk_bf16_f32 v211, v198, v199
  v_mfma_f32_16x16x32_bf16 v[204:207], a[124:127], a[92:95], v[204:207]
  v_mul_f32 v200, s36, v200
  v_mul_f32 v201, s36, v201
  v_mfma_f32_16x16x32_bf16 v[128:131], v[208:211], a[160:163], v[128:131]
  v_exp_f32 v200, v200
  v_mfma_f32_16x16x32_bf16 v[132:135], v[208:211], a[164:167], v[132:135]
  v_mul_f32 v202, s36, v202
  v_mul_f32 v203, s36, v203
  v_mfma_f32_16x16x32_bf16 v[136:139], v[208:211], a[168:171], v[136:139]
  v_exp_f32 v201, v201
  v_mfma_f32_16x16x32_bf16 v[140:143], v[208:211], a[172:175], v[140:143]
  ds_read_b64_tr_b16 a[216:217], v234 offset:24584
  ds_read_b64_tr_b16 a[218:219], v234 offset:28680
  v_mfma_f32_16x16x32_bf16 v[144:147], v[208:211], a[176:179], v[144:147]
  v_exp_f32 v202, v202
  v_mfma_f32_16x16x32_bf16 v[148:151], v[208:211], a[180:183], v[148:151]
  v_cvt_pk_bf16_f32 v212, v200, v201
  v_mul_f32 v204, s36, v204
  v_mfma_f32_16x16x32_bf16 v[152:155], v[208:211], a[184:187], v[152:155]
  v_exp_f32 v203, v203
  v_mfma_f32_16x16x32_bf16 v[156:159], v[208:211], a[188:191], v[156:159]
  v_mul_f32 v205, s36, v205
  v_mul_f32 v206, s36, v206
  v_mfma_f32_16x16x32_bf16 v[192:195], a[128:131], a[0:3], v[252:255]
  v_exp_f32 v204, v204
  v_mfma_f32_16x16x32_bf16 v[192:195], a[132:135], a[4:7], v[192:195]
  v_cvt_pk_bf16_f32 v213, v202, v203
  v_mul_f32 v207, s36, v207
  v_mfma_f32_16x16x32_bf16 v[192:195], a[136:139], a[8:11], v[192:195]
  v_exp_f32 v205, v205
  v_mfma_f32_16x16x32_bf16 v[192:195], a[140:143], a[12:15], v[192:195]
  v_exp_f32 v206, v206
  v_mfma_f32_16x16x32_bf16 v[196:199], a[144:147], a[0:3], v[252:255]
  ds_read_b64_tr_b16 a[220:221], v228 offset:24584
  ds_read_b64_tr_b16 a[222:223], v228 offset:28680
  v_mfma_f32_16x16x32_bf16 v[196:199], a[148:151], a[4:7], v[196:199]
  v_exp_f32 v207, v207
  v_mfma_f32_16x16x32_bf16 v[196:199], a[152:155], a[8:11], v[196:199]
  v_cvt_pk_bf16_f32 v214, v204, v205
  v_cvt_pk_bf16_f32 v215, v206, v207
  v_mfma_f32_16x16x32_bf16 v[196:199], a[156:159], a[12:15], v[196:199]
  ds_read_b64_tr_b16 v[216:217], v231 offset:6144
  ds_read_b64_tr_b16 v[218:219], v231 offset:6152
  ds_read_b64_tr_b16 v[220:221], v231 offset:7168
  ds_read_b64_tr_b16 v[222:223], v231 offset:7176
  ds_add_rtn_u32 v244, v242, v243
  v_smfmac_f32_16x16x64_bf16 a[232:235], a[248:251], v[208:215], v227
  v_mul_f32 v192, s36, v192
  v_mul_f32 v193, s36, v193
  v_mfma_f32_16x16x32_bf16 v[160:163], v[212:215], a[160:163], v[160:163]
  v_exp_f32 v192, v192
  v_mfma_f32_16x16x32_bf16 v[164:167], v[212:215], a[164:167], v[164:167]
  v_mul_f32 v194, s36, v194
  v_mul_f32 v195, s36, v195
  v_mfma_f32_16x16x32_bf16 v[168:171], v[212:215], a[168:171], v[168:171]
  v_exp_f32 v193, v193
  v_mfma_f32_16x16x32_bf16 v[172:175], v[212:215], a[172:175], v[172:175]
  ds_read_b128 a[96:99], v224 offset:32768
  ds_read_b128 a[100:103], v224 offset:33024
  v_mfma_f32_16x16x32_bf16 v[176:179], v[212:215], a[176:179], v[176:179]
  v_exp_f32 v194, v194
  v_mfma_f32_16x16x32_bf16 v[180:183], v[212:215], a[180:183], v[180:183]
  v_cvt_pk_bf16_f32 v208, v192, v193
  v_mul_f32 v196, s36, v196
  v_mfma_f32_16x16x32_bf16 v[184:187], v[212:215], a[184:187], v[184:187]
  v_exp_f32 v195, v195
  v_mfma_f32_16x16x32_bf16 v[188:191], v[212:215], a[188:191], v[188:191]
  v_mul_f32 v197, s36, v197
  v_mul_f32 v198, s36, v198
  v_mfma_f32_16x16x32_bf16 v[200:203], a[128:131], a[16:19], v[252:255]
  v_exp_f32 v196, v196
  v_mfma_f32_16x16x32_bf16 v[200:203], a[132:135], a[20:23], v[200:203]
  v_cvt_pk_bf16_f32 v209, v194, v195
  v_mul_f32 v199, s36, v199
  v_mfma_f32_16x16x32_bf16 v[200:203], a[136:139], a[24:27], v[200:203]
  v_exp_f32 v197, v197
  v_mfma_f32_16x16x32_bf16 v[200:203], a[140:143], a[28:31], v[200:203]
  v_exp_f32 v198, v198
  v_mfma_f32_16x16x32_bf16 v[204:207], a[144:147], a[16:19], v[252:255]
  ds_read_b128 a[104:107], v224 offset:33280
  ds_read_b128 a[108:111], v224 offset:33536
  v_mfma_f32_16x16x32_bf16 v[204:207], a[148:151], a[20:23], v[204:207]
  v_exp_f32 v199, v199
  v_mfma_f32_16x16x32_bf16 v[204:207], a[152:155], a[24:27], v[204:207]
  v_cvt_pk_bf16_f32 v210, v196, v197
  v_cvt_pk_bf16_f32 v211, v198, v199
  v_mfma_f32_16x16x32_bf16 v[204:207], a[156:159], a[28:31], v[204:207]
  s_waitcnt lgkmcnt(4)
  v_mul_f32 v200, s36, v200
  v_mul_f32 v201, s36, v201
  v_mfma_f32_16x16x32_bf16 v[0:3], v[208:211], a[192:195], v[0:3]
  v_exp_f32 v200, v200
  v_mfma_f32_16x16x32_bf16 v[4:7], v[208:211], a[196:199], v[4:7]
  v_mul_f32 v202, s36, v202
  v_mul_f32 v203, s36, v203
  v_mfma_f32_16x16x32_bf16 v[8:11], v[208:211], a[200:203], v[8:11]
  v_exp_f32 v201, v201
  v_mfma_f32_16x16x32_bf16 v[12:15], v[208:211], a[204:207], v[12:15]
  ds_read_b128 a[112:115], v224 offset:36864
  ds_read_b128 a[116:119], v224 offset:37120
  v_mfma_f32_16x16x32_bf16 v[16:19], v[208:211], a[208:211], v[16:19]
  v_exp_f32 v202, v202
  v_mfma_f32_16x16x32_bf16 v[20:23], v[208:211], a[212:215], v[20:23]
  v_cvt_pk_bf16_f32 v212, v200, v201
  v_mul_f32 v204, s36, v204
  v_mfma_f32_16x16x32_bf16 v[24:27], v[208:211], a[216:219], v[24:27]
  v_exp_f32 v203, v203
  v_mfma_f32_16x16x32_bf16 v[28:31], v[208:211], a[220:223], v[28:31]
  v_mul_f32 v205, s36, v205
  v_mul_f32 v206, s36, v206
  v_mfma_f32_16x16x32_bf16 v[192:195], a[128:131], a[32:35], v[252:255]
  v_exp_f32 v204, v204
  v_mfma_f32_16x16x32_bf16 v[192:195], a[132:135], a[36:39], v[192:195]
  v_cvt_pk_bf16_f32 v213, v202, v203
  v_mul_f32 v207, s36, v207
  v_mfma_f32_16x16x32_bf16 v[192:195], a[136:139], a[40:43], v[192:195]
  v_exp_f32 v205, v205
  v_mfma_f32_16x16x32_bf16 v[192:195], a[140:143], a[44:47], v[192:195]
  v_exp_f32 v206, v206
  v_mfma_f32_16x16x32_bf16 v[196:199], a[144:147], a[32:35], v[252:255]
  ds_read_b128 a[120:123], v224 offset:37376
  ds_read_b128 a[124:127], v224 offset:37632
  v_mfma_f32_16x16x32_bf16 v[196:199], a[148:151], a[36:39], v[196:199]
  v_exp_f32 v207, v207
  v_mfma_f32_16x16x32_bf16 v[196:199], a[152:155], a[40:43], v[196:199]
  v_cvt_pk_bf16_f32 v214, v204, v205
  v_cvt_pk_bf16_f32 v215, v206, v207
  v_mfma_f32_16x16x32_bf16 v[196:199], a[156:159], a[44:47], v[196:199]
  buffer_store_dwordx4 v[216:219], v232, s[28:31], s42 offen offset:512 nt
  v_cmp_gt_u32 vcc, s58, v244
  v_smfmac_f32_16x16x64_bf16 a[224:227], a[248:251], v[208:215], v227
  v_mul_f32 v192, s36, v192
  v_mul_f32 v193, s36, v193
  v_mfma_f32_16x16x32_bf16 v[32:35], v[212:215], a[192:195], v[32:35]
  s_cbranch_vccnz L_s6_B5
L_r6_B5:
  v_exp_f32 v192, v192
  v_mfma_f32_16x16x32_bf16 v[36:39], v[212:215], a[196:199], v[36:39]
  s_add_u32 s58, s58, 1
  v_mul_f32 v194, s36, v194
  v_mul_f32 v195, s36, v195
  v_mfma_f32_16x16x32_bf16 v[40:43], v[212:215], a[200:203], v[40:43]
  v_exp_f32 v193, v193
  v_mfma_f32_16x16x32_bf16 v[44:47], v[212:215], a[204:207], v[44:47]
  ds_read_b64_tr_b16 a[160:161], v226 offset:40960
  ds_read_b64_tr_b16 a[162:163], v226 offset:45056
  v_mfma_f32_16x16x32_bf16 v[48:51], v[212:215], a[208:211], v[48:51]
  v_exp_f32 v194, v194
  v_mfma_f32_16x16x32_bf16 v[52:55], v[212:215], a[212:215], v[52:55]
  v_cvt_pk_bf16_f32 v208, v192, v193
  v_mul_f32 v196, s36, v196
  v_mfma_f32_16x16x32_bf16 v[56:59], v[212:215], a[216:219], v[56:59]
  v_exp_f32 v195, v195
  v_mfma_f32_16x16x32_bf16 v[60:63], v[212:215], a[220:223], v[60:63]
  v_mul_f32 v197, s36, v197
  v_mul_f32 v198, s36, v198
  v_mfma_f32_16x16x32_bf16 v[200:203], a[128:131], a[48:51], v[252:255]
  v_exp_f32 v196, v196
  v_mfma_f32_16x16x32_bf16 v[200:203], a[132:135], a[52:55], v[200:203]
  v_cvt_pk_bf16_f32 v209, v194, v195
  v_mul_f32 v199, s36, v199
  v_mfma_f32_16x16x32_bf16 v[200:203], a[136:139], a[56:59], v[200:203]
  v_exp_f32 v197, v197
  v_mfma_f32_16x16x32_bf16 v[200:203], a[140:143], a[60:63], v[200:203]
  v_exp_f32 v198, v198
  v_mfma_f32_16x16x32_bf16 v[204:207], a[144:147], a[48:51], v[252:255]
  ds_read_b64_tr_b16 a[164:165], v237 offset:40960
  ds_read_b64_tr_b16 a[166:167], v237 offset:45056
  v_mfma_f32_16x16x32_bf16 v[204:207], a[148:151], a[52:55], v[204:207]
  v_exp_f32 v199, v199
  v_mfma_f32_16x16x32_bf16 v[204:207], a[152:155], a[56:59], v[204:207]
  v_cvt_pk_bf16_f32 v210, v196, v197
  v_cvt_pk_bf16_f32 v211, v198, v199
  v_mfma_f32_16x16x32_bf16 v[204:207], a[156:159], a[60:63], v[204:207]
  v_mul_f32 v200, s36, v200
  v_mul_f32 v201, s36, v201
  v_mfma_f32_16x16x32_bf16 v[64:67], v[208:211], a[192:195], v[64:67]
  v_exp_f32 v200, v200
  v_mfma_f32_16x16x32_bf16 v[68:71], v[208:211], a[196:199], v[68:71]
  v_mul_f32 v202, s36, v202
  v_mul_f32 v203, s36, v203
  v_mfma_f32_16x16x32_bf16 v[72:75], v[208:211], a[200:203], v[72:75]
  v_exp_f32 v201, v201
  v_mfma_f32_16x16x32_bf16 v[76:79], v[208:211], a[204:207], v[76:79]
  ds_read_b64_tr_b16 a[168:169], v234 offset:40960
  ds_read_b64_tr_b16 a[170:171], v234 offset:45056
  v_mfma_f32_16x16x32_bf16 v[80:83], v[208:211], a[208:211], v[80:83]
  v_exp_f32 v202, v202
  v_mfma_f32_16x16x32_bf16 v[84:87], v[208:211], a[212:215], v[84:87]
  v_cvt_pk_bf16_f32 v212, v200, v201
  v_mul_f32 v204, s36, v204
  v_mfma_f32_16x16x32_bf16 v[88:91], v[208:211], a[216:219], v[88:91]
  v_exp_f32 v203, v203
  v_mfma_f32_16x16x32_bf16 v[92:95], v[208:211], a[220:223], v[92:95]
  v_mul_f32 v205, s36, v205
  v_mul_f32 v206, s36, v206
  v_mfma_f32_16x16x32_bf16 v[192:195], a[128:131], a[64:67], v[252:255]
  v_exp_f32 v204, v204
  v_mfma_f32_16x16x32_bf16 v[192:195], a[132:135], a[68:71], v[192:195]
  v_cvt_pk_bf16_f32 v213, v202, v203
  v_mul_f32 v207, s36, v207
  v_mfma_f32_16x16x32_bf16 v[192:195], a[136:139], a[72:75], v[192:195]
  v_exp_f32 v205, v205
  v_mfma_f32_16x16x32_bf16 v[192:195], a[140:143], a[76:79], v[192:195]
  v_exp_f32 v206, v206
  v_mfma_f32_16x16x32_bf16 v[196:199], a[144:147], a[64:67], v[252:255]
  ds_read_b64_tr_b16 a[172:173], v228 offset:40960
  ds_read_b64_tr_b16 a[174:175], v228 offset:45056
  v_mfma_f32_16x16x32_bf16 v[196:199], a[148:151], a[68:71], v[196:199]
  v_exp_f32 v207, v207
  v_mfma_f32_16x16x32_bf16 v[196:199], a[152:155], a[72:75], v[196:199]
  v_cvt_pk_bf16_f32 v214, v204, v205
  v_cvt_pk_bf16_f32 v215, v206, v207
  v_mfma_f32_16x16x32_bf16 v[196:199], a[156:159], a[76:79], v[196:199]
  buffer_store_dwordx4 v[220:223], v232, s[28:31], s42 offen offset:768 nt
  v_add_u32 v231, 0x2000, v231
  v_smfmac_f32_16x16x64_bf16 a[228:231], a[248:251], v[208:215], v227
  s_add_u32 s42, s42, 4096
  v_mul_f32 v192, s36, v192
  v_mul_f32 v193, s36, v193
  v_mfma_f32_16x16x32_bf16 v[96:99], v[212:215], a[192:195], v[96:99]
  v_exp_f32 v192, v192
  v_mfma_f32_16x16x32_bf16 v[100:103], v[212:215], a[196:199], v[100:103]
  v_mul_f32 v194, s36, v194
  v_mul_f32 v195, s36, v195
  v_mfma_f32_16x16x32_bf16 v[104:107], v[212:215], a[200:203], v[104:107]
  v_exp_f32 v193, v193
  v_mfma_f32_16x16x32_bf16 v[108:111], v[212:215], a[204:207], v[108:111]
  ds_read_b64_tr_b16 a[176:177], v226 offset:40968
  ds_read_b64_tr_b16 a[178:179], v226 offset:45064
  v_mfma_f32_16x16x32_bf16 v[112:115], v[212:215], a[208:211], v[112:115]
  v_exp_f32 v194, v194
  v_mfma_f32_16x16x32_bf16 v[116:119], v[212:215], a[212:215], v[116:119]
  v_cvt_pk_bf16_f32 v208, v192, v193
  v_mul_f32 v196, s36, v196
  v_mfma_f32_16x16x32_bf16 v[120:123], v[212:215], a[216:219], v[120:123]
  v_exp_f32 v195, v195
  v_mfma_f32_16x16x32_bf16 v[124:127], v[212:215], a[220:223], v[124:127]
  v_mul_f32 v197, s36, v197
  v_mul_f32 v198, s36, v198
  v_mfma_f32_16x16x32_bf16 v[200:203], a[128:131], a[80:83], v[252:255]
  v_exp_f32 v196, v196
  v_mfma_f32_16x16x32_bf16 v[200:203], a[132:135], a[84:87], v[200:203]
  v_cvt_pk_bf16_f32 v209, v194, v195
  v_mul_f32 v199, s36, v199
  v_mfma_f32_16x16x32_bf16 v[200:203], a[136:139], a[88:91], v[200:203]
  v_exp_f32 v197, v197
  v_mfma_f32_16x16x32_bf16 v[200:203], a[140:143], a[92:95], v[200:203]
  s_waitcnt lgkmcnt(10)
  v_exp_f32 v198, v198
  v_mfma_f32_16x16x32_bf16 v[204:207], a[144:147], a[80:83], v[252:255]
  ds_read_b64_tr_b16 a[180:181], v237 offset:40968
  ds_read_b64_tr_b16 a[182:183], v237 offset:45064
  v_mfma_f32_16x16x32_bf16 v[204:207], a[148:151], a[84:87], v[204:207]
  v_exp_f32 v199, v199
  v_mfma_f32_16x16x32_bf16 v[204:207], a[152:155], a[88:91], v[204:207]
  v_cvt_pk_bf16_f32 v210, v196, v197
  v_cvt_pk_bf16_f32 v211, v198, v199
  v_mfma_f32_16x16x32_bf16 v[204:207], a[156:159], a[92:95], v[204:207]
  v_mul_f32 v200, s36, v200
  v_mul_f32 v201, s36, v201
  v_mfma_f32_16x16x32_bf16 v[128:131], v[208:211], a[192:195], v[128:131]
  v_exp_f32 v200, v200
  v_mfma_f32_16x16x32_bf16 v[132:135], v[208:211], a[196:199], v[132:135]
  v_mul_f32 v202, s36, v202
  v_mul_f32 v203, s36, v203
  v_mfma_f32_16x16x32_bf16 v[136:139], v[208:211], a[200:203], v[136:139]
  s_add_u32 s44, s44, 1
  v_exp_f32 v201, v201
  v_mfma_f32_16x16x32_bf16 v[140:143], v[208:211], a[204:207], v[140:143]
  ds_read_b64_tr_b16 a[184:185], v234 offset:40968
  ds_read_b64_tr_b16 a[186:187], v234 offset:45064
  v_mfma_f32_16x16x32_bf16 v[144:147], v[208:211], a[208:211], v[144:147]
  v_exp_f32 v202, v202
  v_mfma_f32_16x16x32_bf16 v[148:151], v[208:211], a[212:215], v[148:151]
  v_cvt_pk_bf16_f32 v212, v200, v201
  v_mul_f32 v204, s36, v204
  v_mfma_f32_16x16x32_bf16 v[152:155], v[208:211], a[216:219], v[152:155]
  v_exp_f32 v203, v203
  v_mfma_f32_16x16x32_bf16 v[156:159], v[208:211], a[220:223], v[156:159]
  s_cmp_lt_u32 s44, 3
  v_mul_f32 v205, s36, v205
  v_mul_f32 v206, s36, v206
  s_cbranch_scc1 L_B6
L_E6:
  v_mfma_f32_16x16x32_bf16 v[192:195], a[96:99], a[0:3], v[252:255]
  v_exp_f32 v204, v204
  v_mfma_f32_16x16x32_bf16 v[192:195], a[100:103], a[4:7], v[192:195]
  v_cvt_pk_bf16_f32 v213, v202, v203
  v_mul_f32 v207, s36, v207
  v_mfma_f32_16x16x32_bf16 v[192:195], a[104:107], a[8:11], v[192:195]
  v_exp_f32 v205, v205
  v_mfma_f32_16x16x32_bf16 v[192:195], a[108:111], a[12:15], v[192:195]
  v_exp_f32 v206, v206
  v_mfma_f32_16x16x32_bf16 v[196:199], a[112:115], a[0:3], v[252:255]
  ds_read_b64_tr_b16 a[188:189], v228 offset:40968
  ds_read_b64_tr_b16 a[190:191], v228 offset:45064
  v_mfma_f32_16x16x32_bf16 v[196:199], a[116:119], a[4:7], v[196:199]
  v_exp_f32 v207, v207
  v_mfma_f32_16x16x32_bf16 v[196:199], a[120:123], a[8:11], v[196:199]
  v_cvt_pk_bf16_f32 v214, v204, v205
  v_cvt_pk_bf16_f32 v215, v206, v207
  v_mfma_f32_16x16x32_bf16 v[196:199], a[124:127], a[12:15], v[196:199]
  ds_add_rtn_u32 v244, v242, v243
  v_smfmac_f32_16x16x64_bf16 a[232:235], a[248:251], v[208:215], v227
  v_mul_f32 v192, s36, v192
  v_mul_f32 v193, s36, v193
  v_mfma_f32_16x16x32_bf16 v[160:163], v[212:215], a[192:195], v[160:163]
  v_exp_f32 v192, v192
  v_mfma_f32_16x16x32_bf16 v[164:167], v[212:215], a[196:199], v[164:167]
  v_mul_f32 v194, s36, v194
  v_mul_f32 v195, s36, v195
  v_mfma_f32_16x16x32_bf16 v[168:171], v[212:215], a[200:203], v[168:171]
  v_exp_f32 v193, v193
  v_mfma_f32_16x16x32_bf16 v[172:175], v[212:215], a[204:207], v[172:175]
  ds_read_b128 a[128:131], v224 offset:49152
  ds_read_b128 a[132:135], v224 offset:49408
  v_mfma_f32_16x16x32_bf16 v[176:179], v[212:215], a[208:211], v[176:179]
  v_exp_f32 v194, v194
  v_mfma_f32_16x16x32_bf16 v[180:183], v[212:215], a[212:215], v[180:183]
  v_cvt_pk_bf16_f32 v208, v192, v193
  v_mul_f32 v196, s36, v196
  v_mfma_f32_16x16x32_bf16 v[184:187], v[212:215], a[216:219], v[184:187]
  v_exp_f32 v195, v195
  v_mfma_f32_16x16x32_bf16 v[188:191], v[212:215], a[220:223], v[188:191]
  v_mul_f32 v197, s36, v197
  v_mul_f32 v198, s36, v198
  v_mfma_f32_16x16x32_bf16 v[200:203], a[96:99], a[16:19], v[252:255]
  v_exp_f32 v196, v196
  v_mfma_f32_16x16x32_bf16 v[200:203], a[100:103], a[20:23], v[200:203]
  v_cvt_pk_bf16_f32 v209, v194, v195
  v_mul_f32 v199, s36, v199
  v_mfma_f32_16x16x32_bf16 v[200:203], a[104:107], a[24:27], v[200:203]
  v_exp_f32 v197, v197
  v_mfma_f32_16x16x32_bf16 v[200:203], a[108:111], a[28:31], v[200:203]
  v_exp_f32 v198, v198
  v_mfma_f32_16x16x32_bf16 v[204:207], a[112:115], a[16:19], v[252:255]
  ds_read_b128 a[136:139], v224 offset:49664
  ds_read_b128 a[140:143], v224 offset:49920
  v_mfma_f32_16x16x32_bf16 v[204:207], a[116:119], a[20:23], v[204:207]
  v_exp_f32 v199, v199
  v_mfma_f32_16x16x32_bf16 v[204:207], a[120:123], a[24:27], v[204:207]
  v_cvt_pk_bf16_f32 v210, v196, v197
  v_cvt_pk_bf16_f32 v211, v198, v199
  v_mfma_f32_16x16x32_bf16 v[204:207], a[124:127], a[28:31], v[204:207]
  s_waitcnt lgkmcnt(4)
  v_mul_f32 v200, s36, v200
  v_mul_f32 v201, s36, v201
  v_mfma_f32_16x16x32_bf16 v[0:3], v[208:211], a[160:163], v[0:3]
  v_exp_f32 v200, v200
  v_mfma_f32_16x16x32_bf16 v[4:7], v[208:211], a[164:167], v[4:7]
  v_mul_f32 v202, s36, v202
  v_mul_f32 v203, s36, v203
  v_mfma_f32_16x16x32_bf16 v[8:11], v[208:211], a[168:171], v[8:11]
  v_exp_f32 v201, v201
  v_mfma_f32_16x16x32_bf16 v[12:15], v[208:211], a[172:175], v[12:15]
  ds_read_b128 a[144:147], v224 offset:53248
  ds_read_b128 a[148:151], v224 offset:53504
  v_mfma_f32_16x16x32_bf16 v[16:19], v[208:211], a[176:179], v[16:19]
  v_exp_f32 v202, v202
  v_mfma_f32_16x16x32_bf16 v[20:23], v[208:211], a[180:183], v[20:23]
  v_cvt_pk_bf16_f32 v212, v200, v201
  v_mul_f32 v204, s36, v204
  v_mfma_f32_16x16x32_bf16 v[24:27], v[208:211], a[184:187], v[24:27]
  v_exp_f32 v203, v203
  v_mfma_f32_16x16x32_bf16 v[28:31], v[208:211], a[188:191], v[28:31]
  v_mul_f32 v205, s36, v205
  v_mul_f32 v206, s36, v206
  v_mfma_f32_16x16x32_bf16 v[192:195], a[96:99], a[32:35], v[252:255]
  v_exp_f32 v204, v204
  v_mfma_f32_16x16x32_bf16 v[192:195], a[100:103], a[36:39], v[192:195]
  v_cvt_pk_bf16_f32 v213, v202, v203
  v_mul_f32 v207, s36, v207
  v_mfma_f32_16x16x32_bf16 v[192:195], a[104:107], a[40:43], v[192:195]
  v_exp_f32 v205, v205
  v_mfma_f32_16x16x32_bf16 v[192:195], a[108:111], a[44:47], v[192:195]
  v_exp_f32 v206, v206
  v_mfma_f32_16x16x32_bf16 v[196:199], a[112:115], a[32:35], v[252:255]
  ds_read_b128 a[152:155], v224 offset:53760
  ds_read_b128 a[156:159], v224 offset:54016
  v_mfma_f32_16x16x32_bf16 v[196:199], a[116:119], a[36:39], v[196:199]
  v_exp_f32 v207, v207
  v_mfma_f32_16x16x32_bf16 v[196:199], a[120:123], a[40:43], v[196:199]
  v_cvt_pk_bf16_f32 v214, v204, v205
  v_cvt_pk_bf16_f32 v215, v206, v207
  v_mfma_f32_16x16x32_bf16 v[196:199], a[124:127], a[44:47], v[196:199]
  v_cmp_gt_u32 vcc, s58, v244
  v_smfmac_f32_16x16x64_bf16 a[224:227], a[248:251], v[208:215], v227
  v_mul_f32 v192, s36, v192
  v_mul_f32 v193, s36, v193
  v_mfma_f32_16x16x32_bf16 v[32:35], v[212:215], a[160:163], v[32:35]
  s_cbranch_vccnz L_s6_1414
L_r6_1414:
  v_exp_f32 v192, v192
  v_mfma_f32_16x16x32_bf16 v[36:39], v[212:215], a[164:167], v[36:39]
  s_add_u32 s58, s58, 1
  v_mul_f32 v194, s36, v194
  v_mul_f32 v195, s36, v195
  v_mfma_f32_16x16x32_bf16 v[40:43], v[212:215], a[168:171], v[40:43]
  v_exp_f32 v193, v193
  v_mfma_f32_16x16x32_bf16 v[44:47], v[212:215], a[172:175], v[44:47]
  ds_read_b64_tr_b16 a[192:193], v226 offset:57344
  ds_read_b64_tr_b16 a[194:195], v226 offset:61440
  v_mfma_f32_16x16x32_bf16 v[48:51], v[212:215], a[176:179], v[48:51]
  v_exp_f32 v194, v194
  v_mfma_f32_16x16x32_bf16 v[52:55], v[212:215], a[180:183], v[52:55]
  v_cvt_pk_bf16_f32 v208, v192, v193
  v_mul_f32 v196, s36, v196
  v_mfma_f32_16x16x32_bf16 v[56:59], v[212:215], a[184:187], v[56:59]
  v_exp_f32 v195, v195
  v_mfma_f32_16x16x32_bf16 v[60:63], v[212:215], a[188:191], v[60:63]
  v_mul_f32 v197, s36, v197
  v_mul_f32 v198, s36, v198
  v_mfma_f32_16x16x32_bf16 v[200:203], a[96:99], a[48:51], v[252:255]
  v_exp_f32 v196, v196
  v_mfma_f32_16x16x32_bf16 v[200:203], a[100:103], a[52:55], v[200:203]
  v_cvt_pk_bf16_f32 v209, v194, v195
  v_mul_f32 v199, s36, v199
  v_mfma_f32_16x16x32_bf16 v[200:203], a[104:107], a[56:59], v[200:203]
  v_exp_f32 v197, v197
  v_mfma_f32_16x16x32_bf16 v[200:203], a[108:111], a[60:63], v[200:203]
  v_exp_f32 v198, v198
  v_mfma_f32_16x16x32_bf16 v[204:207], a[112:115], a[48:51], v[252:255]
  ds_read_b64_tr_b16 a[196:197], v237 offset:57344
  ds_read_b64_tr_b16 a[198:199], v237 offset:61440
  v_mfma_f32_16x16x32_bf16 v[204:207], a[116:119], a[52:55], v[204:207]
  v_exp_f32 v199, v199
  v_mfma_f32_16x16x32_bf16 v[204:207], a[120:123], a[56:59], v[204:207]
  v_cvt_pk_bf16_f32 v210, v196, v197
  v_cvt_pk_bf16_f32 v211, v198, v199
  v_mfma_f32_16x16x32_bf16 v[204:207], a[124:127], a[60:63], v[204:207]
  v_mul_f32 v200, s36, v200
  v_mul_f32 v201, s36, v201
  v_mfma_f32_16x16x32_bf16 v[64:67], v[208:211], a[160:163], v[64:67]
  v_exp_f32 v200, v200
  v_mfma_f32_16x16x32_bf16 v[68:71], v[208:211], a[164:167], v[68:71]
  v_mul_f32 v202, s36, v202
  v_mul_f32 v203, s36, v203
  v_mfma_f32_16x16x32_bf16 v[72:75], v[208:211], a[168:171], v[72:75]
  v_exp_f32 v201, v201
  v_mfma_f32_16x16x32_bf16 v[76:79], v[208:211], a[172:175], v[76:79]
  ds_read_b64_tr_b16 a[200:201], v234 offset:57344
  ds_read_b64_tr_b16 a[202:203], v234 offset:61440
  v_mfma_f32_16x16x32_bf16 v[80:83], v[208:211], a[176:179], v[80:83]
  v_exp_f32 v202, v202
  v_mfma_f32_16x16x32_bf16 v[84:87], v[208:211], a[180:183], v[84:87]
  v_cvt_pk_bf16_f32 v212, v200, v201
  v_mul_f32 v204, s36, v204
  v_mfma_f32_16x16x32_bf16 v[88:91], v[208:211], a[184:187], v[88:91]
  v_exp_f32 v203, v203
  v_mfma_f32_16x16x32_bf16 v[92:95], v[208:211], a[188:191], v[92:95]
  v_mul_f32 v205, s36, v205
  v_mul_f32 v206, s36, v206
  v_mfma_f32_16x16x32_bf16 v[192:195], a[96:99], a[64:67], v[252:255]
  v_exp_f32 v204, v204
  v_mfma_f32_16x16x32_bf16 v[192:195], a[100:103], a[68:71], v[192:195]
  v_cvt_pk_bf16_f32 v213, v202, v203
  v_mul_f32 v207, s36, v207
  v_mfma_f32_16x16x32_bf16 v[192:195], a[104:107], a[72:75], v[192:195]
  v_exp_f32 v205, v205
  v_mfma_f32_16x16x32_bf16 v[192:195], a[108:111], a[76:79], v[192:195]
  v_exp_f32 v206, v206
  v_mfma_f32_16x16x32_bf16 v[196:199], a[112:115], a[64:67], v[252:255]
  ds_read_b64_tr_b16 a[204:205], v228 offset:57344
  ds_read_b64_tr_b16 a[206:207], v228 offset:61440
  v_mfma_f32_16x16x32_bf16 v[196:199], a[116:119], a[68:71], v[196:199]
  v_exp_f32 v207, v207
  v_mfma_f32_16x16x32_bf16 v[196:199], a[120:123], a[72:75], v[196:199]
  v_cvt_pk_bf16_f32 v214, v204, v205
  v_cvt_pk_bf16_f32 v215, v206, v207
  v_mfma_f32_16x16x32_bf16 v[196:199], a[124:127], a[76:79], v[196:199]
  v_add_u32 v231, 0xffffa000, v231
  v_smfmac_f32_16x16x64_bf16 a[228:231], a[248:251], v[208:215], v227
  v_mul_f32 v192, s36, v192
  v_mul_f32 v193, s36, v193
  v_mfma_f32_16x16x32_bf16 v[96:99], v[212:215], a[160:163], v[96:99]
  v_exp_f32 v192, v192
  v_mfma_f32_16x16x32_bf16 v[100:103], v[212:215], a[164:167], v[100:103]
  v_mul_f32 v194, s36, v194
  v_mul_f32 v195, s36, v195
  v_mfma_f32_16x16x32_bf16 v[104:107], v[212:215], a[168:171], v[104:107]
  v_exp_f32 v193, v193
  v_mfma_f32_16x16x32_bf16 v[108:111], v[212:215], a[172:175], v[108:111]
  ds_read_b64_tr_b16 a[208:209], v226 offset:57352
  ds_read_b64_tr_b16 a[210:211], v226 offset:61448
  v_mfma_f32_16x16x32_bf16 v[112:115], v[212:215], a[176:179], v[112:115]
  v_exp_f32 v194, v194
  v_mfma_f32_16x16x32_bf16 v[116:119], v[212:215], a[180:183], v[116:119]
  v_cvt_pk_bf16_f32 v208, v192, v193
  v_mul_f32 v196, s36, v196
  v_mfma_f32_16x16x32_bf16 v[120:123], v[212:215], a[184:187], v[120:123]
  v_exp_f32 v195, v195
  v_mfma_f32_16x16x32_bf16 v[124:127], v[212:215], a[188:191], v[124:127]
  v_mul_f32 v197, s36, v197
  v_mul_f32 v198, s36, v198
  v_mfma_f32_16x16x32_bf16 v[200:203], a[96:99], a[80:83], v[252:255]
  v_exp_f32 v196, v196
  v_mfma_f32_16x16x32_bf16 v[200:203], a[100:103], a[84:87], v[200:203]
  v_cvt_pk_bf16_f32 v209, v194, v195
  v_mul_f32 v199, s36, v199
  v_mfma_f32_16x16x32_bf16 v[200:203], a[104:107], a[88:91], v[200:203]
  v_exp_f32 v197, v197
  v_mfma_f32_16x16x32_bf16 v[200:203], a[108:111], a[92:95], v[200:203]
  s_waitcnt lgkmcnt(10)
  v_exp_f32 v198, v198
  v_mfma_f32_16x16x32_bf16 v[204:207], a[112:115], a[80:83], v[252:255]
  ds_read_b64_tr_b16 a[212:213], v237 offset:57352
  ds_read_b64_tr_b16 a[214:215], v237 offset:61448
  v_mfma_f32_16x16x32_bf16 v[204:207], a[116:119], a[84:87], v[204:207]
  v_exp_f32 v199, v199
  v_mfma_f32_16x16x32_bf16 v[204:207], a[120:123], a[88:91], v[204:207]
  v_cvt_pk_bf16_f32 v210, v196, v197
  v_cvt_pk_bf16_f32 v211, v198, v199
  v_mfma_f32_16x16x32_bf16 v[204:207], a[124:127], a[92:95], v[204:207]
  v_mul_f32 v200, s36, v200
  v_mul_f32 v201, s36, v201
  v_mfma_f32_16x16x32_bf16 v[128:131], v[208:211], a[160:163], v[128:131]
  v_exp_f32 v200, v200
  v_mfma_f32_16x16x32_bf16 v[132:135], v[208:211], a[164:167], v[132:135]
  v_mul_f32 v202, s36, v202
  v_mul_f32 v203, s36, v203
  v_mfma_f32_16x16x32_bf16 v[136:139], v[208:211], a[168:171], v[136:139]
  s_add_u32 s45, s45, 1
  v_exp_f32 v201, v201
  v_mfma_f32_16x16x32_bf16 v[140:143], v[208:211], a[172:175], v[140:143]
  ds_read_b64_tr_b16 a[216:217], v234 offset:57352
  ds_read_b64_tr_b16 a[218:219], v234 offset:61448
  v_mfma_f32_16x16x32_bf16 v[144:147], v[208:211], a[176:179], v[144:147]
  v_exp_f32 v202, v202
  v_mfma_f32_16x16x32_bf16 v[148:151], v[208:211], a[180:183], v[148:151]
  v_cvt_pk_bf16_f32 v212, v200, v201
  v_mul_f32 v204, s36, v204
  v_mfma_f32_16x16x32_bf16 v[152:155], v[208:211], a[184:187], v[152:155]
  v_exp_f32 v203, v203
  v_mfma_f32_16x16x32_bf16 v[156:159], v[208:211], a[188:191], v[156:159]
  s_cmp_lt_u32 s45, 4
  v_mul_f32 v205, s36, v205
  v_mul_f32 v206, s36, v206
  s_cbranch_scc1 L_A6
  v_mfma_f32_16x16x32_bf16 v[192:195], a[128:131], a[0:3], v[252:255]
  s_add_u32 s42, s51, 565248
  v_exp_f32 v204, v204
  v_mfma_f32_16x16x32_bf16 v[192:195], a[132:135], a[4:7], v[192:195]
  s_add_u32 s30, s42, 24576
  v_cvt_pk_bf16_f32 v213, v202, v203
  v_mul_f32 v207, s36, v207
  v_mfma_f32_16x16x32_bf16 v[192:195], a[136:139], a[8:11], v[192:195]
  v_exp_f32 v205, v205
  v_mfma_f32_16x16x32_bf16 v[192:195], a[140:143], a[12:15], v[192:195]
  v_exp_f32 v206, v206
  v_mfma_f32_16x16x32_bf16 v[196:199], a[144:147], a[0:3], v[252:255]
  ds_read_b64_tr_b16 a[220:221], v228 offset:57352
  ds_read_b64_tr_b16 a[222:223], v228 offset:61448
  v_mfma_f32_16x16x32_bf16 v[196:199], a[148:151], a[4:7], v[196:199]
  v_exp_f32 v207, v207
  v_mfma_f32_16x16x32_bf16 v[196:199], a[152:155], a[8:11], v[196:199]
  s_waitcnt vmcnt(32)
  v_cvt_pk_bf16_f32 v214, v204, v205
  v_cvt_pk_bf16_f32 v215, v206, v207
  v_mfma_f32_16x16x32_bf16 v[196:199], a[156:159], a[12:15], v[196:199]
  s_nop 0
  v_smfmac_f32_16x16x64_bf16 a[232:235], a[248:251], v[208:215], v227
  v_mul_f32 v192, s36, v192
  v_mul_f32 v193, s36, v193
  v_mfma_f32_16x16x32_bf16 v[160:163], v[212:215], a[160:163], v[160:163]
  v_exp_f32 v192, v192
  v_mfma_f32_16x16x32_bf16 v[164:167], v[212:215], a[164:167], v[164:167]
  v_mul_f32 v194, s36, v194
  v_mul_f32 v195, s36, v195
  v_mfma_f32_16x16x32_bf16 v[168:171], v[212:215], a[168:171], v[168:171]
  v_exp_f32 v193, v193
  v_mfma_f32_16x16x32_bf16 v[172:175], v[212:215], a[172:175], v[172:175]
  v_accvgpr_read_b32 v216, a224
  v_accvgpr_read_b32 v218, a225
  v_mfma_f32_16x16x32_bf16 v[176:179], v[212:215], a[176:179], v[176:179]
  v_exp_f32 v194, v194
  v_mfma_f32_16x16x32_bf16 v[180:183], v[212:215], a[180:183], v[180:183]
  v_cvt_pk_bf16_f32 v208, v192, v193
  v_mul_f32 v196, s36, v196
  v_mfma_f32_16x16x32_bf16 v[184:187], v[212:215], a[184:187], v[184:187]
  v_exp_f32 v195, v195
  v_mfma_f32_16x16x32_bf16 v[188:191], v[212:215], a[188:191], v[188:191]
  v_mul_f32 v197, s36, v197
  v_mul_f32 v198, s36, v198
  v_mfma_f32_16x16x32_bf16 v[200:203], a[128:131], a[16:19], v[252:255]
  v_exp_f32 v196, v196
  v_mfma_f32_16x16x32_bf16 v[200:203], a[132:135], a[20:23], v[200:203]
  v_cvt_pk_bf16_f32 v209, v194, v195
  v_mul_f32 v199, s36, v199
  v_mfma_f32_16x16x32_bf16 v[200:203], a[136:139], a[24:27], v[200:203]
  v_exp_f32 v197, v197
  v_mfma_f32_16x16x32_bf16 v[200:203], a[140:143], a[28:31], v[200:203]
  v_exp_f32 v198, v198
  v_mfma_f32_16x16x32_bf16 v[204:207], a[144:147], a[16:19], v[252:255]
  v_mfma_f32_16x16x32_bf16 v[204:207], a[148:151], a[20:23], v[204:207]
  v_exp_f32 v199, v199
  v_mfma_f32_16x16x32_bf16 v[204:207], a[152:155], a[24:27], v[204:207]
  v_cvt_pk_bf16_f32 v210, v196, v197
  v_cvt_pk_bf16_f32 v211, v198, v199
  v_mfma_f32_16x16x32_bf16 v[204:207], a[156:159], a[28:31], v[204:207]
  s_waitcnt lgkmcnt(0)
  v_mfma_f32_16x16x32_bf16 v[216:219], a[248:251], v[208:211], v[216:219]
  v_mul_f32 v200, s36, v200
  v_mul_f32 v201, s36, v201
  v_mfma_f32_16x16x32_bf16 v[0:3], v[208:211], a[192:195], v[0:3]
  v_exp_f32 v200, v200
  v_mfma_f32_16x16x32_bf16 v[4:7], v[208:211], a[196:199], v[4:7]
  v_mul_f32 v202, s36, v202
  v_mul_f32 v203, s36, v203
  v_mfma_f32_16x16x32_bf16 v[8:11], v[208:211], a[200:203], v[8:11]
  v_exp_f32 v201, v201
  v_add_f32 v238, v216, v218
  v_rcp_f32 v216, v238
  v_add_u32 v238, 0xd5800000, v238
  ds_write_b32 v250, v216 offset:0
  ds_read_b128 v[216:219], v251 offset:0
  v_mfma_f32_16x16x32_bf16 v[12:15], v[208:211], a[204:207], v[12:15]
  v_accvgpr_read_b32 v220, a226
  v_accvgpr_read_b32 v222, a227
  v_mfma_f32_16x16x32_bf16 v[16:19], v[208:211], a[208:211], v[16:19]
  v_exp_f32 v202, v202
  v_mfma_f32_16x16x32_bf16 v[20:23], v[208:211], a[212:215], v[20:23]
  v_cvt_pk_bf16_f32 v212, v200, v201
  v_mul_f32 v204, s36, v204
  v_mfma_f32_16x16x32_bf16 v[24:27], v[208:211], a[216:219], v[24:27]
  v_exp_f32 v203, v203
  v_mfma_f32_16x16x32_bf16 v[28:31], v[208:211], a[220:223], v[28:31]
  v_mul_f32 v205, s36, v205
  v_mul_f32 v206, s36, v206
  v_mfma_f32_16x16x32_bf16 v[192:195], a[128:131], a[32:35], v[252:255]
  v_exp_f32 v204, v204
  v_mfma_f32_16x16x32_bf16 v[192:195], a[132:135], a[36:39], v[192:195]
  v_cvt_pk_bf16_f32 v213, v202, v203
  v_mul_f32 v207, s36, v207
  v_mfma_f32_16x16x32_bf16 v[192:195], a[136:139], a[40:43], v[192:195]
  v_exp_f32 v205, v205
  v_mfma_f32_16x16x32_bf16 v[192:195], a[140:143], a[44:47], v[192:195]
  v_exp_f32 v206, v206
  v_mfma_f32_16x16x32_bf16 v[196:199], a[144:147], a[32:35], v[252:255]
  s_waitcnt lgkmcnt(0)
  v_cmp_le_u32 vcc, 0x34000000, v238
  v_pk_mul_f32 v[0:1], v[0:1], v[216:217]
  v_pk_mul_f32 v[2:3], v[2:3], v[218:219]
  v_pk_mul_f32 v[4:5], v[4:5], v[216:217]
  v_pk_mul_f32 v[6:7], v[6:7], v[218:219]
  v_pk_mul_f32 v[8:9], v[8:9], v[216:217]
  v_pk_mul_f32 v[10:11], v[10:11], v[218:219]
  v_pk_mul_f32 v[12:13], v[12:13], v[216:217]
  v_pk_mul_f32 v[14:15], v[14:15], v[218:219]
  v_cvt_pk_bf16_f32 v0, v0, v4
  v_cvt_pk_bf16_f32 v4, v1, v5
  v_cvt_pk_bf16_f32 v1, v8, v12
  v_cvt_pk_bf16_f32 v5, v9, v13
  v_cvt_pk_bf16_f32 v8, v2, v6
  v_cvt_pk_bf16_f32 v12, v3, v7
  v_pk_mul_f32 v[16:17], v[16:17], v[216:217]
  v_pk_mul_f32 v[20:21], v[20:21], v[216:217]
  v_pk_mul_f32 v[24:25], v[24:25], v[216:217]
  v_pk_mul_f32 v[28:29], v[28:29], v[216:217]
  v_cvt_pk_bf16_f32 v2, v16, v20
  v_cvt_pk_bf16_f32 v3, v24, v28
  ds_write_b128 v233, v[0:3] offset:0
  v_cvt_pk_bf16_f32 v6, v17, v21
  v_cvt_pk_bf16_f32 v7, v25, v29
  v_cvt_pk_bf16_f32 v9, v10, v14
  v_cvt_pk_bf16_f32 v13, v11, v15
  v_pk_mul_f32 v[18:19], v[18:19], v[218:219]
  ds_write_b128 v233, v[4:7] offset:1024
  v_pk_mul_f32 v[22:23], v[22:23], v[218:219]
  v_pk_mul_f32 v[26:27], v[26:27], v[218:219]
  v_pk_mul_f32 v[30:31], v[30:31], v[218:219]
  v_cvt_pk_bf16_f32 v10, v18, v22
  v_cvt_pk_bf16_f32 v11, v26, v30
  v_cvt_pk_bf16_f32 v14, v19, v23
  v_cvt_pk_bf16_f32 v15, v27, v31
  v_mfma_f32_16x16x32_bf16 v[196:199], a[148:151], a[36:39], v[196:199]
  s_and_b32 vcc_lo, vcc_lo, 0xffff
  ds_read_b64_tr_b16 a[0:1], v231 offset:0
  ds_read_b64_tr_b16 a[2:3], v231 offset:8
  v_exp_f32 v207, v207
  v_mfma_f32_16x16x32_bf16 v[196:199], a[152:155], a[40:43], v[196:199]
  s_addc_u32 s46, s46, s46
  v_cvt_pk_bf16_f32 v214, v204, v205
  v_cvt_pk_bf16_f32 v215, v206, v207
  v_mfma_f32_16x16x32_bf16 v[196:199], a[156:159], a[44:47], v[196:199]
  ds_write_b128 v233, v[8:11] offset:2048
  v_mfma_f32_16x16x32_bf16 v[220:223], a[248:251], v[212:215], v[220:223]
  v_mul_f32 v192, s36, v192
  v_mul_f32 v193, s36, v193
  v_mfma_f32_16x16x32_bf16 v[32:35], v[212:215], a[192:195], v[32:35]
  ds_write_b128 v233, v[12:15] offset:3072
  ds_read_b64_tr_b16 a[4:5], v231 offset:1024
  ds_read_b64_tr_b16 a[6:7], v231 offset:1032
  v_exp_f32 v192, v192
  v_mfma_f32_16x16x32_bf16 v[36:39], v[212:215], a[196:199], v[36:39]
  s_waitcnt lgkmcnt(4)
  buffer_store_dwordx4 a[0:3], v232, s[28:31], s42 offen offset:0 nt
  v_mul_f32 v194, s36, v194
  v_mul_f32 v195, s36, v195
  v_mfma_f32_16x16x32_bf16 v[40:43], v[212:215], a[200:203], v[40:43]
  v_exp_f32 v193, v193
  v_add_f32 v239, v220, v222
  v_rcp_f32 v220, v239
  v_add_u32 v239, 0xd5800000, v239
  ds_write_b32 v250, v220 offset:4096
  ds_read_b128 v[220:223], v251 offset:4096
  v_mfma_f32_16x16x32_bf16 v[44:47], v[212:215], a[204:207], v[44:47]
  ds_read_b64_tr_b16 a[8:9], v231 offset:2048
  ds_read_b64_tr_b16 a[10:11], v231 offset:2056
  v_accvgpr_read_b32 v216, a228
  v_accvgpr_read_b32 v218, a229
  v_mfma_f32_16x16x32_bf16 v[48:51], v[212:215], a[208:211], v[48:51]
  s_waitcnt lgkmcnt(4)
  buffer_store_dwordx4 a[4:7], v232, s[28:31], s42 offen offset:256 nt
  v_exp_f32 v194, v194
  v_mfma_f32_16x16x32_bf16 v[52:55], v[212:215], a[212:215], v[52:55]
  ds_read_b64_tr_b16 a[12:13], v231 offset:3072
  ds_read_b64_tr_b16 a[14:15], v231 offset:3080
  v_cvt_pk_bf16_f32 v208, v192, v193
  v_mul_f32 v196, s36, v196
  v_mfma_f32_16x16x32_bf16 v[56:59], v[212:215], a[216:219], v[56:59]
  v_exp_f32 v195, v195
  v_mfma_f32_16x16x32_bf16 v[60:63], v[212:215], a[220:223], v[60:63]
  s_waitcnt lgkmcnt(2)
  buffer_store_dwordx4 a[8:11], v232, s[28:31], s42 offen offset:512 nt
  v_mul_f32 v197, s36, v197
  v_mul_f32 v198, s36, v198
  v_mfma_f32_16x16x32_bf16 v[200:203], a[128:131], a[48:51], v[252:255]
  v_exp_f32 v196, v196
  v_mfma_f32_16x16x32_bf16 v[200:203], a[132:135], a[52:55], v[200:203]
  v_cvt_pk_bf16_f32 v209, v194, v195
  v_mul_f32 v199, s36, v199
  v_mfma_f32_16x16x32_bf16 v[200:203], a[136:139], a[56:59], v[200:203]
  v_exp_f32 v197, v197
  v_mfma_f32_16x16x32_bf16 v[200:203], a[140:143], a[60:63], v[200:203]
  s_waitcnt lgkmcnt(0)
  buffer_store_dwordx4 a[12:15], v232, s[28:31], s42 offen offset:768 nt
  s_add_u32 s42, s42, 4096
  v_exp_f32 v198, v198
  v_mfma_f32_16x16x32_bf16 v[204:207], a[144:147], a[48:51], v[252:255]
  s_waitcnt lgkmcnt(4)
  v_cmp_le_u32 vcc, 0x34000000, v239
  v_pk_mul_f32 v[32:33], v[32:33], v[220:221]
  v_pk_mul_f32 v[36:37], v[36:37], v[220:221]
  v_pk_mul_f32 v[40:41], v[40:41], v[220:221]
  v_pk_mul_f32 v[44:45], v[44:45], v[220:221]
  v_pk_mul_f32 v[48:49], v[48:49], v[220:221]
  v_pk_mul_f32 v[52:53], v[52:53], v[220:221]
  v_pk_mul_f32 v[56:57], v[56:57], v[220:221]
  v_pk_mul_f32 v[60:61], v[60:61], v[220:221]
  v_cvt_pk_bf16_f32 v0, v32, v36
  v_cvt_pk_bf16_f32 v1, v40, v44
  v_cvt_pk_bf16_f32 v2, v48, v52
  v_cvt_pk_bf16_f32 v3, v56, v60
  ds_write_b128 v233, v[0:3] offset:4096
  v_cvt_pk_bf16_f32 v4, v33, v37
  v_cvt_pk_bf16_f32 v5, v41, v45
  v_cvt_pk_bf16_f32 v6, v49, v53
  v_cvt_pk_bf16_f32 v7, v57, v61
  v_pk_mul_f32 v[34:35], v[34:35], v[222:223]
  v_pk_mul_f32 v[38:39], v[38:39], v[222:223]
  v_pk_mul_f32 v[42:43], v[42:43], v[222:223]
  v_pk_mul_f32 v[46:47], v[46:47], v[222:223]
  ds_write_b128 v233, v[4:7] offset:5120
  v_pk_mul_f32 v[50:51], v[50:51], v[222:223]
  v_pk_mul_f32 v[54:55], v[54:55], v[222:223]
  v_pk_mul_f32 v[58:59], v[58:59], v[222:223]
  v_pk_mul_f32 v[62:63], v[62:63], v[222:223]
  v_cvt_pk_bf16_f32 v8, v34, v38
  v_cvt_pk_bf16_f32 v9, v42, v46
  v_cvt_pk_bf16_f32 v10, v50, v54
  v_cvt_pk_bf16_f32 v11, v58, v62
  ds_write_b128 v233, v[8:11] offset:6144
  v_cvt_pk_bf16_f32 v12, v35, v39
  v_cvt_pk_bf16_f32 v13, v43, v47
  v_cvt_pk_bf16_f32 v14, v51, v55
  v_cvt_pk_bf16_f32 v15, v59, v63
  v_mfma_f32_16x16x32_bf16 v[204:207], a[148:151], a[52:55], v[204:207]
  s_and_b32 vcc_lo, vcc_lo, 0xffff
  ds_read_b64_tr_b16 a[16:17], v231 offset:4096
  ds_read_b64_tr_b16 a[18:19], v231 offset:4104
  v_exp_f32 v199, v199
  v_mfma_f32_16x16x32_bf16 v[204:207], a[152:155], a[56:59], v[204:207]
  s_addc_u32 s46, s46, s46
  v_cvt_pk_bf16_f32 v210, v196, v197
  v_cvt_pk_bf16_f32 v211, v198, v199
  v_mfma_f32_16x16x32_bf16 v[204:207], a[156:159], a[60:63], v[204:207]
  ds_write_b128 v233, v[12:15] offset:7168
  v_mfma_f32_16x16x32_bf16 v[216:219], a[248:251], v[208:211], v[216:219]
  v_mul_f32 v200, s36, v200
  v_mul_f32 v201, s36, v201
  v_mfma_f32_16x16x32_bf16 v[64:67], v[208:211], a[192:195], v[64:67]
  ds_read_b64_tr_b16 a[20:21], v231 offset:5120
  ds_read_b64_tr_b16 a[22:23], v231 offset:5128
  v_exp_f32 v200, v200
  v_mfma_f32_16x16x32_bf16 v[68:71], v[208:211], a[196:199], v[68:71]
  s_waitcnt lgkmcnt(3)
  buffer_store_dwordx4 a[16:19], v232, s[28:31], s42 offen offset:0 nt
  v_mul_f32 v202, s36, v202
  v_mul_f32 v203, s36, v203
  v_mfma_f32_16x16x32_bf16 v[72:75], v[208:211], a[200:203], v[72:75]
  v_exp_f32 v201, v201
  v_add_f32 v238, v216, v218
  v_rcp_f32 v216, v238
  v_add_u32 v238, 0xd5800000, v238
  ds_write_b32 v250, v216 offset:8192
  ds_read_b128 v[216:219], v251 offset:8192
  v_mfma_f32_16x16x32_bf16 v[76:79], v[208:211], a[204:207], v[76:79]
  ds_read_b64_tr_b16 a[24:25], v231 offset:6144
  ds_read_b64_tr_b16 a[26:27], v231 offset:6152
  v_accvgpr_read_b32 v220, a230
  v_accvgpr_read_b32 v222, a231
  v_mfma_f32_16x16x32_bf16 v[80:83], v[208:211], a[208:211], v[80:83]
  s_waitcnt lgkmcnt(4)
  buffer_store_dwordx4 a[20:23], v232, s[28:31], s42 offen offset:256 nt
  v_exp_f32 v202, v202
  v_mfma_f32_16x16x32_bf16 v[84:87], v[208:211], a[212:215], v[84:87]
  ds_read_b64_tr_b16 a[28:29], v231 offset:7168
  ds_read_b64_tr_b16 a[30:31], v231 offset:7176
  v_cvt_pk_bf16_f32 v212, v200, v201
  v_mul_f32 v204, s36, v204
  v_mfma_f32_16x16x32_bf16 v[88:91], v[208:211], a[216:219], v[88:91]
  v_exp_f32 v203, v203
  v_mfma_f32_16x16x32_bf16 v[92:95], v[208:211], a[220:223], v[92:95]
  s_waitcnt lgkmcnt(2)
  buffer_store_dwordx4 a[24:27], v232, s[28:31], s42 offen offset:512 nt
  v_mul_f32 v205, s36, v205
  v_mul_f32 v206, s36, v206
  v_mfma_f32_16x16x32_bf16 v[192:195], a[128:131], a[64:67], v[252:255]
  v_exp_f32 v204, v204
  v_mfma_f32_16x16x32_bf16 v[192:195], a[132:135], a[68:71], v[192:195]
  v_cvt_pk_bf16_f32 v213, v202, v203
  v_mul_f32 v207, s36, v207
  v_mfma_f32_16x16x32_bf16 v[192:195], a[136:139], a[72:75], v[192:195]
  v_exp_f32 v205, v205
  v_mfma_f32_16x16x32_bf16 v[192:195], a[140:143], a[76:79], v[192:195]
  s_waitcnt lgkmcnt(0)
  buffer_store_dwordx4 a[28:31], v232, s[28:31], s42 offen offset:768 nt
  s_add_u32 s42, s42, 4096
  v_exp_f32 v206, v206
  v_mfma_f32_16x16x32_bf16 v[196:199], a[144:147], a[64:67], v[252:255]
  s_waitcnt lgkmcnt(4)
  v_cmp_le_u32 vcc, 0x34000000, v238
  v_pk_mul_f32 v[64:65], v[64:65], v[216:217]
  v_pk_mul_f32 v[68:69], v[68:69], v[216:217]
  v_pk_mul_f32 v[72:73], v[72:73], v[216:217]
  v_pk_mul_f32 v[76:77], v[76:77], v[216:217]
  v_pk_mul_f32 v[80:81], v[80:81], v[216:217]
  v_pk_mul_f32 v[84:85], v[84:85], v[216:217]
  v_pk_mul_f32 v[88:89], v[88:89], v[216:217]
  v_pk_mul_f32 v[92:93], v[92:93], v[216:217]
  v_cvt_pk_bf16_f32 v32, v64, v68
  v_cvt_pk_bf16_f32 v33, v72, v76
  v_cvt_pk_bf16_f32 v34, v80, v84
  v_cvt_pk_bf16_f32 v35, v88, v92
  ds_write_b128 v233, v[32:35] offset:8192
  v_cvt_pk_bf16_f32 v36, v65, v69
  v_cvt_pk_bf16_f32 v37, v73, v77
  v_cvt_pk_bf16_f32 v38, v81, v85
  v_cvt_pk_bf16_f32 v39, v89, v93
  v_pk_mul_f32 v[66:67], v[66:67], v[218:219]
  v_pk_mul_f32 v[70:71], v[70:71], v[218:219]
  v_pk_mul_f32 v[74:75], v[74:75], v[218:219]
  v_pk_mul_f32 v[78:79], v[78:79], v[218:219]
  ds_write_b128 v233, v[36:39] offset:9216
  v_pk_mul_f32 v[82:83], v[82:83], v[218:219]
  v_pk_mul_f32 v[86:87], v[86:87], v[218:219]
  v_pk_mul_f32 v[90:91], v[90:91], v[218:219]
  v_pk_mul_f32 v[94:95], v[94:95], v[218:219]
  v_cvt_pk_bf16_f32 v40, v66, v70
  v_cvt_pk_bf16_f32 v41, v74, v78
  v_cvt_pk_bf16_f32 v42, v82, v86
  v_cvt_pk_bf16_f32 v43, v90, v94
  ds_write_b128 v233, v[40:43] offset:10240
  v_cvt_pk_bf16_f32 v44, v67, v71
  v_cvt_pk_bf16_f32 v45, v75, v79
  v_cvt_pk_bf16_f32 v46, v83, v87
  v_cvt_pk_bf16_f32 v47, v91, v95
  v_mfma_f32_16x16x32_bf16 v[196:199], a[148:151], a[68:71], v[196:199]
  s_and_b32 vcc_lo, vcc_lo, 0xffff
  ds_read_b64_tr_b16 a[32:33], v231 offset:8192
  ds_read_b64_tr_b16 a[34:35], v231 offset:8200
  v_exp_f32 v207, v207
  v_mfma_f32_16x16x32_bf16 v[196:199], a[152:155], a[72:75], v[196:199]
  s_addc_u32 s46, s46, s46
  v_cvt_pk_bf16_f32 v214, v204, v205
  v_cvt_pk_bf16_f32 v215, v206, v207
  v_mfma_f32_16x16x32_bf16 v[196:199], a[156:159], a[76:79], v[196:199]
  ds_write_b128 v233, v[44:47] offset:11264
  v_mfma_f32_16x16x32_bf16 v[220:223], a[248:251], v[212:215], v[220:223]
  v_mul_f32 v192, s36, v192
  v_mul_f32 v193, s36, v193
  v_mfma_f32_16x16x32_bf16 v[96:99], v[212:215], a[192:195], v[96:99]
  ds_read_b64_tr_b16 a[36:37], v231 offset:9216
  ds_read_b64_tr_b16 a[38:39], v231 offset:9224
  v_exp_f32 v192, v192
  v_mfma_f32_16x16x32_bf16 v[100:103], v[212:215], a[196:199], v[100:103]
  s_waitcnt lgkmcnt(3)
  buffer_store_dwordx4 a[32:35], v232, s[28:31], s42 offen offset:0 nt
  v_mul_f32 v194, s36, v194
  v_mul_f32 v195, s36, v195
  v_mfma_f32_16x16x32_bf16 v[104:107], v[212:215], a[200:203], v[104:107]
  v_exp_f32 v193, v193
  v_add_f32 v239, v220, v222
  v_rcp_f32 v220, v239
  v_add_u32 v239, 0xd5800000, v239
  ds_write_b32 v250, v220 offset:12288
  ds_read_b128 v[220:223], v251 offset:12288
  v_mfma_f32_16x16x32_bf16 v[108:111], v[212:215], a[204:207], v[108:111]
  ds_read_b64_tr_b16 a[40:41], v231 offset:10240
  ds_read_b64_tr_b16 a[42:43], v231 offset:10248
  v_accvgpr_read_b32 v216, a232
  v_accvgpr_read_b32 v218, a233
  v_mfma_f32_16x16x32_bf16 v[112:115], v[212:215], a[208:211], v[112:115]
  s_waitcnt lgkmcnt(4)
  buffer_store_dwordx4 a[36:39], v232, s[28:31], s42 offen offset:256 nt
  v_exp_f32 v194, v194
  v_mfma_f32_16x16x32_bf16 v[116:119], v[212:215], a[212:215], v[116:119]
  ds_read_b64_tr_b16 a[44:45], v231 offset:11264
  ds_read_b64_tr_b16 a[46:47], v231 offset:11272
  v_cvt_pk_bf16_f32 v208, v192, v193
  v_mul_f32 v196, s36, v196
  v_mfma_f32_16x16x32_bf16 v[120:123], v[212:215], a[216:219], v[120:123]
  v_exp_f32 v195, v195
  v_mfma_f32_16x16x32_bf16 v[124:127], v[212:215], a[220:223], v[124:127]
  s_waitcnt lgkmcnt(2)
  buffer_store_dwordx4 a[40:43], v232, s[28:31], s42 offen offset:512 nt
  v_mul_f32 v197, s36, v197
  v_mul_f32 v198, s36, v198
  v_mfma_f32_16x16x32_bf16 v[200:203], a[128:131], a[80:83], v[252:255]
  v_exp_f32 v196, v196
  v_mfma_f32_16x16x32_bf16 v[200:203], a[132:135], a[84:87], v[200:203]
  v_cvt_pk_bf16_f32 v209, v194, v195
  v_mul_f32 v199, s36, v199
  v_mfma_f32_16x16x32_bf16 v[200:203], a[136:139], a[88:91], v[200:203]
  v_exp_f32 v197, v197
  v_mfma_f32_16x16x32_bf16 v[200:203], a[140:143], a[92:95], v[200:203]
  s_waitcnt lgkmcnt(0)
  buffer_store_dwordx4 a[44:47], v232, s[28:31], s42 offen offset:768 nt
  s_add_u32 s42, s42, 4096
  v_exp_f32 v198, v198
  v_mfma_f32_16x16x32_bf16 v[204:207], a[144:147], a[80:83], v[252:255]
  s_waitcnt lgkmcnt(4)
  v_cmp_le_u32 vcc, 0x34000000, v239
  v_pk_mul_f32 v[96:97], v[96:97], v[220:221]
  v_pk_mul_f32 v[100:101], v[100:101], v[220:221]
  v_pk_mul_f32 v[104:105], v[104:105], v[220:221]
  v_pk_mul_f32 v[108:109], v[108:109], v[220:221]
  v_pk_mul_f32 v[112:113], v[112:113], v[220:221]
  v_pk_mul_f32 v[116:117], v[116:117], v[220:221]
  v_pk_mul_f32 v[120:121], v[120:121], v[220:221]
  v_pk_mul_f32 v[124:125], v[124:125], v[220:221]
  v_cvt_pk_bf16_f32 v64, v96, v100
  v_cvt_pk_bf16_f32 v65, v104, v108
  v_cvt_pk_bf16_f32 v66, v112, v116
  v_cvt_pk_bf16_f32 v67, v120, v124
  ds_write_b128 v233, v[64:67] offset:12288
  v_cvt_pk_bf16_f32 v68, v97, v101
  v_cvt_pk_bf16_f32 v69, v105, v109
  v_cvt_pk_bf16_f32 v70, v113, v117
  v_cvt_pk_bf16_f32 v71, v121, v125
  v_pk_mul_f32 v[98:99], v[98:99], v[222:223]
  v_pk_mul_f32 v[102:103], v[102:103], v[222:223]
  v_pk_mul_f32 v[106:107], v[106:107], v[222:223]
  v_pk_mul_f32 v[110:111], v[110:111], v[222:223]
  ds_write_b128 v233, v[68:71] offset:13312
  v_pk_mul_f32 v[114:115], v[114:115], v[222:223]
  v_pk_mul_f32 v[118:119], v[118:119], v[222:223]
  v_pk_mul_f32 v[122:123], v[122:123], v[222:223]
  v_pk_mul_f32 v[126:127], v[126:127], v[222:223]
  v_cvt_pk_bf16_f32 v72, v98, v102
  v_cvt_pk_bf16_f32 v73, v106, v110
  v_cvt_pk_bf16_f32 v74, v114, v118
  v_cvt_pk_bf16_f32 v75, v122, v126
  ds_write_b128 v233, v[72:75] offset:14336
  v_cvt_pk_bf16_f32 v76, v99, v103
  v_cvt_pk_bf16_f32 v77, v107, v111
  v_cvt_pk_bf16_f32 v78, v115, v119
  v_cvt_pk_bf16_f32 v79, v123, v127
  v_mfma_f32_16x16x32_bf16 v[204:207], a[148:151], a[84:87], v[204:207]
  s_and_b32 vcc_lo, vcc_lo, 0xffff
  ds_read_b64_tr_b16 a[48:49], v231 offset:12288
  ds_read_b64_tr_b16 a[50:51], v231 offset:12296
  v_exp_f32 v199, v199
  v_mfma_f32_16x16x32_bf16 v[204:207], a[152:155], a[88:91], v[204:207]
  s_addc_u32 s46, s46, s46
  v_cvt_pk_bf16_f32 v210, v196, v197
  v_cvt_pk_bf16_f32 v211, v198, v199
  v_mfma_f32_16x16x32_bf16 v[204:207], a[156:159], a[92:95], v[204:207]
  ds_write_b128 v233, v[76:79] offset:15360
  v_mfma_f32_16x16x32_bf16 v[216:219], a[248:251], v[208:211], v[216:219]
  v_mul_f32 v200, s36, v200
  v_mul_f32 v201, s36, v201
  v_mfma_f32_16x16x32_bf16 v[128:131], v[208:211], a[192:195], v[128:131]
  ds_read_b64_tr_b16 a[52:53], v231 offset:13312
  ds_read_b64_tr_b16 a[54:55], v231 offset:13320
  v_exp_f32 v200, v200
  v_mfma_f32_16x16x32_bf16 v[132:135], v[208:211], a[196:199], v[132:135]
  s_waitcnt lgkmcnt(3)
  buffer_store_dwordx4 a[48:51], v232, s[28:31], s42 offen offset:0 nt
  v_mul_f32 v202, s36, v202
  v_mul_f32 v203, s36, v203
  v_mfma_f32_16x16x32_bf16 v[136:139], v[208:211], a[200:203], v[136:139]
  v_exp_f32 v201, v201
  v_add_f32 v238, v216, v218
  v_rcp_f32 v216, v238
  v_add_u32 v238, 0xd5800000, v238
  ds_write_b32 v250, v216 offset:16384
  ds_read_b128 v[216:219], v251 offset:16384
  v_mfma_f32_16x16x32_bf16 v[140:143], v[208:211], a[204:207], v[140:143]
  ds_read_b64_tr_b16 a[56:57], v231 offset:14336
  ds_read_b64_tr_b16 a[58:59], v231 offset:14344
  v_accvgpr_read_b32 v220, a234
  v_accvgpr_read_b32 v222, a235
  v_mfma_f32_16x16x32_bf16 v[144:147], v[208:211], a[208:211], v[144:147]
  s_waitcnt lgkmcnt(4)
  buffer_store_dwordx4 a[52:55], v232, s[28:31], s42 offen offset:256 nt
  v_exp_f32 v202, v202
  v_mfma_f32_16x16x32_bf16 v[148:151], v[208:211], a[212:215], v[148:151]
  ds_read_b64_tr_b16 a[60:61], v231 offset:15360
  ds_read_b64_tr_b16 a[62:63], v231 offset:15368
  v_cvt_pk_bf16_f32 v212, v200, v201
  v_mul_f32 v204, s36, v204
  v_mfma_f32_16x16x32_bf16 v[152:155], v[208:211], a[216:219], v[152:155]
  v_exp_f32 v203, v203
  v_mfma_f32_16x16x32_bf16 v[156:159], v[208:211], a[220:223], v[156:159]
  s_waitcnt lgkmcnt(2)
  buffer_store_dwordx4 a[56:59], v232, s[28:31], s42 offen offset:512 nt
  v_mul_f32 v205, s36, v205
  v_mul_f32 v206, s36, v206
  v_exp_f32 v204, v204
  s_waitcnt lgkmcnt(4)
  v_cmp_le_u32 vcc, 0x34000000, v238
  v_cvt_pk_bf16_f32 v213, v202, v203
  v_mul_f32 v207, s36, v207
  v_exp_f32 v205, v205
  v_pk_mul_f32 v[128:129], v[128:129], v[216:217]
  v_exp_f32 v206, v206
  v_pk_mul_f32 v[132:133], v[132:133], v[216:217]
  v_exp_f32 v207, v207
  v_pk_mul_f32 v[136:137], v[136:137], v[216:217]
  v_cvt_pk_bf16_f32 v214, v204, v205
  v_cvt_pk_bf16_f32 v215, v206, v207
  s_waitcnt lgkmcnt(0)
  buffer_store_dwordx4 a[60:63], v232, s[28:31], s42 offen offset:768 nt
  s_add_u32 s42, s42, 4096
  v_pk_mul_f32 v[140:141], v[140:141], v[216:217]
  v_pk_mul_f32 v[144:145], v[144:145], v[216:217]
  v_mfma_f32_16x16x32_bf16 v[220:223], a[248:251], v[212:215], v[220:223]
  s_and_b32 vcc_lo, vcc_lo, 0xffff
  s_addc_u32 s46, s46, s46
  v_pk_mul_f32 v[148:149], v[148:149], v[216:217]
  v_mfma_f32_16x16x32_bf16 v[160:163], v[212:215], a[192:195], v[160:163]
  v_pk_mul_f32 v[152:153], v[152:153], v[216:217]
  v_mfma_f32_16x16x32_bf16 v[164:167], v[212:215], a[196:199], v[164:167]
  v_pk_mul_f32 v[156:157], v[156:157], v[216:217]
  v_mfma_f32_16x16x32_bf16 v[168:171], v[212:215], a[200:203], v[168:171]
  v_cvt_pk_bf16_f32 v96, v128, v132
  v_mfma_f32_16x16x32_bf16 v[172:175], v[212:215], a[204:207], v[172:175]
  v_cvt_pk_bf16_f32 v97, v136, v140
  v_mfma_f32_16x16x32_bf16 v[176:179], v[212:215], a[208:211], v[176:179]
  v_cvt_pk_bf16_f32 v98, v144, v148
  v_mfma_f32_16x16x32_bf16 v[180:183], v[212:215], a[212:215], v[180:183]
  v_add_f32 v239, v220, v222
  v_rcp_f32 v220, v239
  v_add_u32 v239, 0xd5800000, v239
  ds_write_b32 v250, v220 offset:20480
  ds_read_b128 v[220:223], v251 offset:20480
  v_cvt_pk_bf16_f32 v99, v152, v156
  v_mfma_f32_16x16x32_bf16 v[184:187], v[212:215], a[216:219], v[184:187]
  ds_write_b128 v233, v[96:99] offset:16384
  v_mfma_f32_16x16x32_bf16 v[188:191], v[212:215], a[220:223], v[188:191]
  v_cvt_pk_bf16_f32 v100, v129, v133
  v_cvt_pk_bf16_f32 v101, v137, v141
  ds_read_b64_tr_b16 a[64:65], v231 offset:16384
  ds_read_b64_tr_b16 a[66:67], v231 offset:16392
  v_cvt_pk_bf16_f32 v102, v145, v149
  v_cvt_pk_bf16_f32 v103, v153, v157
  v_pk_mul_f32 v[130:131], v[130:131], v[218:219]
  v_pk_mul_f32 v[134:135], v[134:135], v[218:219]
  v_pk_mul_f32 v[138:139], v[138:139], v[218:219]
  v_pk_mul_f32 v[142:143], v[142:143], v[218:219]
  ds_write_b128 v233, v[100:103] offset:17408
  v_pk_mul_f32 v[146:147], v[146:147], v[218:219]
  s_waitcnt lgkmcnt(1)
  buffer_store_dwordx4 a[64:67], v232, s[28:31], s42 offen offset:0 nt
  v_pk_mul_f32 v[150:151], v[150:151], v[218:219]
  ds_read_b64_tr_b16 a[68:69], v231 offset:17408
  ds_read_b64_tr_b16 a[70:71], v231 offset:17416
  v_pk_mul_f32 v[154:155], v[154:155], v[218:219]
  v_pk_mul_f32 v[158:159], v[158:159], v[218:219]
  v_cvt_pk_bf16_f32 v104, v130, v134
  v_cvt_pk_bf16_f32 v105, v138, v142
  v_cvt_pk_bf16_f32 v106, v146, v150
  v_cvt_pk_bf16_f32 v107, v154, v158
  ds_write_b128 v233, v[104:107] offset:18432
  v_cvt_pk_bf16_f32 v108, v131, v135
  s_waitcnt lgkmcnt(1)
  buffer_store_dwordx4 a[68:71], v232, s[28:31], s42 offen offset:256 nt
  v_cvt_pk_bf16_f32 v109, v139, v143
  ds_read_b64_tr_b16 a[72:73], v231 offset:18432
  ds_read_b64_tr_b16 a[74:75], v231 offset:18440
  v_cvt_pk_bf16_f32 v110, v147, v151
  v_cvt_pk_bf16_f32 v111, v155, v159
  ds_write_b128 v233, v[108:111] offset:19456
  s_waitcnt lgkmcnt(10)
  v_cmp_le_u32 vcc, 0x34000000, v239
  ds_read_b64_tr_b16 a[76:77], v231 offset:19456
  ds_read_b64_tr_b16 a[78:79], v231 offset:19464
  v_pk_mul_f32 v[160:161], v[160:161], v[220:221]
  v_pk_mul_f32 v[164:165], v[164:165], v[220:221]
  v_pk_mul_f32 v[168:169], v[168:169], v[220:221]
  s_waitcnt lgkmcnt(3)
  buffer_store_dwordx4 a[72:75], v232, s[28:31], s42 offen offset:512 nt
  v_pk_mul_f32 v[172:173], v[172:173], v[220:221]
  v_pk_mul_f32 v[176:177], v[176:177], v[220:221]
  v_pk_mul_f32 v[180:181], v[180:181], v[220:221]
  s_and_b32 vcc_lo, vcc_lo, 0xffff
  s_addc_u32 s46, s46, s46
  v_pk_mul_f32 v[184:185], v[184:185], v[220:221]
  v_pk_mul_f32 v[188:189], v[188:189], v[220:221]
  s_waitcnt lgkmcnt(0)
  buffer_store_dwordx4 a[76:79], v232, s[28:31], s42 offen offset:768 nt
  s_add_u32 s42, s42, 4096
  v_cvt_pk_bf16_f32 v128, v160, v164
  v_cvt_pk_bf16_f32 v129, v168, v172
  v_cvt_pk_bf16_f32 v130, v176, v180
  v_cvt_pk_bf16_f32 v131, v184, v188
  ds_write_b128 v233, v[128:131] offset:20480
  v_cvt_pk_bf16_f32 v132, v161, v165
  v_cvt_pk_bf16_f32 v133, v169, v173
  ds_read_b64_tr_b16 a[80:81], v231 offset:20480
  ds_read_b64_tr_b16 a[82:83], v231 offset:20488
  v_cvt_pk_bf16_f32 v134, v177, v181
  v_cvt_pk_bf16_f32 v135, v185, v189
  v_pk_mul_f32 v[162:163], v[162:163], v[222:223]
  s_brev_b32 s46, s46
  s_lshr_b32 s46, s46, 8
  s_mov_b32 s56, 6
  v_pk_mul_f32 v[166:167], v[166:167], v[222:223]
  v_pk_mul_f32 v[170:171], v[170:171], v[222:223]
  v_pk_mul_f32 v[174:175], v[174:175], v[222:223]
  ds_write_b128 v233, v[132:135] offset:21504
  v_pk_mul_f32 v[178:179], v[178:179], v[222:223]
  s_waitcnt lgkmcnt(1)
  buffer_store_dwordx4 a[80:83], v232, s[28:31], s42 offen offset:0 nt
  v_pk_mul_f32 v[182:183], v[182:183], v[222:223]
  ds_read_b64_tr_b16 a[84:85], v231 offset:21504
  ds_read_b64_tr_b16 a[86:87], v231 offset:21512
  v_pk_mul_f32 v[186:187], v[186:187], v[222:223]
  v_pk_mul_f32 v[190:191], v[190:191], v[222:223]
  v_cvt_pk_bf16_f32 v136, v162, v166
  v_cvt_pk_bf16_f32 v137, v170, v174
  v_cvt_pk_bf16_f32 v138, v178, v182
  v_cvt_pk_bf16_f32 v139, v186, v190
  ds_write_b128 v233, v[136:139] offset:22528
  v_cvt_pk_bf16_f32 v140, v163, v167
  s_waitcnt lgkmcnt(1)
  buffer_store_dwordx4 a[84:87], v232, s[28:31], s42 offen offset:256 nt
  v_cvt_pk_bf16_f32 v141, v171, v175
  ds_read_b64_tr_b16 a[88:89], v231 offset:22528
  ds_read_b64_tr_b16 a[90:91], v231 offset:22536
  v_cvt_pk_bf16_f32 v142, v179, v183
  v_cvt_pk_bf16_f32 v143, v187, v191
  ds_write_b128 v233, v[140:143] offset:23552
  ds_read_b64_tr_b16 a[92:93], v231 offset:23552
  ds_read_b64_tr_b16 a[94:95], v231 offset:23560
  s_waitcnt lgkmcnt(3)
  buffer_store_dwordx4 a[88:91], v232, s[28:31], s42 offen offset:512 nt
  s_waitcnt lgkmcnt(0)
  buffer_store_dwordx4 a[92:95], v232, s[28:31], s42 offen offset:768 nt
  s_branch L_tail
.p2align 6
L_C6:
  v_mfma_f32_16x16x32_bf16 v[192:195], a[96:99], a[0:3], v[252:255]
  v_exp_f32 v204, v204
  v_mfma_f32_16x16x32_bf16 v[192:195], a[100:103], a[4:7], v[192:195]
  v_cvt_pk_bf16_f32 v213, v202, v203
  v_mul_f32 v207, s36, v207
  v_mfma_f32_16x16x32_bf16 v[192:195], a[104:107], a[8:11], v[192:195]
  v_exp_f32 v205, v205
  v_mfma_f32_16x16x32_bf16 v[192:195], a[108:111], a[12:15], v[192:195]
  v_exp_f32 v206, v206
  v_mfma_f32_16x16x32_bf16 v[196:199], a[112:115], a[0:3], v[252:255]
  ds_read_b64_tr_b16 a[188:189], v228 offset:40968
  ds_read_b64_tr_b16 a[190:191], v228 offset:45064
  v_mfma_f32_16x16x32_bf16 v[196:199], a[116:119], a[4:7], v[196:199]
  v_exp_f32 v207, v207
  v_mfma_f32_16x16x32_bf16 v[196:199], a[120:123], a[8:11], v[196:199]
  v_cvt_pk_bf16_f32 v214, v204, v205
  v_cvt_pk_bf16_f32 v215, v206, v207
  v_mfma_f32_16x16x32_bf16 v[196:199], a[124:127], a[12:15], v[196:199]
  ds_read_b64_tr_b16 v[216:217], v231 offset:0
  ds_read_b64_tr_b16 v[218:219], v231 offset:8
  ds_read_b64_tr_b16 v[220:221], v231 offset:1024
  ds_read_b64_tr_b16 v[222:223], v231 offset:1032
  ds_read_b64_tr_b16 a[244:245], v231 offset:2048
  ds_read_b64_tr_b16 a[246:247], v231 offset:2056
  ds_add_rtn_u32 v244, v242, v243
  v_smfmac_f32_16x16x64_bf16 a[232:235], a[248:251], v[208:215], v227
  v_mul_f32 v192, s36, v192
  v_mul_f32 v193, s36, v193
  v_mfma_f32_16x16x32_bf16 v[160:163], v[212:215], a[192:195], v[160:163]
  v_exp_f32 v192, v192
  v_mfma_f32_16x16x32_bf16 v[164:167], v[212:215], a[196:199], v[164:167]
  v_mul_f32 v194, s36, v194
  v_mul_f32 v195, s36, v195
  v_mfma_f32_16x16x32_bf16 v[168:171], v[212:215], a[200:203], v[168:171]
  v_exp_f32 v193, v193
  v_mfma_f32_16x16x32_bf16 v[172:175], v[212:215], a[204:207], v[172:175]
  ds_read_b128 a[128:131], v224 offset:49152
  ds_read_b128 a[132:135], v224 offset:49408
  v_mfma_f32_16x16x32_bf16 v[176:179], v[212:215], a[208:211], v[176:179]
  v_exp_f32 v194, v194
  v_mfma_f32_16x16x32_bf16 v[180:183], v[212:215], a[212:215], v[180:183]
  v_cvt_pk_bf16_f32 v208, v192, v193
  v_mul_f32 v196, s36, v196
  v_mfma_f32_16x16x32_bf16 v[184:187], v[212:215], a[216:219], v[184:187]
  v_exp_f32 v195, v195
  v_mfma_f32_16x16x32_bf16 v[188:191], v[212:215], a[220:223], v[188:191]
  v_mul_f32 v197, s36, v197
  v_mul_f32 v198, s36, v198
  v_mfma_f32_16x16x32_bf16 v[200:203], a[96:99], a[16:19], v[252:255]
  v_exp_f32 v196, v196
  v_mfma_f32_16x16x32_bf16 v[200:203], a[100:103], a[20:23], v[200:203]
  v_cvt_pk_bf16_f32 v209, v194, v195
  v_mul_f32 v199, s36, v199
  v_mfma_f32_16x16x32_bf16 v[200:203], a[104:107], a[24:27], v[200:203]
  v_exp_f32 v197, v197
  v_mfma_f32_16x16x32_bf16 v[200:203], a[108:111], a[28:31], v[200:203]
  v_exp_f32 v198, v198
  v_mfma_f32_16x16x32_bf16 v[204:207], a[112:115], a[16:19], v[252:255]
  ds_read_b128 a[136:139], v224 offset:49664
  ds_read_b128 a[140:143], v224 offset:49920
  v_mfma_f32_16x16x32_bf16 v[204:207], a[116:119], a[20:23], v[204:207]
  v_exp_f32 v199, v199
  v_mfma_f32_16x16x32_bf16 v[204:207], a[120:123], a[24:27], v[204:207]
  v_cvt_pk_bf16_f32 v210, v196, v197
  v_cvt_pk_bf16_f32 v211, v198, v199
  v_mfma_f32_16x16x32_bf16 v[204:207], a[124:127], a[28:31], v[204:207]
  s_waitcnt lgkmcnt(4)
  v_mul_f32 v200, s36, v200
  v_mul_f32 v201, s36, v201
  v_mfma_f32_16x16x32_bf16 v[0:3], v[208:211], a[160:163], v[0:3]
  v_exp_f32 v200, v200
  v_mfma_f32_16x16x32_bf16 v[4:7], v[208:211], a[164:167], v[4:7]
  v_mul_f32 v202, s36, v202
  v_mul_f32 v203, s36, v203
  v_mfma_f32_16x16x32_bf16 v[8:11], v[208:211], a[168:171], v[8:11]
  v_exp_f32 v201, v201
  v_mfma_f32_16x16x32_bf16 v[12:15], v[208:211], a[172:175], v[12:15]
  ds_read_b128 a[144:147], v224 offset:53248
  ds_read_b128 a[148:151], v224 offset:53504
  v_mfma_f32_16x16x32_bf16 v[16:19], v[208:211], a[176:179], v[16:19]
  v_exp_f32 v202, v202
  v_mfma_f32_16x16x32_bf16 v[20:23], v[208:211], a[180:183], v[20:23]
  v_cvt_pk_bf16_f32 v212, v200, v201
  v_mul_f32 v204, s36, v204
  v_mfma_f32_16x16x32_bf16 v[24:27], v[208:211], a[184:187], v[24:27]
  v_exp_f32 v203, v203
  v_mfma_f32_16x16x32_bf16 v[28:31], v[208:211], a[188:191], v[28:31]
  v_mul_f32 v205, s36, v205
  v_mul_f32 v206, s36, v206
  v_mfma_f32_16x16x32_bf16 v[192:195], a[96:99], a[32:35], v[252:255]
  v_exp_f32 v204, v204
  v_mfma_f32_16x16x32_bf16 v[192:195], a[100:103], a[36:39], v[192:195]
  v_cvt_pk_bf16_f32 v213, v202, v203
  v_mul_f32 v207, s36, v207
  v_mfma_f32_16x16x32_bf16 v[192:195], a[104:107], a[40:43], v[192:195]
  v_exp_f32 v205, v205
  v_mfma_f32_16x16x32_bf16 v[192:195], a[108:111], a[44:47], v[192:195]
  v_exp_f32 v206, v206
  v_mfma_f32_16x16x32_bf16 v[196:199], a[112:115], a[32:35], v[252:255]
  ds_read_b128 a[152:155], v224 offset:53760
  ds_read_b128 a[156:159], v224 offset:54016
  v_mfma_f32_16x16x32_bf16 v[196:199], a[116:119], a[36:39], v[196:199]
  v_exp_f32 v207, v207
  v_mfma_f32_16x16x32_bf16 v[196:199], a[120:123], a[40:43], v[196:199]
  v_cvt_pk_bf16_f32 v214, v204, v205
  v_cvt_pk_bf16_f32 v215, v206, v207
  v_mfma_f32_16x16x32_bf16 v[196:199], a[124:127], a[44:47], v[196:199]
  buffer_store_dwordx4 v[216:219], v232, s[28:31], s42 offen offset:0 nt
  v_cmp_gt_u32 vcc, s58, v244
  v_smfmac_f32_16x16x64_bf16 a[224:227], a[248:251], v[208:215], v227
  v_mul_f32 v192, s36, v192
  v_mul_f32 v193, s36, v193
  v_mfma_f32_16x16x32_bf16 v[32:35], v[212:215], a[160:163], v[32:35]
  s_cbranch_vccnz L_s6_C2
L_r6_C2:
  v_exp_f32 v192, v192
  v_mfma_f32_16x16x32_bf16 v[36:39], v[212:215], a[164:167], v[36:39]
  s_add_u32 s58, s58, 1
  v_mul_f32 v194, s36, v194
  v_mul_f32 v195, s36, v195
  v_mfma_f32_16x16x32_bf16 v[40:43], v[212:215], a[168:171], v[40:43]
  v_exp_f32 v193, v193
  v_mfma_f32_16x16x32_bf16 v[44:47], v[212:215], a[172:175], v[44:47]
  ds_read_b64_tr_b16 a[192:193], v226 offset:57344
  ds_read_b64_tr_b16 a[194:195], v226 offset:61440
  v_mfma_f32_16x16x32_bf16 v[48:51], v[212:215], a[176:179], v[48:51]
  v_exp_f32 v194, v194
  v_mfma_f32_16x16x32_bf16 v[52:55], v[212:215], a[180:183], v[52:55]
  v_cvt_pk_bf16_f32 v208, v192, v193
  v_mul_f32 v196, s36, v196
  v_mfma_f32_16x16x32_bf16 v[56:59], v[212:215], a[184:187], v[56:59]
  v_exp_f32 v195, v195
  v_mfma_f32_16x16x32_bf16 v[60:63], v[212:215], a[188:191], v[60:63]
  v_mul_f32 v197, s36, v197
  v_mul_f32 v198, s36, v198
  v_mfma_f32_16x16x32_bf16 v[200:203], a[96:99], a[48:51], v[252:255]
  v_exp_f32 v196, v196
  v_mfma_f32_16x16x32_bf16 v[200:203], a[100:103], a[52:55], v[200:203]
  v_cvt_pk_bf16_f32 v209, v194, v195
  v_mul_f32 v199, s36, v199
  v_mfma_f32_16x16x32_bf16 v[200:203], a[104:107], a[56:59], v[200:203]
  v_exp_f32 v197, v197
  v_mfma_f32_16x16x32_bf16 v[200:203], a[108:111], a[60:63], v[200:203]
  v_exp_f32 v198, v198
  v_mfma_f32_16x16x32_bf16 v[204:207], a[112:115], a[48:51], v[252:255]
  ds_read_b64_tr_b16 a[196:197], v237 offset:57344
  ds_read_b64_tr_b16 a[198:199], v237 offset:61440
  v_mfma_f32_16x16x32_bf16 v[204:207], a[116:119], a[52:55], v[204:207]
  v_exp_f32 v199, v199
  v_mfma_f32_16x16x32_bf16 v[204:207], a[120:123], a[56:59], v[204:207]
  v_cvt_pk_bf16_f32 v210, v196, v197
  v_cvt_pk_bf16_f32 v211, v198, v199
  v_mfma_f32_16x16x32_bf16 v[204:207], a[124:127], a[60:63], v[204:207]
  v_mul_f32 v200, s36, v200
  v_mul_f32 v201, s36, v201
  v_mfma_f32_16x16x32_bf16 v[64:67], v[208:211], a[160:163], v[64:67]
  v_exp_f32 v200, v200
  v_mfma_f32_16x16x32_bf16 v[68:71], v[208:211], a[164:167], v[68:71]
  v_mul_f32 v202, s36, v202
  v_mul_f32 v203, s36, v203
  v_mfma_f32_16x16x32_bf16 v[72:75], v[208:211], a[168:171], v[72:75]
  v_exp_f32 v201, v201
  v_mfma_f32_16x16x32_bf16 v[76:79], v[208:211], a[172:175], v[76:79]
  ds_read_b64_tr_b16 a[200:201], v234 offset:57344
  ds_read_b64_tr_b16 a[202:203], v234 offset:61440
  v_mfma_f32_16x16x32_bf16 v[80:83], v[208:211], a[176:179], v[80:83]
  v_exp_f32 v202, v202
  v_mfma_f32_16x16x32_bf16 v[84:87], v[208:211], a[180:183], v[84:87]
  v_cvt_pk_bf16_f32 v212, v200, v201
  v_mul_f32 v204, s36, v204
  v_mfma_f32_16x16x32_bf16 v[88:91], v[208:211], a[184:187], v[88:91]
  v_exp_f32 v203, v203
  v_mfma_f32_16x16x32_bf16 v[92:95], v[208:211], a[188:191], v[92:95]
  v_mul_f32 v205, s36, v205
  v_mul_f32 v206, s36, v206
  v_mfma_f32_16x16x32_bf16 v[192:195], a[96:99], a[64:67], v[252:255]
  v_exp_f32 v204, v204
  v_mfma_f32_16x16x32_bf16 v[192:195], a[100:103], a[68:71], v[192:195]
  v_cvt_pk_bf16_f32 v213, v202, v203
  v_mul_f32 v207, s36, v207
  v_mfma_f32_16x16x32_bf16 v[192:195], a[104:107], a[72:75], v[192:195]
  v_exp_f32 v205, v205
  v_mfma_f32_16x16x32_bf16 v[192:195], a[108:111], a[76:79], v[192:195]
  v_exp_f32 v206, v206
  v_mfma_f32_16x16x32_bf16 v[196:199], a[112:115], a[64:67], v[252:255]
  ds_read_b64_tr_b16 a[204:205], v228 offset:57344
  ds_read_b64_tr_b16 a[206:207], v228 offset:61440
  v_mfma_f32_16x16x32_bf16 v[196:199], a[116:119], a[68:71], v[196:199]
  v_exp_f32 v207, v207
  v_mfma_f32_16x16x32_bf16 v[196:199], a[120:123], a[72:75], v[196:199]
  v_cvt_pk_bf16_f32 v214, v204, v205
  v_cvt_pk_bf16_f32 v215, v206, v207
  v_mfma_f32_16x16x32_bf16 v[196:199], a[124:127], a[76:79], v[196:199]
  buffer_store_dwordx4 v[220:223], v232, s[28:31], s42 offen offset:256 nt
  v_smfmac_f32_16x16x64_bf16 a[228:231], a[248:251], v[208:215], v227
  v_mul_f32 v192, s36, v192
  v_mul_f32 v193, s36, v193
  v_mfma_f32_16x16x32_bf16 v[96:99], v[212:215], a[160:163], v[96:99]
  v_exp_f32 v192, v192
  v_mfma_f32_16x16x32_bf16 v[100:103], v[212:215], a[164:167], v[100:103]
  v_mul_f32 v194, s36, v194
  v_mul_f32 v195, s36, v195
  v_mfma_f32_16x16x32_bf16 v[104:107], v[212:215], a[168:171], v[104:107]
  v_exp_f32 v193, v193
  v_mfma_f32_16x16x32_bf16 v[108:111], v[212:215], a[172:175], v[108:111]
  ds_read_b64_tr_b16 a[208:209], v226 offset:57352
  ds_read_b64_tr_b16 a[210:211], v226 offset:61448
  v_mfma_f32_16x16x32_bf16 v[112:115], v[212:215], a[176:179], v[112:115]
  v_exp_f32 v194, v194
  v_mfma_f32_16x16x32_bf16 v[116:119], v[212:215], a[180:183], v[116:119]
  v_cvt_pk_bf16_f32 v208, v192, v193
  v_mul_f32 v196, s36, v196
  v_mfma_f32_16x16x32_bf16 v[120:123], v[212:215], a[184:187], v[120:123]
  v_exp_f32 v195, v195
  v_mfma_f32_16x16x32_bf16 v[124:127], v[212:215], a[188:191], v[124:127]
  v_mul_f32 v197, s36, v197
  v_mul_f32 v198, s36, v198
  v_mfma_f32_16x16x32_bf16 v[200:203], a[96:99], a[80:83], v[252:255]
  v_exp_f32 v196, v196
  v_mfma_f32_16x16x32_bf16 v[200:203], a[100:103], a[84:87], v[200:203]
  v_cvt_pk_bf16_f32 v209, v194, v195
  v_mul_f32 v199, s36, v199
  v_mfma_f32_16x16x32_bf16 v[200:203], a[104:107], a[88:91], v[200:203]
  v_exp_f32 v197, v197
  v_mfma_f32_16x16x32_bf16 v[200:203], a[108:111], a[92:95], v[200:203]
  s_waitcnt lgkmcnt(10)
  v_exp_f32 v198, v198
  v_mfma_f32_16x16x32_bf16 v[204:207], a[112:115], a[80:83], v[252:255]
  ds_read_b64_tr_b16 a[212:213], v237 offset:57352
  ds_read_b64_tr_b16 a[214:215], v237 offset:61448
  v_mfma_f32_16x16x32_bf16 v[204:207], a[116:119], a[84:87], v[204:207]
  v_exp_f32 v199, v199
  v_mfma_f32_16x16x32_bf16 v[204:207], a[120:123], a[88:91], v[204:207]
  v_cvt_pk_bf16_f32 v210, v196, v197
  v_cvt_pk_bf16_f32 v211, v198, v199
  v_mfma_f32_16x16x32_bf16 v[204:207], a[124:127], a[92:95], v[204:207]
  buffer_store_dwordx4 a[244:247], v232, s[28:31], s42 offen offset:512 nt
  v_mul_f32 v200, s36, v200
  v_mul_f32 v201, s36, v201
  v_mfma_f32_16x16x32_bf16 v[128:131], v[208:211], a[160:163], v[128:131]
  v_exp_f32 v200, v200
  v_mfma_f32_16x16x32_bf16 v[132:135], v[208:211], a[164:167], v[132:135]
  v_mul_f32 v202, s36, v202
  v_mul_f32 v203, s36, v203
  v_mfma_f32_16x16x32_bf16 v[136:139], v[208:211], a[168:171], v[136:139]
  v_exp_f32 v201, v201
  v_mfma_f32_16x16x32_bf16 v[140:143], v[208:211], a[172:175], v[140:143]
  ds_read_b64_tr_b16 a[216:217], v234 offset:57352
  ds_read_b64_tr_b16 a[218:219], v234 offset:61448
  v_mfma_f32_16x16x32_bf16 v[144:147], v[208:211], a[176:179], v[144:147]
  v_exp_f32 v202, v202
  v_mfma_f32_16x16x32_bf16 v[148:151], v[208:211], a[180:183], v[148:151]
  v_cvt_pk_bf16_f32 v212, v200, v201
  v_mul_f32 v204, s36, v204
  v_mfma_f32_16x16x32_bf16 v[152:155], v[208:211], a[184:187], v[152:155]
  v_exp_f32 v203, v203
  v_mfma_f32_16x16x32_bf16 v[156:159], v[208:211], a[188:191], v[156:159]
  v_mul_f32 v205, s36, v205
  v_mul_f32 v206, s36, v206
  v_mfma_f32_16x16x32_bf16 v[192:195], a[128:131], a[0:3], v[252:255]
  v_exp_f32 v204, v204
  v_mfma_f32_16x16x32_bf16 v[192:195], a[132:135], a[4:7], v[192:195]
  v_cvt_pk_bf16_f32 v213, v202, v203
  v_mul_f32 v207, s36, v207
  v_mfma_f32_16x16x32_bf16 v[192:195], a[136:139], a[8:11], v[192:195]
  v_exp_f32 v205, v205
  v_mfma_f32_16x16x32_bf16 v[192:195], a[140:143], a[12:15], v[192:195]
  v_exp_f32 v206, v206
  v_mfma_f32_16x16x32_bf16 v[196:199], a[144:147], a[0:3], v[252:255]
  ds_read_b64_tr_b16 a[220:221], v228 offset:57352
  ds_read_b64_tr_b16 a[222:223], v228 offset:61448
  v_mfma_f32_16x16x32_bf16 v[196:199], a[148:151], a[4:7], v[196:199]
  v_exp_f32 v207, v207
  v_mfma_f32_16x16x32_bf16 v[196:199], a[152:155], a[8:11], v[196:199]
  v_cvt_pk_bf16_f32 v214, v204, v205
  v_cvt_pk_bf16_f32 v215, v206, v207
  v_mfma_f32_16x16x32_bf16 v[196:199], a[156:159], a[12:15], v[196:199]
  ds_read_b64_tr_b16 v[216:217], v231 offset:3072
  ds_read_b64_tr_b16 v[218:219], v231 offset:3080
  ds_read_b64_tr_b16 v[220:221], v231 offset:4096
  ds_read_b64_tr_b16 v[222:223], v231 offset:4104
  ds_read_b64_tr_b16 a[244:245], v231 offset:5120
  ds_read_b64_tr_b16 a[246:247], v231 offset:5128
  ds_add_rtn_u32 v244, v242, v243
  v_smfmac_f32_16x16x64_bf16 a[232:235], a[248:251], v[208:215], v227
  v_mul_f32 v192, s36, v192
  v_mul_f32 v193, s36, v193
  v_mfma_f32_16x16x32_bf16 v[160:163], v[212:215], a[160:163], v[160:163]
  v_exp_f32 v192, v192
  v_mfma_f32_16x16x32_bf16 v[164:167], v[212:215], a[164:167], v[164:167]
  v_mul_f32 v194, s36, v194
  v_mul_f32 v195, s36, v195
  v_mfma_f32_16x16x32_bf16 v[168:171], v[212:215], a[168:171], v[168:171]
  v_exp_f32 v193, v193
  v_mfma_f32_16x16x32_bf16 v[172:175], v[212:215], a[172:175], v[172:175]
  ds_read_b128 a[96:99], v224 offset:0
  ds_read_b128 a[100:103], v224 offset:256
  v_mfma_f32_16x16x32_bf16 v[176:179], v[212:215], a[176:179], v[176:179]
  v_exp_f32 v194, v194
  v_mfma_f32_16x16x32_bf16 v[180:183], v[212:215], a[180:183], v[180:183]
  v_cvt_pk_bf16_f32 v208, v192, v193
  v_mul_f32 v196, s36, v196
  v_mfma_f32_16x16x32_bf16 v[184:187], v[212:215], a[184:187], v[184:187]
  v_exp_f32 v195, v195
  v_mfma_f32_16x16x32_bf16 v[188:191], v[212:215], a[188:191], v[188:191]
  v_mul_f32 v197, s36, v197
  v_mul_f32 v198, s36, v198
  v_mfma_f32_16x16x32_bf16 v[200:203], a[128:131], a[16:19], v[252:255]
  v_exp_f32 v196, v196
  v_mfma_f32_16x16x32_bf16 v[200:203], a[132:135], a[20:23], v[200:203]
  v_cvt_pk_bf16_f32 v209, v194, v195
  v_mul_f32 v199, s36, v199
  v_mfma_f32_16x16x32_bf16 v[200:203], a[136:139], a[24:27], v[200:203]
  v_exp_f32 v197, v197
  v_mfma_f32_16x16x32_bf16 v[200:203], a[140:143], a[28:31], v[200:203]
  v_exp_f32 v198, v198
  v_mfma_f32_16x16x32_bf16 v[204:207], a[144:147], a[16:19], v[252:255]
  ds_read_b128 a[104:107], v224 offset:512
  ds_read_b128 a[108:111], v224 offset:768
  v_mfma_f32_16x16x32_bf16 v[204:207], a[148:151], a[20:23], v[204:207]
  v_exp_f32 v199, v199
  v_mfma_f32_16x16x32_bf16 v[204:207], a[152:155], a[24:27], v[204:207]
  v_cvt_pk_bf16_f32 v210, v196, v197
  v_cvt_pk_bf16_f32 v211, v198, v199
  v_mfma_f32_16x16x32_bf16 v[204:207], a[156:159], a[28:31], v[204:207]
  s_waitcnt lgkmcnt(4)
  v_mul_f32 v200, s36, v200
  v_mul_f32 v201, s36, v201
  v_mfma_f32_16x16x32_bf16 v[0:3], v[208:211], a[192:195], v[0:3]
  v_exp_f32 v200, v200
  v_mfma_f32_16x16x32_bf16 v[4:7], v[208:211], a[196:199], v[4:7]
  v_mul_f32 v202, s36, v202
  v_mul_f32 v203, s36, v203
  v_mfma_f32_16x16x32_bf16 v[8:11], v[208:211], a[200:203], v[8:11]
  v_exp_f32 v201, v201
  v_mfma_f32_16x16x32_bf16 v[12:15], v[208:211], a[204:207], v[12:15]
  ds_read_b128 a[112:115], v224 offset:4096
  ds_read_b128 a[116:119], v224 offset:4352
  v_mfma_f32_16x16x32_bf16 v[16:19], v[208:211], a[208:211], v[16:19]
  v_exp_f32 v202, v202
  v_mfma_f32_16x16x32_bf16 v[20:23], v[208:211], a[212:215], v[20:23]
  v_cvt_pk_bf16_f32 v212, v200, v201
  v_mul_f32 v204, s36, v204
  v_mfma_f32_16x16x32_bf16 v[24:27], v[208:211], a[216:219], v[24:27]
  v_exp_f32 v203, v203
  v_mfma_f32_16x16x32_bf16 v[28:31], v[208:211], a[220:223], v[28:31]
  v_mul_f32 v205, s36, v205
  v_mul_f32 v206, s36, v206
  v_mfma_f32_16x16x32_bf16 v[192:195], a[128:131], a[32:35], v[252:255]
  v_exp_f32 v204, v204
  v_mfma_f32_16x16x32_bf16 v[192:195], a[132:135], a[36:39], v[192:195]
  v_cvt_pk_bf16_f32 v213, v202, v203
  v_mul_f32 v207, s36, v207
  v_mfma_f32_16x16x32_bf16 v[192:195], a[136:139], a[40:43], v[192:195]
  v_exp_f32 v205, v205
  v_mfma_f32_16x16x32_bf16 v[192:195], a[140:143], a[44:47], v[192:195]
  v_exp_f32 v206, v206
  v_mfma_f32_16x16x32_bf16 v[196:199], a[144:147], a[32:35], v[252:255]
  ds_read_b128 a[120:123], v224 offset:4608
  ds_read_b128 a[124:127], v224 offset:4864
  v_mfma_f32_16x16x32_bf16 v[196:199], a[148:151], a[36:39], v[196:199]
  v_exp_f32 v207, v207
  v_mfma_f32_16x16x32_bf16 v[196:199], a[152:155], a[40:43], v[196:199]
  v_cvt_pk_bf16_f32 v214, v204, v205
  v_cvt_pk_bf16_f32 v215, v206, v207
  v_mfma_f32_16x16x32_bf16 v[196:199], a[156:159], a[44:47], v[196:199]
  buffer_store_dwordx4 v[216:219], v232, s[28:31], s42 offen offset:768 nt
  v_cmp_gt_u32 vcc, s58, v244
  v_smfmac_f32_16x16x64_bf16 a[224:227], a[248:251], v[208:215], v227
  s_add_u32 s42, s42, 4096
  v_mul_f32 v192, s36, v192
  v_mul_f32 v193, s36, v193
  v_mfma_f32_16x16x32_bf16 v[32:35], v[212:215], a[192:195], v[32:35]
  s_cbranch_vccnz L_s6_C3
L_r6_C3:
  v_exp_f32 v192, v192
  v_mfma_f32_16x16x32_bf16 v[36:39], v[212:215], a[196:199], v[36:39]
  s_add_u32 s58, s58, 1
  v_mul_f32 v194, s36, v194
  v_mul_f32 v195, s36, v195
  v_mfma_f32_16x16x32_bf16 v[40:43], v[212:215], a[200:203], v[40:43]
  v_exp_f32 v193, v193
  v_mfma_f32_16x16x32_bf16 v[44:47], v[212:215], a[204:207], v[44:47]
  ds_read_b64_tr_b16 a[160:161], v226 offset:8192
  ds_read_b64_tr_b16 a[162:163], v226 offset:12288
  v_mfma_f32_16x16x32_bf16 v[48:51], v[212:215], a[208:211], v[48:51]
  v_exp_f32 v194, v194
  v_mfma_f32_16x16x32_bf16 v[52:55], v[212:215], a[212:215], v[52:55]
  v_cvt_pk_bf16_f32 v208, v192, v193
  v_mul_f32 v196, s36, v196
  v_mfma_f32_16x16x32_bf16 v[56:59], v[212:215], a[216:219], v[56:59]
  v_exp_f32 v195, v195
  v_mfma_f32_16x16x32_bf16 v[60:63], v[212:215], a[220:223], v[60:63]
  v_mul_f32 v197, s36, v197
  v_mul_f32 v198, s36, v198
  v_mfma_f32_16x16x32_bf16 v[200:203], a[128:131], a[48:51], v[252:255]
  v_exp_f32 v196, v196
  v_mfma_f32_16x16x32_bf16 v[200:203], a[132:135], a[52:55], v[200:203]
  v_cvt_pk_bf16_f32 v209, v194, v195
  v_mul_f32 v199, s36, v199
  v_mfma_f32_16x16x32_bf16 v[200:203], a[136:139], a[56:59], v[200:203]
  v_exp_f32 v197, v197
  v_mfma_f32_16x16x32_bf16 v[200:203], a[140:143], a[60:63], v[200:203]
  v_exp_f32 v198, v198
  v_mfma_f32_16x16x32_bf16 v[204:207], a[144:147], a[48:51], v[252:255]
  ds_read_b64_tr_b16 a[164:165], v237 offset:8192
  ds_read_b64_tr_b16 a[166:167], v237 offset:12288
  v_mfma_f32_16x16x32_bf16 v[204:207], a[148:151], a[52:55], v[204:207]
  v_exp_f32 v199, v199
  v_mfma_f32_16x16x32_bf16 v[204:207], a[152:155], a[56:59], v[204:207]
  v_cvt_pk_bf16_f32 v210, v196, v197
  v_cvt_pk_bf16_f32 v211, v198, v199
  v_mfma_f32_16x16x32_bf16 v[204:207], a[156:159], a[60:63], v[204:207]
  v_mul_f32 v200, s36, v200
  v_mul_f32 v201, s36, v201
  v_mfma_f32_16x16x32_bf16 v[64:67], v[208:211], a[192:195], v[64:67]
  v_exp_f32 v200, v200
  v_mfma_f32_16x16x32_bf16 v[68:71], v[208:211], a[196:199], v[68:71]
  v_mul_f32 v202, s36, v202
  v_mul_f32 v203, s36, v203
  v_mfma_f32_16x16x32_bf16 v[72:75], v[208:211], a[200:203], v[72:75]
  v_exp_f32 v201, v201
  v_mfma_f32_16x16x32_bf16 v[76:79], v[208:211], a[204:207], v[76:79]
  ds_read_b64_tr_b16 a[168:169], v234 offset:8192
  ds_read_b64_tr_b16 a[170:171], v234 offset:12288
  v_mfma_f32_16x16x32_bf16 v[80:83], v[208:211], a[208:211], v[80:83]
  v_exp_f32 v202, v202
  v_mfma_f32_16x16x32_bf16 v[84:87], v[208:211], a[212:215], v[84:87]
  v_cvt_pk_bf16_f32 v212, v200, v201
  v_mul_f32 v204, s36, v204
  v_mfma_f32_16x16x32_bf16 v[88:91], v[208:211], a[216:219], v[88:91]
  v_exp_f32 v203, v203
  v_mfma_f32_16x16x32_bf16 v[92:95], v[208:211], a[220:223], v[92:95]
  v_mul_f32 v205, s36, v205
  v_mul_f32 v206, s36, v206
  v_mfma_f32_16x16x32_bf16 v[192:195], a[128:131], a[64:67], v[252:255]
  v_exp_f32 v204, v204
  v_mfma_f32_16x16x32_bf16 v[192:195], a[132:135], a[68:71], v[192:195]
  v_cvt_pk_bf16_f32 v213, v202, v203
  v_mul_f32 v207, s36, v207
  v_mfma_f32_16x16x32_bf16 v[192:195], a[136:139], a[72:75], v[192:195]
  v_exp_f32 v205, v205
  v_mfma_f32_16x16x32_bf16 v[192:195], a[140:143], a[76:79], v[192:195]
  v_exp_f32 v206, v206
  v_mfma_f32_16x16x32_bf16 v[196:199], a[144:147], a[64:67], v[252:255]
  ds_read_b64_tr_b16 a[172:173], v228 offset:8192
  ds_read_b64_tr_b16 a[174:175], v228 offset:12288
  v_mfma_f32_16x16x32_bf16 v[196:199], a[148:151], a[68:71], v[196:199]
  v_exp_f32 v207, v207
  v_mfma_f32_16x16x32_bf16 v[196:199], a[152:155], a[72:75], v[196:199]
  v_cvt_pk_bf16_f32 v214, v204, v205
  v_cvt_pk_bf16_f32 v215, v206, v207
  v_mfma_f32_16x16x32_bf16 v[196:199], a[156:159], a[76:79], v[196:199]
  buffer_store_dwordx4 v[220:223], v232, s[28:31], s42 offen offset:0 nt
  v_smfmac_f32_16x16x64_bf16 a[228:231], a[248:251], v[208:215], v227
  v_mul_f32 v192, s36, v192
  v_mul_f32 v193, s36, v193
  v_mfma_f32_16x16x32_bf16 v[96:99], v[212:215], a[192:195], v[96:99]
  v_exp_f32 v192, v192
  v_mfma_f32_16x16x32_bf16 v[100:103], v[212:215], a[196:199], v[100:103]
  v_mul_f32 v194, s36, v194
  v_mul_f32 v195, s36, v195
  v_mfma_f32_16x16x32_bf16 v[104:107], v[212:215], a[200:203], v[104:107]
  v_exp_f32 v193, v193
  v_mfma_f32_16x16x32_bf16 v[108:111], v[212:215], a[204:207], v[108:111]
  ds_read_b64_tr_b16 a[176:177], v226 offset:8200
  ds_read_b64_tr_b16 a[178:179], v226 offset:12296
  v_mfma_f32_16x16x32_bf16 v[112:115], v[212:215], a[208:211], v[112:115]
  v_exp_f32 v194, v194
  v_mfma_f32_16x16x32_bf16 v[116:119], v[212:215], a[212:215], v[116:119]
  v_cvt_pk_bf16_f32 v208, v192, v193
  v_mul_f32 v196, s36, v196
  v_mfma_f32_16x16x32_bf16 v[120:123], v[212:215], a[216:219], v[120:123]
  v_exp_f32 v195, v195
  v_mfma_f32_16x16x32_bf16 v[124:127], v[212:215], a[220:223], v[124:127]
  v_mul_f32 v197, s36, v197
  v_mul_f32 v198, s36, v198
  v_mfma_f32_16x16x32_bf16 v[200:203], a[128:131], a[80:83], v[252:255]
  v_exp_f32 v196, v196
  v_mfma_f32_16x16x32_bf16 v[200:203], a[132:135], a[84:87], v[200:203]
  v_cvt_pk_bf16_f32 v209, v194, v195
  v_mul_f32 v199, s36, v199
  v_mfma_f32_16x16x32_bf16 v[200:203], a[136:139], a[88:91], v[200:203]
  v_exp_f32 v197, v197
  v_mfma_f32_16x16x32_bf16 v[200:203], a[140:143], a[92:95], v[200:203]
  s_waitcnt lgkmcnt(10)
  v_exp_f32 v198, v198
  v_mfma_f32_16x16x32_bf16 v[204:207], a[144:147], a[80:83], v[252:255]
  ds_read_b64_tr_b16 a[180:181], v237 offset:8200
  ds_read_b64_tr_b16 a[182:183], v237 offset:12296
  v_mfma_f32_16x16x32_bf16 v[204:207], a[148:151], a[84:87], v[204:207]
  v_exp_f32 v199, v199
  v_mfma_f32_16x16x32_bf16 v[204:207], a[152:155], a[88:91], v[204:207]
  v_cvt_pk_bf16_f32 v210, v196, v197
  v_cvt_pk_bf16_f32 v211, v198, v199
  v_mfma_f32_16x16x32_bf16 v[204:207], a[156:159], a[92:95], v[204:207]
  buffer_store_dwordx4 a[244:247], v232, s[28:31], s42 offen offset:256 nt
  v_mul_f32 v200, s36, v200
  v_mul_f32 v201, s36, v201
  v_mfma_f32_16x16x32_bf16 v[128:131], v[208:211], a[192:195], v[128:131]
  v_exp_f32 v200, v200
  v_mfma_f32_16x16x32_bf16 v[132:135], v[208:211], a[196:199], v[132:135]
  v_mul_f32 v202, s36, v202
  v_mul_f32 v203, s36, v203
  v_mfma_f32_16x16x32_bf16 v[136:139], v[208:211], a[200:203], v[136:139]
  v_exp_f32 v201, v201
  v_mfma_f32_16x16x32_bf16 v[140:143], v[208:211], a[204:207], v[140:143]
  ds_read_b64_tr_b16 a[184:185], v234 offset:8200
  ds_read_b64_tr_b16 a[186:187], v234 offset:12296
  v_mfma_f32_16x16x32_bf16 v[144:147], v[208:211], a[208:211], v[144:147]
  v_exp_f32 v202, v202
  v_mfma_f32_16x16x32_bf16 v[148:151], v[208:211], a[212:215], v[148:151]
  v_cvt_pk_bf16_f32 v212, v200, v201
  v_mul_f32 v204, s36, v204
  v_mfma_f32_16x16x32_bf16 v[152:155], v[208:211], a[216:219], v[152:155]
  v_exp_f32 v203, v203
  v_mfma_f32_16x16x32_bf16 v[156:159], v[208:211], a[220:223], v[156:159]
  v_mul_f32 v205, s36, v205
  v_mul_f32 v206, s36, v206
  v_mfma_f32_16x16x32_bf16 v[192:195], a[96:99], a[0:3], v[252:255]
  v_exp_f32 v204, v204
  v_mfma_f32_16x16x32_bf16 v[192:195], a[100:103], a[4:7], v[192:195]
  v_cvt_pk_bf16_f32 v213, v202, v203
  v_mul_f32 v207, s36, v207
  v_mfma_f32_16x16x32_bf16 v[192:195], a[104:107], a[8:11], v[192:195]
  v_exp_f32 v205, v205
  v_mfma_f32_16x16x32_bf16 v[192:195], a[108:111], a[12:15], v[192:195]
  v_exp_f32 v206, v206
  v_mfma_f32_16x16x32_bf16 v[196:199], a[112:115], a[0:3], v[252:255]
  ds_read_b64_tr_b16 a[188:189], v228 offset:8200
  ds_read_b64_tr_b16 a[190:191], v228 offset:12296
  v_mfma_f32_16x16x32_bf16 v[196:199], a[116:119], a[4:7], v[196:199]
  v_exp_f32 v207, v207
  v_mfma_f32_16x16x32_bf16 v[196:199], a[120:123], a[8:11], v[196:199]
  v_cvt_pk_bf16_f32 v214, v204, v205
  v_cvt_pk_bf16_f32 v215, v206, v207
  v_mfma_f32_16x16x32_bf16 v[196:199], a[124:127], a[12:15], v[196:199]
  ds_read_b64_tr_b16 v[216:217], v231 offset:6144
  ds_read_b64_tr_b16 v[218:219], v231 offset:6152
  ds_read_b64_tr_b16 v[220:221], v231 offset:7168
  ds_read_b64_tr_b16 v[222:223], v231 offset:7176
  ds_read_b64_tr_b16 a[244:245], v231 offset:8192
  ds_read_b64_tr_b16 a[246:247], v231 offset:8200
  ds_add_rtn_u32 v244, v242, v243
  v_smfmac_f32_16x16x64_bf16 a[232:235], a[248:251], v[208:215], v227
  v_mul_f32 v192, s36, v192
  v_mul_f32 v193, s36, v193
  v_mfma_f32_16x16x32_bf16 v[160:163], v[212:215], a[192:195], v[160:163]
  v_exp_f32 v192, v192
  v_mfma_f32_16x16x32_bf16 v[164:167], v[212:215], a[196:199], v[164:167]
  v_mul_f32 v194, s36, v194
  v_mul_f32 v195, s36, v195
  v_mfma_f32_16x16x32_bf16 v[168:171], v[212:215], a[200:203], v[168:171]
  v_exp_f32 v193, v193
  v_mfma_f32_16x16x32_bf16 v[172:175], v[212:215], a[204:207], v[172:175]
  ds_read_b128 a[128:131], v224 offset:16384
  ds_read_b128 a[132:135], v224 offset:16640
  v_mfma_f32_16x16x32_bf16 v[176:179], v[212:215], a[208:211], v[176:179]
  v_exp_f32 v194, v194
  v_mfma_f32_16x16x32_bf16 v[180:183], v[212:215], a[212:215], v[180:183]
  v_cvt_pk_bf16_f32 v208, v192, v193
  v_mul_f32 v196, s36, v196
  v_mfma_f32_16x16x32_bf16 v[184:187], v[212:215], a[216:219], v[184:187]
  v_exp_f32 v195, v195
  v_mfma_f32_16x16x32_bf16 v[188:191], v[212:215], a[220:223], v[188:191]
  v_mul_f32 v197, s36, v197
  v_mul_f32 v198, s36, v198
  v_mfma_f32_16x16x32_bf16 v[200:203], a[96:99], a[16:19], v[252:255]
  v_exp_f32 v196, v196
  v_mfma_f32_16x16x32_bf16 v[200:203], a[100:103], a[20:23], v[200:203]
  v_cvt_pk_bf16_f32 v209, v194, v195
  v_mul_f32 v199, s36, v199
  v_mfma_f32_16x16x32_bf16 v[200:203], a[104:107], a[24:27], v[200:203]
  v_exp_f32 v197, v197
  v_mfma_f32_16x16x32_bf16 v[200:203], a[108:111], a[28:31], v[200:203]
  v_exp_f32 v198, v198
  v_mfma_f32_16x16x32_bf16 v[204:207], a[112:115], a[16:19], v[252:255]
  ds_read_b128 a[136:139], v224 offset:16896
  ds_read_b128 a[140:143], v224 offset:17152
  v_mfma_f32_16x16x32_bf16 v[204:207], a[116:119], a[20:23], v[204:207]
  v_exp_f32 v199, v199
  v_mfma_f32_16x16x32_bf16 v[204:207], a[120:123], a[24:27], v[204:207]
  v_cvt_pk_bf16_f32 v210, v196, v197
  v_cvt_pk_bf16_f32 v211, v198, v199
  v_mfma_f32_16x16x32_bf16 v[204:207], a[124:127], a[28:31], v[204:207]
  s_waitcnt lgkmcnt(4)
  v_mul_f32 v200, s36, v200
  v_mul_f32 v201, s36, v201
  v_mfma_f32_16x16x32_bf16 v[0:3], v[208:211], a[160:163], v[0:3]
  v_exp_f32 v200, v200
  v_mfma_f32_16x16x32_bf16 v[4:7], v[208:211], a[164:167], v[4:7]
  v_mul_f32 v202, s36, v202
  v_mul_f32 v203, s36, v203
  v_mfma_f32_16x16x32_bf16 v[8:11], v[208:211], a[168:171], v[8:11]
  v_exp_f32 v201, v201
  v_mfma_f32_16x16x32_bf16 v[12:15], v[208:211], a[172:175], v[12:15]
  ds_read_b128 a[144:147], v224 offset:20480
  ds_read_b128 a[148:151], v224 offset:20736
  v_mfma_f32_16x16x32_bf16 v[16:19], v[208:211], a[176:179], v[16:19]
  v_exp_f32 v202, v202
  v_mfma_f32_16x16x32_bf16 v[20:23], v[208:211], a[180:183], v[20:23]
  v_cvt_pk_bf16_f32 v212, v200, v201
  v_mul_f32 v204, s36, v204
  v_mfma_f32_16x16x32_bf16 v[24:27], v[208:211], a[184:187], v[24:27]
  v_exp_f32 v203, v203
  v_mfma_f32_16x16x32_bf16 v[28:31], v[208:211], a[188:191], v[28:31]
  v_mul_f32 v205, s36, v205
  v_mul_f32 v206, s36, v206
  v_mfma_f32_16x16x32_bf16 v[192:195], a[96:99], a[32:35], v[252:255]
  v_exp_f32 v204, v204
  v_mfma_f32_16x16x32_bf16 v[192:195], a[100:103], a[36:39], v[192:195]
  v_cvt_pk_bf16_f32 v213, v202, v203
  v_mul_f32 v207, s36, v207
  v_mfma_f32_16x16x32_bf16 v[192:195], a[104:107], a[40:43], v[192:195]
  v_exp_f32 v205, v205
  v_mfma_f32_16x16x32_bf16 v[192:195], a[108:111], a[44:47], v[192:195]
  v_exp_f32 v206, v206
  v_mfma_f32_16x16x32_bf16 v[196:199], a[112:115], a[32:35], v[252:255]
  ds_read_b128 a[152:155], v224 offset:20992
  ds_read_b128 a[156:159], v224 offset:21248
  v_mfma_f32_16x16x32_bf16 v[196:199], a[116:119], a[36:39], v[196:199]
  v_exp_f32 v207, v207
  v_mfma_f32_16x16x32_bf16 v[196:199], a[120:123], a[40:43], v[196:199]
  v_cvt_pk_bf16_f32 v214, v204, v205
  v_cvt_pk_bf16_f32 v215, v206, v207
  v_mfma_f32_16x16x32_bf16 v[196:199], a[124:127], a[44:47], v[196:199]
  buffer_store_dwordx4 v[216:219], v232, s[28:31], s42 offen offset:512 nt
  v_cmp_gt_u32 vcc, s58, v244
  v_smfmac_f32_16x16x64_bf16 a[224:227], a[248:251], v[208:215], v227
  v_mul_f32 v192, s36, v192
  v_mul_f32 v193, s36, v193
  v_mfma_f32_16x16x32_bf16 v[32:35], v[212:215], a[160:163], v[32:35]
  s_cbranch_vccnz L_s6_C4
L_r6_C4:
  v_exp_f32 v192, v192
  v_mfma_f32_16x16x32_bf16 v[36:39], v[212:215], a[164:167], v[36:39]
  s_add_u32 s58, s58, 1
  v_mul_f32 v194, s36, v194
  v_mul_f32 v195, s36, v195
  v_mfma_f32_16x16x32_bf16 v[40:43], v[212:215], a[168:171], v[40:43]
  v_exp_f32 v193, v193
  v_mfma_f32_16x16x32_bf16 v[44:47], v[212:215], a[172:175], v[44:47]
  ds_read_b64_tr_b16 a[192:193], v226 offset:24576
  ds_read_b64_tr_b16 a[194:195], v226 offset:28672
  v_mfma_f32_16x16x32_bf16 v[48:51], v[212:215], a[176:179], v[48:51]
  v_exp_f32 v194, v194
  v_mfma_f32_16x16x32_bf16 v[52:55], v[212:215], a[180:183], v[52:55]
  v_cvt_pk_bf16_f32 v208, v192, v193
  v_mul_f32 v196, s36, v196
  v_mfma_f32_16x16x32_bf16 v[56:59], v[212:215], a[184:187], v[56:59]
  v_exp_f32 v195, v195
  v_mfma_f32_16x16x32_bf16 v[60:63], v[212:215], a[188:191], v[60:63]
  v_mul_f32 v197, s36, v197
  v_mul_f32 v198, s36, v198
  v_mfma_f32_16x16x32_bf16 v[200:203], a[96:99], a[48:51], v[252:255]
  v_exp_f32 v196, v196
  v_mfma_f32_16x16x32_bf16 v[200:203], a[100:103], a[52:55], v[200:203]
  v_cvt_pk_bf16_f32 v209, v194, v195
  v_mul_f32 v199, s36, v199
  v_mfma_f32_16x16x32_bf16 v[200:203], a[104:107], a[56:59], v[200:203]
  v_exp_f32 v197, v197
  v_mfma_f32_16x16x32_bf16 v[200:203], a[108:111], a[60:63], v[200:203]
  v_exp_f32 v198, v198
  v_mfma_f32_16x16x32_bf16 v[204:207], a[112:115], a[48:51], v[252:255]
  ds_read_b64_tr_b16 a[196:197], v237 offset:24576
  ds_read_b64_tr_b16 a[198:199], v237 offset:28672
  v_mfma_f32_16x16x32_bf16 v[204:207], a[116:119], a[52:55], v[204:207]
  v_exp_f32 v199, v199
  v_mfma_f32_16x16x32_bf16 v[204:207], a[120:123], a[56:59], v[204:207]
  v_cvt_pk_bf16_f32 v210, v196, v197
  v_cvt_pk_bf16_f32 v211, v198, v199
  v_mfma_f32_16x16x32_bf16 v[204:207], a[124:127], a[60:63], v[204:207]
  v_mul_f32 v200, s36, v200
  v_mul_f32 v201, s36, v201
  v_mfma_f32_16x16x32_bf16 v[64:67], v[208:211], a[160:163], v[64:67]
  v_exp_f32 v200, v200
  v_mfma_f32_16x16x32_bf16 v[68:71], v[208:211], a[164:167], v[68:71]
  v_mul_f32 v202, s36, v202
  v_mul_f32 v203, s36, v203
  v_mfma_f32_16x16x32_bf16 v[72:75], v[208:211], a[168:171], v[72:75]
  v_exp_f32 v201, v201
  v_mfma_f32_16x16x32_bf16 v[76:79], v[208:211], a[172:175], v[76:79]
  ds_read_b64_tr_b16 a[200:201], v234 offset:24576
  ds_read_b64_tr_b16 a[202:203], v234 offset:28672
  v_mfma_f32_16x16x32_bf16 v[80:83], v[208:211], a[176:179], v[80:83]
  v_exp_f32 v202, v202
  v_mfma_f32_16x16x32_bf16 v[84:87], v[208:211], a[180:183], v[84:87]
  v_cvt_pk_bf16_f32 v212, v200, v201
  v_mul_f32 v204, s36, v204
  v_mfma_f32_16x16x32_bf16 v[88:91], v[208:211], a[184:187], v[88:91]
  v_exp_f32 v203, v203
  v_mfma_f32_16x16x32_bf16 v[92:95], v[208:211], a[188:191], v[92:95]
  v_mul_f32 v205, s36, v205
  v_mul_f32 v206, s36, v206
  v_mfma_f32_16x16x32_bf16 v[192:195], a[96:99], a[64:67], v[252:255]
  v_exp_f32 v204, v204
  v_mfma_f32_16x16x32_bf16 v[192:195], a[100:103], a[68:71], v[192:195]
  v_cvt_pk_bf16_f32 v213, v202, v203
  v_mul_f32 v207, s36, v207
  v_mfma_f32_16x16x32_bf16 v[192:195], a[104:107], a[72:75], v[192:195]
  v_exp_f32 v205, v205
  v_mfma_f32_16x16x32_bf16 v[192:195], a[108:111], a[76:79], v[192:195]
  v_exp_f32 v206, v206
  v_mfma_f32_16x16x32_bf16 v[196:199], a[112:115], a[64:67], v[252:255]
  ds_read_b64_tr_b16 a[204:205], v228 offset:24576
  ds_read_b64_tr_b16 a[206:207], v228 offset:28672
  v_mfma_f32_16x16x32_bf16 v[196:199], a[116:119], a[68:71], v[196:199]
  v_exp_f32 v207, v207
  v_mfma_f32_16x16x32_bf16 v[196:199], a[120:123], a[72:75], v[196:199]
  v_cvt_pk_bf16_f32 v214, v204, v205
  v_cvt_pk_bf16_f32 v215, v206, v207
  v_mfma_f32_16x16x32_bf16 v[196:199], a[124:127], a[76:79], v[196:199]
  buffer_store_dwordx4 v[220:223], v232, s[28:31], s42 offen offset:768 nt
  v_smfmac_f32_16x16x64_bf16 a[228:231], a[248:251], v[208:215], v227
  s_add_u32 s42, s42, 4096
  v_mul_f32 v192, s36, v192
  v_mul_f32 v193, s36, v193
  v_mfma_f32_16x16x32_bf16 v[96:99], v[212:215], a[160:163], v[96:99]
  v_exp_f32 v192, v192
  v_mfma_f32_16x16x32_bf16 v[100:103], v[212:215], a[164:167], v[100:103]
  v_mul_f32 v194, s36, v194
  v_mul_f32 v195, s36, v195
  v_mfma_f32_16x16x32_bf16 v[104:107], v[212:215], a[168:171], v[104:107]
  v_exp_f32 v193, v193
  v_mfma_f32_16x16x32_bf16 v[108:111], v[212:215], a[172:175], v[108:111]
  ds_read_b64_tr_b16 a[208:209], v226 offset:24584
  ds_read_b64_tr_b16 a[210:211], v226 offset:28680
  v_mfma_f32_16x16x32_bf16 v[112:115], v[212:215], a[176:179], v[112:115]
  v_exp_f32 v194, v194
  v_mfma_f32_16x16x32_bf16 v[116:119], v[212:215], a[180:183], v[116:119]
  v_cvt_pk_bf16_f32 v208, v192, v193
  v_mul_f32 v196, s36, v196
  v_mfma_f32_16x16x32_bf16 v[120:123], v[212:215], a[184:187], v[120:123]
  v_exp_f32 v195, v195
  v_mfma_f32_16x16x32_bf16 v[124:127], v[212:215], a[188:191], v[124:127]
  v_mul_f32 v197, s36, v197
  v_mul_f32 v198, s36, v198
  v_mfma_f32_16x16x32_bf16 v[200:203], a[96:99], a[80:83], v[252:255]
  v_exp_f32 v196, v196
  v_mfma_f32_16x16x32_bf16 v[200:203], a[100:103], a[84:87], v[200:203]
  v_cvt_pk_bf16_f32 v209, v194, v195
  v_mul_f32 v199, s36, v199
  v_mfma_f32_16x16x32_bf16 v[200:203], a[104:107], a[88:91], v[200:203]
  v_exp_f32 v197, v197
  v_mfma_f32_16x16x32_bf16 v[200:203], a[108:111], a[92:95], v[200:203]
  s_waitcnt lgkmcnt(10)
  v_exp_f32 v198, v198
  v_mfma_f32_16x16x32_bf16 v[204:207], a[112:115], a[80:83], v[252:255]
  ds_read_b64_tr_b16 a[212:213], v237 offset:24584
  ds_read_b64_tr_b16 a[214:215], v237 offset:28680
  v_mfma_f32_16x16x32_bf16 v[204:207], a[116:119], a[84:87], v[204:207]
  v_exp_f32 v199, v199
  v_mfma_f32_16x16x32_bf16 v[204:207], a[120:123], a[88:91], v[204:207]
  v_cvt_pk_bf16_f32 v210, v196, v197
  v_cvt_pk_bf16_f32 v211, v198, v199
  v_mfma_f32_16x16x32_bf16 v[204:207], a[124:127], a[92:95], v[204:207]
  buffer_store_dwordx4 a[244:247], v232, s[28:31], s42 offen offset:0 nt
  v_mul_f32 v200, s36, v200
  v_mul_f32 v201, s36, v201
  v_mfma_f32_16x16x32_bf16 v[128:131], v[208:211], a[160:163], v[128:131]
  v_exp_f32 v200, v200
  v_mfma_f32_16x16x32_bf16 v[132:135], v[208:211], a[164:167], v[132:135]
  v_mul_f32 v202, s36, v202
  v_mul_f32 v203, s36, v203
  v_mfma_f32_16x16x32_bf16 v[136:139], v[208:211], a[168:171], v[136:139]
  v_exp_f32 v201, v201
  v_mfma_f32_16x16x32_bf16 v[140:143], v[208:211], a[172:175], v[140:143]
  ds_read_b64_tr_b16 a[216:217], v234 offset:24584
  ds_read_b64_tr_b16 a[218:219], v234 offset:28680
  v_mfma_f32_16x16x32_bf16 v[144:147], v[208:211], a[176:179], v[144:147]
  v_exp_f32 v202, v202
  v_mfma_f32_16x16x32_bf16 v[148:151], v[208:211], a[180:183], v[148:151]
  v_cvt_pk_bf16_f32 v212, v200, v201
  v_mul_f32 v204, s36, v204
  v_mfma_f32_16x16x32_bf16 v[152:155], v[208:211], a[184:187], v[152:155]
  v_exp_f32 v203, v203
  v_mfma_f32_16x16x32_bf16 v[156:159], v[208:211], a[188:191], v[156:159]
  v_mul_f32 v205, s36, v205
  v_mul_f32 v206, s36, v206
  v_mfma_f32_16x16x32_bf16 v[192:195], a[128:131], a[0:3], v[252:255]
  v_exp_f32 v204, v204
  v_mfma_f32_16x16x32_bf16 v[192:195], a[132:135], a[4:7], v[192:195]
  v_cvt_pk_bf16_f32 v213, v202, v203
  v_mul_f32 v207, s36, v207
  v_mfma_f32_16x16x32_bf16 v[192:195], a[136:139], a[8:11], v[192:195]
  v_exp_f32 v205, v205
  v_mfma_f32_16x16x32_bf16 v[192:195], a[140:143], a[12:15], v[192:195]
  v_exp_f32 v206, v206
  v_mfma_f32_16x16x32_bf16 v[196:199], a[144:147], a[0:3], v[252:255]
  ds_read_b64_tr_b16 a[220:221], v228 offset:24584
  ds_read_b64_tr_b16 a[222:223], v228 offset:28680
  v_mfma_f32_16x16x32_bf16 v[196:199], a[148:151], a[4:7], v[196:199]
  v_exp_f32 v207, v207
  v_mfma_f32_16x16x32_bf16 v[196:199], a[152:155], a[8:11], v[196:199]
  v_cvt_pk_bf16_f32 v214, v204, v205
  v_cvt_pk_bf16_f32 v215, v206, v207
  v_mfma_f32_16x16x32_bf16 v[196:199], a[156:159], a[12:15], v[196:199]
  ds_read_b64_tr_b16 v[216:217], v231 offset:9216
  ds_read_b64_tr_b16 v[218:219], v231 offset:9224
  ds_read_b64_tr_b16 v[220:221], v231 offset:10240
  ds_read_b64_tr_b16 v[222:223], v231 offset:10248
  ds_read_b64_tr_b16 a[244:245], v231 offset:11264
  ds_read_b64_tr_b16 a[246:247], v231 offset:11272
  ds_add_rtn_u32 v244, v242, v243
  v_smfmac_f32_16x16x64_bf16 a[232:235], a[248:251], v[208:215], v227
  v_mul_f32 v192, s36, v192
  v_mul_f32 v193, s36, v193
  v_mfma_f32_16x16x32_bf16 v[160:163], v[212:215], a[160:163], v[160:163]
  v_exp_f32 v192, v192
  v_mfma_f32_16x16x32_bf16 v[164:167], v[212:215], a[164:167], v[164:167]
  v_mul_f32 v194, s36, v194
  v_mul_f32 v195, s36, v195
  v_mfma_f32_16x16x32_bf16 v[168:171], v[212:215], a[168:171], v[168:171]
  v_exp_f32 v193, v193
  v_mfma_f32_16x16x32_bf16 v[172:175], v[212:215], a[172:175], v[172:175]
  ds_read_b128 a[96:99], v224 offset:32768
  ds_read_b128 a[100:103], v224 offset:33024
  v_mfma_f32_16x16x32_bf16 v[176:179], v[212:215], a[176:179], v[176:179]
  v_exp_f32 v194, v194
  v_mfma_f32_16x16x32_bf16 v[180:183], v[212:215], a[180:183], v[180:183]
  v_cvt_pk_bf16_f32 v208, v192, v193
  v_mul_f32 v196, s36, v196
  v_mfma_f32_16x16x32_bf16 v[184:187], v[212:215], a[184:187], v[184:187]
  v_exp_f32 v195, v195
  v_mfma_f32_16x16x32_bf16 v[188:191], v[212:215], a[188:191], v[188:191]
  v_mul_f32 v197, s36, v197
  v_mul_f32 v198, s36, v198
  v_mfma_f32_16x16x32_bf16 v[200:203], a[128:131], a[16:19], v[252:255]
  v_exp_f32 v196, v196
  v_mfma_f32_16x16x32_bf16 v[200:203], a[132:135], a[20:23], v[200:203]
  v_cvt_pk_bf16_f32 v209, v194, v195
  v_mul_f32 v199, s36, v199
  v_mfma_f32_16x16x32_bf16 v[200:203], a[136:139], a[24:27], v[200:203]
  v_exp_f32 v197, v197
  v_mfma_f32_16x16x32_bf16 v[200:203], a[140:143], a[28:31], v[200:203]
  v_exp_f32 v198, v198
  v_mfma_f32_16x16x32_bf16 v[204:207], a[144:147], a[16:19], v[252:255]
  ds_read_b128 a[104:107], v224 offset:33280
  ds_read_b128 a[108:111], v224 offset:33536
  v_mfma_f32_16x16x32_bf16 v[204:207], a[148:151], a[20:23], v[204:207]
  v_exp_f32 v199, v199
  v_mfma_f32_16x16x32_bf16 v[204:207], a[152:155], a[24:27], v[204:207]
  v_cvt_pk_bf16_f32 v210, v196, v197
  v_cvt_pk_bf16_f32 v211, v198, v199
  v_mfma_f32_16x16x32_bf16 v[204:207], a[156:159], a[28:31], v[204:207]
  s_waitcnt lgkmcnt(4)
  v_mul_f32 v200, s36, v200
  v_mul_f32 v201, s36, v201
  v_mfma_f32_16x16x32_bf16 v[0:3], v[208:211], a[192:195], v[0:3]
  v_exp_f32 v200, v200
  v_mfma_f32_16x16x32_bf16 v[4:7], v[208:211], a[196:199], v[4:7]
  v_mul_f32 v202, s36, v202
  v_mul_f32 v203, s36, v203
  v_mfma_f32_16x16x32_bf16 v[8:11], v[208:211], a[200:203], v[8:11]
  v_exp_f32 v201, v201
  v_mfma_f32_16x16x32_bf16 v[12:15], v[208:211], a[204:207], v[12:15]
  ds_read_b128 a[112:115], v224 offset:36864
  ds_read_b128 a[116:119], v224 offset:37120
  v_mfma_f32_16x16x32_bf16 v[16:19], v[208:211], a[208:211], v[16:19]
  v_exp_f32 v202, v202
  v_mfma_f32_16x16x32_bf16 v[20:23], v[208:211], a[212:215], v[20:23]
  v_cvt_pk_bf16_f32 v212, v200, v201
  v_mul_f32 v204, s36, v204
  v_mfma_f32_16x16x32_bf16 v[24:27], v[208:211], a[216:219], v[24:27]
  v_exp_f32 v203, v203
  v_mfma_f32_16x16x32_bf16 v[28:31], v[208:211], a[220:223], v[28:31]
  v_mul_f32 v205, s36, v205
  v_mul_f32 v206, s36, v206
  v_mfma_f32_16x16x32_bf16 v[192:195], a[128:131], a[32:35], v[252:255]
  v_exp_f32 v204, v204
  v_mfma_f32_16x16x32_bf16 v[192:195], a[132:135], a[36:39], v[192:195]
  v_cvt_pk_bf16_f32 v213, v202, v203
  v_mul_f32 v207, s36, v207
  v_mfma_f32_16x16x32_bf16 v[192:195], a[136:139], a[40:43], v[192:195]
  v_exp_f32 v205, v205
  v_mfma_f32_16x16x32_bf16 v[192:195], a[140:143], a[44:47], v[192:195]
  v_exp_f32 v206, v206
  v_mfma_f32_16x16x32_bf16 v[196:199], a[144:147], a[32:35], v[252:255]
  ds_read_b128 a[120:123], v224 offset:37376
  ds_read_b128 a[124:127], v224 offset:37632
  v_mfma_f32_16x16x32_bf16 v[196:199], a[148:151], a[36:39], v[196:199]
  v_exp_f32 v207, v207
  v_mfma_f32_16x16x32_bf16 v[196:199], a[152:155], a[40:43], v[196:199]
  v_cvt_pk_bf16_f32 v214, v204, v205
  v_cvt_pk_bf16_f32 v215, v206, v207
  v_mfma_f32_16x16x32_bf16 v[196:199], a[156:159], a[44:47], v[196:199]
  buffer_store_dwordx4 v[216:219], v232, s[28:31], s42 offen offset:256 nt
  v_cmp_gt_u32 vcc, s58, v244
  v_smfmac_f32_16x16x64_bf16 a[224:227], a[248:251], v[208:215], v227
  v_mul_f32 v192, s36, v192
  v_mul_f32 v193, s36, v193
  v_mfma_f32_16x16x32_bf16 v[32:35], v[212:215], a[192:195], v[32:35]
  s_cbranch_vccnz L_s6_C5
L_r6_C5:
  v_exp_f32 v192, v192
  v_mfma_f32_16x16x32_bf16 v[36:39], v[212:215], a[196:199], v[36:39]
  s_add_u32 s58, s58, 1
  v_mul_f32 v194, s36, v194
  v_mul_f32 v195, s36, v195
  v_mfma_f32_16x16x32_bf16 v[40:43], v[212:215], a[200:203], v[40:43]
  v_exp_f32 v193, v193
  v_mfma_f32_16x16x32_bf16 v[44:47], v[212:215], a[204:207], v[44:47]
  ds_read_b64_tr_b16 a[160:161], v226 offset:40960
  ds_read_b64_tr_b16 a[162:163], v226 offset:45056
  v_mfma_f32_16x16x32_bf16 v[48:51], v[212:215], a[208:211], v[48:51]
  v_exp_f32 v194, v194
  v_mfma_f32_16x16x32_bf16 v[52:55], v[212:215], a[212:215], v[52:55]
  v_cvt_pk_bf16_f32 v208, v192, v193
  v_mul_f32 v196, s36, v196
  v_mfma_f32_16x16x32_bf16 v[56:59], v[212:215], a[216:219], v[56:59]
  v_exp_f32 v195, v195
  v_mfma_f32_16x16x32_bf16 v[60:63], v[212:215], a[220:223], v[60:63]
  v_mul_f32 v197, s36, v197
  v_mul_f32 v198, s36, v198
  v_mfma_f32_16x16x32_bf16 v[200:203], a[128:131], a[48:51], v[252:255]
  v_exp_f32 v196, v196
  v_mfma_f32_16x16x32_bf16 v[200:203], a[132:135], a[52:55], v[200:203]
  v_cvt_pk_bf16_f32 v209, v194, v195
  v_mul_f32 v199, s36, v199
  v_mfma_f32_16x16x32_bf16 v[200:203], a[136:139], a[56:59], v[200:203]
  v_exp_f32 v197, v197
  v_mfma_f32_16x16x32_bf16 v[200:203], a[140:143], a[60:63], v[200:203]
  v_exp_f32 v198, v198
  v_mfma_f32_16x16x32_bf16 v[204:207], a[144:147], a[48:51], v[252:255]
  ds_read_b64_tr_b16 a[164:165], v237 offset:40960
  ds_read_b64_tr_b16 a[166:167], v237 offset:45056
  v_mfma_f32_16x16x32_bf16 v[204:207], a[148:151], a[52:55], v[204:207]
  v_exp_f32 v199, v199
  v_mfma_f32_16x16x32_bf16 v[204:207], a[152:155], a[56:59], v[204:207]
  v_cvt_pk_bf16_f32 v210, v196, v197
  v_cvt_pk_bf16_f32 v211, v198, v199
  v_mfma_f32_16x16x32_bf16 v[204:207], a[156:159], a[60:63], v[204:207]
  v_mul_f32 v200, s36, v200
  v_mul_f32 v201, s36, v201
  v_mfma_f32_16x16x32_bf16 v[64:67], v[208:211], a[192:195], v[64:67]
  v_exp_f32 v200, v200
  v_mfma_f32_16x16x32_bf16 v[68:71], v[208:211], a[196:199], v[68:71]
  v_mul_f32 v202, s36, v202
  v_mul_f32 v203, s36, v203
  v_mfma_f32_16x16x32_bf16 v[72:75], v[208:211], a[200:203], v[72:75]
  v_exp_f32 v201, v201
  v_mfma_f32_16x16x32_bf16 v[76:79], v[208:211], a[204:207], v[76:79]
  ds_read_b64_tr_b16 a[168:169], v234 offset:40960
  ds_read_b64_tr_b16 a[170:171], v234 offset:45056
  v_mfma_f32_16x16x32_bf16 v[80:83], v[208:211], a[208:211], v[80:83]
  v_exp_f32 v202, v202
  v_mfma_f32_16x16x32_bf16 v[84:87], v[208:211], a[212:215], v[84:87]
  v_cvt_pk_bf16_f32 v212, v200, v201
  v_mul_f32 v204, s36, v204
  v_mfma_f32_16x16x32_bf16 v[88:91], v[208:211], a[216:219], v[88:91]
  v_exp_f32 v203, v203
  v_mfma_f32_16x16x32_bf16 v[92:95], v[208:211], a[220:223], v[92:95]
  v_mul_f32 v205, s36, v205
  v_mul_f32 v206, s36, v206
  v_mfma_f32_16x16x32_bf16 v[192:195], a[128:131], a[64:67], v[252:255]
  v_exp_f32 v204, v204
  v_mfma_f32_16x16x32_bf16 v[192:195], a[132:135], a[68:71], v[192:195]
  v_cvt_pk_bf16_f32 v213, v202, v203
  v_mul_f32 v207, s36, v207
  v_mfma_f32_16x16x32_bf16 v[192:195], a[136:139], a[72:75], v[192:195]
  v_exp_f32 v205, v205
  v_mfma_f32_16x16x32_bf16 v[192:195], a[140:143], a[76:79], v[192:195]
  v_exp_f32 v206, v206
  v_mfma_f32_16x16x32_bf16 v[196:199], a[144:147], a[64:67], v[252:255]
  ds_read_b64_tr_b16 a[172:173], v228 offset:40960
  ds_read_b64_tr_b16 a[174:175], v228 offset:45056
  v_mfma_f32_16x16x32_bf16 v[196:199], a[148:151], a[68:71], v[196:199]
  v_exp_f32 v207, v207
  v_mfma_f32_16x16x32_bf16 v[196:199], a[152:155], a[72:75], v[196:199]
  v_cvt_pk_bf16_f32 v214, v204, v205
  v_cvt_pk_bf16_f32 v215, v206, v207
  v_mfma_f32_16x16x32_bf16 v[196:199], a[156:159], a[76:79], v[196:199]
  buffer_store_dwordx4 v[220:223], v232, s[28:31], s42 offen offset:512 nt
  v_add_u32 v231, 0x3000, v231
  v_smfmac_f32_16x16x64_bf16 a[228:231], a[248:251], v[208:215], v227
  v_mul_f32 v192, s36, v192
  v_mul_f32 v193, s36, v193
  v_mfma_f32_16x16x32_bf16 v[96:99], v[212:215], a[192:195], v[96:99]
  v_exp_f32 v192, v192
  v_mfma_f32_16x16x32_bf16 v[100:103], v[212:215], a[196:199], v[100:103]
  v_mul_f32 v194, s36, v194
  v_mul_f32 v195, s36, v195
  v_mfma_f32_16x16x32_bf16 v[104:107], v[212:215], a[200:203], v[104:107]
  v_exp_f32 v193, v193
  v_mfma_f32_16x16x32_bf16 v[108:111], v[212:215], a[204:207], v[108:111]
  ds_read_b64_tr_b16 a[176:177], v226 offset:40968
  ds_read_b64_tr_b16 a[178:179], v226 offset:45064
  v_mfma_f32_16x16x32_bf16 v[112:115], v[212:215], a[208:211], v[112:115]
  v_exp_f32 v194, v194
  v_mfma_f32_16x16x32_bf16 v[116:119], v[212:215], a[212:215], v[116:119]
  v_cvt_pk_bf16_f32 v208, v192, v193
  v_mul_f32 v196, s36, v196
  v_mfma_f32_16x16x32_bf16 v[120:123], v[212:215], a[216:219], v[120:123]
  v_exp_f32 v195, v195
  v_mfma_f32_16x16x32_bf16 v[124:127], v[212:215], a[220:223], v[124:127]
  v_mul_f32 v197, s36, v197
  v_mul_f32 v198, s36, v198
  v_mfma_f32_16x16x32_bf16 v[200:203], a[128:131], a[80:83], v[252:255]
  v_exp_f32 v196, v196
  v_mfma_f32_16x16x32_bf16 v[200:203], a[132:135], a[84:87], v[200:203]
  v_cvt_pk_bf16_f32 v209, v194, v195
  v_mul_f32 v199, s36, v199
  v_mfma_f32_16x16x32_bf16 v[200:203], a[136:139], a[88:91], v[200:203]
  v_exp_f32 v197, v197
  v_mfma_f32_16x16x32_bf16 v[200:203], a[140:143], a[92:95], v[200:203]
  s_waitcnt lgkmcnt(10)
  v_exp_f32 v198, v198
  v_mfma_f32_16x16x32_bf16 v[204:207], a[144:147], a[80:83], v[252:255]
  ds_read_b64_tr_b16 a[180:181], v237 offset:40968
  ds_read_b64_tr_b16 a[182:183], v237 offset:45064
  v_mfma_f32_16x16x32_bf16 v[204:207], a[148:151], a[84:87], v[204:207]
  v_exp_f32 v199, v199
  v_mfma_f32_16x16x32_bf16 v[204:207], a[152:155], a[88:91], v[204:207]
  v_cvt_pk_bf16_f32 v210, v196, v197
  v_cvt_pk_bf16_f32 v211, v198, v199
  v_mfma_f32_16x16x32_bf16 v[204:207], a[156:159], a[92:95], v[204:207]
  buffer_store_dwordx4 a[244:247], v232, s[28:31], s42 offen offset:768 nt
  v_mul_f32 v200, s36, v200
  v_mul_f32 v201, s36, v201
  v_mfma_f32_16x16x32_bf16 v[128:131], v[208:211], a[192:195], v[128:131]
  s_add_u32 s42, s42, 4096
  v_exp_f32 v200, v200
  v_mfma_f32_16x16x32_bf16 v[132:135], v[208:211], a[196:199], v[132:135]
  v_mul_f32 v202, s36, v202
  v_mul_f32 v203, s36, v203
  v_mfma_f32_16x16x32_bf16 v[136:139], v[208:211], a[200:203], v[136:139]
  s_add_u32 s44, s44, 1
  v_exp_f32 v201, v201
  v_mfma_f32_16x16x32_bf16 v[140:143], v[208:211], a[204:207], v[140:143]
  ds_read_b64_tr_b16 a[184:185], v234 offset:40968
  ds_read_b64_tr_b16 a[186:187], v234 offset:45064
  v_mfma_f32_16x16x32_bf16 v[144:147], v[208:211], a[208:211], v[144:147]
  v_exp_f32 v202, v202
  v_mfma_f32_16x16x32_bf16 v[148:151], v[208:211], a[212:215], v[148:151]
  v_cvt_pk_bf16_f32 v212, v200, v201
  v_mul_f32 v204, s36, v204
  v_mfma_f32_16x16x32_bf16 v[152:155], v[208:211], a[216:219], v[152:155]
  v_exp_f32 v203, v203
  v_mfma_f32_16x16x32_bf16 v[156:159], v[208:211], a[220:223], v[156:159]
  s_cmp_lt_u32 s44, 2
  v_mul_f32 v205, s36, v205
  v_mul_f32 v206, s36, v206
  s_cbranch_scc1 L_C6
L_D6:
  v_mfma_f32_16x16x32_bf16 v[192:195], a[96:99], a[0:3], v[252:255]
  v_exp_f32 v204, v204
  v_mfma_f32_16x16x32_bf16 v[192:195], a[100:103], a[4:7], v[192:195]
  v_cvt_pk_bf16_f32 v213, v202, v203
  v_mul_f32 v207, s36, v207
  v_mfma_f32_16x16x32_bf16 v[192:195], a[104:107], a[8:11], v[192:195]
  v_exp_f32 v205, v205
  v_mfma_f32_16x16x32_bf16 v[192:195], a[108:111], a[12:15], v[192:195]
  v_exp_f32 v206, v206
  v_mfma_f32_16x16x32_bf16 v[196:199], a[112:115], a[0:3], v[252:255]
  ds_read_b64_tr_b16 a[188:189], v228 offset:40968
  ds_read_b64_tr_b16 a[190:191], v228 offset:45064
  v_mfma_f32_16x16x32_bf16 v[196:199], a[116:119], a[4:7], v[196:199]
  v_exp_f32 v207, v207
  v_mfma_f32_16x16x32_bf16 v[196:199], a[120:123], a[8:11], v[196:199]
  v_cvt_pk_bf16_f32 v214, v204, v205
  v_cvt_pk_bf16_f32 v215, v206, v207
  v_mfma_f32_16x16x32_bf16 v[196:199], a[124:127], a[12:15], v[196:199]
  ds_add_rtn_u32 v244, v242, v243
  v_smfmac_f32_16x16x64_bf16 a[232:235], a[248:251], v[208:215], v227
  v_mul_f32 v192, s36, v192
  v_mul_f32 v193, s36, v193
  v_mfma_f32_16x16x32_bf16 v[160:163], v[212:215], a[192:195], v[160:163]
  v_exp_f32 v192, v192
  v_mfma_f32_16x16x32_bf16 v[164:167], v[212:215], a[196:199], v[164:167]
  v_mul_f32 v194, s36, v194
  v_mul_f32 v195, s36, v195
  v_mfma_f32_16x16x32_bf16 v[168:171], v[212:215], a[200:203], v[168:171]
  v_exp_f32 v193, v193
  v_mfma_f32_16x16x32_bf16 v[172:175], v[212:215], a[204:207], v[172:175]
  ds_read_b128 a[128:131], v224 offset:49152
  ds_read_b128 a[132:135], v224 offset:49408
  v_mfma_f32_16x16x32_bf16 v[176:179], v[212:215], a[208:211], v[176:179]
  v_exp_f32 v194, v194
  v_mfma_f32_16x16x32_bf16 v[180:183], v[212:215], a[212:215], v[180:183]
  v_cvt_pk_bf16_f32 v208, v192, v193
  v_mul_f32 v196, s36, v196
  v_mfma_f32_16x16x32_bf16 v[184:187], v[212:215], a[216:219], v[184:187]
  v_exp_f32 v195, v195
  v_mfma_f32_16x16x32_bf16 v[188:191], v[212:215], a[220:223], v[188:191]
  v_mul_f32 v197, s36, v197
  v_mul_f32 v198, s36, v198
  v_mfma_f32_16x16x32_bf16 v[200:203], a[96:99], a[16:19], v[252:255]
  v_exp_f32 v196, v196
  v_mfma_f32_16x16x32_bf16 v[200:203], a[100:103], a[20:23], v[200:203]
  v_cvt_pk_bf16_f32 v209, v194, v195
  v_mul_f32 v199, s36, v199
  v_mfma_f32_16x16x32_bf16 v[200:203], a[104:107], a[24:27], v[200:203]
  v_exp_f32 v197, v197
  v_mfma_f32_16x16x32_bf16 v[200:203], a[108:111], a[28:31], v[200:203]
  v_exp_f32 v198, v198
  v_mfma_f32_16x16x32_bf16 v[204:207], a[112:115], a[16:19], v[252:255]
  ds_read_b128 a[136:139], v224 offset:49664
  ds_read_b128 a[140:143], v224 offset:49920
  v_mfma_f32_16x16x32_bf16 v[204:207], a[116:119], a[20:23], v[204:207]
  v_exp_f32 v199, v199
  v_mfma_f32_16x16x32_bf16 v[204:207], a[120:123], a[24:27], v[204:207]
  v_cvt_pk_bf16_f32 v210, v196, v197
  v_cvt_pk_bf16_f32 v211, v198, v199
  v_mfma_f32_16x16x32_bf16 v[204:207], a[124:127], a[28:31], v[204:207]
  s_waitcnt lgkmcnt(4)
  v_mul_f32 v200, s36, v200
  v_mul_f32 v201, s36, v201
  v_mfma_f32_16x16x32_bf16 v[0:3], v[208:211], a[160:163], v[0:3]
  v_exp_f32 v200, v200
  v_mfma_f32_16x16x32_bf16 v[4:7], v[208:211], a[164:167], v[4:7]
  v_mul_f32 v202, s36, v202
  v_mul_f32 v203, s36, v203
  v_mfma_f32_16x16x32_bf16 v[8:11], v[208:211], a[168:171], v[8:11]
  v_exp_f32 v201, v201
  v_mfma_f32_16x16x32_bf16 v[12:15], v[208:211], a[172:175], v[12:15]
  ds_read_b128 a[144:147], v224 offset:53248
  ds_read_b128 a[148:151], v224 offset:53504
  v_mfma_f32_16x16x32_bf16 v[16:19], v[208:211], a[176:179], v[16:19]
  v_exp_f32 v202, v202
  v_mfma_f32_16x16x32_bf16 v[20:23], v[208:211], a[180:183], v[20:23]
  v_cvt_pk_bf16_f32 v212, v200, v201
  v_mul_f32 v204, s36, v204
  v_mfma_f32_16x16x32_bf16 v[24:27], v[208:211], a[184:187], v[24:27]
  v_exp_f32 v203, v203
  v_mfma_f32_16x16x32_bf16 v[28:31], v[208:211], a[188:191], v[28:31]
  v_mul_f32 v205, s36, v205
  v_mul_f32 v206, s36, v206
  v_mfma_f32_16x16x32_bf16 v[192:195], a[96:99], a[32:35], v[252:255]
  v_exp_f32 v204, v204
  v_mfma_f32_16x16x32_bf16 v[192:195], a[100:103], a[36:39], v[192:195]
  v_cvt_pk_bf16_f32 v213, v202, v203
  v_mul_f32 v207, s36, v207
  v_mfma_f32_16x16x32_bf16 v[192:195], a[104:107], a[40:43], v[192:195]
  v_exp_f32 v205, v205
  v_mfma_f32_16x16x32_bf16 v[192:195], a[108:111], a[44:47], v[192:195]
  v_exp_f32 v206, v206
  v_mfma_f32_16x16x32_bf16 v[196:199], a[112:115], a[32:35], v[252:255]
  ds_read_b128 a[152:155], v224 offset:53760
  ds_read_b128 a[156:159], v224 offset:54016
  v_mfma_f32_16x16x32_bf16 v[196:199], a[116:119], a[36:39], v[196:199]
  v_exp_f32 v207, v207
  v_mfma_f32_16x16x32_bf16 v[196:199], a[120:123], a[40:43], v[196:199]
  v_cvt_pk_bf16_f32 v214, v204, v205
  v_cvt_pk_bf16_f32 v215, v206, v207
  v_mfma_f32_16x16x32_bf16 v[196:199], a[124:127], a[44:47], v[196:199]
  v_cmp_gt_u32 vcc, s58, v244
  v_smfmac_f32_16x16x64_bf16 a[224:227], a[248:251], v[208:215], v227
  v_mul_f32 v192, s36, v192
  v_mul_f32 v193, s36, v193
  v_mfma_f32_16x16x32_bf16 v[32:35], v[212:215], a[160:163], v[32:35]
  s_cbranch_vccnz L_s6_D10
L_r6_D10:
  v_exp_f32 v192, v192
  v_mfma_f32_16x16x32_bf16 v[36:39], v[212:215], a[164:167], v[36:39]
  s_add_u32 s58, s58, 1
  v_mul_f32 v194, s36, v194
  v_mul_f32 v195, s36, v195
  v_mfma_f32_16x16x32_bf16 v[40:43], v[212:215], a[168:171], v[40:43]
  v_exp_f32 v193, v193
  v_mfma_f32_16x16x32_bf16 v[44:47], v[212:215], a[172:175], v[44:47]
  ds_read_b64_tr_b16 a[192:193], v226 offset:57344
  ds_read_b64_tr_b16 a[194:195], v226 offset:61440
  v_mfma_f32_16x16x32_bf16 v[48:51], v[212:215], a[176:179], v[48:51]
  v_exp_f32 v194, v194
  v_mfma_f32_16x16x32_bf16 v[52:55], v[212:215], a[180:183], v[52:55]
  v_cvt_pk_bf16_f32 v208, v192, v193
  v_mul_f32 v196, s36, v196
  v_mfma_f32_16x16x32_bf16 v[56:59], v[212:215], a[184:187], v[56:59]
  v_exp_f32 v195, v195
  v_mfma_f32_16x16x32_bf16 v[60:63], v[212:215], a[188:191], v[60:63]
  v_mul_f32 v197, s36, v197
  v_mul_f32 v198, s36, v198
  v_mfma_f32_16x16x32_bf16 v[200:203], a[96:99], a[48:51], v[252:255]
  v_exp_f32 v196, v196
  v_mfma_f32_16x16x32_bf16 v[200:203], a[100:103], a[52:55], v[200:203]
  v_cvt_pk_bf16_f32 v209, v194, v195
  v_mul_f32 v199, s36, v199
  v_mfma_f32_16x16x32_bf16 v[200:203], a[104:107], a[56:59], v[200:203]
  v_exp_f32 v197, v197
  v_mfma_f32_16x16x32_bf16 v[200:203], a[108:111], a[60:63], v[200:203]
  v_exp_f32 v198, v198
  v_mfma_f32_16x16x32_bf16 v[204:207], a[112:115], a[48:51], v[252:255]
  ds_read_b64_tr_b16 a[196:197], v237 offset:57344
  ds_read_b64_tr_b16 a[198:199], v237 offset:61440
  v_mfma_f32_16x16x32_bf16 v[204:207], a[116:119], a[52:55], v[204:207]
  v_exp_f32 v199, v199
  v_mfma_f32_16x16x32_bf16 v[204:207], a[120:123], a[56:59], v[204:207]
  v_cvt_pk_bf16_f32 v210, v196, v197
  v_cvt_pk_bf16_f32 v211, v198, v199
  v_mfma_f32_16x16x32_bf16 v[204:207], a[124:127], a[60:63], v[204:207]
  v_mul_f32 v200, s36, v200
  v_mul_f32 v201, s36, v201
  v_mfma_f32_16x16x32_bf16 v[64:67], v[208:211], a[160:163], v[64:67]
  v_exp_f32 v200, v200
  v_mfma_f32_16x16x32_bf16 v[68:71], v[208:211], a[164:167], v[68:71]
  v_mul_f32 v202, s36, v202
  v_mul_f32 v203, s36, v203
  v_mfma_f32_16x16x32_bf16 v[72:75], v[208:211], a[168:171], v[72:75]
  v_exp_f32 v201, v201
  v_mfma_f32_16x16x32_bf16 v[76:79], v[208:211], a[172:175], v[76:79]
  ds_read_b64_tr_b16 a[200:201], v234 offset:57344
  ds_read_b64_tr_b16 a[202:203], v234 offset:61440
  v_mfma_f32_16x16x32_bf16 v[80:83], v[208:211], a[176:179], v[80:83]
  v_exp_f32 v202, v202
  v_mfma_f32_16x16x32_bf16 v[84:87], v[208:211], a[180:183], v[84:87]
  v_cvt_pk_bf16_f32 v212, v200, v201
  v_mul_f32 v204, s36, v204
  v_mfma_f32_16x16x32_bf16 v[88:91], v[208:211], a[184:187], v[88:91]
  v_exp_f32 v203, v203
  v_mfma_f32_16x16x32_bf16 v[92:95], v[208:211], a[188:191], v[92:95]
  v_mul_f32 v205, s36, v205
  v_mul_f32 v206, s36, v206
  v_mfma_f32_16x16x32_bf16 v[192:195], a[96:99], a[64:67], v[252:255]
  v_exp_f32 v204, v204
  v_mfma_f32_16x16x32_bf16 v[192:195], a[100:103], a[68:71], v[192:195]
  v_cvt_pk_bf16_f32 v213, v202, v203
  v_mul_f32 v207, s36, v207
  v_mfma_f32_16x16x32_bf16 v[192:195], a[104:107], a[72:75], v[192:195]
  v_exp_f32 v205, v205
  v_mfma_f32_16x16x32_bf16 v[192:195], a[108:111], a[76:79], v[192:195]
  v_exp_f32 v206, v206
  v_mfma_f32_16x16x32_bf16 v[196:199], a[112:115], a[64:67], v[252:255]
  ds_read_b64_tr_b16 a[204:205], v228 offset:57344
  ds_read_b64_tr_b16 a[206:207], v228 offset:61440
  v_mfma_f32_16x16x32_bf16 v[196:199], a[116:119], a[68:71], v[196:199]
  v_exp_f32 v207, v207
  v_mfma_f32_16x16x32_bf16 v[196:199], a[120:123], a[72:75], v[196:199]
  v_cvt_pk_bf16_f32 v214, v204, v205
  v_cvt_pk_bf16_f32 v215, v206, v207
  v_mfma_f32_16x16x32_bf16 v[196:199], a[124:127], a[76:79], v[196:199]
  s_nop 0
  v_smfmac_f32_16x16x64_bf16 a[228:231], a[248:251], v[208:215], v227
  v_mul_f32 v192, s36, v192
  v_mul_f32 v193, s36, v193
  v_mfma_f32_16x16x32_bf16 v[96:99], v[212:215], a[160:163], v[96:99]
  v_exp_f32 v192, v192
  v_mfma_f32_16x16x32_bf16 v[100:103], v[212:215], a[164:167], v[100:103]
  v_mul_f32 v194, s36, v194
  v_mul_f32 v195, s36, v195
  v_mfma_f32_16x16x32_bf16 v[104:107], v[212:215], a[168:171], v[104:107]
  v_exp_f32 v193, v193
  v_mfma_f32_16x16x32_bf16 v[108:111], v[212:215], a[172:175], v[108:111]
  ds_read_b64_tr_b16 a[208:209], v226 offset:57352
  ds_read_b64_tr_b16 a[210:211], v226 offset:61448
  v_mfma_f32_16x16x32_bf16 v[112:115], v[212:215], a[176:179], v[112:115]
  v_exp_f32 v194, v194
  v_mfma_f32_16x16x32_bf16 v[116:119], v[212:215], a[180:183], v[116:119]
  v_cvt_pk_bf16_f32 v208, v192, v193
  v_mul_f32 v196, s36, v196
  v_mfma_f32_16x16x32_bf16 v[120:123], v[212:215], a[184:187], v[120:123]
  v_exp_f32 v195, v195
  v_mfma_f32_16x16x32_bf16 v[124:127], v[212:215], a[188:191], v[124:127]
  v_mul_f32 v197, s36, v197
  v_mul_f32 v198, s36, v198
  v_mfma_f32_16x16x32_bf16 v[200:203], a[96:99], a[80:83], v[252:255]
  v_exp_f32 v196, v196
  v_mfma_f32_16x16x32_bf16 v[200:203], a[100:103], a[84:87], v[200:203]
  v_cvt_pk_bf16_f32 v209, v194, v195
  v_mul_f32 v199, s36, v199
  v_mfma_f32_16x16x32_bf16 v[200:203], a[104:107], a[88:91], v[200:203]
  v_exp_f32 v197, v197
  v_mfma_f32_16x16x32_bf16 v[200:203], a[108:111], a[92:95], v[200:203]
  s_waitcnt lgkmcnt(10)
  v_exp_f32 v198, v198
  v_mfma_f32_16x16x32_bf16 v[204:207], a[112:115], a[80:83], v[252:255]
  ds_read_b64_tr_b16 a[212:213], v237 offset:57352
  ds_read_b64_tr_b16 a[214:215], v237 offset:61448
  v_mfma_f32_16x16x32_bf16 v[204:207], a[116:119], a[84:87], v[204:207]
  v_exp_f32 v199, v199
  v_mfma_f32_16x16x32_bf16 v[204:207], a[120:123], a[88:91], v[204:207]
  v_cvt_pk_bf16_f32 v210, v196, v197
  v_cvt_pk_bf16_f32 v211, v198, v199
  v_mfma_f32_16x16x32_bf16 v[204:207], a[124:127], a[92:95], v[204:207]
  v_mul_f32 v200, s36, v200
  v_mul_f32 v201, s36, v201
  v_mfma_f32_16x16x32_bf16 v[128:131], v[208:211], a[160:163], v[128:131]
  v_exp_f32 v200, v200
  v_mfma_f32_16x16x32_bf16 v[132:135], v[208:211], a[164:167], v[132:135]
  v_mul_f32 v202, s36, v202
  v_mul_f32 v203, s36, v203
  v_mfma_f32_16x16x32_bf16 v[136:139], v[208:211], a[168:171], v[136:139]
  v_exp_f32 v201, v201
  v_mfma_f32_16x16x32_bf16 v[140:143], v[208:211], a[172:175], v[140:143]
  ds_read_b64_tr_b16 a[216:217], v234 offset:57352
  ds_read_b64_tr_b16 a[218:219], v234 offset:61448
  v_mfma_f32_16x16x32_bf16 v[144:147], v[208:211], a[176:179], v[144:147]
  v_exp_f32 v202, v202
  v_mfma_f32_16x16x32_bf16 v[148:151], v[208:211], a[180:183], v[148:151]
  v_cvt_pk_bf16_f32 v212, v200, v201
  v_mul_f32 v204, s36, v204
  v_mfma_f32_16x16x32_bf16 v[152:155], v[208:211], a[184:187], v[152:155]
  v_exp_f32 v203, v203
  v_mfma_f32_16x16x32_bf16 v[156:159], v[208:211], a[188:191], v[156:159]
  v_mul_f32 v205, s36, v205
  v_mul_f32 v206, s36, v206
  v_mfma_f32_16x16x32_bf16 v[192:195], a[128:131], a[0:3], v[252:255]
  v_exp_f32 v204, v204
  v_mfma_f32_16x16x32_bf16 v[192:195], a[132:135], a[4:7], v[192:195]
  v_cvt_pk_bf16_f32 v213, v202, v203
  v_mul_f32 v207, s36, v207
  v_mfma_f32_16x16x32_bf16 v[192:195], a[136:139], a[8:11], v[192:195]
  v_exp_f32 v205, v205
  v_mfma_f32_16x16x32_bf16 v[192:195], a[140:143], a[12:15], v[192:195]
  v_exp_f32 v206, v206
  v_mfma_f32_16x16x32_bf16 v[196:199], a[144:147], a[0:3], v[252:255]
  ds_read_b64_tr_b16 a[220:221], v228 offset:57352
  ds_read_b64_tr_b16 a[222:223], v228 offset:61448
  v_mfma_f32_16x16x32_bf16 v[196:199], a[148:151], a[4:7], v[196:199]
  v_exp_f32 v207, v207
  v_mfma_f32_16x16x32_bf16 v[196:199], a[152:155], a[8:11], v[196:199]
  v_cvt_pk_bf16_f32 v214, v204, v205
  v_cvt_pk_bf16_f32 v215, v206, v207
  v_mfma_f32_16x16x32_bf16 v[196:199], a[156:159], a[12:15], v[196:199]
  ds_add_rtn_u32 v244, v242, v243
  v_smfmac_f32_16x16x64_bf16 a[232:235], a[248:251], v[208:215], v227
  v_mul_f32 v192, s36, v192
  v_mul_f32 v193, s36, v193
  v_mfma_f32_16x16x32_bf16 v[160:163], v[212:215], a[160:163], v[160:163]
  v_exp_f32 v192, v192
  v_mfma_f32_16x16x32_bf16 v[164:167], v[212:215], a[164:167], v[164:167]
  v_mul_f32 v194, s36, v194
  v_mul_f32 v195, s36, v195
  v_mfma_f32_16x16x32_bf16 v[168:171], v[212:215], a[168:171], v[168:171]
  v_exp_f32 v193, v193
  v_mfma_f32_16x16x32_bf16 v[172:175], v[212:215], a[172:175], v[172:175]
  ds_read_b128 a[96:99], v224 offset:0
  ds_read_b128 a[100:103], v224 offset:256
  v_mfma_f32_16x16x32_bf16 v[176:179], v[212:215], a[176:179], v[176:179]
  v_exp_f32 v194, v194
  v_mfma_f32_16x16x32_bf16 v[180:183], v[212:215], a[180:183], v[180:183]
  v_cvt_pk_bf16_f32 v208, v192, v193
  v_mul_f32 v196, s36, v196
  v_mfma_f32_16x16x32_bf16 v[184:187], v[212:215], a[184:187], v[184:187]
  v_exp_f32 v195, v195
  v_mfma_f32_16x16x32_bf16 v[188:191], v[212:215], a[188:191], v[188:191]
  v_mul_f32 v197, s36, v197
  v_mul_f32 v198, s36, v198
  v_mfma_f32_16x16x32_bf16 v[200:203], a[128:131], a[16:19], v[252:255]
  v_exp_f32 v196, v196
  v_mfma_f32_16x16x32_bf16 v[200:203], a[132:135], a[20:23], v[200:203]
  v_cvt_pk_bf16_f32 v209, v194, v195
  v_mul_f32 v199, s36, v199
  v_mfma_f32_16x16x32_bf16 v[200:203], a[136:139], a[24:27], v[200:203]
  v_exp_f32 v197, v197
  v_mfma_f32_16x16x32_bf16 v[200:203], a[140:143], a[28:31], v[200:203]
  v_exp_f32 v198, v198
  v_mfma_f32_16x16x32_bf16 v[204:207], a[144:147], a[16:19], v[252:255]
  ds_read_b128 a[104:107], v224 offset:512
  ds_read_b128 a[108:111], v224 offset:768
  v_mfma_f32_16x16x32_bf16 v[204:207], a[148:151], a[20:23], v[204:207]
  v_exp_f32 v199, v199
  v_mfma_f32_16x16x32_bf16 v[204:207], a[152:155], a[24:27], v[204:207]
  v_cvt_pk_bf16_f32 v210, v196, v197
  v_cvt_pk_bf16_f32 v211, v198, v199
  v_mfma_f32_16x16x32_bf16 v[204:207], a[156:159], a[28:31], v[204:207]
  s_waitcnt lgkmcnt(4)
  v_mul_f32 v200, s36, v200
  v_mul_f32 v201, s36, v201
  v_mfma_f32_16x16x32_bf16 v[0:3], v[208:211], a[192:195], v[0:3]
  v_exp_f32 v200, v200
  v_mfma_f32_16x16x32_bf16 v[4:7], v[208:211], a[196:199], v[4:7]
  v_mul_f32 v202, s36, v202
  v_mul_f32 v203, s36, v203
  v_mfma_f32_16x16x32_bf16 v[8:11], v[208:211], a[200:203], v[8:11]
  v_exp_f32 v201, v201
  v_mfma_f32_16x16x32_bf16 v[12:15], v[208:211], a[204:207], v[12:15]
  ds_read_b128 a[112:115], v224 offset:4096
  ds_read_b128 a[116:119], v224 offset:4352
  v_mfma_f32_16x16x32_bf16 v[16:19], v[208:211], a[208:211], v[16:19]
  v_exp_f32 v202, v202
  v_mfma_f32_16x16x32_bf16 v[20:23], v[208:211], a[212:215], v[20:23]
  v_cvt_pk_bf16_f32 v212, v200, v201
  v_mul_f32 v204, s36, v204
  v_mfma_f32_16x16x32_bf16 v[24:27], v[208:211], a[216:219], v[24:27]
  v_exp_f32 v203, v203
  v_mfma_f32_16x16x32_bf16 v[28:31], v[208:211], a[220:223], v[28:31]
  v_mul_f32 v205, s36, v205
  v_mul_f32 v206, s36, v206
  v_mfma_f32_16x16x32_bf16 v[192:195], a[128:131], a[32:35], v[252:255]
  v_exp_f32 v204, v204
  v_mfma_f32_16x16x32_bf16 v[192:195], a[132:135], a[36:39], v[192:195]
  v_cvt_pk_bf16_f32 v213, v202, v203
  v_mul_f32 v207, s36, v207
  v_mfma_f32_16x16x32_bf16 v[192:195], a[136:139], a[40:43], v[192:195]
  v_exp_f32 v205, v205
  v_mfma_f32_16x16x32_bf16 v[192:195], a[140:143], a[44:47], v[192:195]
  v_exp_f32 v206, v206
  v_mfma_f32_16x16x32_bf16 v[196:199], a[144:147], a[32:35], v[252:255]
  ds_read_b128 a[120:123], v224 offset:4608
  ds_read_b128 a[124:127], v224 offset:4864
  v_mfma_f32_16x16x32_bf16 v[196:199], a[148:151], a[36:39], v[196:199]
  v_exp_f32 v207, v207
  v_mfma_f32_16x16x32_bf16 v[196:199], a[152:155], a[40:43], v[196:199]
  v_cvt_pk_bf16_f32 v214, v204, v205
  v_cvt_pk_bf16_f32 v215, v206, v207
  v_mfma_f32_16x16x32_bf16 v[196:199], a[156:159], a[44:47], v[196:199]
  v_cmp_gt_u32 vcc, s58, v244
  v_smfmac_f32_16x16x64_bf16 a[224:227], a[248:251], v[208:215], v227
  v_mul_f32 v192, s36, v192
  v_mul_f32 v193, s36, v193
  v_mfma_f32_16x16x32_bf16 v[32:35], v[212:215], a[192:195], v[32:35]
  s_cbranch_vccnz L_s6_D11
L_r6_D11:
  v_exp_f32 v192, v192
  v_mfma_f32_16x16x32_bf16 v[36:39], v[212:215], a[196:199], v[36:39]
  s_add_u32 s58, s58, 1
  v_mul_f32 v194, s36, v194
  v_mul_f32 v195, s36, v195
  v_mfma_f32_16x16x32_bf16 v[40:43], v[212:215], a[200:203], v[40:43]
  v_exp_f32 v193, v193
  v_mfma_f32_16x16x32_bf16 v[44:47], v[212:215], a[204:207], v[44:47]
  ds_read_b64_tr_b16 a[160:161], v226 offset:8192
  ds_read_b64_tr_b16 a[162:163], v226 offset:12288
  v_mfma_f32_16x16x32_bf16 v[48:51], v[212:215], a[208:211], v[48:51]
  v_exp_f32 v194, v194
  v_mfma_f32_16x16x32_bf16 v[52:55], v[212:215], a[212:215], v[52:55]
  v_cvt_pk_bf16_f32 v208, v192, v193
  v_mul_f32 v196, s36, v196
  v_mfma_f32_16x16x32_bf16 v[56:59], v[212:215], a[216:219], v[56:59]
  v_exp_f32 v195, v195
  v_mfma_f32_16x16x32_bf16 v[60:63], v[212:215], a[220:223], v[60:63]
  v_mul_f32 v197, s36, v197
  v_mul_f32 v198, s36, v198
  v_mfma_f32_16x16x32_bf16 v[200:203], a[128:131], a[48:51], v[252:255]
  v_exp_f32 v196, v196
  v_mfma_f32_16x16x32_bf16 v[200:203], a[132:135], a[52:55], v[200:203]
  v_cvt_pk_bf16_f32 v209, v194, v195
  v_mul_f32 v199, s36, v199
  v_mfma_f32_16x16x32_bf16 v[200:203], a[136:139], a[56:59], v[200:203]
  v_exp_f32 v197, v197
  v_mfma_f32_16x16x32_bf16 v[200:203], a[140:143], a[60:63], v[200:203]
  v_exp_f32 v198, v198
  v_mfma_f32_16x16x32_bf16 v[204:207], a[144:147], a[48:51], v[252:255]
  ds_read_b64_tr_b16 a[164:165], v237 offset:8192
  ds_read_b64_tr_b16 a[166:167], v237 offset:12288
  v_mfma_f32_16x16x32_bf16 v[204:207], a[148:151], a[52:55], v[204:207]
  v_exp_f32 v199, v199
  v_mfma_f32_16x16x32_bf16 v[204:207], a[152:155], a[56:59], v[204:207]
  v_cvt_pk_bf16_f32 v210, v196, v197
  v_cvt_pk_bf16_f32 v211, v198, v199
  v_mfma_f32_16x16x32_bf16 v[204:207], a[156:159], a[60:63], v[204:207]
  v_mul_f32 v200, s36, v200
  v_mul_f32 v201, s36, v201
  v_mfma_f32_16x16x32_bf16 v[64:67], v[208:211], a[192:195], v[64:67]
  v_exp_f32 v200, v200
  v_mfma_f32_16x16x32_bf16 v[68:71], v[208:211], a[196:199], v[68:71]
  v_mul_f32 v202, s36, v202
  v_mul_f32 v203, s36, v203
  v_mfma_f32_16x16x32_bf16 v[72:75], v[208:211], a[200:203], v[72:75]
  v_exp_f32 v201, v201
  v_mfma_f32_16x16x32_bf16 v[76:79], v[208:211], a[204:207], v[76:79]
  ds_read_b64_tr_b16 a[168:169], v234 offset:8192
  ds_read_b64_tr_b16 a[170:171], v234 offset:12288
  v_mfma_f32_16x16x32_bf16 v[80:83], v[208:211], a[208:211], v[80:83]
  v_exp_f32 v202, v202
  v_mfma_f32_16x16x32_bf16 v[84:87], v[208:211], a[212:215], v[84:87]
  v_cvt_pk_bf16_f32 v212, v200, v201
  v_mul_f32 v204, s36, v204
  v_mfma_f32_16x16x32_bf16 v[88:91], v[208:211], a[216:219], v[88:91]
  v_exp_f32 v203, v203
  v_mfma_f32_16x16x32_bf16 v[92:95], v[208:211], a[220:223], v[92:95]
  v_mul_f32 v205, s36, v205
  v_mul_f32 v206, s36, v206
  v_mfma_f32_16x16x32_bf16 v[192:195], a[128:131], a[64:67], v[252:255]
  v_exp_f32 v204, v204
  v_mfma_f32_16x16x32_bf16 v[192:195], a[132:135], a[68:71], v[192:195]
  v_cvt_pk_bf16_f32 v213, v202, v203
  v_mul_f32 v207, s36, v207
  v_mfma_f32_16x16x32_bf16 v[192:195], a[136:139], a[72:75], v[192:195]
  v_exp_f32 v205, v205
  v_mfma_f32_16x16x32_bf16 v[192:195], a[140:143], a[76:79], v[192:195]
  v_exp_f32 v206, v206
  v_mfma_f32_16x16x32_bf16 v[196:199], a[144:147], a[64:67], v[252:255]
  ds_read_b64_tr_b16 a[172:173], v228 offset:8192
  ds_read_b64_tr_b16 a[174:175], v228 offset:12288
  v_mfma_f32_16x16x32_bf16 v[196:199], a[148:151], a[68:71], v[196:199]
  v_exp_f32 v207, v207
  v_mfma_f32_16x16x32_bf16 v[196:199], a[152:155], a[72:75], v[196:199]
  v_cvt_pk_bf16_f32 v214, v204, v205
  v_cvt_pk_bf16_f32 v215, v206, v207
  v_mfma_f32_16x16x32_bf16 v[196:199], a[156:159], a[76:79], v[196:199]
  s_nop 0
  v_smfmac_f32_16x16x64_bf16 a[228:231], a[248:251], v[208:215], v227
  v_mul_f32 v192, s36, v192
  v_mul_f32 v193, s36, v193
  v_mfma_f32_16x16x32_bf16 v[96:99], v[212:215], a[192:195], v[96:99]
  v_exp_f32 v192, v192
  v_mfma_f32_16x16x32_bf16 v[100:103], v[212:215], a[196:199], v[100:103]
  v_mul_f32 v194, s36, v194
  v_mul_f32 v195, s36, v195
  v_mfma_f32_16x16x32_bf16 v[104:107], v[212:215], a[200:203], v[104:107]
  v_exp_f32 v193, v193
  v_mfma_f32_16x16x32_bf16 v[108:111], v[212:215], a[204:207], v[108:111]
  ds_read_b64_tr_b16 a[176:177], v226 offset:8200
  ds_read_b64_tr_b16 a[178:179], v226 offset:12296
  v_mfma_f32_16x16x32_bf16 v[112:115], v[212:215], a[208:211], v[112:115]
  v_exp_f32 v194, v194
  v_mfma_f32_16x16x32_bf16 v[116:119], v[212:215], a[212:215], v[116:119]
  v_cvt_pk_bf16_f32 v208, v192, v193
  v_mul_f32 v196, s36, v196
  v_mfma_f32_16x16x32_bf16 v[120:123], v[212:215], a[216:219], v[120:123]
  v_exp_f32 v195, v195
  v_mfma_f32_16x16x32_bf16 v[124:127], v[212:215], a[220:223], v[124:127]
  v_mul_f32 v197, s36, v197
  v_mul_f32 v198, s36, v198
  v_mfma_f32_16x16x32_bf16 v[200:203], a[128:131], a[80:83], v[252:255]
  v_exp_f32 v196, v196
  v_mfma_f32_16x16x32_bf16 v[200:203], a[132:135], a[84:87], v[200:203]
  v_cvt_pk_bf16_f32 v209, v194, v195
  v_mul_f32 v199, s36, v199
  v_mfma_f32_16x16x32_bf16 v[200:203], a[136:139], a[88:91], v[200:203]
  v_exp_f32 v197, v197
  v_mfma_f32_16x16x32_bf16 v[200:203], a[140:143], a[92:95], v[200:203]
  s_waitcnt lgkmcnt(10)
  v_exp_f32 v198, v198
  v_mfma_f32_16x16x32_bf16 v[204:207], a[144:147], a[80:83], v[252:255]
  ds_read_b64_tr_b16 a[180:181], v237 offset:8200
  ds_read_b64_tr_b16 a[182:183], v237 offset:12296
  v_mfma_f32_16x16x32_bf16 v[204:207], a[148:151], a[84:87], v[204:207]
  v_exp_f32 v199, v199
  v_mfma_f32_16x16x32_bf16 v[204:207], a[152:155], a[88:91], v[204:207]
  v_cvt_pk_bf16_f32 v210, v196, v197
  v_cvt_pk_bf16_f32 v211, v198, v199
  v_mfma_f32_16x16x32_bf16 v[204:207], a[156:159], a[92:95], v[204:207]
  v_mul_f32 v200, s36, v200
  v_mul_f32 v201, s36, v201
  v_mfma_f32_16x16x32_bf16 v[128:131], v[208:211], a[192:195], v[128:131]
  v_exp_f32 v200, v200
  v_mfma_f32_16x16x32_bf16 v[132:135], v[208:211], a[196:199], v[132:135]
  v_mul_f32 v202, s36, v202
  v_mul_f32 v203, s36, v203
  v_mfma_f32_16x16x32_bf16 v[136:139], v[208:211], a[200:203], v[136:139]
  v_exp_f32 v201, v201
  v_mfma_f32_16x16x32_bf16 v[140:143], v[208:211], a[204:207], v[140:143]
  ds_read_b64_tr_b16 a[184:185], v234 offset:8200
  ds_read_b64_tr_b16 a[186:187], v234 offset:12296
  v_mfma_f32_16x16x32_bf16 v[144:147], v[208:211], a[208:211], v[144:147]
  v_exp_f32 v202, v202
  v_mfma_f32_16x16x32_bf16 v[148:151], v[208:211], a[212:215], v[148:151]
  v_cvt_pk_bf16_f32 v212, v200, v201
  v_mul_f32 v204, s36, v204
  v_mfma_f32_16x16x32_bf16 v[152:155], v[208:211], a[216:219], v[152:155]
  v_exp_f32 v203, v203
  v_mfma_f32_16x16x32_bf16 v[156:159], v[208:211], a[220:223], v[156:159]
  v_mul_f32 v205, s36, v205
  v_mul_f32 v206, s36, v206
  v_mfma_f32_16x16x32_bf16 v[192:195], a[96:99], a[0:3], v[252:255]
  v_exp_f32 v204, v204
  v_mfma_f32_16x16x32_bf16 v[192:195], a[100:103], a[4:7], v[192:195]
  v_cvt_pk_bf16_f32 v213, v202, v203
  v_mul_f32 v207, s36, v207
  v_mfma_f32_16x16x32_bf16 v[192:195], a[104:107], a[8:11], v[192:195]
  v_exp_f32 v205, v205
  v_mfma_f32_16x16x32_bf16 v[192:195], a[108:111], a[12:15], v[192:195]
  v_exp_f32 v206, v206
  v_mfma_f32_16x16x32_bf16 v[196:199], a[112:115], a[0:3], v[252:255]
  ds_read_b64_tr_b16 a[188:189], v228 offset:8200
  ds_read_b64_tr_b16 a[190:191], v228 offset:12296
  v_mfma_f32_16x16x32_bf16 v[196:199], a[116:119], a[4:7], v[196:199]
  v_exp_f32 v207, v207
  v_mfma_f32_16x16x32_bf16 v[196:199], a[120:123], a[8:11], v[196:199]
  v_cvt_pk_bf16_f32 v214, v204, v205
  v_cvt_pk_bf16_f32 v215, v206, v207
  v_mfma_f32_16x16x32_bf16 v[196:199], a[124:127], a[12:15], v[196:199]
  ds_add_rtn_u32 v244, v242, v243
  v_smfmac_f32_16x16x64_bf16 a[232:235], a[248:251], v[208:215], v227
  v_mul_f32 v192, s36, v192
  v_mul_f32 v193, s36, v193
  v_mfma_f32_16x16x32_bf16 v[160:163], v[212:215], a[192:195], v[160:163]
  v_exp_f32 v192, v192
  v_mfma_f32_16x16x32_bf16 v[164:167], v[212:215], a[196:199], v[164:167]
  v_mul_f32 v194, s36, v194
  v_mul_f32 v195, s36, v195
  v_mfma_f32_16x16x32_bf16 v[168:171], v[212:215], a[200:203], v[168:171]
  v_exp_f32 v193, v193
  v_mfma_f32_16x16x32_bf16 v[172:175], v[212:215], a[204:207], v[172:175]
  ds_read_b128 a[128:131], v224 offset:16384
  ds_read_b128 a[132:135], v224 offset:16640
  v_mfma_f32_16x16x32_bf16 v[176:179], v[212:215], a[208:211], v[176:179]
  v_exp_f32 v194, v194
  v_mfma_f32_16x16x32_bf16 v[180:183], v[212:215], a[212:215], v[180:183]
  v_cvt_pk_bf16_f32 v208, v192, v193
  v_mul_f32 v196, s36, v196
  v_mfma_f32_16x16x32_bf16 v[184:187], v[212:215], a[216:219], v[184:187]
  v_exp_f32 v195, v195
  v_mfma_f32_16x16x32_bf16 v[188:191], v[212:215], a[220:223], v[188:191]
  v_mul_f32 v197, s36, v197
  v_mul_f32 v198, s36, v198
  v_mfma_f32_16x16x32_bf16 v[200:203], a[96:99], a[16:19], v[252:255]
  v_exp_f32 v196, v196
  v_mfma_f32_16x16x32_bf16 v[200:203], a[100:103], a[20:23], v[200:203]
  v_cvt_pk_bf16_f32 v209, v194, v195
  v_mul_f32 v199, s36, v199
  v_mfma_f32_16x16x32_bf16 v[200:203], a[104:107], a[24:27], v[200:203]
  v_exp_f32 v197, v197
  v_mfma_f32_16x16x32_bf16 v[200:203], a[108:111], a[28:31], v[200:203]
  v_exp_f32 v198, v198
  v_mfma_f32_16x16x32_bf16 v[204:207], a[112:115], a[16:19], v[252:255]
  ds_read_b128 a[136:139], v224 offset:16896
  ds_read_b128 a[140:143], v224 offset:17152
  v_mfma_f32_16x16x32_bf16 v[204:207], a[116:119], a[20:23], v[204:207]
  v_exp_f32 v199, v199
  v_mfma_f32_16x16x32_bf16 v[204:207], a[120:123], a[24:27], v[204:207]
  v_cvt_pk_bf16_f32 v210, v196, v197
  v_cvt_pk_bf16_f32 v211, v198, v199
  v_mfma_f32_16x16x32_bf16 v[204:207], a[124:127], a[28:31], v[204:207]
  s_waitcnt lgkmcnt(4)
  v_mul_f32 v200, s36, v200
  v_mul_f32 v201, s36, v201
  v_mfma_f32_16x16x32_bf16 v[0:3], v[208:211], a[160:163], v[0:3]
  v_exp_f32 v200, v200
  v_mfma_f32_16x16x32_bf16 v[4:7], v[208:211], a[164:167], v[4:7]
  v_mul_f32 v202, s36, v202
  v_mul_f32 v203, s36, v203
  v_mfma_f32_16x16x32_bf16 v[8:11], v[208:211], a[168:171], v[8:11]
  v_exp_f32 v201, v201
  v_mfma_f32_16x16x32_bf16 v[12:15], v[208:211], a[172:175], v[12:15]
  ds_read_b128 a[144:147], v224 offset:20480
  ds_read_b128 a[148:151], v224 offset:20736
  v_mfma_f32_16x16x32_bf16 v[16:19], v[208:211], a[176:179], v[16:19]
  v_exp_f32 v202, v202
  v_mfma_f32_16x16x32_bf16 v[20:23], v[208:211], a[180:183], v[20:23]
  v_cvt_pk_bf16_f32 v212, v200, v201
  v_mul_f32 v204, s36, v204
  v_mfma_f32_16x16x32_bf16 v[24:27], v[208:211], a[184:187], v[24:27]
  v_exp_f32 v203, v203
  v_mfma_f32_16x16x32_bf16 v[28:31], v[208:211], a[188:191], v[28:31]
  v_mul_f32 v205, s36, v205
  v_mul_f32 v206, s36, v206
  v_mfma_f32_16x16x32_bf16 v[192:195], a[96:99], a[32:35], v[252:255]
  v_exp_f32 v204, v204
  v_mfma_f32_16x16x32_bf16 v[192:195], a[100:103], a[36:39], v[192:195]
  v_cvt_pk_bf16_f32 v213, v202, v203
  v_mul_f32 v207, s36, v207
  v_mfma_f32_16x16x32_bf16 v[192:195], a[104:107], a[40:43], v[192:195]
  v_exp_f32 v205, v205
  v_mfma_f32_16x16x32_bf16 v[192:195], a[108:111], a[44:47], v[192:195]
  v_exp_f32 v206, v206
  v_mfma_f32_16x16x32_bf16 v[196:199], a[112:115], a[32:35], v[252:255]
  ds_read_b128 a[152:155], v224 offset:20992
  ds_read_b128 a[156:159], v224 offset:21248
  v_mfma_f32_16x16x32_bf16 v[196:199], a[116:119], a[36:39], v[196:199]
  v_exp_f32 v207, v207
  v_mfma_f32_16x16x32_bf16 v[196:199], a[120:123], a[40:43], v[196:199]
  v_cvt_pk_bf16_f32 v214, v204, v205
  v_cvt_pk_bf16_f32 v215, v206, v207
  v_mfma_f32_16x16x32_bf16 v[196:199], a[124:127], a[44:47], v[196:199]
  v_cmp_gt_u32 vcc, s58, v244
  v_smfmac_f32_16x16x64_bf16 a[224:227], a[248:251], v[208:215], v227
  v_mul_f32 v192, s36, v192
  v_mul_f32 v193, s36, v193
  v_mfma_f32_16x16x32_bf16 v[32:35], v[212:215], a[160:163], v[32:35]
  s_cbranch_vccnz L_s6_D12
L_r6_D12:
  v_exp_f32 v192, v192
  v_mfma_f32_16x16x32_bf16 v[36:39], v[212:215], a[164:167], v[36:39]
  s_add_u32 s58, s58, 1
  v_mul_f32 v194, s36, v194
  v_mul_f32 v195, s36, v195
  v_mfma_f32_16x16x32_bf16 v[40:43], v[212:215], a[168:171], v[40:43]
  v_exp_f32 v193, v193
  v_mfma_f32_16x16x32_bf16 v[44:47], v[212:215], a[172:175], v[44:47]
  ds_read_b64_tr_b16 a[192:193], v226 offset:24576
  ds_read_b64_tr_b16 a[194:195], v226 offset:28672
  v_mfma_f32_16x16x32_bf16 v[48:51], v[212:215], a[176:179], v[48:51]
  v_exp_f32 v194, v194
  v_mfma_f32_16x16x32_bf16 v[52:55], v[212:215], a[180:183], v[52:55]
  v_cvt_pk_bf16_f32 v208, v192, v193
  v_mul_f32 v196, s36, v196
  v_mfma_f32_16x16x32_bf16 v[56:59], v[212:215], a[184:187], v[56:59]
  v_exp_f32 v195, v195
  v_mfma_f32_16x16x32_bf16 v[60:63], v[212:215], a[188:191], v[60:63]
  v_mul_f32 v197, s36, v197
  v_mul_f32 v198, s36, v198
  v_mfma_f32_16x16x32_bf16 v[200:203], a[96:99], a[48:51], v[252:255]
  v_exp_f32 v196, v196
  v_mfma_f32_16x16x32_bf16 v[200:203], a[100:103], a[52:55], v[200:203]
  v_cvt_pk_bf16_f32 v209, v194, v195
  v_mul_f32 v199, s36, v199
  v_mfma_f32_16x16x32_bf16 v[200:203], a[104:107], a[56:59], v[200:203]
  v_exp_f32 v197, v197
  v_mfma_f32_16x16x32_bf16 v[200:203], a[108:111], a[60:63], v[200:203]
  v_exp_f32 v198, v198
  v_mfma_f32_16x16x32_bf16 v[204:207], a[112:115], a[48:51], v[252:255]
  ds_read_b64_tr_b16 a[196:197], v237 offset:24576
  ds_read_b64_tr_b16 a[198:199], v237 offset:28672
  v_mfma_f32_16x16x32_bf16 v[204:207], a[116:119], a[52:55], v[204:207]
  v_exp_f32 v199, v199
  v_mfma_f32_16x16x32_bf16 v[204:207], a[120:123], a[56:59], v[204:207]
  v_cvt_pk_bf16_f32 v210, v196, v197
  v_cvt_pk_bf16_f32 v211, v198, v199
  v_mfma_f32_16x16x32_bf16 v[204:207], a[124:127], a[60:63], v[204:207]
  v_mul_f32 v200, s36, v200
  v_mul_f32 v201, s36, v201
  v_mfma_f32_16x16x32_bf16 v[64:67], v[208:211], a[160:163], v[64:67]
  v_exp_f32 v200, v200
  v_mfma_f32_16x16x32_bf16 v[68:71], v[208:211], a[164:167], v[68:71]
  v_mul_f32 v202, s36, v202
  v_mul_f32 v203, s36, v203
  v_mfma_f32_16x16x32_bf16 v[72:75], v[208:211], a[168:171], v[72:75]
  v_exp_f32 v201, v201
  v_mfma_f32_16x16x32_bf16 v[76:79], v[208:211], a[172:175], v[76:79]
  ds_read_b64_tr_b16 a[200:201], v234 offset:24576
  ds_read_b64_tr_b16 a[202:203], v234 offset:28672
  v_mfma_f32_16x16x32_bf16 v[80:83], v[208:211], a[176:179], v[80:83]
  v_exp_f32 v202, v202
  v_mfma_f32_16x16x32_bf16 v[84:87], v[208:211], a[180:183], v[84:87]
  v_cvt_pk_bf16_f32 v212, v200, v201
  v_mul_f32 v204, s36, v204
  v_mfma_f32_16x16x32_bf16 v[88:91], v[208:211], a[184:187], v[88:91]
  v_exp_f32 v203, v203
  v_mfma_f32_16x16x32_bf16 v[92:95], v[208:211], a[188:191], v[92:95]
  v_mul_f32 v205, s36, v205
  v_mul_f32 v206, s36, v206
  v_mfma_f32_16x16x32_bf16 v[192:195], a[96:99], a[64:67], v[252:255]
  v_exp_f32 v204, v204
  v_mfma_f32_16x16x32_bf16 v[192:195], a[100:103], a[68:71], v[192:195]
  v_cvt_pk_bf16_f32 v213, v202, v203
  v_mul_f32 v207, s36, v207
  v_mfma_f32_16x16x32_bf16 v[192:195], a[104:107], a[72:75], v[192:195]
  v_exp_f32 v205, v205
  v_mfma_f32_16x16x32_bf16 v[192:195], a[108:111], a[76:79], v[192:195]
  v_exp_f32 v206, v206
  v_mfma_f32_16x16x32_bf16 v[196:199], a[112:115], a[64:67], v[252:255]
  ds_read_b64_tr_b16 a[204:205], v228 offset:24576
  ds_read_b64_tr_b16 a[206:207], v228 offset:28672
  v_mfma_f32_16x16x32_bf16 v[196:199], a[116:119], a[68:71], v[196:199]
  v_exp_f32 v207, v207
  v_mfma_f32_16x16x32_bf16 v[196:199], a[120:123], a[72:75], v[196:199]
  v_cvt_pk_bf16_f32 v214, v204, v205
  v_cvt_pk_bf16_f32 v215, v206, v207
  v_mfma_f32_16x16x32_bf16 v[196:199], a[124:127], a[76:79], v[196:199]
  s_nop 0
  v_smfmac_f32_16x16x64_bf16 a[228:231], a[248:251], v[208:215], v227
  v_mul_f32 v192, s36, v192
  v_mul_f32 v193, s36, v193
  v_mfma_f32_16x16x32_bf16 v[96:99], v[212:215], a[160:163], v[96:99]
  v_exp_f32 v192, v192
  v_mfma_f32_16x16x32_bf16 v[100:103], v[212:215], a[164:167], v[100:103]
  v_mul_f32 v194, s36, v194
  v_mul_f32 v195, s36, v195
  v_mfma_f32_16x16x32_bf16 v[104:107], v[212:215], a[168:171], v[104:107]
  v_exp_f32 v193, v193
  v_mfma_f32_16x16x32_bf16 v[108:111], v[212:215], a[172:175], v[108:111]
  ds_read_b64_tr_b16 a[208:209], v226 offset:24584
  ds_read_b64_tr_b16 a[210:211], v226 offset:28680
  v_mfma_f32_16x16x32_bf16 v[112:115], v[212:215], a[176:179], v[112:115]
  v_exp_f32 v194, v194
  v_mfma_f32_16x16x32_bf16 v[116:119], v[212:215], a[180:183], v[116:119]
  v_cvt_pk_bf16_f32 v208, v192, v193
  v_mul_f32 v196, s36, v196
  v_mfma_f32_16x16x32_bf16 v[120:123], v[212:215], a[184:187], v[120:123]
  v_exp_f32 v195, v195
  v_mfma_f32_16x16x32_bf16 v[124:127], v[212:215], a[188:191], v[124:127]
  v_mul_f32 v197, s36, v197
  v_mul_f32 v198, s36, v198
  v_mfma_f32_16x16x32_bf16 v[200:203], a[96:99], a[80:83], v[252:255]
  v_exp_f32 v196, v196
  v_mfma_f32_16x16x32_bf16 v[200:203], a[100:103], a[84:87], v[200:203]
  v_cvt_pk_bf16_f32 v209, v194, v195
  v_mul_f32 v199, s36, v199
  v_mfma_f32_16x16x32_bf16 v[200:203], a[104:107], a[88:91], v[200:203]
  v_exp_f32 v197, v197
  v_mfma_f32_16x16x32_bf16 v[200:203], a[108:111], a[92:95], v[200:203]
  s_waitcnt lgkmcnt(10)
  v_exp_f32 v198, v198
  v_mfma_f32_16x16x32_bf16 v[204:207], a[112:115], a[80:83], v[252:255]
  ds_read_b64_tr_b16 a[212:213], v237 offset:24584
  ds_read_b64_tr_b16 a[214:215], v237 offset:28680
  v_mfma_f32_16x16x32_bf16 v[204:207], a[116:119], a[84:87], v[204:207]
  v_exp_f32 v199, v199
  v_mfma_f32_16x16x32_bf16 v[204:207], a[120:123], a[88:91], v[204:207]
  v_cvt_pk_bf16_f32 v210, v196, v197
  v_cvt_pk_bf16_f32 v211, v198, v199
  v_mfma_f32_16x16x32_bf16 v[204:207], a[124:127], a[92:95], v[204:207]
  v_mul_f32 v200, s36, v200
  v_mul_f32 v201, s36, v201
  v_mfma_f32_16x16x32_bf16 v[128:131], v[208:211], a[160:163], v[128:131]
  v_exp_f32 v200, v200
  v_mfma_f32_16x16x32_bf16 v[132:135], v[208:211], a[164:167], v[132:135]
  v_mul_f32 v202, s36, v202
  v_mul_f32 v203, s36, v203
  v_mfma_f32_16x16x32_bf16 v[136:139], v[208:211], a[168:171], v[136:139]
  v_exp_f32 v201, v201
  v_mfma_f32_16x16x32_bf16 v[140:143], v[208:211], a[172:175], v[140:143]
  ds_read_b64_tr_b16 a[216:217], v234 offset:24584
  ds_read_b64_tr_b16 a[218:219], v234 offset:28680
  v_mfma_f32_16x16x32_bf16 v[144:147], v[208:211], a[176:179], v[144:147]
  v_exp_f32 v202, v202
  v_mfma_f32_16x16x32_bf16 v[148:151], v[208:211], a[180:183], v[148:151]
  v_cvt_pk_bf16_f32 v212, v200, v201
  v_mul_f32 v204, s36, v204
  v_mfma_f32_16x16x32_bf16 v[152:155], v[208:211], a[184:187], v[152:155]
  v_exp_f32 v203, v203
  v_mfma_f32_16x16x32_bf16 v[156:159], v[208:211], a[188:191], v[156:159]
  v_mul_f32 v205, s36, v205
  v_mul_f32 v206, s36, v206
  v_mfma_f32_16x16x32_bf16 v[192:195], a[128:131], a[0:3], v[252:255]
  v_exp_f32 v204, v204
  v_mfma_f32_16x16x32_bf16 v[192:195], a[132:135], a[4:7], v[192:195]
  v_cvt_pk_bf16_f32 v213, v202, v203
  v_mul_f32 v207, s36, v207
  v_mfma_f32_16x16x32_bf16 v[192:195], a[136:139], a[8:11], v[192:195]
  v_exp_f32 v205, v205
  v_mfma_f32_16x16x32_bf16 v[192:195], a[140:143], a[12:15], v[192:195]
  v_exp_f32 v206, v206
  v_mfma_f32_16x16x32_bf16 v[196:199], a[144:147], a[0:3], v[252:255]
  ds_read_b64_tr_b16 a[220:221], v228 offset:24584
  ds_read_b64_tr_b16 a[222:223], v228 offset:28680
  v_mfma_f32_16x16x32_bf16 v[196:199], a[148:151], a[4:7], v[196:199]
  v_exp_f32 v207, v207
  v_mfma_f32_16x16x32_bf16 v[196:199], a[152:155], a[8:11], v[196:199]
  v_cvt_pk_bf16_f32 v214, v204, v205
  v_cvt_pk_bf16_f32 v215, v206, v207
  v_mfma_f32_16x16x32_bf16 v[196:199], a[156:159], a[12:15], v[196:199]
  ds_add_rtn_u32 v244, v242, v243
  v_smfmac_f32_16x16x64_bf16 a[232:235], a[248:251], v[208:215], v227
  v_mul_f32 v192, s36, v192
  v_mul_f32 v193, s36, v193
  v_mfma_f32_16x16x32_bf16 v[160:163], v[212:215], a[160:163], v[160:163]
  v_exp_f32 v192, v192
  v_mfma_f32_16x16x32_bf16 v[164:167], v[212:215], a[164:167], v[164:167]
  v_mul_f32 v194, s36, v194
  v_mul_f32 v195, s36, v195
  v_mfma_f32_16x16x32_bf16 v[168:171], v[212:215], a[168:171], v[168:171]
  v_exp_f32 v193, v193
  v_mfma_f32_16x16x32_bf16 v[172:175], v[212:215], a[172:175], v[172:175]
  ds_read_b128 a[96:99], v224 offset:32768
  ds_read_b128 a[100:103], v224 offset:33024
  v_mfma_f32_16x16x32_bf16 v[176:179], v[212:215], a[176:179], v[176:179]
  v_exp_f32 v194, v194
  v_mfma_f32_16x16x32_bf16 v[180:183], v[212:215], a[180:183], v[180:183]
  v_cvt_pk_bf16_f32 v208, v192, v193
  v_mul_f32 v196, s36, v196
  v_mfma_f32_16x16x32_bf16 v[184:187], v[212:215], a[184:187], v[184:187]
  v_exp_f32 v195, v195
  v_mfma_f32_16x16x32_bf16 v[188:191], v[212:215], a[188:191], v[188:191]
  v_mul_f32 v197, s36, v197
  v_mul_f32 v198, s36, v198
  v_mfma_f32_16x16x32_bf16 v[200:203], a[128:131], a[16:19], v[252:255]
  v_exp_f32 v196, v196
  v_mfma_f32_16x16x32_bf16 v[200:203], a[132:135], a[20:23], v[200:203]
  v_cvt_pk_bf16_f32 v209, v194, v195
  v_mul_f32 v199, s36, v199
  v_mfma_f32_16x16x32_bf16 v[200:203], a[136:139], a[24:27], v[200:203]
  v_exp_f32 v197, v197
  v_mfma_f32_16x16x32_bf16 v[200:203], a[140:143], a[28:31], v[200:203]
  v_exp_f32 v198, v198
  v_mfma_f32_16x16x32_bf16 v[204:207], a[144:147], a[16:19], v[252:255]
  ds_read_b128 a[104:107], v224 offset:33280
  ds_read_b128 a[108:111], v224 offset:33536
  v_mfma_f32_16x16x32_bf16 v[204:207], a[148:151], a[20:23], v[204:207]
  v_exp_f32 v199, v199
  v_mfma_f32_16x16x32_bf16 v[204:207], a[152:155], a[24:27], v[204:207]
  v_cvt_pk_bf16_f32 v210, v196, v197
  v_cvt_pk_bf16_f32 v211, v198, v199
  v_mfma_f32_16x16x32_bf16 v[204:207], a[156:159], a[28:31], v[204:207]
  s_waitcnt lgkmcnt(4)
  v_mul_f32 v200, s36, v200
  v_mul_f32 v201, s36, v201
  v_mfma_f32_16x16x32_bf16 v[0:3], v[208:211], a[192:195], v[0:3]
  v_exp_f32 v200, v200
  v_mfma_f32_16x16x32_bf16 v[4:7], v[208:211], a[196:199], v[4:7]
  v_mul_f32 v202, s36, v202
  v_mul_f32 v203, s36, v203
  v_mfma_f32_16x16x32_bf16 v[8:11], v[208:211], a[200:203], v[8:11]
  v_exp_f32 v201, v201
  v_mfma_f32_16x16x32_bf16 v[12:15], v[208:211], a[204:207], v[12:15]
  ds_read_b128 a[112:115], v224 offset:36864
  ds_read_b128 a[116:119], v224 offset:37120
  v_mfma_f32_16x16x32_bf16 v[16:19], v[208:211], a[208:211], v[16:19]
  v_exp_f32 v202, v202
  v_mfma_f32_16x16x32_bf16 v[20:23], v[208:211], a[212:215], v[20:23]
  v_cvt_pk_bf16_f32 v212, v200, v201
  v_mul_f32 v204, s36, v204
  v_mfma_f32_16x16x32_bf16 v[24:27], v[208:211], a[216:219], v[24:27]
  v_exp_f32 v203, v203
  v_mfma_f32_16x16x32_bf16 v[28:31], v[208:211], a[220:223], v[28:31]
  v_mul_f32 v205, s36, v205
  v_mul_f32 v206, s36, v206
  v_mfma_f32_16x16x32_bf16 v[192:195], a[128:131], a[32:35], v[252:255]
  v_exp_f32 v204, v204
  v_mfma_f32_16x16x32_bf16 v[192:195], a[132:135], a[36:39], v[192:195]
  v_cvt_pk_bf16_f32 v213, v202, v203
  v_mul_f32 v207, s36, v207
  v_mfma_f32_16x16x32_bf16 v[192:195], a[136:139], a[40:43], v[192:195]
  v_exp_f32 v205, v205
  v_mfma_f32_16x16x32_bf16 v[192:195], a[140:143], a[44:47], v[192:195]
  v_exp_f32 v206, v206
  v_mfma_f32_16x16x32_bf16 v[196:199], a[144:147], a[32:35], v[252:255]
  ds_read_b128 a[120:123], v224 offset:37376
  ds_read_b128 a[124:127], v224 offset:37632
  v_mfma_f32_16x16x32_bf16 v[196:199], a[148:151], a[36:39], v[196:199]
  v_exp_f32 v207, v207
  v_mfma_f32_16x16x32_bf16 v[196:199], a[152:155], a[40:43], v[196:199]
  v_cvt_pk_bf16_f32 v214, v204, v205
  v_cvt_pk_bf16_f32 v215, v206, v207
  v_mfma_f32_16x16x32_bf16 v[196:199], a[156:159], a[44:47], v[196:199]
  v_cmp_gt_u32 vcc, s58, v244
  v_smfmac_f32_16x16x64_bf16 a[224:227], a[248:251], v[208:215], v227
  v_mul_f32 v192, s36, v192
  v_mul_f32 v193, s36, v193
  v_mfma_f32_16x16x32_bf16 v[32:35], v[212:215], a[192:195], v[32:35]
  s_cbranch_vccnz L_s6_D13
L_r6_D13:
  v_exp_f32 v192, v192
  v_mfma_f32_16x16x32_bf16 v[36:39], v[212:215], a[196:199], v[36:39]
  s_add_u32 s58, s58, 1
  v_mul_f32 v194, s36, v194
  v_mul_f32 v195, s36, v195
  v_mfma_f32_16x16x32_bf16 v[40:43], v[212:215], a[200:203], v[40:43]
  v_exp_f32 v193, v193
  v_mfma_f32_16x16x32_bf16 v[44:47], v[212:215], a[204:207], v[44:47]
  ds_read_b64_tr_b16 a[160:161], v226 offset:40960
  ds_read_b64_tr_b16 a[162:163], v226 offset:45056
  v_mfma_f32_16x16x32_bf16 v[48:51], v[212:215], a[208:211], v[48:51]
  v_exp_f32 v194, v194
  v_mfma_f32_16x16x32_bf16 v[52:55], v[212:215], a[212:215], v[52:55]
  v_cvt_pk_bf16_f32 v208, v192, v193
  v_mul_f32 v196, s36, v196
  v_mfma_f32_16x16x32_bf16 v[56:59], v[212:215], a[216:219], v[56:59]
  v_exp_f32 v195, v195
  v_mfma_f32_16x16x32_bf16 v[60:63], v[212:215], a[220:223], v[60:63]
  v_mul_f32 v197, s36, v197
  v_mul_f32 v198, s36, v198
  v_mfma_f32_16x16x32_bf16 v[200:203], a[128:131], a[48:51], v[252:255]
  v_exp_f32 v196, v196
  v_mfma_f32_16x16x32_bf16 v[200:203], a[132:135], a[52:55], v[200:203]
  v_cvt_pk_bf16_f32 v209, v194, v195
  v_mul_f32 v199, s36, v199
  v_mfma_f32_16x16x32_bf16 v[200:203], a[136:139], a[56:59], v[200:203]
  v_exp_f32 v197, v197
  v_mfma_f32_16x16x32_bf16 v[200:203], a[140:143], a[60:63], v[200:203]
  v_exp_f32 v198, v198
  v_mfma_f32_16x16x32_bf16 v[204:207], a[144:147], a[48:51], v[252:255]
  ds_read_b64_tr_b16 a[164:165], v237 offset:40960
  ds_read_b64_tr_b16 a[166:167], v237 offset:45056
  v_mfma_f32_16x16x32_bf16 v[204:207], a[148:151], a[52:55], v[204:207]
  v_exp_f32 v199, v199
  v_mfma_f32_16x16x32_bf16 v[204:207], a[152:155], a[56:59], v[204:207]
  v_cvt_pk_bf16_f32 v210, v196, v197
  v_cvt_pk_bf16_f32 v211, v198, v199
  v_mfma_f32_16x16x32_bf16 v[204:207], a[156:159], a[60:63], v[204:207]
  v_mul_f32 v200, s36, v200
  v_mul_f32 v201, s36, v201
  v_mfma_f32_16x16x32_bf16 v[64:67], v[208:211], a[192:195], v[64:67]
  v_exp_f32 v200, v200
  v_mfma_f32_16x16x32_bf16 v[68:71], v[208:211], a[196:199], v[68:71]
  v_mul_f32 v202, s36, v202
  v_mul_f32 v203, s36, v203
  v_mfma_f32_16x16x32_bf16 v[72:75], v[208:211], a[200:203], v[72:75]
  v_exp_f32 v201, v201
  v_mfma_f32_16x16x32_bf16 v[76:79], v[208:211], a[204:207], v[76:79]
  ds_read_b64_tr_b16 a[168:169], v234 offset:40960
  ds_read_b64_tr_b16 a[170:171], v234 offset:45056
  v_mfma_f32_16x16x32_bf16 v[80:83], v[208:211], a[208:211], v[80:83]
  v_exp_f32 v202, v202
  v_mfma_f32_16x16x32_bf16 v[84:87], v[208:211], a[212:215], v[84:87]
  v_cvt_pk_bf16_f32 v212, v200, v201
  v_mul_f32 v204, s36, v204
  v_mfma_f32_16x16x32_bf16 v[88:91], v[208:211], a[216:219], v[88:91]
  v_exp_f32 v203, v203
  v_mfma_f32_16x16x32_bf16 v[92:95], v[208:211], a[220:223], v[92:95]
  v_mul_f32 v205, s36, v205
  v_mul_f32 v206, s36, v206
  v_mfma_f32_16x16x32_bf16 v[192:195], a[128:131], a[64:67], v[252:255]
  v_exp_f32 v204, v204
  v_mfma_f32_16x16x32_bf16 v[192:195], a[132:135], a[68:71], v[192:195]
  v_cvt_pk_bf16_f32 v213, v202, v203
  v_mul_f32 v207, s36, v207
  v_mfma_f32_16x16x32_bf16 v[192:195], a[136:139], a[72:75], v[192:195]
  v_exp_f32 v205, v205
  v_mfma_f32_16x16x32_bf16 v[192:195], a[140:143], a[76:79], v[192:195]
  v_exp_f32 v206, v206
  v_mfma_f32_16x16x32_bf16 v[196:199], a[144:147], a[64:67], v[252:255]
  ds_read_b64_tr_b16 a[172:173], v228 offset:40960
  ds_read_b64_tr_b16 a[174:175], v228 offset:45056
  v_mfma_f32_16x16x32_bf16 v[196:199], a[148:151], a[68:71], v[196:199]
  v_exp_f32 v207, v207
  v_mfma_f32_16x16x32_bf16 v[196:199], a[152:155], a[72:75], v[196:199]
  v_cvt_pk_bf16_f32 v214, v204, v205
  v_cvt_pk_bf16_f32 v215, v206, v207
  v_mfma_f32_16x16x32_bf16 v[196:199], a[156:159], a[76:79], v[196:199]
  s_nop 0
  v_smfmac_f32_16x16x64_bf16 a[228:231], a[248:251], v[208:215], v227
  v_mul_f32 v192, s36, v192
  v_mul_f32 v193, s36, v193
  v_mfma_f32_16x16x32_bf16 v[96:99], v[212:215], a[192:195], v[96:99]
  v_exp_f32 v192, v192
  v_mfma_f32_16x16x32_bf16 v[100:103], v[212:215], a[196:199], v[100:103]
  v_mul_f32 v194, s36, v194
  v_mul_f32 v195, s36, v195
  v_mfma_f32_16x16x32_bf16 v[104:107], v[212:215], a[200:203], v[104:107]
  v_exp_f32 v193, v193
  v_mfma_f32_16x16x32_bf16 v[108:111], v[212:215], a[204:207], v[108:111]
  ds_read_b64_tr_b16 a[176:177], v226 offset:40968
  ds_read_b64_tr_b16 a[178:179], v226 offset:45064
  v_mfma_f32_16x16x32_bf16 v[112:115], v[212:215], a[208:211], v[112:115]
  v_exp_f32 v194, v194
  v_mfma_f32_16x16x32_bf16 v[116:119], v[212:215], a[212:215], v[116:119]
  v_cvt_pk_bf16_f32 v208, v192, v193
  v_mul_f32 v196, s36, v196
  v_mfma_f32_16x16x32_bf16 v[120:123], v[212:215], a[216:219], v[120:123]
  v_exp_f32 v195, v195
  v_mfma_f32_16x16x32_bf16 v[124:127], v[212:215], a[220:223], v[124:127]
  v_mul_f32 v197, s36, v197
  v_mul_f32 v198, s36, v198
  v_mfma_f32_16x16x32_bf16 v[200:203], a[128:131], a[80:83], v[252:255]
  v_exp_f32 v196, v196
  v_mfma_f32_16x16x32_bf16 v[200:203], a[132:135], a[84:87], v[200:203]
  v_cvt_pk_bf16_f32 v209, v194, v195
  v_mul_f32 v199, s36, v199
  v_mfma_f32_16x16x32_bf16 v[200:203], a[136:139], a[88:91], v[200:203]
  v_exp_f32 v197, v197
  v_mfma_f32_16x16x32_bf16 v[200:203], a[140:143], a[92:95], v[200:203]
  s_waitcnt lgkmcnt(10)
  v_exp_f32 v198, v198
  v_mfma_f32_16x16x32_bf16 v[204:207], a[144:147], a[80:83], v[252:255]
  ds_read_b64_tr_b16 a[180:181], v237 offset:40968
  ds_read_b64_tr_b16 a[182:183], v237 offset:45064
  v_mfma_f32_16x16x32_bf16 v[204:207], a[148:151], a[84:87], v[204:207]
  v_exp_f32 v199, v199
  v_mfma_f32_16x16x32_bf16 v[204:207], a[152:155], a[88:91], v[204:207]
  v_cvt_pk_bf16_f32 v210, v196, v197
  v_cvt_pk_bf16_f32 v211, v198, v199
  v_mfma_f32_16x16x32_bf16 v[204:207], a[156:159], a[92:95], v[204:207]
  v_mul_f32 v200, s36, v200
  v_mul_f32 v201, s36, v201
  v_mfma_f32_16x16x32_bf16 v[128:131], v[208:211], a[192:195], v[128:131]
  v_exp_f32 v200, v200
  v_mfma_f32_16x16x32_bf16 v[132:135], v[208:211], a[196:199], v[132:135]
  v_mul_f32 v202, s36, v202
  v_mul_f32 v203, s36, v203
  v_mfma_f32_16x16x32_bf16 v[136:139], v[208:211], a[200:203], v[136:139]
  s_add_u32 s44, s44, 1
  v_exp_f32 v201, v201
  v_mfma_f32_16x16x32_bf16 v[140:143], v[208:211], a[204:207], v[140:143]
  ds_read_b64_tr_b16 a[184:185], v234 offset:40968
  ds_read_b64_tr_b16 a[186:187], v234 offset:45064
  v_mfma_f32_16x16x32_bf16 v[144:147], v[208:211], a[208:211], v[144:147]
  v_exp_f32 v202, v202
  v_mfma_f32_16x16x32_bf16 v[148:151], v[208:211], a[212:215], v[148:151]
  v_cvt_pk_bf16_f32 v212, v200, v201
  v_mul_f32 v204, s36, v204
  v_mfma_f32_16x16x32_bf16 v[152:155], v[208:211], a[216:219], v[152:155]
  v_exp_f32 v203, v203
  v_mfma_f32_16x16x32_bf16 v[156:159], v[208:211], a[220:223], v[156:159]
  s_cmp_lt_u32 s44, 3
  v_mul_f32 v205, s36, v205
  v_mul_f32 v206, s36, v206
  s_cbranch_scc1 L_D6
  s_branch L_E6
L_s6_a:
  s_mov_b32 s59, 1048576
L_s6_a_l:
  ds_read_b32 v244, v242
  s_sub_u32 s59, s59, 1
  s_cbranch_scc1 L_s6_a_x
  s_waitcnt lgkmcnt(0)
  v_cmp_gt_u32 vcc, s58, v244
  s_nop 0
  s_cbranch_vccnz L_s6_a_l
L_s6_a_x:
  s_waitcnt lgkmcnt(0)
  s_branch L_r6_a
L_s6_1515:
  s_mov_b32 s59, 1048576
L_s6_1515_l:
  ds_read_b32 v244, v242
  s_sub_u32 s59, s59, 1
  s_cbranch_scc1 L_s6_1515_x
  s_waitcnt lgkmcnt(0)
  v_cmp_gt_u32 vcc, s58, v244
  s_nop 0
  s_cbranch_vccnz L_s6_1515_l
L_s6_1515_x:
  ds_read_b128 a[96:99], v224 offset:0
  ds_read_b128 a[100:103], v224 offset:256
  ds_read_b128 a[104:107], v224 offset:512
  ds_read_b128 a[108:111], v224 offset:768
  ds_read_b128 a[112:115], v224 offset:4096
  ds_read_b128 a[116:119], v224 offset:4352
  ds_read_b128 a[120:123], v224 offset:4608
  ds_read_b128 a[124:127], v224 offset:4864
  s_waitcnt lgkmcnt(0)
  s_branch L_r6_1515
L_s6_00:
  s_mov_b32 s59, 1048576
L_s6_00_l:
  ds_read_b32 v244, v242
  s_sub_u32 s59, s59, 1
  s_cbranch_scc1 L_s6_00_x
  s_waitcnt lgkmcnt(0)
  v_cmp_gt_u32 vcc, s58, v244
  s_nop 0
  s_cbranch_vccnz L_s6_00_l
L_s6_00_x:
  ds_read_b128 a[128:131], v224 offset:16384
  ds_read_b128 a[132:135], v224 offset:16640
  ds_read_b128 a[136:139], v224 offset:16896
  ds_read_b128 a[140:143], v224 offset:17152
  ds_read_b128 a[144:147], v224 offset:20480
  ds_read_b128 a[148:151], v224 offset:20736
  ds_read_b128 a[152:155], v224 offset:20992
  ds_read_b128 a[156:159], v224 offset:21248
  s_waitcnt lgkmcnt(0)
  s_branch L_r6_00
L_s6_11:
  s_mov_b32 s59, 1048576
L_s6_11_l:
  ds_read_b32 v244, v242
  s_sub_u32 s59, s59, 1
  s_cbranch_scc1 L_s6_11_x
  s_waitcnt lgkmcnt(0)
  v_cmp_gt_u32 vcc, s58, v244
  s_nop 0
  s_cbranch_vccnz L_s6_11_l
L_s6_11_x:
  ds_read_b128 a[96:99], v224 offset:32768
  ds_read_b128 a[100:103], v224 offset:33024
  ds_read_b128 a[104:107], v224 offset:33280
  ds_read_b128 a[108:111], v224 offset:33536
  ds_read_b128 a[112:115], v224 offset:36864
  ds_read_b128 a[116:119], v224 offset:37120
  ds_read_b128 a[120:123], v224 offset:37376
  ds_read_b128 a[124:127], v224 offset:37632
  s_waitcnt lgkmcnt(0)
  s_branch L_r6_11
L_s6_B2:
  s_mov_b32 s59, 1048576
L_s6_B2_l:
  ds_read_b32 v244, v242
  s_sub_u32 s59, s59, 1
  s_cbranch_scc1 L_s6_B2_x
  s_waitcnt lgkmcnt(0)
  v_cmp_gt_u32 vcc, s58, v244
  s_nop 0
  s_cbranch_vccnz L_s6_B2_l
L_s6_B2_x:
  ds_read_b128 a[128:131], v224 offset:49152
  ds_read_b128 a[132:135], v224 offset:49408
  ds_read_b128 a[136:139], v224 offset:49664
  ds_read_b128 a[140:143], v224 offset:49920
  ds_read_b128 a[144:147], v224 offset:53248
  ds_read_b128 a[148:151], v224 offset:53504
  ds_read_b128 a[152:155], v224 offset:53760
  ds_read_b128 a[156:159], v224 offset:54016
  s_waitcnt lgkmcnt(0)
  s_branch L_r6_B2
L_s6_B3:
  s_mov_b32 s59, 1048576
L_s6_B3_l:
  ds_read_b32 v244, v242
  s_sub_u32 s59, s59, 1
  s_cbranch_scc1 L_s6_B3_x
  s_waitcnt lgkmcnt(0)
  v_cmp_gt_u32 vcc, s58, v244
  s_nop 0
  s_cbranch_vccnz L_s6_B3_l
L_s6_B3_x:
  ds_read_b128 a[96:99], v224 offset:0
  ds_read_b128 a[100:103], v224 offset:256
  ds_read_b128 a[104:107], v224 offset:512
  ds_read_b128 a[108:111], v224 offset:768
  ds_read_b128 a[112:115], v224 offset:4096
  ds_read_b128 a[116:119], v224 offset:4352
  ds_read_b128 a[120:123], v224 offset:4608
  ds_read_b128 a[124:127], v224 offset:4864
  s_waitcnt lgkmcnt(0)
  s_branch L_r6_B3
L_s6_B4:
  s_mov_b32 s59, 1048576
L_s6_B4_l:
  ds_read_b32 v244, v242
  s_sub_u32 s59, s59, 1
  s_cbranch_scc1 L_s6_B4_x
  s_waitcnt lgkmcnt(0)
  v_cmp_gt_u32 vcc, s58, v244
  s_nop 0
  s_cbranch_vccnz L_s6_B4_l
L_s6_B4_x:
  ds_read_b128 a[128:131], v224 offset:16384
  ds_read_b128 a[132:135], v224 offset:16640
  ds_read_b128 a[136:139], v224 offset:16896
  ds_read_b128 a[140:143], v224 offset:17152
  ds_read_b128 a[144:147], v224 offset:20480
  ds_read_b128 a[148:151], v224 offset:20736
  ds_read_b128 a[152:155], v224 offset:20992
  ds_read_b128 a[156:159], v224 offset:21248
  s_waitcnt lgkmcnt(0)
  s_branch L_r6_B4
L_s6_B5:
  s_mov_b32 s59, 1048576
L_s6_B5_l:
  ds_read_b32 v244, v242
  s_sub_u32 s59, s59, 1
  s_cbranch_scc1 L_s6_B5_x
  s_waitcnt lgkmcnt(0)
  v_cmp_gt_u32 vcc, s58, v244
  s_nop 0
  s_cbranch_vccnz L_s6_B5_l
L_s6_B5_x:
  ds_read_b128 a[96:99], v224 offset:32768
  ds_read_b128 a[100:103], v224 offset:33024
  ds_read_b128 a[104:107], v224 offset:33280
  ds_read_b128 a[108:111], v224 offset:33536
  ds_read_b128 a[112:115], v224 offset:36864
  ds_read_b128 a[116:119], v224 offset:37120
  ds_read_b128 a[120:123], v224 offset:37376
  ds_read_b128 a[124:127], v224 offset:37632
  s_waitcnt lgkmcnt(0)
  s_branch L_r6_B5
L_s6_C2:
  s_mov_b32 s59, 1048576
L_s6_C2_l:
  ds_read_b32 v244, v242
  s_sub_u32 s59, s59, 1
  s_cbranch_scc1 L_s6_C2_x
  s_waitcnt lgkmcnt(0)
  v_cmp_gt_u32 vcc, s58, v244
  s_nop 0
  s_cbranch_vccnz L_s6_C2_l
L_s6_C2_x:
  ds_read_b128 a[128:131], v224 offset:49152
  ds_read_b128 a[132:135], v224 offset:49408
  ds_read_b128 a[136:139], v224 offset:49664
  ds_read_b128 a[140:143], v224 offset:49920
  ds_read_b128 a[144:147], v224 offset:53248
  ds_read_b128 a[148:151], v224 offset:53504
  ds_read_b128 a[152:155], v224 offset:53760
  ds_read_b128 a[156:159], v224 offset:54016
  s_waitcnt lgkmcnt(0)
  s_branch L_r6_C2
L_s6_C3:
  s_mov_b32 s59, 1048576
L_s6_C3_l:
  ds_read_b32 v244, v242
  s_sub_u32 s59, s59, 1
  s_cbranch_scc1 L_s6_C3_x
  s_waitcnt lgkmcnt(0)
  v_cmp_gt_u32 vcc, s58, v244
  s_nop 0
  s_cbranch_vccnz L_s6_C3_l
L_s6_C3_x:
  ds_read_b128 a[96:99], v224 offset:0
  ds_read_b128 a[100:103], v224 offset:256
  ds_read_b128 a[104:107], v224 offset:512
  ds_read_b128 a[108:111], v224 offset:768
  ds_read_b128 a[112:115], v224 offset:4096
  ds_read_b128 a[116:119], v224 offset:4352
  ds_read_b128 a[120:123], v224 offset:4608
  ds_read_b128 a[124:127], v224 offset:4864
  s_waitcnt lgkmcnt(0)
  s_branch L_r6_C3
L_s6_C4:
  s_mov_b32 s59, 1048576
L_s6_C4_l:
  ds_read_b32 v244, v242
  s_sub_u32 s59, s59, 1
  s_cbranch_scc1 L_s6_C4_x
  s_waitcnt lgkmcnt(0)
  v_cmp_gt_u32 vcc, s58, v244
  s_nop 0
  s_cbranch_vccnz L_s6_C4_l
L_s6_C4_x:
  ds_read_b128 a[128:131], v224 offset:16384
  ds_read_b128 a[132:135], v224 offset:16640
  ds_read_b128 a[136:139], v224 offset:16896
  ds_read_b128 a[140:143], v224 offset:17152
  ds_read_b128 a[144:147], v224 offset:20480
  ds_read_b128 a[148:151], v224 offset:20736
  ds_read_b128 a[152:155], v224 offset:20992
  ds_read_b128 a[156:159], v224 offset:21248
  s_waitcnt lgkmcnt(0)
  s_branch L_r6_C4
L_s6_C5:
  s_mov_b32 s59, 1048576
L_s6_C5_l:
  ds_read_b32 v244, v242
  s_sub_u32 s59, s59, 1
  s_cbranch_scc1 L_s6_C5_x
  s_waitcnt lgkmcnt(0)
  v_cmp_gt_u32 vcc, s58, v244
  s_nop 0
  s_cbranch_vccnz L_s6_C5_l
L_s6_C5_x:
  ds_read_b128 a[96:99], v224 offset:32768
  ds_read_b128 a[100:103], v224 offset:33024
  ds_read_b128 a[104:107], v224 offset:33280
  ds_read_b128 a[108:111], v224 offset:33536
  ds_read_b128 a[112:115], v224 offset:36864
  ds_read_b128 a[116:119], v224 offset:37120
  ds_read_b128 a[120:123], v224 offset:37376
  ds_read_b128 a[124:127], v224 offset:37632
  s_waitcnt lgkmcnt(0)
  s_branch L_r6_C5
L_s6_D10:
  s_mov_b32 s59, 1048576
L_s6_D10_l:
  ds_read_b32 v244, v242
  s_sub_u32 s59, s59, 1
  s_cbranch_scc1 L_s6_D10_x
  s_waitcnt lgkmcnt(0)
  v_cmp_gt_u32 vcc, s58, v244
  s_nop 0
  s_cbranch_vccnz L_s6_D10_l
L_s6_D10_x:
  ds_read_b128 a[128:131], v224 offset:49152
  ds_read_b128 a[132:135], v224 offset:49408
  ds_read_b128 a[136:139], v224 offset:49664
  ds_read_b128 a[140:143], v224 offset:49920
  ds_read_b128 a[144:147], v224 offset:53248
  ds_read_b128 a[148:151], v224 offset:53504
  ds_read_b128 a[152:155], v224 offset:53760
  ds_read_b128 a[156:159], v224 offset:54016
  s_waitcnt lgkmcnt(0)
  s_branch L_r6_D10
L_s6_D11:
  s_mov_b32 s59, 1048576
L_s6_D11_l:
  ds_read_b32 v244, v242
  s_sub_u32 s59, s59, 1
  s_cbranch_scc1 L_s6_D11_x
  s_waitcnt lgkmcnt(0)
  v_cmp_gt_u32 vcc, s58, v244
  s_nop 0
  s_cbranch_vccnz L_s6_D11_l
L_s6_D11_x:
  ds_read_b128 a[96:99], v224 offset:0
  ds_read_b128 a[100:103], v224 offset:256
  ds_read_b128 a[104:107], v224 offset:512
  ds_read_b128 a[108:111], v224 offset:768
  ds_read_b128 a[112:115], v224 offset:4096
  ds_read_b128 a[116:119], v224 offset:4352
  ds_read_b128 a[120:123], v224 offset:4608
  ds_read_b128 a[124:127], v224 offset:4864
  s_waitcnt lgkmcnt(0)
  s_branch L_r6_D11
L_s6_D12:
  s_mov_b32 s59, 1048576
L_s6_D12_l:
  ds_read_b32 v244, v242
  s_sub_u32 s59, s59, 1
  s_cbranch_scc1 L_s6_D12_x
  s_waitcnt lgkmcnt(0)
  v_cmp_gt_u32 vcc, s58, v244
  s_nop 0
  s_cbranch_vccnz L_s6_D12_l
L_s6_D12_x:
  ds_read_b128 a[128:131], v224 offset:16384
  ds_read_b128 a[132:135], v224 offset:16640
  ds_read_b128 a[136:139], v224 offset:16896
  ds_read_b128 a[140:143], v224 offset:17152
  ds_read_b128 a[144:147], v224 offset:20480
  ds_read_b128 a[148:151], v224 offset:20736
  ds_read_b128 a[152:155], v224 offset:20992
  ds_read_b128 a[156:159], v224 offset:21248
  s_waitcnt lgkmcnt(0)
  s_branch L_r6_D12
L_s6_D13:
  s_mov_b32 s59, 1048576
L_s6_D13_l:
  ds_read_b32 v244, v242
  s_sub_u32 s59, s59, 1
  s_cbranch_scc1 L_s6_D13_x
  s_waitcnt lgkmcnt(0)
  v_cmp_gt_u32 vcc, s58, v244
  s_nop 0
  s_cbranch_vccnz L_s6_D13_l
L_s6_D13_x:
  ds_read_b128 a[96:99], v224 offset:32768
  ds_read_b128 a[100:103], v224 offset:33024
  ds_read_b128 a[104:107], v224 offset:33280
  ds_read_b128 a[108:111], v224 offset:33536
  ds_read_b128 a[112:115], v224 offset:36864
  ds_read_b128 a[116:119], v224 offset:37120
  ds_read_b128 a[120:123], v224 offset:37376
  ds_read_b128 a[124:127], v224 offset:37632
  s_waitcnt lgkmcnt(0)
  s_branch L_r6_D13
L_s6_1414:
  s_mov_b32 s59, 1048576
L_s6_1414_l:
  ds_read_b32 v244, v242
  s_sub_u32 s59, s59, 1
  s_cbranch_scc1 L_s6_1414_x
  s_waitcnt lgkmcnt(0)
  v_cmp_gt_u32 vcc, s58, v244
  s_nop 0
  s_cbranch_vccnz L_s6_1414_l
L_s6_1414_x:
  ds_read_b128 a[128:131], v224 offset:49152
  ds_read_b128 a[132:135], v224 offset:49408
  ds_read_b128 a[136:139], v224 offset:49664
  ds_read_b128 a[140:143], v224 offset:49920
  ds_read_b128 a[144:147], v224 offset:53248
  ds_read_b128 a[148:151], v224 offset:53504
  ds_read_b128 a[152:155], v224 offset:53760
  ds_read_b128 a[156:159], v224 offset:54016
  s_waitcnt lgkmcnt(0)
  s_branch L_r6_1414
L_pro5:
  s_add_u32 m0, s39, 0
  s_nop 0
  buffer_load_dwordx4 v228, s[20:23], s37 offen offset:0 lds
  buffer_load_dwordx4 v228, s[20:23], s37 offen offset:1024 lds
  s_add_u32 s37, s37, 8192
  s_add_u32 m0, s40, 0
  s_nop 0
  buffer_load_dwordx4 v241, s[24:27], s38 offen offset:0 lds
  buffer_load_dwordx4 v241, s[24:27], s38 offen offset:2048 lds
  s_add_u32 s38, s38, 8192
  s_add_u32 m0, s39, 16384
  s_nop 0
  buffer_load_dwordx4 v228, s[20:23], s37 offen offset:0 lds
  buffer_load_dwordx4 v228, s[20:23], s37 offen offset:1024 lds
  s_add_u32 s37, s37, 8192
  s_add_u32 m0, s40, 16384
  s_nop 0
  buffer_load_dwordx4 v241, s[24:27], s38 offen offset:0 lds
  buffer_load_dwordx4 v241, s[24:27], s38 offen offset:2048 lds
  s_add_u32 s38, s38, 8192
  s_mov_b32 s41, s51
  s_add_u32 s37, s53, 16384
  s_add_u32 s38, s53, 16384
  s_add_u32 m0, s50, 0
  s_nop 0
  buffer_load_dwordx4 v229, s[16:19], s41 offen offset:0 nt lds
  buffer_load_dwordx4 v229, s[16:19], s41 offen offset:1024 nt lds
  buffer_load_dwordx4 v230, s[16:19], s41 offen offset:2048 nt lds
  buffer_load_dwordx4 v230, s[16:19], s41 offen offset:3072 nt lds
  s_add_u32 s41, s41, 4096
  s_add_u32 m0, s50, 4096
  s_nop 0
  buffer_load_dwordx4 v229, s[16:19], s41 offen offset:0 nt lds
  buffer_load_dwordx4 v229, s[16:19], s41 offen offset:1024 nt lds
  buffer_load_dwordx4 v230, s[16:19], s41 offen offset:2048 nt lds
  buffer_load_dwordx4 v230, s[16:19], s41 offen offset:3072 nt lds
  s_add_u32 s41, s41, 4096
  v_and_b32 v253, 2, v250
  v_xor_b32 v253, v253, v251
  v_lshlrev_b32 v224, 10, v250
  v_lshl_add_u32 v224, v252, 6, v224
  v_lshl_add_u32 v224, v253, 4, v224
  v_add_u32 v225, s50, v224
  v_lshlrev_b32 v253, 4, v250
  v_lshl_add_u32 v253, v252, 6, v253
  v_lshl_add_u32 v226, v250, 8, v253
  v_lshl_add_u32 v226, v251, 10, v226
  v_xor_b32 v237, 16, v226
  v_xor_b32 v234, 32, v226
  v_xor_b32 v228, 48, v226
  v_lshl_add_u32 v231, v251, 8, v253
  v_lshrrev_b32 v231, 0, v231
  v_add_u32 v231, s50, v231
  v_lshl_add_u32 v233, v248, 4, s50
  v_and_b32 v253, 15, v248
  v_lshlrev_b32 v232, 10, v251
  v_lshl_add_u32 v232, v253, 4, v232
  s_nop 0
  s_nop 0
  v_mov_b32 v250, 0x3f803f80
  v_cmp_eq_u32 vcc, 0, v253
  s_nop 1
  v_cndmask_b32 v250, 0, v250, vcc
  v_accvgpr_write_b32 a248, v250
  v_accvgpr_write_b32 a249, v250
  v_accvgpr_write_b32 a250, v250
  v_accvgpr_write_b32 a251, v250
  s_mov_b32 s36, 0x3e0293ee
  s_mov_b32 s45, 0
  s_mov_b32 s46, 0
  v_lshlrev_b32 v245, 2, v248
  v_add_u32 v245, 162816, v245
  v_mov_b32 v250, 2
  v_mov_b32 v243, 1
  ds_write_b32 v245, v250
  ds_write_b32 v245, v250 offset:256
  ds_write_b32 v245, v250 offset:512
  v_add_u32 v245, 512, v245
  v_lshrrev_b32 v250, 4, v248
  v_min_u32 v250, 2, v250
  v_and_b32 v251, 15, v248
  v_lshlrev_b32 v250, 7, v250
  v_lshl_add_u32 v250, v251, 2, v250
  v_add_u32 v242, 162816, v250
  s_mov_b32 s58, 4
  v_lshlrev_b32 v235, 7, v248
  s_bitcmp1_b32 s2, 3
  s_cselect_b32 s73, 8192, 0
  s_add_u32 s73, s73, 32768
  s_lshr_b32 s48, s2, 3
  s_mul_i32 s54, s52, 8
  s_add_u32 s48, s48, s54
  s_and_b32 s48, s48, 31
  s_lshl_b32 s48, s48, 13
  v_lshl_add_u32 v246, v248, 7, s48
  v_min_u32 v246, L_end-L_pc, v246
  v_mov_b32 v247, 0
  v_lshl_add_u64 v[246:247], v[246:247], 0, s[74:75]
  s_nop 0
  s_waitcnt lgkmcnt(0)
  v_xor_b32 v250, 0, v248
  v_lshl_add_u32 v250, v250, 2, s50
  v_and_b32 v251, 48, v248
  v_add_u32 v251, s50, v251
  v_mov_b32 v252, 0x42b00000
  v_mov_b32 v253, 0x42b00000
  v_mov_b32 v254, 0x42b00000
  v_mov_b32 v255, 0x42b00000
  s_waitcnt vmcnt(8)
  s_barrier
  s_add_u32 m0, s50, 8192
  s_nop 0
  buffer_load_dwordx4 v229, s[16:19], s41 offen offset:0 nt lds
  buffer_load_dwordx4 v229, s[16:19], s41 offen offset:1024 nt lds
  buffer_load_dwordx4 v230, s[16:19], s41 offen offset:2048 nt lds
  buffer_load_dwordx4 v230, s[16:19], s41 offen offset:3072 nt lds
  s_add_u32 s41, s41, 4096
  s_mov_b32 m0, 32768
  s_nop 0
  buffer_load_dwordx4 v229, s[20:23], s37 offen offset:0 lds
  buffer_load_dwordx4 v229, s[20:23], s37 offen offset:1024 lds
  buffer_load_dwordx4 v230, s[20:23], s37 offen offset:2048 lds
  buffer_load_dwordx4 v230, s[20:23], s37 offen offset:3072 lds
  s_add_u32 s37, s37, 4096
  s_mov_b32 m0, 36864
  s_nop 0
  buffer_load_dwordx4 v229, s[20:23], s37 offen offset:0 lds
  buffer_load_dwordx4 v229, s[20:23], s37 offen offset:1024 lds
  buffer_load_dwordx4 v230, s[20:23], s37 offen offset:2048 lds
  buffer_load_dwordx4 v230, s[20:23], s37 offen offset:3072 lds
  s_add_u32 s37, s37, 4096
  ds_read_b128 a[96:99], v224 offset:0
  ds_read_b128 a[100:103], v224 offset:256
  ds_read_b128 a[104:107], v224 offset:512
  ds_read_b128 a[108:111], v224 offset:768
  ds_read_b128 a[112:115], v224 offset:4096
  ds_read_b128 a[116:119], v224 offset:4352
  ds_read_b128 a[120:123], v224 offset:4608
  ds_read_b128 a[124:127], v224 offset:4864
  ds_read_b128 a[128:131], v224 offset:16384
  ds_read_b128 a[132:135], v224 offset:16640
  ds_read_b128 a[136:139], v224 offset:16896
  ds_read_b128 a[140:143], v224 offset:17152
  ds_read_b128 a[144:147], v224 offset:20480
  ds_read_b128 a[148:151], v224 offset:20736
  ds_read_b128 a[152:155], v224 offset:20992
  ds_read_b128 a[156:159], v224 offset:21248
  ds_read_b64_tr_b16 a[160:161], v226 offset:8192
  ds_read_b64_tr_b16 a[162:163], v226 offset:12288
  ds_read_b64_tr_b16 a[164:165], v237 offset:8192
  ds_read_b64_tr_b16 a[166:167], v237 offset:12288
  ds_read_b64_tr_b16 a[168:169], v234 offset:8192
  ds_read_b64_tr_b16 a[170:171], v234 offset:12288
  ds_read_b64_tr_b16 a[172:173], v228 offset:8192
  ds_read_b64_tr_b16 a[174:175], v228 offset:12288
  ds_read_b64_tr_b16 a[176:177], v226 offset:8200
  ds_read_b64_tr_b16 a[178:179], v226 offset:12296
  ds_read_b64_tr_b16 a[180:181], v237 offset:8200
  ds_read_b64_tr_b16 a[182:183], v237 offset:12296
  ds_read_b64_tr_b16 a[184:185], v234 offset:8200
  ds_read_b64_tr_b16 a[186:187], v234 offset:12296
  ds_read_b64_tr_b16 a[188:189], v228 offset:8200
  ds_read_b64_tr_b16 a[190:191], v228 offset:12296
  s_waitcnt vmcnt(16)
  ds_read_b128 a[0:3], v225 offset:0
  ds_read_b128 a[4:7], v225 offset:256
  ds_read_b128 a[8:11], v225 offset:512
  ds_read_b128 a[12:15], v225 offset:768
  ds_read_b64_tr_b16 a[192:193], v226 offset:24576
  ds_read_b64_tr_b16 a[194:195], v226 offset:28672
  ds_read_b64_tr_b16 a[196:197], v237 offset:24576
  ds_read_b64_tr_b16 a[198:199], v237 offset:28672
  ds_read_b64_tr_b16 a[200:201], v234 offset:24576
  ds_read_b64_tr_b16 a[202:203], v234 offset:28672
  ds_read_b64_tr_b16 a[204:205], v228 offset:24576
  ds_read_b64_tr_b16 a[206:207], v228 offset:28672
  ds_read_b64_tr_b16 a[208:209], v226 offset:24584
  ds_read_b64_tr_b16 a[210:211], v226 offset:28680
  ds_read_b64_tr_b16 a[212:213], v237 offset:24584
  ds_read_b64_tr_b16 a[214:215], v237 offset:28680
  ds_read_b64_tr_b16 a[216:217], v234 offset:24584
  ds_read_b64_tr_b16 a[218:219], v234 offset:28680
  ds_read_b64_tr_b16 a[220:221], v228 offset:24584
  ds_read_b64_tr_b16 a[222:223], v228 offset:28680
  s_waitcnt lgkmcnt(15)
  v_mfma_f32_16x16x32_bf16 v[192:195], a[96:99], a[0:3], v[252:255]
  s_add_u32 m0, s50, 12288
  v_mfma_f32_16x16x32_bf16 v[192:195], a[100:103], a[4:7], v[192:195]
  buffer_load_dwordx4 v229, s[16:19], s41 offen offset:0 nt lds
  v_mfma_f32_16x16x32_bf16 v[192:195], a[104:107], a[8:11], v[192:195]
  buffer_load_dwordx4 v229, s[16:19], s41 offen offset:1024 nt lds
  v_mfma_f32_16x16x32_bf16 v[192:195], a[108:111], a[12:15], v[192:195]
  buffer_load_dwordx4 v230, s[16:19], s41 offen offset:2048 nt lds
  v_mfma_f32_16x16x32_bf16 v[196:199], a[112:115], a[0:3], v[252:255]
  v_mfma_f32_16x16x32_bf16 v[196:199], a[116:119], a[4:7], v[196:199]
  buffer_load_dwordx4 v230, s[16:19], s41 offen offset:3072 nt lds
  v_mfma_f32_16x16x32_bf16 v[196:199], a[120:123], a[8:11], v[196:199]
  s_add_u32 s41, s41, 4096
  v_mfma_f32_16x16x32_bf16 v[196:199], a[124:127], a[12:15], v[196:199]
  s_nop 0
  s_nop 3
  v_mul_f32 v192, s36, v192
  v_mul_f32 v193, s36, v193
  s_nop 1
  s_waitcnt lgkmcnt(0)
  v_exp_f32 v192, v192
  s_nop 1
  v_mul_f32 v194, s36, v194
  v_mul_f32 v195, s36, v195
  s_nop 1
  v_exp_f32 v193, v193
  s_nop 1
  s_nop 1
  v_exp_f32 v194, v194
  s_nop 1
  v_cvt_pk_bf16_f32 v208, v192, v193
  v_mul_f32 v196, s36, v196
  s_nop 1
  v_exp_f32 v195, v195
  s_nop 1
  v_mul_f32 v197, s36, v197
  v_mul_f32 v198, s36, v198
  v_mfma_f32_16x16x32_bf16 v[200:203], a[128:131], a[0:3], v[252:255]
  s_add_u32 m0, s50, 16384
  v_exp_f32 v196, v196
  v_mfma_f32_16x16x32_bf16 v[200:203], a[132:135], a[4:7], v[200:203]
  buffer_load_dwordx4 v229, s[16:19], s41 offen offset:0 nt lds
  v_cvt_pk_bf16_f32 v209, v194, v195
  v_mul_f32 v199, s36, v199
  v_mfma_f32_16x16x32_bf16 v[200:203], a[136:139], a[8:11], v[200:203]
  buffer_load_dwordx4 v229, s[16:19], s41 offen offset:1024 nt lds
  v_exp_f32 v197, v197
  v_mfma_f32_16x16x32_bf16 v[200:203], a[140:143], a[12:15], v[200:203]
  buffer_load_dwordx4 v230, s[16:19], s41 offen offset:2048 nt lds
  v_exp_f32 v198, v198
  v_mfma_f32_16x16x32_bf16 v[204:207], a[144:147], a[0:3], v[252:255]
  ds_read_b32 v244, v242
  v_mfma_f32_16x16x32_bf16 v[204:207], a[148:151], a[4:7], v[204:207]
  v_exp_f32 v199, v199
  v_mfma_f32_16x16x32_bf16 v[204:207], a[152:155], a[8:11], v[204:207]
  s_waitcnt vmcnt(19)
  buffer_load_dwordx4 v230, s[16:19], s41 offen offset:3072 nt lds
  v_cvt_pk_bf16_f32 v210, v196, v197
  v_cvt_pk_bf16_f32 v211, v198, v199
  v_mfma_f32_16x16x32_bf16 v[204:207], a[156:159], a[12:15], v[204:207]
  s_add_u32 s41, s41, 4096
  ds_read_b128 a[16:19], v225 offset:4096
  ds_read_b128 a[20:23], v225 offset:4352
  ds_read_b128 a[24:27], v225 offset:4608
  ds_read_b128 a[28:31], v225 offset:4864
  v_mfma_f32_16x16x32_bf16 v[0:3], v[208:211], a[160:163], 0
  v_mul_f32 v200, s36, v200
  v_mul_f32 v201, s36, v201
  v_mfma_f32_16x16x32_bf16 v[4:7], v[208:211], a[164:167], 0
  v_exp_f32 v200, v200
  v_mfma_f32_16x16x32_bf16 v[8:11], v[208:211], a[168:171], 0
  v_mul_f32 v202, s36, v202
  v_mul_f32 v203, s36, v203
  v_mfma_f32_16x16x32_bf16 v[12:15], v[208:211], a[172:175], 0
  v_exp_f32 v201, v201
  v_mfma_f32_16x16x32_bf16 v[16:19], v[208:211], a[176:179], 0
  s_waitcnt lgkmcnt(4)
  v_cmp_gt_u32 vcc, s58, v244
  v_mfma_f32_16x16x32_bf16 v[20:23], v[208:211], a[180:183], 0
  v_exp_f32 v202, v202
  v_mfma_f32_16x16x32_bf16 v[24:27], v[208:211], a[184:187], 0
  s_cbranch_vccnz L_s5_a
L_r5_a:
  v_cvt_pk_bf16_f32 v212, v200, v201
  v_mul_f32 v204, s36, v204
  v_mfma_f32_16x16x32_bf16 v[28:31], v[208:211], a[188:191], 0
  s_add_u32 s58, s58, 1
  v_exp_f32 v203, v203
  v_mfma_f32_16x16x32_bf16 a[224:227], a[248:251], v[208:211], 0
  s_waitcnt lgkmcnt(0)
  v_mul_f32 v205, s36, v205
  v_mul_f32 v206, s36, v206
  v_mfma_f32_16x16x32_bf16 v[192:195], a[96:99], a[16:19], v[252:255]
  s_mov_b32 m0, 40960
  v_exp_f32 v204, v204
  v_mfma_f32_16x16x32_bf16 v[192:195], a[100:103], a[20:23], v[192:195]
  buffer_load_dwordx4 v241, s[24:27], s38 offen offset:0 lds
  v_cvt_pk_bf16_f32 v213, v202, v203
  v_mul_f32 v207, s36, v207
  v_mfma_f32_16x16x32_bf16 v[192:195], a[104:107], a[24:27], v[192:195]
  buffer_load_dwordx4 v241, s[24:27], s38 offen offset:1024 lds
  v_exp_f32 v205, v205
  v_mfma_f32_16x16x32_bf16 v[192:195], a[108:111], a[28:31], v[192:195]
  buffer_load_dwordx4 v241, s[24:27], s38 offen offset:2048 lds
  v_exp_f32 v206, v206
  v_mfma_f32_16x16x32_bf16 v[196:199], a[112:115], a[16:19], v[252:255]
  v_mfma_f32_16x16x32_bf16 v[196:199], a[116:119], a[20:23], v[196:199]
  buffer_load_dwordx4 v241, s[24:27], s38 offen offset:3072 lds
  v_exp_f32 v207, v207
  v_mfma_f32_16x16x32_bf16 v[196:199], a[120:123], a[24:27], v[196:199]
  s_add_u32 s38, s38, 4096
  v_cvt_pk_bf16_f32 v214, v204, v205
  v_cvt_pk_bf16_f32 v215, v206, v207
  v_mfma_f32_16x16x32_bf16 v[196:199], a[124:127], a[28:31], v[196:199]
  s_mov_b32 m0, 45056
  v_mfma_f32_16x16x32_bf16 v[0:3], v[212:215], a[192:195], v[0:3]
  buffer_load_dwordx4 v241, s[24:27], s38 offen offset:0 lds
  v_mul_f32 v192, s36, v192
  v_mul_f32 v193, s36, v193
  v_mfma_f32_16x16x32_bf16 v[4:7], v[212:215], a[196:199], v[4:7]
  buffer_load_dwordx4 v241, s[24:27], s38 offen offset:1024 lds
  v_exp_f32 v192, v192
  v_mfma_f32_16x16x32_bf16 v[8:11], v[212:215], a[200:203], v[8:11]
  buffer_load_dwordx4 v241, s[24:27], s38 offen offset:2048 lds
  v_mul_f32 v194, s36, v194
  v_mul_f32 v195, s36, v195
  v_mfma_f32_16x16x32_bf16 v[12:15], v[212:215], a[204:207], v[12:15]
  buffer_load_dwordx4 v241, s[24:27], s38 offen offset:3072 lds
  v_exp_f32 v193, v193
  v_mfma_f32_16x16x32_bf16 v[16:19], v[212:215], a[208:211], v[16:19]
  s_add_u32 s38, s38, 4096
  v_mfma_f32_16x16x32_bf16 v[20:23], v[212:215], a[212:215], v[20:23]
  v_exp_f32 v194, v194
  v_mfma_f32_16x16x32_bf16 v[24:27], v[212:215], a[216:219], v[24:27]
  v_cvt_pk_bf16_f32 v208, v192, v193
  v_mul_f32 v196, s36, v196
  v_mfma_f32_16x16x32_bf16 v[28:31], v[212:215], a[220:223], v[28:31]
  v_exp_f32 v195, v195
  v_mfma_f32_16x16x32_bf16 a[224:227], a[248:251], v[212:215], a[224:227]
  v_mul_f32 v197, s36, v197
  v_mul_f32 v198, s36, v198
  v_mfma_f32_16x16x32_bf16 v[200:203], a[128:131], a[16:19], v[252:255]
  s_mov_b32 m0, 49152
  v_exp_f32 v196, v196
  v_mfma_f32_16x16x32_bf16 v[200:203], a[132:135], a[20:23], v[200:203]
  buffer_load_dwordx4 v229, s[20:23], s37 offen offset:0 lds
  v_cvt_pk_bf16_f32 v209, v194, v195
  v_mul_f32 v199, s36, v199
  v_mfma_f32_16x16x32_bf16 v[200:203], a[136:139], a[24:27], v[200:203]
  buffer_load_dwordx4 v229, s[20:23], s37 offen offset:1024 lds
  v_exp_f32 v197, v197
  v_mfma_f32_16x16x32_bf16 v[200:203], a[140:143], a[28:31], v[200:203]
  buffer_load_dwordx4 v230, s[20:23], s37 offen offset:2048 lds
  v_exp_f32 v198, v198
  v_mfma_f32_16x16x32_bf16 v[204:207], a[144:147], a[16:19], v[252:255]
  v_mfma_f32_16x16x32_bf16 v[204:207], a[148:151], a[20:23], v[204:207]
  v_exp_f32 v199, v199
  v_mfma_f32_16x16x32_bf16 v[204:207], a[152:155], a[24:27], v[204:207]
  s_waitcnt vmcnt(27)
  buffer_load_dwordx4 v230, s[20:23], s37 offen offset:3072 lds
  v_cvt_pk_bf16_f32 v210, v196, v197
  v_cvt_pk_bf16_f32 v211, v198, v199
  v_mfma_f32_16x16x32_bf16 v[204:207], a[156:159], a[28:31], v[204:207]
  s_add_u32 s37, s37, 4096
  ds_read_b128 a[32:35], v225 offset:8192
  ds_read_b128 a[36:39], v225 offset:8448
  ds_read_b128 a[40:43], v225 offset:8704
  ds_read_b128 a[44:47], v225 offset:8960
  v_mfma_f32_16x16x32_bf16 v[32:35], v[208:211], a[160:163], 0
  s_mov_b32 m0, 53248
  v_mul_f32 v200, s36, v200
  v_mul_f32 v201, s36, v201
  v_mfma_f32_16x16x32_bf16 v[36:39], v[208:211], a[164:167], 0
  buffer_load_dwordx4 v229, s[20:23], s37 offen offset:0 lds
  v_exp_f32 v200, v200
  v_mfma_f32_16x16x32_bf16 v[40:43], v[208:211], a[168:171], 0
  buffer_load_dwordx4 v229, s[20:23], s37 offen offset:1024 lds
  v_mul_f32 v202, s36, v202
  v_mul_f32 v203, s36, v203
  v_mfma_f32_16x16x32_bf16 v[44:47], v[208:211], a[172:175], 0
  buffer_load_dwordx4 v230, s[20:23], s37 offen offset:2048 lds
  v_exp_f32 v201, v201
  v_mfma_f32_16x16x32_bf16 v[48:51], v[208:211], a[176:179], 0
  v_mfma_f32_16x16x32_bf16 v[52:55], v[208:211], a[180:183], 0
  buffer_load_dwordx4 v230, s[20:23], s37 offen offset:3072 lds
  v_exp_f32 v202, v202
  v_mfma_f32_16x16x32_bf16 v[56:59], v[208:211], a[184:187], 0
  s_add_u32 s37, s37, 4096
  v_cvt_pk_bf16_f32 v212, v200, v201
  v_mul_f32 v204, s36, v204
  v_mfma_f32_16x16x32_bf16 v[60:63], v[208:211], a[188:191], 0
  v_exp_f32 v203, v203
  v_mfma_f32_16x16x32_bf16 a[228:231], a[248:251], v[208:211], 0
  s_waitcnt lgkmcnt(0)
  v_mul_f32 v205, s36, v205
  v_mul_f32 v206, s36, v206
  v_mfma_f32_16x16x32_bf16 v[192:195], a[96:99], a[32:35], v[252:255]
  s_mov_b32 m0, 57344
  v_exp_f32 v204, v204
  v_mfma_f32_16x16x32_bf16 v[192:195], a[100:103], a[36:39], v[192:195]
  buffer_load_dwordx4 v241, s[24:27], s38 offen offset:0 lds
  v_cvt_pk_bf16_f32 v213, v202, v203
  v_mul_f32 v207, s36, v207
  v_mfma_f32_16x16x32_bf16 v[192:195], a[104:107], a[40:43], v[192:195]
  buffer_load_dwordx4 v241, s[24:27], s38 offen offset:1024 lds
  v_exp_f32 v205, v205
  v_mfma_f32_16x16x32_bf16 v[192:195], a[108:111], a[44:47], v[192:195]
  buffer_load_dwordx4 v241, s[24:27], s38 offen offset:2048 lds
  v_exp_f32 v206, v206
  v_mfma_f32_16x16x32_bf16 v[196:199], a[112:115], a[32:35], v[252:255]
  v_mfma_f32_16x16x32_bf16 v[196:199], a[116:119], a[36:39], v[196:199]
  buffer_load_dwordx4 v241, s[24:27], s38 offen offset:3072 lds
  v_exp_f32 v207, v207
  v_mfma_f32_16x16x32_bf16 v[196:199], a[120:123], a[40:43], v[196:199]
  s_add_u32 s38, s38, 4096
  v_cvt_pk_bf16_f32 v214, v204, v205
  v_cvt_pk_bf16_f32 v215, v206, v207
  v_mfma_f32_16x16x32_bf16 v[196:199], a[124:127], a[44:47], v[196:199]
  s_mov_b32 m0, 61440
  v_mfma_f32_16x16x32_bf16 v[32:35], v[212:215], a[192:195], v[32:35]
  buffer_load_dwordx4 v241, s[24:27], s38 offen offset:0 lds
  v_mul_f32 v192, s36, v192
  v_mul_f32 v193, s36, v193
  v_mfma_f32_16x16x32_bf16 v[36:39], v[212:215], a[196:199], v[36:39]
  buffer_load_dwordx4 v241, s[24:27], s38 offen offset:1024 lds
  v_exp_f32 v192, v192
  v_mfma_f32_16x16x32_bf16 v[40:43], v[212:215], a[200:203], v[40:43]
  buffer_load_dwordx4 v241, s[24:27], s38 offen offset:2048 lds
  v_mul_f32 v194, s36, v194
  v_mul_f32 v195, s36, v195
  v_mfma_f32_16x16x32_bf16 v[44:47], v[212:215], a[204:207], v[44:47]
  buffer_load_dwordx4 v241, s[24:27], s38 offen offset:3072 lds
  v_exp_f32 v193, v193
  v_mfma_f32_16x16x32_bf16 v[48:51], v[212:215], a[208:211], v[48:51]
  s_add_u32 s38, s38, 4096
  v_mfma_f32_16x16x32_bf16 v[52:55], v[212:215], a[212:215], v[52:55]
  v_exp_f32 v194, v194
  v_mfma_f32_16x16x32_bf16 v[56:59], v[212:215], a[216:219], v[56:59]
  v_cvt_pk_bf16_f32 v208, v192, v193
  v_mul_f32 v196, s36, v196
  v_mfma_f32_16x16x32_bf16 v[60:63], v[212:215], a[220:223], v[60:63]
  v_exp_f32 v195, v195
  v_mfma_f32_16x16x32_bf16 a[228:231], a[248:251], v[212:215], a[228:231]
  v_mul_f32 v197, s36, v197
  v_mul_f32 v198, s36, v198
  v_mfma_f32_16x16x32_bf16 v[200:203], a[128:131], a[32:35], v[252:255]
  s_mov_b32 m0, 0
  v_exp_f32 v196, v196
  v_mfma_f32_16x16x32_bf16 v[200:203], a[132:135], a[36:39], v[200:203]
  buffer_load_dwordx4 v229, s[20:23], s37 offen offset:0 lds
  v_cvt_pk_bf16_f32 v209, v194, v195
  v_mul_f32 v199, s36, v199
  v_mfma_f32_16x16x32_bf16 v[200:203], a[136:139], a[40:43], v[200:203]
  buffer_load_dwordx4 v229, s[20:23], s37 offen offset:1024 lds
  v_exp_f32 v197, v197
  v_mfma_f32_16x16x32_bf16 v[200:203], a[140:143], a[44:47], v[200:203]
  buffer_load_dwordx4 v230, s[20:23], s37 offen offset:2048 lds
  v_exp_f32 v198, v198
  v_mfma_f32_16x16x32_bf16 v[204:207], a[144:147], a[32:35], v[252:255]
  v_mfma_f32_16x16x32_bf16 v[204:207], a[148:151], a[36:39], v[204:207]
  v_exp_f32 v199, v199
  v_mfma_f32_16x16x32_bf16 v[204:207], a[152:155], a[40:43], v[204:207]
  s_waitcnt vmcnt(31)
  buffer_load_dwordx4 v230, s[20:23], s37 offen offset:3072 lds
  v_cvt_pk_bf16_f32 v210, v196, v197
  v_cvt_pk_bf16_f32 v211, v198, v199
  v_mfma_f32_16x16x32_bf16 v[204:207], a[156:159], a[44:47], v[204:207]
  s_add_u32 s37, s37, 4096
  ds_read_b128 a[48:51], v225 offset:12288
  ds_read_b128 a[52:55], v225 offset:12544
  ds_read_b128 a[56:59], v225 offset:12800
  ds_read_b128 a[60:63], v225 offset:13056
  v_mfma_f32_16x16x32_bf16 v[64:67], v[208:211], a[160:163], 0
  s_mov_b32 m0, 4096
  v_mul_f32 v200, s36, v200
  v_mul_f32 v201, s36, v201
  v_mfma_f32_16x16x32_bf16 v[68:71], v[208:211], a[164:167], 0
  buffer_load_dwordx4 v229, s[20:23], s37 offen offset:0 lds
  v_exp_f32 v200, v200
  v_mfma_f32_16x16x32_bf16 v[72:75], v[208:211], a[168:171], 0
  buffer_load_dwordx4 v229, s[20:23], s37 offen offset:1024 lds
  v_mul_f32 v202, s36, v202
  v_mul_f32 v203, s36, v203
  v_mfma_f32_16x16x32_bf16 v[76:79], v[208:211], a[172:175], 0
  buffer_load_dwordx4 v230, s[20:23], s37 offen offset:2048 lds
  v_exp_f32 v201, v201
  v_mfma_f32_16x16x32_bf16 v[80:83], v[208:211], a[176:179], 0
  v_mfma_f32_16x16x32_bf16 v[84:87], v[208:211], a[180:183], 0
  buffer_load_dwordx4 v230, s[20:23], s37 offen offset:3072 lds
  v_exp_f32 v202, v202
  v_mfma_f32_16x16x32_bf16 v[88:91], v[208:211], a[184:187], 0
  s_add_u32 s37, s37, 4096
  v_cvt_pk_bf16_f32 v212, v200, v201
  v_mul_f32 v204, s36, v204
  v_mfma_f32_16x16x32_bf16 v[92:95], v[208:211], a[188:191], 0
  v_exp_f32 v203, v203
  v_mfma_f32_16x16x32_bf16 a[232:235], a[248:251], v[208:211], 0
  s_waitcnt lgkmcnt(0)
  v_mul_f32 v205, s36, v205
  v_mul_f32 v206, s36, v206
  v_mfma_f32_16x16x32_bf16 v[192:195], a[96:99], a[48:51], v[252:255]
  s_mov_b32 m0, 8192
  v_exp_f32 v204, v204
  v_mfma_f32_16x16x32_bf16 v[192:195], a[100:103], a[52:55], v[192:195]
  buffer_load_dwordx4 v241, s[24:27], s38 offen offset:0 lds
  v_cvt_pk_bf16_f32 v213, v202, v203
  v_mul_f32 v207, s36, v207
  v_mfma_f32_16x16x32_bf16 v[192:195], a[104:107], a[56:59], v[192:195]
  buffer_load_dwordx4 v241, s[24:27], s38 offen offset:1024 lds
  v_exp_f32 v205, v205
  v_mfma_f32_16x16x32_bf16 v[192:195], a[108:111], a[60:63], v[192:195]
  buffer_load_dwordx4 v241, s[24:27], s38 offen offset:2048 lds
  v_exp_f32 v206, v206
  v_mfma_f32_16x16x32_bf16 v[196:199], a[112:115], a[48:51], v[252:255]
  v_mfma_f32_16x16x32_bf16 v[196:199], a[116:119], a[52:55], v[196:199]
  v_exp_f32 v207, v207
  v_mfma_f32_16x16x32_bf16 v[196:199], a[120:123], a[56:59], v[196:199]
  s_waitcnt vmcnt(35)
  buffer_load_dwordx4 v241, s[24:27], s38 offen offset:3072 lds
  v_cvt_pk_bf16_f32 v214, v204, v205
  v_cvt_pk_bf16_f32 v215, v206, v207
  v_mfma_f32_16x16x32_bf16 v[196:199], a[124:127], a[60:63], v[196:199]
  s_add_u32 s38, s38, 4096
  ds_read_b128 a[64:67], v225 offset:16384
  ds_read_b128 a[68:71], v225 offset:16640
  ds_read_b128 a[72:75], v225 offset:16896
  ds_read_b128 a[76:79], v225 offset:17152
  v_mfma_f32_16x16x32_bf16 v[64:67], v[212:215], a[192:195], v[64:67]
  s_mov_b32 m0, 12288
  v_mul_f32 v192, s36, v192
  v_mul_f32 v193, s36, v193
  v_mfma_f32_16x16x32_bf16 v[68:71], v[212:215], a[196:199], v[68:71]
  buffer_load_dwordx4 v241, s[24:27], s38 offen offset:0 lds
  v_exp_f32 v192, v192
  v_mfma_f32_16x16x32_bf16 v[72:75], v[212:215], a[200:203], v[72:75]
  buffer_load_dwordx4 v241, s[24:27], s38 offen offset:1024 lds
  v_mul_f32 v194, s36, v194
  v_mul_f32 v195, s36, v195
  v_mfma_f32_16x16x32_bf16 v[76:79], v[212:215], a[204:207], v[76:79]
  buffer_load_dwordx4 v241, s[24:27], s38 offen offset:2048 lds
  v_exp_f32 v193, v193
  v_mfma_f32_16x16x32_bf16 v[80:83], v[212:215], a[208:211], v[80:83]
  v_mfma_f32_16x16x32_bf16 v[84:87], v[212:215], a[212:215], v[84:87]
  buffer_load_dwordx4 v241, s[24:27], s38 offen offset:3072 lds
  v_exp_f32 v194, v194
  v_mfma_f32_16x16x32_bf16 v[88:91], v[212:215], a[216:219], v[88:91]
  s_add_u32 s38, s38, 4096
  v_cvt_pk_bf16_f32 v208, v192, v193
  v_mul_f32 v196, s36, v196
  v_mfma_f32_16x16x32_bf16 v[92:95], v[212:215], a[220:223], v[92:95]
  v_exp_f32 v195, v195
  v_mfma_f32_16x16x32_bf16 a[232:235], a[248:251], v[212:215], a[232:235]
  s_waitcnt lgkmcnt(0)
  v_mul_f32 v197, s36, v197
  v_mul_f32 v198, s36, v198
  v_mfma_f32_16x16x32_bf16 v[200:203], a[96:99], a[64:67], v[252:255]
  s_mov_b32 m0, 16384
  v_exp_f32 v196, v196
  v_mfma_f32_16x16x32_bf16 v[200:203], a[100:103], a[68:71], v[200:203]
  buffer_load_dwordx4 v229, s[20:23], s37 offen offset:0 lds
  v_cvt_pk_bf16_f32 v209, v194, v195
  v_mul_f32 v199, s36, v199
  v_mfma_f32_16x16x32_bf16 v[200:203], a[104:107], a[72:75], v[200:203]
  buffer_load_dwordx4 v229, s[20:23], s37 offen offset:1024 lds
  v_exp_f32 v197, v197
  v_mfma_f32_16x16x32_bf16 v[200:203], a[108:111], a[76:79], v[200:203]
  buffer_load_dwordx4 v230, s[20:23], s37 offen offset:2048 lds
  v_exp_f32 v198, v198
  v_mfma_f32_16x16x32_bf16 v[204:207], a[112:115], a[64:67], v[252:255]
  v_mfma_f32_16x16x32_bf16 v[204:207], a[116:119], a[68:71], v[204:207]
  buffer_load_dwordx4 v230, s[20:23], s37 offen offset:3072 lds
  v_exp_f32 v199, v199
  v_mfma_f32_16x16x32_bf16 v[204:207], a[120:123], a[72:75], v[204:207]
  s_add_u32 s37, s37, 4096
  v_cvt_pk_bf16_f32 v210, v196, v197
  v_cvt_pk_bf16_f32 v211, v198, v199
  v_mfma_f32_16x16x32_bf16 v[204:207], a[124:127], a[76:79], v[204:207]
  s_waitcnt vmcnt(36)
  ds_add_u32 v245, v243
  v_mfma_f32_16x16x32_bf16 v[96:99], v[208:211], a[160:163], 0
  s_mov_b32 m0, 20480
  v_mul_f32 v200, s36, v200
  v_mul_f32 v201, s36, v201
  v_mfma_f32_16x16x32_bf16 v[100:103], v[208:211], a[164:167], 0
  buffer_load_dwordx4 v229, s[20:23], s37 offen offset:0 lds
  v_exp_f32 v200, v200
  v_mfma_f32_16x16x32_bf16 v[104:107], v[208:211], a[168:171], 0
  buffer_load_dwordx4 v229, s[20:23], s37 offen offset:1024 lds
  v_mul_f32 v202, s36, v202
  v_mul_f32 v203, s36, v203
  v_mfma_f32_16x16x32_bf16 v[108:111], v[208:211], a[172:175], 0
  buffer_load_dwordx4 v230, s[20:23], s37 offen offset:2048 lds
  v_exp_f32 v201, v201
  v_mfma_f32_16x16x32_bf16 v[112:115], v[208:211], a[176:179], 0
  v_mfma_f32_16x16x32_bf16 v[116:119], v[208:211], a[180:183], 0
  buffer_load_dwordx4 v230, s[20:23], s37 offen offset:3072 lds
  v_exp_f32 v202, v202
  v_mfma_f32_16x16x32_bf16 v[120:123], v[208:211], a[184:187], 0
  s_add_u32 s37, s37, 4096
  v_cvt_pk_bf16_f32 v212, v200, v201
  v_mul_f32 v204, s36, v204
  v_mfma_f32_16x16x32_bf16 v[124:127], v[208:211], a[188:191], 0
  v_exp_f32 v203, v203
  v_mfma_f32_16x16x32_bf16 a[236:239], a[248:251], v[208:211], 0
  v_mul_f32 v205, s36, v205
  v_mul_f32 v206, s36, v206
  v_mfma_f32_16x16x32_bf16 v[192:195], a[128:131], a[48:51], v[252:255]
  s_mov_b32 m0, 24576
  ds_read_b128 a[96:99], v224 offset:32768
  ds_read_b128 a[100:103], v224 offset:33024
  v_exp_f32 v204, v204
  v_mfma_f32_16x16x32_bf16 v[192:195], a[132:135], a[52:55], v[192:195]
  buffer_load_dwordx4 v241, s[24:27], s38 offen offset:0 lds
  v_cvt_pk_bf16_f32 v213, v202, v203
  v_mul_f32 v207, s36, v207
  v_mfma_f32_16x16x32_bf16 v[192:195], a[136:139], a[56:59], v[192:195]
  buffer_load_dwordx4 v241, s[24:27], s38 offen offset:1024 lds
  v_exp_f32 v205, v205
  v_mfma_f32_16x16x32_bf16 v[192:195], a[140:143], a[60:63], v[192:195]
  buffer_load_dwordx4 v241, s[24:27], s38 offen offset:2048 lds
  v_exp_f32 v206, v206
  v_mfma_f32_16x16x32_bf16 v[196:199], a[144:147], a[48:51], v[252:255]
  ds_read_b128 a[104:107], v224 offset:33280
  ds_read_b128 a[108:111], v224 offset:33536
  v_mfma_f32_16x16x32_bf16 v[196:199], a[148:151], a[52:55], v[196:199]
  buffer_load_dwordx4 v241, s[24:27], s38 offen offset:3072 lds
  v_exp_f32 v207, v207
  v_mfma_f32_16x16x32_bf16 v[196:199], a[152:155], a[56:59], v[196:199]
  s_add_u32 s38, s38, 4096
  v_cvt_pk_bf16_f32 v214, v204, v205
  v_cvt_pk_bf16_f32 v215, v206, v207
  v_mfma_f32_16x16x32_bf16 v[196:199], a[156:159], a[60:63], v[196:199]
  s_mov_b32 m0, 28672
  ds_read_b128 a[112:115], v224 offset:36864
  ds_read_b128 a[116:119], v224 offset:37120
  v_mfma_f32_16x16x32_bf16 v[128:131], v[212:215], a[160:163], 0
  buffer_load_dwordx4 v241, s[24:27], s38 offen offset:0 lds
  v_mul_f32 v192, s36, v192
  v_mul_f32 v193, s36, v193
  v_mfma_f32_16x16x32_bf16 v[132:135], v[212:215], a[164:167], 0
  buffer_load_dwordx4 v241, s[24:27], s38 offen offset:1024 lds
  v_exp_f32 v192, v192
  v_mfma_f32_16x16x32_bf16 v[136:139], v[212:215], a[168:171], 0
  buffer_load_dwordx4 v241, s[24:27], s38 offen offset:2048 lds
  v_mul_f32 v194, s36, v194
  v_mul_f32 v195, s36, v195
  v_mfma_f32_16x16x32_bf16 v[140:143], v[212:215], a[172:175], 0
  buffer_load_dwordx4 v241, s[24:27], s38 offen offset:3072 lds
  v_exp_f32 v193, v193
  v_mfma_f32_16x16x32_bf16 v[144:147], v[212:215], a[176:179], 0
  s_add_u32 s38, s38, 4096
  ds_read_b128 a[120:123], v224 offset:37376
  ds_read_b128 a[124:127], v224 offset:37632
  v_mfma_f32_16x16x32_bf16 v[148:151], v[212:215], a[180:183], 0
  v_exp_f32 v194, v194
  v_mfma_f32_16x16x32_bf16 v[152:155], v[212:215], a[184:187], 0
  v_cvt_pk_bf16_f32 v208, v192, v193
  v_mul_f32 v196, s36, v196
  v_mfma_f32_16x16x32_bf16 v[156:159], v[212:215], a[188:191], 0
  v_exp_f32 v195, v195
  v_mfma_f32_16x16x32_bf16 a[240:243], a[248:251], v[212:215], 0
  v_mul_f32 v197, s36, v197
  v_mul_f32 v198, s36, v198
  v_mfma_f32_16x16x32_bf16 v[200:203], a[128:131], a[64:67], v[252:255]
  ds_read_b64_tr_b16 a[160:161], v226 offset:40960
  ds_read_b64_tr_b16 a[162:163], v226 offset:45056
  v_exp_f32 v196, v196
  v_mfma_f32_16x16x32_bf16 v[200:203], a[132:135], a[68:71], v[200:203]
  v_cvt_pk_bf16_f32 v209, v194, v195
  v_mul_f32 v199, s36, v199
  v_mfma_f32_16x16x32_bf16 v[200:203], a[136:139], a[72:75], v[200:203]
  ds_read_b64_tr_b16 a[164:165], v237 offset:40960
  ds_read_b64_tr_b16 a[166:167], v237 offset:45056
  v_exp_f32 v197, v197
  v_mfma_f32_16x16x32_bf16 v[200:203], a[140:143], a[76:79], v[200:203]
  s_waitcnt lgkmcnt(4)
  v_exp_f32 v198, v198
  v_mfma_f32_16x16x32_bf16 v[204:207], a[144:147], a[64:67], v[252:255]
  ds_read_b64_tr_b16 a[168:169], v234 offset:40960
  ds_read_b64_tr_b16 a[170:171], v234 offset:45056
  ds_read_b64_tr_b16 a[172:173], v228 offset:40960
  ds_read_b64_tr_b16 a[174:175], v228 offset:45056
  v_mfma_f32_16x16x32_bf16 v[204:207], a[148:151], a[68:71], v[204:207]
  v_exp_f32 v199, v199
  v_mfma_f32_16x16x32_bf16 v[204:207], a[152:155], a[72:75], v[204:207]
  v_cvt_pk_bf16_f32 v210, v196, v197
  v_cvt_pk_bf16_f32 v211, v198, v199
  v_mfma_f32_16x16x32_bf16 v[204:207], a[156:159], a[76:79], v[204:207]
  s_waitcnt vmcnt(32)
  ds_add_u32 v245, v243
  v_mfma_f32_16x16x32_bf16 v[96:99], v[208:211], a[192:195], v[96:99]
  v_mul_f32 v200, s36, v200
  v_mul_f32 v201, s36, v201
  v_mfma_f32_16x16x32_bf16 v[100:103], v[208:211], a[196:199], v[100:103]
  ds_read_b64_tr_b16 a[176:177], v226 offset:40968
  ds_read_b64_tr_b16 a[178:179], v226 offset:45064
  v_exp_f32 v200, v200
  v_mfma_f32_16x16x32_bf16 v[104:107], v[208:211], a[200:203], v[104:107]
  v_mul_f32 v202, s36, v202
  v_mul_f32 v203, s36, v203
  v_mfma_f32_16x16x32_bf16 v[108:111], v[208:211], a[204:207], v[108:111]
  v_exp_f32 v201, v201
  v_mfma_f32_16x16x32_bf16 v[112:115], v[208:211], a[208:211], v[112:115]
  ds_read_b64_tr_b16 a[180:181], v237 offset:40968
  ds_read_b64_tr_b16 a[182:183], v237 offset:45064
  ds_read_b64_tr_b16 a[184:185], v234 offset:40968
  ds_read_b64_tr_b16 a[186:187], v234 offset:45064
  v_mfma_f32_16x16x32_bf16 v[116:119], v[208:211], a[212:215], v[116:119]
  v_exp_f32 v202, v202
  v_mfma_f32_16x16x32_bf16 v[120:123], v[208:211], a[216:219], v[120:123]
  v_cvt_pk_bf16_f32 v212, v200, v201
  v_mul_f32 v204, s36, v204
  v_mfma_f32_16x16x32_bf16 v[124:127], v[208:211], a[220:223], v[124:127]
  ds_read_b64_tr_b16 a[188:189], v228 offset:40968
  ds_read_b64_tr_b16 a[190:191], v228 offset:45064
  v_exp_f32 v203, v203
  v_mfma_f32_16x16x32_bf16 a[236:239], a[248:251], v[208:211], a[236:239]
  v_mul_f32 v205, s36, v205
  v_mul_f32 v206, s36, v206
  s_mov_b32 s42, 0
  s_mov_b32 s30, 0
  s_add_u32 s41, s51, 188416
  s_add_u32 s18, s41, 20480
  s_sub_u32 s41, s41, 73728
  s_mov_b32 s43, 65536
  s_mov_b32 s44, 0
  s_branch L_B5
.p2align 6
L_A5:
  v_mfma_f32_16x16x32_bf16 v[200:203], a[128:131], a[0:3], v[252:255]
  v_exp_f32 v196, v196
  v_mfma_f32_16x16x32_bf16 v[200:203], a[132:135], a[4:7], v[200:203]
  v_cvt_pk_bf16_f32 v209, v194, v195
  v_mul_f32 v199, s36, v199
  v_mfma_f32_16x16x32_bf16 v[200:203], a[136:139], a[8:11], v[200:203]
  v_exp_f32 v197, v197
  v_mfma_f32_16x16x32_bf16 v[200:203], a[140:143], a[12:15], v[200:203]
  v_exp_f32 v198, v198
  v_mfma_f32_16x16x32_bf16 v[204:207], a[144:147], a[0:3], v[252:255]
  ds_read_b128 a[96:99], v224 offset:0
  ds_read_b128 a[100:103], v224 offset:256
  v_mfma_f32_16x16x32_bf16 v[204:207], a[148:151], a[4:7], v[204:207]
  v_exp_f32 v199, v199
  v_mfma_f32_16x16x32_bf16 v[204:207], a[152:155], a[8:11], v[204:207]
  v_cvt_pk_bf16_f32 v210, v196, v197
  v_cvt_pk_bf16_f32 v211, v198, v199
  v_mfma_f32_16x16x32_bf16 v[204:207], a[156:159], a[12:15], v[204:207]
  ds_read_b32 v244, v242
  ds_read_b128 a[0:3], v225 offset:0
  ds_read_b128 a[4:7], v225 offset:256
  v_mfma_f32_16x16x32_bf16 v[128:131], v[208:211], a[160:163], v[128:131]
  ds_read_b128 a[8:11], v225 offset:512
  ds_read_b128 a[12:15], v225 offset:768
  v_mul_f32 v200, s36, v200
  v_mul_f32 v201, s36, v201
  v_mfma_f32_16x16x32_bf16 v[132:135], v[208:211], a[164:167], v[132:135]
  v_exp_f32 v200, v200
  v_mfma_f32_16x16x32_bf16 v[136:139], v[208:211], a[168:171], v[136:139]
  v_mul_f32 v202, s36, v202
  v_mul_f32 v203, s36, v203
  v_mfma_f32_16x16x32_bf16 v[140:143], v[208:211], a[172:175], v[140:143]
  v_exp_f32 v201, v201
  v_mfma_f32_16x16x32_bf16 v[144:147], v[208:211], a[176:179], v[144:147]
  ds_read_b128 a[104:107], v224 offset:512
  ds_read_b128 a[108:111], v224 offset:768
  v_mfma_f32_16x16x32_bf16 v[148:151], v[208:211], a[180:183], v[148:151]
  s_waitcnt lgkmcnt(6)
  v_exp_f32 v202, v202
  v_cmp_gt_u32 vcc, s58, v244
  v_mfma_f32_16x16x32_bf16 v[152:155], v[208:211], a[184:187], v[152:155]
  v_cvt_pk_bf16_f32 v212, v200, v201
  v_mul_f32 v204, s36, v204
  v_mfma_f32_16x16x32_bf16 v[156:159], v[208:211], a[188:191], v[156:159]
  s_cbranch_vccnz L_s5_1515
L_r5_1515:
  v_exp_f32 v203, v203
  v_mfma_f32_16x16x32_bf16 a[240:243], a[248:251], v[208:211], a[240:243]
  s_add_u32 s58, s58, 1
  v_mul_f32 v205, s36, v205
  v_mul_f32 v206, s36, v206
  v_mfma_f32_16x16x32_bf16 v[192:195], a[128:131], a[16:19], v[252:255]
  buffer_load_dword v236, v235, s[24:27], s72 offen
  v_exp_f32 v204, v204
  v_mfma_f32_16x16x32_bf16 v[192:195], a[132:135], a[20:23], v[192:195]
  s_add_u32 s72, s72, 16384
  v_cvt_pk_bf16_f32 v213, v202, v203
  v_mul_f32 v207, s36, v207
  v_mfma_f32_16x16x32_bf16 v[192:195], a[136:139], a[24:27], v[192:195]
  s_mov_b32 m0, 49152
  v_exp_f32 v205, v205
  v_mfma_f32_16x16x32_bf16 v[192:195], a[140:143], a[28:31], v[192:195]
  buffer_load_dwordx4 v229, s[20:23], s37 offen offset:0 lds
  v_exp_f32 v206, v206
  v_mfma_f32_16x16x32_bf16 v[196:199], a[144:147], a[16:19], v[252:255]
  ds_read_b128 a[112:115], v224 offset:4096
  ds_read_b128 a[116:119], v224 offset:4352
  v_mfma_f32_16x16x32_bf16 v[196:199], a[148:151], a[20:23], v[196:199]
  buffer_load_dwordx4 v229, s[20:23], s37 offen offset:1024 lds
  v_exp_f32 v207, v207
  v_mfma_f32_16x16x32_bf16 v[196:199], a[152:155], a[24:27], v[196:199]
  v_cvt_pk_bf16_f32 v214, v204, v205
  v_cvt_pk_bf16_f32 v215, v206, v207
  v_mfma_f32_16x16x32_bf16 v[196:199], a[156:159], a[28:31], v[196:199]
  ds_read_b128 a[16:19], v225 offset:4096
  ds_read_b128 a[20:23], v225 offset:4352
  v_mfma_f32_16x16x32_bf16 v[0:3], v[212:215], a[192:195], v[0:3]
  ds_read_b128 a[24:27], v225 offset:4608
  ds_read_b128 a[28:31], v225 offset:4864
  v_mul_f32 v192, s36, v192
  v_mul_f32 v193, s36, v193
  v_mfma_f32_16x16x32_bf16 v[4:7], v[212:215], a[196:199], v[4:7]
  buffer_load_dwordx4 v230, s[20:23], s37 offen offset:2048 lds
  v_exp_f32 v192, v192
  v_mfma_f32_16x16x32_bf16 v[8:11], v[212:215], a[200:203], v[8:11]
  v_mul_f32 v194, s36, v194
  v_mul_f32 v195, s36, v195
  v_mfma_f32_16x16x32_bf16 v[12:15], v[212:215], a[204:207], v[12:15]
  buffer_load_dwordx4 v230, s[20:23], s37 offen offset:3072 lds
  v_exp_f32 v193, v193
  v_mfma_f32_16x16x32_bf16 v[16:19], v[212:215], a[208:211], v[16:19]
  s_add_u32 s37, s37, 4096
  ds_read_b128 a[120:123], v224 offset:4608
  ds_read_b128 a[124:127], v224 offset:4864
  v_mfma_f32_16x16x32_bf16 v[20:23], v[212:215], a[212:215], v[20:23]
  s_mov_b32 m0, 53248
  v_exp_f32 v194, v194
  v_mfma_f32_16x16x32_bf16 v[24:27], v[212:215], a[216:219], v[24:27]
  buffer_load_dwordx4 v229, s[20:23], s37 offen offset:0 lds
  v_cvt_pk_bf16_f32 v208, v192, v193
  v_mul_f32 v196, s36, v196
  v_mfma_f32_16x16x32_bf16 v[28:31], v[212:215], a[220:223], v[28:31]
  v_exp_f32 v195, v195
  v_mfma_f32_16x16x32_bf16 a[224:227], a[248:251], v[212:215], a[224:227]
  buffer_load_dwordx4 v229, s[20:23], s37 offen offset:1024 lds
  v_mul_f32 v197, s36, v197
  v_mul_f32 v198, s36, v198
  v_mfma_f32_16x16x32_bf16 v[200:203], a[128:131], a[32:35], v[252:255]
  v_exp_f32 v196, v196
  v_mfma_f32_16x16x32_bf16 v[200:203], a[132:135], a[36:39], v[200:203]
  buffer_load_dwordx4 v230, s[20:23], s37 offen offset:2048 lds
  v_cvt_pk_bf16_f32 v209, v194, v195
  v_mul_f32 v199, s36, v199
  v_mfma_f32_16x16x32_bf16 v[200:203], a[136:139], a[40:43], v[200:203]
  v_exp_f32 v197, v197
  v_accvgpr_read_b32 v238, a224
  v_rcp_f32 v216, v238
  v_add_u32 v238, 0xd5800000, v238
  ds_write_b32 v250, v216 offset:0
  ds_read_b128 v[216:219], v251 offset:0
  v_mfma_f32_16x16x32_bf16 v[200:203], a[140:143], a[44:47], v[200:203]
  buffer_load_dword v236, v235, s[24:27], s72 offen
  v_exp_f32 v198, v198
  v_mfma_f32_16x16x32_bf16 v[204:207], a[144:147], a[32:35], v[252:255]
  s_add_u32 s72, s72, 16384
  ds_read_b64_tr_b16 a[160:161], v226 offset:8192
  ds_read_b64_tr_b16 a[162:163], v226 offset:12288
  v_mfma_f32_16x16x32_bf16 v[204:207], a[148:151], a[36:39], v[204:207]
  buffer_load_dwordx4 v230, s[20:23], s37 offen offset:3072 lds
  v_exp_f32 v199, v199
  v_mfma_f32_16x16x32_bf16 v[204:207], a[152:155], a[40:43], v[204:207]
  s_add_u32 s37, s37, 4096
  v_cvt_pk_bf16_f32 v210, v196, v197
  v_cvt_pk_bf16_f32 v211, v198, v199
  v_mfma_f32_16x16x32_bf16 v[204:207], a[156:159], a[44:47], v[204:207]
  ds_read_b128 a[32:35], v225 offset:8192
  ds_read_b128 a[36:39], v225 offset:8448
  v_mfma_f32_16x16x32_bf16 v[32:35], v[208:211], a[192:195], v[32:35]
  s_waitcnt lgkmcnt(4)
  ds_read_b64_tr_b16 a[164:165], v237 offset:8192
  ds_read_b64_tr_b16 a[166:167], v237 offset:12288
  ds_read_b128 a[40:43], v225 offset:8704
  ds_read_b128 a[44:47], v225 offset:8960
  v_mul_f32 v200, s36, v200
  v_mul_f32 v201, s36, v201
  v_cmp_le_u32 vcc, 0x34000000, v238
  v_pk_mul_f32 v[0:1], v[0:1], v[216:217]
  v_pk_mul_f32 v[2:3], v[2:3], v[218:219]
  v_pk_mul_f32 v[4:5], v[4:5], v[216:217]
  v_pk_mul_f32 v[6:7], v[6:7], v[218:219]
  v_pk_mul_f32 v[8:9], v[8:9], v[216:217]
  v_pk_mul_f32 v[10:11], v[10:11], v[218:219]
  v_pk_mul_f32 v[12:13], v[12:13], v[216:217]
  v_pk_mul_f32 v[14:15], v[14:15], v[218:219]
  v_cvt_pk_bf16_f32 v0, v0, v4
  v_cvt_pk_bf16_f32 v4, v1, v5
  v_cvt_pk_bf16_f32 v1, v8, v12
  v_cvt_pk_bf16_f32 v5, v9, v13
  v_cvt_pk_bf16_f32 v8, v2, v6
  v_cvt_pk_bf16_f32 v12, v3, v7
  v_pk_mul_f32 v[16:17], v[16:17], v[216:217]
  v_pk_mul_f32 v[20:21], v[20:21], v[216:217]
  v_pk_mul_f32 v[24:25], v[24:25], v[216:217]
  v_pk_mul_f32 v[28:29], v[28:29], v[216:217]
  v_cvt_pk_bf16_f32 v2, v16, v20
  v_cvt_pk_bf16_f32 v3, v24, v28
  ds_write_b128 v233, v[0:3] offset:0
  v_cvt_pk_bf16_f32 v6, v17, v21
  v_cvt_pk_bf16_f32 v7, v25, v29
  v_cvt_pk_bf16_f32 v9, v10, v14
  v_cvt_pk_bf16_f32 v13, v11, v15
  v_pk_mul_f32 v[18:19], v[18:19], v[218:219]
  ds_write_b128 v233, v[4:7] offset:1024
  v_pk_mul_f32 v[22:23], v[22:23], v[218:219]
  v_pk_mul_f32 v[26:27], v[26:27], v[218:219]
  v_pk_mul_f32 v[30:31], v[30:31], v[218:219]
  v_cvt_pk_bf16_f32 v10, v18, v22
  v_cvt_pk_bf16_f32 v11, v26, v30
  ds_write_b128 v233, v[8:11] offset:2048
  v_cvt_pk_bf16_f32 v14, v19, v23
  v_cvt_pk_bf16_f32 v15, v27, v31
  ds_write_b128 v233, v[12:15] offset:3072
  s_and_b32 vcc_lo, vcc_lo, 0xffff
  s_addc_u32 s46, s46, s46
  v_mfma_f32_16x16x32_bf16 v[36:39], v[208:211], a[196:199], v[36:39]
  s_mov_b32 m0, 57344
  v_exp_f32 v200, v200
  v_mfma_f32_16x16x32_bf16 v[40:43], v[208:211], a[200:203], v[40:43]
  buffer_load_dwordx4 v241, s[24:27], s38 offen offset:0 lds
  v_mul_f32 v202, s36, v202
  v_mul_f32 v203, s36, v203
  v_mfma_f32_16x16x32_bf16 v[44:47], v[208:211], a[204:207], v[44:47]
  v_exp_f32 v201, v201
  v_mfma_f32_16x16x32_bf16 v[48:51], v[208:211], a[208:211], v[48:51]
  ds_read_b64_tr_b16 a[168:169], v234 offset:8192
  ds_read_b64_tr_b16 a[170:171], v234 offset:12288
  v_mfma_f32_16x16x32_bf16 v[52:55], v[208:211], a[212:215], v[52:55]
  buffer_load_dwordx4 v241, s[24:27], s38 offen offset:1024 lds
  v_exp_f32 v202, v202
  v_mfma_f32_16x16x32_bf16 v[56:59], v[208:211], a[216:219], v[56:59]
  v_cvt_pk_bf16_f32 v212, v200, v201
  v_mul_f32 v204, s36, v204
  v_mfma_f32_16x16x32_bf16 v[60:63], v[208:211], a[220:223], v[60:63]
  buffer_load_dwordx4 v241, s[24:27], s38 offen offset:2048 lds
  v_exp_f32 v203, v203
  v_mfma_f32_16x16x32_bf16 a[228:231], a[248:251], v[208:211], a[228:231]
  v_mul_f32 v205, s36, v205
  v_mul_f32 v206, s36, v206
  v_mfma_f32_16x16x32_bf16 v[192:195], a[128:131], a[48:51], v[252:255]
  buffer_load_dwordx4 v241, s[24:27], s38 offen offset:3072 lds
  v_exp_f32 v204, v204
  v_mfma_f32_16x16x32_bf16 v[192:195], a[132:135], a[52:55], v[192:195]
  s_add_u32 s38, s38, 4096
  v_cvt_pk_bf16_f32 v213, v202, v203
  v_mul_f32 v207, s36, v207
  v_mfma_f32_16x16x32_bf16 v[192:195], a[136:139], a[56:59], v[192:195]
  s_mov_b32 m0, 61440
  v_exp_f32 v205, v205
  v_accvgpr_read_b32 v238, a228
  v_rcp_f32 v216, v238
  v_add_u32 v238, 0xd5800000, v238
  ds_write_b32 v250, v216 offset:4096
  ds_read_b128 v[216:219], v251 offset:4096
  v_mfma_f32_16x16x32_bf16 v[192:195], a[140:143], a[60:63], v[192:195]
  buffer_load_dwordx4 v241, s[24:27], s38 offen offset:0 lds
  v_exp_f32 v206, v206
  v_mfma_f32_16x16x32_bf16 v[196:199], a[144:147], a[48:51], v[252:255]
  ds_read_b64_tr_b16 a[172:173], v228 offset:8192
  ds_read_b64_tr_b16 a[174:175], v228 offset:12288
  v_mfma_f32_16x16x32_bf16 v[196:199], a[148:151], a[52:55], v[196:199]
  buffer_load_dwordx4 v241, s[24:27], s38 offen offset:1024 lds
  v_exp_f32 v207, v207
  v_mfma_f32_16x16x32_bf16 v[196:199], a[152:155], a[56:59], v[196:199]
  v_cvt_pk_bf16_f32 v214, v204, v205
  v_cvt_pk_bf16_f32 v215, v206, v207
  v_mfma_f32_16x16x32_bf16 v[196:199], a[156:159], a[60:63], v[196:199]
  ds_read_b128 a[48:51], v225 offset:12288
  ds_read_b128 a[52:55], v225 offset:12544
  v_mfma_f32_16x16x32_bf16 v[64:67], v[212:215], a[192:195], v[64:67]
  s_waitcnt lgkmcnt(4)
  ds_read_b64_tr_b16 a[176:177], v226 offset:8200
  ds_read_b64_tr_b16 a[178:179], v226 offset:12296
  ds_read_b128 a[56:59], v225 offset:12800
  ds_read_b128 a[60:63], v225 offset:13056
  v_mul_f32 v192, s36, v192
  v_mul_f32 v193, s36, v193
  v_cmp_le_u32 vcc, 0x34000000, v238
  v_pk_mul_f32 v[32:33], v[32:33], v[216:217]
  v_pk_mul_f32 v[36:37], v[36:37], v[216:217]
  v_pk_mul_f32 v[40:41], v[40:41], v[216:217]
  v_pk_mul_f32 v[44:45], v[44:45], v[216:217]
  v_pk_mul_f32 v[48:49], v[48:49], v[216:217]
  v_pk_mul_f32 v[52:53], v[52:53], v[216:217]
  v_pk_mul_f32 v[56:57], v[56:57], v[216:217]
  v_pk_mul_f32 v[60:61], v[60:61], v[216:217]
  v_cvt_pk_bf16_f32 v0, v32, v36
  v_cvt_pk_bf16_f32 v1, v40, v44
  v_cvt_pk_bf16_f32 v2, v48, v52
  v_cvt_pk_bf16_f32 v3, v56, v60
  ds_write_b128 v233, v[0:3] offset:4096
  v_cvt_pk_bf16_f32 v4, v33, v37
  v_cvt_pk_bf16_f32 v5, v41, v45
  v_cvt_pk_bf16_f32 v6, v49, v53
  v_cvt_pk_bf16_f32 v7, v57, v61
  v_pk_mul_f32 v[34:35], v[34:35], v[218:219]
  v_pk_mul_f32 v[38:39], v[38:39], v[218:219]
  v_pk_mul_f32 v[42:43], v[42:43], v[218:219]
  v_pk_mul_f32 v[46:47], v[46:47], v[218:219]
  ds_write_b128 v233, v[4:7] offset:5120
  v_pk_mul_f32 v[50:51], v[50:51], v[218:219]
  v_pk_mul_f32 v[54:55], v[54:55], v[218:219]
  v_pk_mul_f32 v[58:59], v[58:59], v[218:219]
  v_pk_mul_f32 v[62:63], v[62:63], v[218:219]
  v_cvt_pk_bf16_f32 v8, v34, v38
  v_cvt_pk_bf16_f32 v9, v42, v46
  v_cvt_pk_bf16_f32 v10, v50, v54
  v_cvt_pk_bf16_f32 v11, v58, v62
  ds_write_b128 v233, v[8:11] offset:6144
  v_cvt_pk_bf16_f32 v12, v35, v39
  v_cvt_pk_bf16_f32 v13, v43, v47
  v_cvt_pk_bf16_f32 v14, v51, v55
  v_cvt_pk_bf16_f32 v15, v59, v63
  ds_write_b128 v233, v[12:15] offset:7168
  s_and_b32 vcc_lo, vcc_lo, 0xffff
  s_addc_u32 s46, s46, s46
  v_mfma_f32_16x16x32_bf16 v[68:71], v[212:215], a[196:199], v[68:71]
  buffer_load_dwordx4 v241, s[24:27], s38 offen offset:2048 lds
  v_exp_f32 v192, v192
  v_mfma_f32_16x16x32_bf16 v[72:75], v[212:215], a[200:203], v[72:75]
  v_mul_f32 v194, s36, v194
  v_mul_f32 v195, s36, v195
  v_mfma_f32_16x16x32_bf16 v[76:79], v[212:215], a[204:207], v[76:79]
  buffer_load_dwordx4 v241, s[24:27], s38 offen offset:3072 lds
  v_exp_f32 v193, v193
  v_mfma_f32_16x16x32_bf16 v[80:83], v[212:215], a[208:211], v[80:83]
  s_add_u32 s38, s38, 4096
  ds_read_b64_tr_b16 a[180:181], v237 offset:8200
  ds_read_b64_tr_b16 a[182:183], v237 offset:12296
  v_mfma_f32_16x16x32_bf16 v[84:87], v[212:215], a[212:215], v[84:87]
  v_exp_f32 v194, v194
  v_mfma_f32_16x16x32_bf16 v[88:91], v[212:215], a[216:219], v[88:91]
  v_cvt_pk_bf16_f32 v208, v192, v193
  v_mul_f32 v196, s36, v196
  v_mfma_f32_16x16x32_bf16 v[92:95], v[212:215], a[220:223], v[92:95]
  v_exp_f32 v195, v195
  v_mfma_f32_16x16x32_bf16 a[232:235], a[248:251], v[212:215], a[232:235]
  v_mul_f32 v197, s36, v197
  v_mul_f32 v198, s36, v198
  v_mfma_f32_16x16x32_bf16 v[200:203], a[128:131], a[64:67], v[252:255]
  v_exp_f32 v196, v196
  v_mfma_f32_16x16x32_bf16 v[200:203], a[132:135], a[68:71], v[200:203]
  v_cvt_pk_bf16_f32 v209, v194, v195
  v_mul_f32 v199, s36, v199
  v_mfma_f32_16x16x32_bf16 v[200:203], a[136:139], a[72:75], v[200:203]
  v_exp_f32 v197, v197
  v_accvgpr_read_b32 v238, a232
  v_rcp_f32 v216, v238
  v_add_u32 v238, 0xd5800000, v238
  ds_write_b32 v250, v216 offset:8192
  ds_read_b128 v[216:219], v251 offset:8192
  v_mfma_f32_16x16x32_bf16 v[200:203], a[140:143], a[76:79], v[200:203]
  v_exp_f32 v198, v198
  v_mfma_f32_16x16x32_bf16 v[204:207], a[144:147], a[64:67], v[252:255]
  ds_read_b64_tr_b16 a[184:185], v234 offset:8200
  ds_read_b64_tr_b16 a[186:187], v234 offset:12296
  v_mfma_f32_16x16x32_bf16 v[204:207], a[148:151], a[68:71], v[204:207]
  v_exp_f32 v199, v199
  v_mfma_f32_16x16x32_bf16 v[204:207], a[152:155], a[72:75], v[204:207]
  v_cvt_pk_bf16_f32 v210, v196, v197
  v_cvt_pk_bf16_f32 v211, v198, v199
  v_mfma_f32_16x16x32_bf16 v[204:207], a[156:159], a[76:79], v[204:207]
  s_waitcnt vmcnt(35)
  ds_add_u32 v245, v243
  ds_read_b128 a[64:67], v225 offset:16384
  ds_read_b128 a[68:71], v225 offset:16640
  v_mfma_f32_16x16x32_bf16 v[96:99], v[208:211], a[192:195], v[96:99]
  s_waitcnt lgkmcnt(5)
  ds_read_b128 a[72:75], v225 offset:16896
  ds_read_b128 a[76:79], v225 offset:17152
  v_mul_f32 v200, s36, v200
  v_mul_f32 v201, s36, v201
  v_cmp_le_u32 vcc, 0x34000000, v238
  v_pk_mul_f32 v[64:65], v[64:65], v[216:217]
  v_pk_mul_f32 v[68:69], v[68:69], v[216:217]
  v_pk_mul_f32 v[72:73], v[72:73], v[216:217]
  v_pk_mul_f32 v[76:77], v[76:77], v[216:217]
  v_pk_mul_f32 v[80:81], v[80:81], v[216:217]
  v_pk_mul_f32 v[84:85], v[84:85], v[216:217]
  v_pk_mul_f32 v[88:89], v[88:89], v[216:217]
  v_pk_mul_f32 v[92:93], v[92:93], v[216:217]
  v_cvt_pk_bf16_f32 v32, v64, v68
  v_cvt_pk_bf16_f32 v33, v72, v76
  v_cvt_pk_bf16_f32 v34, v80, v84
  v_cvt_pk_bf16_f32 v35, v88, v92
  ds_write_b128 v233, v[32:35] offset:8192
  v_cvt_pk_bf16_f32 v36, v65, v69
  v_cvt_pk_bf16_f32 v37, v73, v77
  v_cvt_pk_bf16_f32 v38, v81, v85
  v_cvt_pk_bf16_f32 v39, v89, v93
  v_pk_mul_f32 v[66:67], v[66:67], v[218:219]
  v_pk_mul_f32 v[70:71], v[70:71], v[218:219]
  v_pk_mul_f32 v[74:75], v[74:75], v[218:219]
  v_pk_mul_f32 v[78:79], v[78:79], v[218:219]
  ds_write_b128 v233, v[36:39] offset:9216
  v_pk_mul_f32 v[82:83], v[82:83], v[218:219]
  v_pk_mul_f32 v[86:87], v[86:87], v[218:219]
  v_pk_mul_f32 v[90:91], v[90:91], v[218:219]
  v_pk_mul_f32 v[94:95], v[94:95], v[218:219]
  v_cvt_pk_bf16_f32 v40, v66, v70
  v_cvt_pk_bf16_f32 v41, v74, v78
  v_cvt_pk_bf16_f32 v42, v82, v86
  v_cvt_pk_bf16_f32 v43, v90, v94
  ds_write_b128 v233, v[40:43] offset:10240
  v_cvt_pk_bf16_f32 v44, v67, v71
  v_cvt_pk_bf16_f32 v45, v75, v79
  v_cvt_pk_bf16_f32 v46, v83, v87
  v_cvt_pk_bf16_f32 v47, v91, v95
  ds_write_b128 v233, v[44:47] offset:11264
  s_and_b32 vcc_lo, vcc_lo, 0xffff
  s_addc_u32 s46, s46, s46
  v_mfma_f32_16x16x32_bf16 v[100:103], v[208:211], a[196:199], v[100:103]
  v_exp_f32 v200, v200
  v_mfma_f32_16x16x32_bf16 v[104:107], v[208:211], a[200:203], v[104:107]
  v_mul_f32 v202, s36, v202
  v_mul_f32 v203, s36, v203
  v_mfma_f32_16x16x32_bf16 v[108:111], v[208:211], a[204:207], v[108:111]
  v_exp_f32 v201, v201
  v_mfma_f32_16x16x32_bf16 v[112:115], v[208:211], a[208:211], v[112:115]
  ds_read_b64_tr_b16 a[188:189], v228 offset:8200
  ds_read_b64_tr_b16 a[190:191], v228 offset:12296
  v_mfma_f32_16x16x32_bf16 v[116:119], v[208:211], a[212:215], v[116:119]
  v_exp_f32 v202, v202
  v_mfma_f32_16x16x32_bf16 v[120:123], v[208:211], a[216:219], v[120:123]
  s_waitcnt lgkmcnt(15)
  v_cvt_pk_bf16_f32 v212, v200, v201
  v_mul_f32 v204, s36, v204
  v_mfma_f32_16x16x32_bf16 v[124:127], v[208:211], a[220:223], v[124:127]
  v_exp_f32 v203, v203
  v_mfma_f32_16x16x32_bf16 a[236:239], a[248:251], v[208:211], a[236:239]
  v_mul_f32 v205, s36, v205
  v_mul_f32 v206, s36, v206
  v_mfma_f32_16x16x32_bf16 v[192:195], a[96:99], a[0:3], v[252:255]
  v_exp_f32 v204, v204
  v_mfma_f32_16x16x32_bf16 v[192:195], a[100:103], a[4:7], v[192:195]
  v_cvt_pk_bf16_f32 v213, v202, v203
  v_mul_f32 v207, s36, v207
  v_mfma_f32_16x16x32_bf16 v[192:195], a[104:107], a[8:11], v[192:195]
  v_exp_f32 v205, v205
  v_accvgpr_read_b32 v238, a236
  v_rcp_f32 v216, v238
  v_add_u32 v238, 0xd5800000, v238
  ds_write_b32 v250, v216 offset:12288
  ds_read_b128 v[216:219], v251 offset:12288
  v_mfma_f32_16x16x32_bf16 v[192:195], a[108:111], a[12:15], v[192:195]
  v_exp_f32 v206, v206
  v_mfma_f32_16x16x32_bf16 v[196:199], a[112:115], a[0:3], v[252:255]
  ds_read_b128 a[128:131], v224 offset:16384
  ds_read_b128 a[132:135], v224 offset:16640
  v_mfma_f32_16x16x32_bf16 v[196:199], a[116:119], a[4:7], v[196:199]
  v_exp_f32 v207, v207
  v_mfma_f32_16x16x32_bf16 v[196:199], a[120:123], a[8:11], v[196:199]
  v_cvt_pk_bf16_f32 v214, v204, v205
  v_cvt_pk_bf16_f32 v215, v206, v207
  v_mfma_f32_16x16x32_bf16 v[196:199], a[124:127], a[12:15], v[196:199]
  ds_read_b32 v244, v242
  v_mfma_f32_16x16x32_bf16 v[128:131], v[212:215], a[192:195], v[128:131]
  s_waitcnt lgkmcnt(3)
  v_mul_f32 v192, s36, v192
  v_mul_f32 v193, s36, v193
  v_cmp_le_u32 vcc, 0x34000000, v238
  v_pk_mul_f32 v[96:97], v[96:97], v[216:217]
  v_pk_mul_f32 v[100:101], v[100:101], v[216:217]
  v_pk_mul_f32 v[104:105], v[104:105], v[216:217]
  v_pk_mul_f32 v[108:109], v[108:109], v[216:217]
  v_pk_mul_f32 v[112:113], v[112:113], v[216:217]
  v_pk_mul_f32 v[116:117], v[116:117], v[216:217]
  v_pk_mul_f32 v[120:121], v[120:121], v[216:217]
  v_pk_mul_f32 v[124:125], v[124:125], v[216:217]
  v_cvt_pk_bf16_f32 v64, v96, v100
  v_cvt_pk_bf16_f32 v65, v104, v108
  v_cvt_pk_bf16_f32 v66, v112, v116
  v_cvt_pk_bf16_f32 v67, v120, v124
  ds_write_b128 v233, v[64:67] offset:12288
  v_cvt_pk_bf16_f32 v68, v97, v101
  v_cvt_pk_bf16_f32 v69, v105, v109
  v_cvt_pk_bf16_f32 v70, v113, v117
  v_cvt_pk_bf16_f32 v71, v121, v125
  v_pk_mul_f32 v[98:99], v[98:99], v[218:219]
  v_pk_mul_f32 v[102:103], v[102:103], v[218:219]
  v_pk_mul_f32 v[106:107], v[106:107], v[218:219]
  v_pk_mul_f32 v[110:111], v[110:111], v[218:219]
  ds_write_b128 v233, v[68:71] offset:13312
  v_pk_mul_f32 v[114:115], v[114:115], v[218:219]
  v_pk_mul_f32 v[118:119], v[118:119], v[218:219]
  v_pk_mul_f32 v[122:123], v[122:123], v[218:219]
  v_pk_mul_f32 v[126:127], v[126:127], v[218:219]
  v_cvt_pk_bf16_f32 v72, v98, v102
  v_cvt_pk_bf16_f32 v73, v106, v110
  v_cvt_pk_bf16_f32 v74, v114, v118
  v_cvt_pk_bf16_f32 v75, v122, v126
  ds_write_b128 v233, v[72:75] offset:14336
  v_cvt_pk_bf16_f32 v76, v99, v103
  v_cvt_pk_bf16_f32 v77, v107, v111
  v_cvt_pk_bf16_f32 v78, v115, v119
  v_cvt_pk_bf16_f32 v79, v123, v127
  ds_write_b128 v233, v[76:79] offset:15360
  s_and_b32 vcc_lo, vcc_lo, 0xffff
  s_addc_u32 s46, s46, s46
  v_mfma_f32_16x16x32_bf16 v[132:135], v[212:215], a[196:199], v[132:135]
  v_exp_f32 v192, v192
  v_mfma_f32_16x16x32_bf16 v[136:139], v[212:215], a[200:203], v[136:139]
  v_mul_f32 v194, s36, v194
  v_mul_f32 v195, s36, v195
  v_mfma_f32_16x16x32_bf16 v[140:143], v[212:215], a[204:207], v[140:143]
  v_exp_f32 v193, v193
  v_mfma_f32_16x16x32_bf16 v[144:147], v[212:215], a[208:211], v[144:147]
  ds_read_b128 a[136:139], v224 offset:16896
  ds_read_b128 a[140:143], v224 offset:17152
  v_mfma_f32_16x16x32_bf16 v[148:151], v[212:215], a[212:215], v[148:151]
  s_waitcnt lgkmcnt(6)
  v_exp_f32 v194, v194
  v_cmp_gt_u32 vcc, s58, v244
  v_mfma_f32_16x16x32_bf16 v[152:155], v[212:215], a[216:219], v[152:155]
  v_cvt_pk_bf16_f32 v208, v192, v193
  v_mul_f32 v196, s36, v196
  v_mfma_f32_16x16x32_bf16 v[156:159], v[212:215], a[220:223], v[156:159]
  s_cbranch_vccnz L_s5_00
L_r5_00:
  v_exp_f32 v195, v195
  v_mfma_f32_16x16x32_bf16 a[240:243], a[248:251], v[212:215], a[240:243]
  s_add_u32 s58, s58, 1
  v_mul_f32 v197, s36, v197
  v_mul_f32 v198, s36, v198
  v_mfma_f32_16x16x32_bf16 v[200:203], a[96:99], a[16:19], v[252:255]
  buffer_load_dword v236, v235, s[24:27], s72 offen
  v_exp_f32 v196, v196
  v_mfma_f32_16x16x32_bf16 v[200:203], a[100:103], a[20:23], v[200:203]
  s_add_u32 s72, s72, 16384
  v_cvt_pk_bf16_f32 v209, v194, v195
  v_mul_f32 v199, s36, v199
  v_mfma_f32_16x16x32_bf16 v[200:203], a[104:107], a[24:27], v[200:203]
  s_mov_b32 m0, 0
  v_exp_f32 v197, v197
  v_accvgpr_read_b32 v238, a240
  v_rcp_f32 v216, v238
  v_add_u32 v238, 0xd5800000, v238
  ds_write_b32 v250, v216 offset:16384
  ds_read_b128 v[216:219], v251 offset:16384
  v_mfma_f32_16x16x32_bf16 v[200:203], a[108:111], a[28:31], v[200:203]
  buffer_load_dwordx4 v229, s[20:23], s37 offen offset:0 lds
  v_exp_f32 v198, v198
  v_mfma_f32_16x16x32_bf16 v[204:207], a[112:115], a[16:19], v[252:255]
  ds_read_b128 a[144:147], v224 offset:20480
  ds_read_b128 a[148:151], v224 offset:20736
  v_mfma_f32_16x16x32_bf16 v[204:207], a[116:119], a[20:23], v[204:207]
  buffer_load_dwordx4 v229, s[20:23], s37 offen offset:1024 lds
  v_exp_f32 v199, v199
  v_mfma_f32_16x16x32_bf16 v[204:207], a[120:123], a[24:27], v[204:207]
  v_cvt_pk_bf16_f32 v210, v196, v197
  v_cvt_pk_bf16_f32 v211, v198, v199
  v_mfma_f32_16x16x32_bf16 v[204:207], a[124:127], a[28:31], v[204:207]
  buffer_load_dwordx4 v230, s[20:23], s37 offen offset:2048 lds
  v_mfma_f32_16x16x32_bf16 v[0:3], v[208:211], a[160:163], 0
  s_waitcnt lgkmcnt(2)
  v_mul_f32 v200, s36, v200
  v_mul_f32 v201, s36, v201
  v_cmp_le_u32 vcc, 0x34000000, v238
  v_pk_mul_f32 v[128:129], v[128:129], v[216:217]
  v_pk_mul_f32 v[132:133], v[132:133], v[216:217]
  v_pk_mul_f32 v[136:137], v[136:137], v[216:217]
  v_pk_mul_f32 v[140:141], v[140:141], v[216:217]
  v_pk_mul_f32 v[144:145], v[144:145], v[216:217]
  v_pk_mul_f32 v[148:149], v[148:149], v[216:217]
  v_pk_mul_f32 v[152:153], v[152:153], v[216:217]
  v_pk_mul_f32 v[156:157], v[156:157], v[216:217]
  v_cvt_pk_bf16_f32 v96, v128, v132
  v_cvt_pk_bf16_f32 v97, v136, v140
  v_cvt_pk_bf16_f32 v98, v144, v148
  v_cvt_pk_bf16_f32 v99, v152, v156
  ds_write_b128 v233, v[96:99] offset:16384
  v_cvt_pk_bf16_f32 v100, v129, v133
  v_cvt_pk_bf16_f32 v101, v137, v141
  v_cvt_pk_bf16_f32 v102, v145, v149
  v_cvt_pk_bf16_f32 v103, v153, v157
  v_pk_mul_f32 v[130:131], v[130:131], v[218:219]
  v_pk_mul_f32 v[134:135], v[134:135], v[218:219]
  v_pk_mul_f32 v[138:139], v[138:139], v[218:219]
  v_pk_mul_f32 v[142:143], v[142:143], v[218:219]
  ds_write_b128 v233, v[100:103] offset:17408
  v_pk_mul_f32 v[146:147], v[146:147], v[218:219]
  v_pk_mul_f32 v[150:151], v[150:151], v[218:219]
  v_pk_mul_f32 v[154:155], v[154:155], v[218:219]
  v_pk_mul_f32 v[158:159], v[158:159], v[218:219]
  v_cvt_pk_bf16_f32 v104, v130, v134
  v_cvt_pk_bf16_f32 v105, v138, v142
  v_cvt_pk_bf16_f32 v106, v146, v150
  v_cvt_pk_bf16_f32 v107, v154, v158
  ds_write_b128 v233, v[104:107] offset:18432
  v_cvt_pk_bf16_f32 v108, v131, v135
  v_cvt_pk_bf16_f32 v109, v139, v143
  v_cvt_pk_bf16_f32 v110, v147, v151
  v_cvt_pk_bf16_f32 v111, v155, v159
  ds_write_b128 v233, v[108:111] offset:19456
  s_and_b32 vcc_lo, vcc_lo, 0xffff
  s_addc_u32 s46, s46, s46
  v_mfma_f32_16x16x32_bf16 v[4:7], v[208:211], a[164:167], 0
  buffer_load_dwordx4 v230, s[20:23], s37 offen offset:3072 lds
  v_exp_f32 v200, v200
  v_mfma_f32_16x16x32_bf16 v[8:11], v[208:211], a[168:171], 0
  s_add_u32 s37, s37, 4096
  v_mul_f32 v202, s36, v202
  v_mul_f32 v203, s36, v203
  v_mfma_f32_16x16x32_bf16 v[12:15], v[208:211], a[172:175], 0
  v_exp_f32 v201, v201
  v_mfma_f32_16x16x32_bf16 v[16:19], v[208:211], a[176:179], 0
  s_mov_b32 m0, 4096
  ds_read_b128 a[152:155], v224 offset:20992
  ds_read_b128 a[156:159], v224 offset:21248
  v_mfma_f32_16x16x32_bf16 v[20:23], v[208:211], a[180:183], 0
  buffer_load_dwordx4 v229, s[20:23], s37 offen offset:0 lds
  v_exp_f32 v202, v202
  v_mfma_f32_16x16x32_bf16 v[24:27], v[208:211], a[184:187], 0
  v_cvt_pk_bf16_f32 v212, v200, v201
  v_mul_f32 v204, s36, v204
  v_mfma_f32_16x16x32_bf16 v[28:31], v[208:211], a[188:191], 0
  buffer_load_dwordx4 v229, s[20:23], s37 offen offset:1024 lds
  v_exp_f32 v203, v203
  v_mfma_f32_16x16x32_bf16 a[224:227], a[248:251], v[208:211], 0
  v_mul_f32 v205, s36, v205
  v_mul_f32 v206, s36, v206
  v_mfma_f32_16x16x32_bf16 v[192:195], a[96:99], a[32:35], v[252:255]
  buffer_load_dwordx4 v230, s[20:23], s37 offen offset:2048 lds
  v_exp_f32 v204, v204
  v_mfma_f32_16x16x32_bf16 v[192:195], a[100:103], a[36:39], v[192:195]
  v_cvt_pk_bf16_f32 v213, v202, v203
  v_mul_f32 v207, s36, v207
  v_mfma_f32_16x16x32_bf16 v[192:195], a[104:107], a[40:43], v[192:195]
  buffer_load_dword v236, v235, s[24:27], s72 offen
  v_exp_f32 v205, v205
  v_mfma_f32_16x16x32_bf16 v[192:195], a[108:111], a[44:47], v[192:195]
  s_add_u32 s72, s72, 16384
  v_exp_f32 v206, v206
  v_mfma_f32_16x16x32_bf16 v[196:199], a[112:115], a[32:35], v[252:255]
  ds_read_b64_tr_b16 a[192:193], v226 offset:24576
  ds_read_b64_tr_b16 a[194:195], v226 offset:28672
  v_mfma_f32_16x16x32_bf16 v[196:199], a[116:119], a[36:39], v[196:199]
  buffer_load_dwordx4 v230, s[20:23], s37 offen offset:3072 lds
  v_exp_f32 v207, v207
  v_mfma_f32_16x16x32_bf16 v[196:199], a[120:123], a[40:43], v[196:199]
  s_add_u32 s37, s37, 4096
  v_cvt_pk_bf16_f32 v214, v204, v205
  v_cvt_pk_bf16_f32 v215, v206, v207
  v_mfma_f32_16x16x32_bf16 v[196:199], a[124:127], a[44:47], v[196:199]
  s_nop 0
  v_mfma_f32_16x16x32_bf16 v[32:35], v[212:215], a[160:163], 0
  s_mov_b32 m0, 8192
  ds_read_b64_tr_b16 a[196:197], v237 offset:24576
  ds_read_b64_tr_b16 a[198:199], v237 offset:28672
  v_mul_f32 v192, s36, v192
  v_mul_f32 v193, s36, v193
  v_mfma_f32_16x16x32_bf16 v[36:39], v[212:215], a[164:167], 0
  buffer_load_dwordx4 v241, s[24:27], s38 offen offset:0 lds
  v_exp_f32 v192, v192
  v_mfma_f32_16x16x32_bf16 v[40:43], v[212:215], a[168:171], 0
  v_mul_f32 v194, s36, v194
  v_mul_f32 v195, s36, v195
  v_mfma_f32_16x16x32_bf16 v[44:47], v[212:215], a[172:175], 0
  buffer_load_dwordx4 v241, s[24:27], s38 offen offset:1024 lds
  v_exp_f32 v193, v193
  v_mfma_f32_16x16x32_bf16 v[48:51], v[212:215], a[176:179], 0
  ds_read_b64_tr_b16 a[200:201], v234 offset:24576
  ds_read_b64_tr_b16 a[202:203], v234 offset:28672
  v_mfma_f32_16x16x32_bf16 v[52:55], v[212:215], a[180:183], 0
  buffer_load_dwordx4 v241, s[24:27], s38 offen offset:2048 lds
  v_exp_f32 v194, v194
  v_mfma_f32_16x16x32_bf16 v[56:59], v[212:215], a[184:187], 0
  v_cvt_pk_bf16_f32 v208, v192, v193
  v_mul_f32 v196, s36, v196
  v_mfma_f32_16x16x32_bf16 v[60:63], v[212:215], a[188:191], 0
  buffer_load_dwordx4 v241, s[24:27], s38 offen offset:3072 lds
  v_exp_f32 v195, v195
  v_mfma_f32_16x16x32_bf16 a[228:231], a[248:251], v[212:215], 0
  s_add_u32 s38, s38, 4096
  v_mul_f32 v197, s36, v197
  v_mul_f32 v198, s36, v198
  v_mfma_f32_16x16x32_bf16 v[200:203], a[96:99], a[48:51], v[252:255]
  s_mov_b32 m0, 12288
  v_exp_f32 v196, v196
  v_mfma_f32_16x16x32_bf16 v[200:203], a[100:103], a[52:55], v[200:203]
  buffer_load_dwordx4 v241, s[24:27], s38 offen offset:0 lds
  v_cvt_pk_bf16_f32 v209, v194, v195
  v_mul_f32 v199, s36, v199
  v_mfma_f32_16x16x32_bf16 v[200:203], a[104:107], a[56:59], v[200:203]
  v_exp_f32 v197, v197
  v_mfma_f32_16x16x32_bf16 v[200:203], a[108:111], a[60:63], v[200:203]
  buffer_load_dwordx4 v241, s[24:27], s38 offen offset:1024 lds
  v_exp_f32 v198, v198
  v_mfma_f32_16x16x32_bf16 v[204:207], a[112:115], a[48:51], v[252:255]
  ds_read_b64_tr_b16 a[204:205], v228 offset:24576
  ds_read_b64_tr_b16 a[206:207], v228 offset:28672
  v_mfma_f32_16x16x32_bf16 v[204:207], a[116:119], a[52:55], v[204:207]
  buffer_load_dwordx4 v241, s[24:27], s38 offen offset:2048 lds
  v_exp_f32 v199, v199
  v_mfma_f32_16x16x32_bf16 v[204:207], a[120:123], a[56:59], v[204:207]
  v_cvt_pk_bf16_f32 v210, v196, v197
  v_cvt_pk_bf16_f32 v211, v198, v199
  v_mfma_f32_16x16x32_bf16 v[204:207], a[124:127], a[60:63], v[204:207]
  buffer_load_dwordx4 v241, s[24:27], s38 offen offset:3072 lds
  v_mfma_f32_16x16x32_bf16 v[64:67], v[208:211], a[160:163], 0
  s_add_u32 s38, s38, 4096
  ds_read_b64_tr_b16 a[208:209], v226 offset:24584
  ds_read_b64_tr_b16 a[210:211], v226 offset:28680
  v_mul_f32 v200, s36, v200
  v_mul_f32 v201, s36, v201
  v_mfma_f32_16x16x32_bf16 v[68:71], v[208:211], a[164:167], 0
  v_exp_f32 v200, v200
  v_mfma_f32_16x16x32_bf16 v[72:75], v[208:211], a[168:171], 0
  v_mul_f32 v202, s36, v202
  v_mul_f32 v203, s36, v203
  v_mfma_f32_16x16x32_bf16 v[76:79], v[208:211], a[172:175], 0
  v_exp_f32 v201, v201
  v_mfma_f32_16x16x32_bf16 v[80:83], v[208:211], a[176:179], 0
  ds_read_b64_tr_b16 a[212:213], v237 offset:24584
  ds_read_b64_tr_b16 a[214:215], v237 offset:28680
  v_mfma_f32_16x16x32_bf16 v[84:87], v[208:211], a[180:183], 0
  v_exp_f32 v202, v202
  v_mfma_f32_16x16x32_bf16 v[88:91], v[208:211], a[184:187], 0
  v_cvt_pk_bf16_f32 v212, v200, v201
  v_mul_f32 v204, s36, v204
  v_mfma_f32_16x16x32_bf16 v[92:95], v[208:211], a[188:191], 0
  v_exp_f32 v203, v203
  v_mfma_f32_16x16x32_bf16 a[232:235], a[248:251], v[208:211], 0
  v_mul_f32 v205, s36, v205
  v_mul_f32 v206, s36, v206
  v_mfma_f32_16x16x32_bf16 v[192:195], a[96:99], a[64:67], v[252:255]
  v_exp_f32 v204, v204
  v_mfma_f32_16x16x32_bf16 v[192:195], a[100:103], a[68:71], v[192:195]
  v_cvt_pk_bf16_f32 v213, v202, v203
  v_mul_f32 v207, s36, v207
  v_mfma_f32_16x16x32_bf16 v[192:195], a[104:107], a[72:75], v[192:195]
  v_exp_f32 v205, v205
  v_mfma_f32_16x16x32_bf16 v[192:195], a[108:111], a[76:79], v[192:195]
  v_exp_f32 v206, v206
  v_mfma_f32_16x16x32_bf16 v[196:199], a[112:115], a[64:67], v[252:255]
  ds_read_b64_tr_b16 a[216:217], v234 offset:24584
  ds_read_b64_tr_b16 a[218:219], v234 offset:28680
  v_mfma_f32_16x16x32_bf16 v[196:199], a[116:119], a[68:71], v[196:199]
  v_exp_f32 v207, v207
  v_mfma_f32_16x16x32_bf16 v[196:199], a[120:123], a[72:75], v[196:199]
  v_cvt_pk_bf16_f32 v214, v204, v205
  v_cvt_pk_bf16_f32 v215, v206, v207
  v_mfma_f32_16x16x32_bf16 v[196:199], a[124:127], a[76:79], v[196:199]
  s_waitcnt vmcnt(36)
  ds_add_u32 v245, v243
  v_mfma_f32_16x16x32_bf16 v[96:99], v[212:215], a[160:163], 0
  v_mul_f32 v192, s36, v192
  v_mul_f32 v193, s36, v193
  v_mfma_f32_16x16x32_bf16 v[100:103], v[212:215], a[164:167], 0
  v_exp_f32 v192, v192
  v_mfma_f32_16x16x32_bf16 v[104:107], v[212:215], a[168:171], 0
  v_mul_f32 v194, s36, v194
  v_mul_f32 v195, s36, v195
  v_mfma_f32_16x16x32_bf16 v[108:111], v[212:215], a[172:175], 0
  v_exp_f32 v193, v193
  v_mfma_f32_16x16x32_bf16 v[112:115], v[212:215], a[176:179], 0
  ds_read_b64_tr_b16 a[220:221], v228 offset:24584
  ds_read_b64_tr_b16 a[222:223], v228 offset:28680
  v_mfma_f32_16x16x32_bf16 v[116:119], v[212:215], a[180:183], 0
  v_exp_f32 v194, v194
  v_mfma_f32_16x16x32_bf16 v[120:123], v[212:215], a[184:187], 0
  s_waitcnt lgkmcnt(15)
  v_cvt_pk_bf16_f32 v208, v192, v193
  v_mul_f32 v196, s36, v196
  v_mfma_f32_16x16x32_bf16 v[124:127], v[212:215], a[188:191], 0
  v_exp_f32 v195, v195
  v_mfma_f32_16x16x32_bf16 a[236:239], a[248:251], v[212:215], 0
  v_mul_f32 v197, s36, v197
  v_mul_f32 v198, s36, v198
  v_mfma_f32_16x16x32_bf16 v[200:203], a[128:131], a[0:3], v[252:255]
  s_mul_i32 s49, s45, 188416
  v_exp_f32 v196, v196
  v_mfma_f32_16x16x32_bf16 v[200:203], a[132:135], a[4:7], v[200:203]
  s_add_u32 s49, s49, s51
  v_cvt_pk_bf16_f32 v209, v194, v195
  v_mul_f32 v199, s36, v199
  v_mfma_f32_16x16x32_bf16 v[200:203], a[136:139], a[8:11], v[200:203]
  s_sub_u32 s42, s49, 188416
  v_exp_f32 v197, v197
  v_mfma_f32_16x16x32_bf16 v[200:203], a[140:143], a[12:15], v[200:203]
  s_add_u32 s30, s42, 20480
  v_exp_f32 v198, v198
  v_mfma_f32_16x16x32_bf16 v[204:207], a[144:147], a[0:3], v[252:255]
  s_add_u32 s41, s49, 188416
  ds_read_b128 a[96:99], v224 offset:32768
  ds_read_b128 a[100:103], v224 offset:33024
  v_mfma_f32_16x16x32_bf16 v[204:207], a[148:151], a[4:7], v[204:207]
  s_add_u32 s18, s41, 20480
  v_exp_f32 v199, v199
  v_mfma_f32_16x16x32_bf16 v[204:207], a[152:155], a[8:11], v[204:207]
  s_sub_u32 s41, s41, 73728
  v_cvt_pk_bf16_f32 v210, v196, v197
  v_cvt_pk_bf16_f32 v211, v198, v199
  v_mfma_f32_16x16x32_bf16 v[204:207], a[156:159], a[12:15], v[204:207]
  s_mov_b32 s43, 65536
  ds_read_b32 v244, v242
  v_mfma_f32_16x16x32_bf16 v[128:131], v[208:211], a[160:163], 0
  s_mov_b32 s44, 0
  v_mul_f32 v200, s36, v200
  v_mul_f32 v201, s36, v201
  v_mfma_f32_16x16x32_bf16 v[132:135], v[208:211], a[164:167], 0
  v_exp_f32 v200, v200
  v_mfma_f32_16x16x32_bf16 v[136:139], v[208:211], a[168:171], 0
  v_mul_f32 v202, s36, v202
  v_mul_f32 v203, s36, v203
  v_mfma_f32_16x16x32_bf16 v[140:143], v[208:211], a[172:175], 0
  v_exp_f32 v201, v201
  v_mfma_f32_16x16x32_bf16 v[144:147], v[208:211], a[176:179], 0
  ds_read_b128 a[104:107], v224 offset:33280
  ds_read_b128 a[108:111], v224 offset:33536
  v_mfma_f32_16x16x32_bf16 v[148:151], v[208:211], a[180:183], 0
  s_waitcnt lgkmcnt(2)
  v_exp_f32 v202, v202
  v_cmp_gt_u32 vcc, s58, v244
  v_mfma_f32_16x16x32_bf16 v[152:155], v[208:211], a[184:187], 0
  v_cvt_pk_bf16_f32 v212, v200, v201
  v_mul_f32 v204, s36, v204
  v_mfma_f32_16x16x32_bf16 v[156:159], v[208:211], a[188:191], 0
  s_cbranch_vccnz L_s5_11
L_r5_11:
  v_exp_f32 v203, v203
  v_mfma_f32_16x16x32_bf16 a[240:243], a[248:251], v[208:211], 0
  s_add_u32 s58, s58, 1
  v_mul_f32 v205, s36, v205
  v_mul_f32 v206, s36, v206
  v_mfma_f32_16x16x32_bf16 v[192:195], a[128:131], a[16:19], v[252:255]
  buffer_load_dword v236, v235, s[24:27], s72 offen
  v_exp_f32 v204, v204
  v_mfma_f32_16x16x32_bf16 v[192:195], a[132:135], a[20:23], v[192:195]
  s_add_u32 s72, s72, 16384
  v_cvt_pk_bf16_f32 v213, v202, v203
  v_mul_f32 v207, s36, v207
  v_mfma_f32_16x16x32_bf16 v[192:195], a[136:139], a[24:27], v[192:195]
  s_mov_b32 m0, 16384
  v_exp_f32 v205, v205
  v_mfma_f32_16x16x32_bf16 v[192:195], a[140:143], a[28:31], v[192:195]
  buffer_load_dwordx4 v229, s[20:23], s37 offen offset:0 lds
  v_exp_f32 v206, v206
  v_mfma_f32_16x16x32_bf16 v[196:199], a[144:147], a[16:19], v[252:255]
  ds_read_b128 a[112:115], v224 offset:36864
  ds_read_b128 a[116:119], v224 offset:37120
  v_mfma_f32_16x16x32_bf16 v[196:199], a[148:151], a[20:23], v[196:199]
  buffer_load_dwordx4 v229, s[20:23], s37 offen offset:1024 lds
  v_exp_f32 v207, v207
  v_mfma_f32_16x16x32_bf16 v[196:199], a[152:155], a[24:27], v[196:199]
  v_cvt_pk_bf16_f32 v214, v204, v205
  v_cvt_pk_bf16_f32 v215, v206, v207
  v_mfma_f32_16x16x32_bf16 v[196:199], a[156:159], a[28:31], v[196:199]
  buffer_load_dwordx4 v230, s[20:23], s37 offen offset:2048 lds
  v_mfma_f32_16x16x32_bf16 v[0:3], v[212:215], a[192:195], v[0:3]
  v_mul_f32 v192, s36, v192
  v_mul_f32 v193, s36, v193
  v_mfma_f32_16x16x32_bf16 v[4:7], v[212:215], a[196:199], v[4:7]
  buffer_load_dwordx4 v230, s[20:23], s37 offen offset:3072 lds
  v_exp_f32 v192, v192
  v_mfma_f32_16x16x32_bf16 v[8:11], v[212:215], a[200:203], v[8:11]
  s_add_u32 s37, s37, 4096
  v_mul_f32 v194, s36, v194
  v_mul_f32 v195, s36, v195
  v_mfma_f32_16x16x32_bf16 v[12:15], v[212:215], a[204:207], v[12:15]
  v_exp_f32 v193, v193
  v_mfma_f32_16x16x32_bf16 v[16:19], v[212:215], a[208:211], v[16:19]
  s_mov_b32 m0, 20480
  ds_read_b128 a[120:123], v224 offset:37376
  ds_read_b128 a[124:127], v224 offset:37632
  v_mfma_f32_16x16x32_bf16 v[20:23], v[212:215], a[212:215], v[20:23]
  buffer_load_dwordx4 v229, s[20:23], s37 offen offset:0 lds
  v_exp_f32 v194, v194
  v_mfma_f32_16x16x32_bf16 v[24:27], v[212:215], a[216:219], v[24:27]
  v_cvt_pk_bf16_f32 v208, v192, v193
  v_mul_f32 v196, s36, v196
  v_mfma_f32_16x16x32_bf16 v[28:31], v[212:215], a[220:223], v[28:31]
  buffer_load_dwordx4 v229, s[20:23], s37 offen offset:1024 lds
  v_exp_f32 v195, v195
  v_mfma_f32_16x16x32_bf16 a[224:227], a[248:251], v[212:215], a[224:227]
  v_mul_f32 v197, s36, v197
  v_mul_f32 v198, s36, v198
  v_mfma_f32_16x16x32_bf16 v[200:203], a[128:131], a[32:35], v[252:255]
  buffer_load_dwordx4 v230, s[20:23], s37 offen offset:2048 lds
  v_exp_f32 v196, v196
  v_mfma_f32_16x16x32_bf16 v[200:203], a[132:135], a[36:39], v[200:203]
  v_cvt_pk_bf16_f32 v209, v194, v195
  v_mul_f32 v199, s36, v199
  v_mfma_f32_16x16x32_bf16 v[200:203], a[136:139], a[40:43], v[200:203]
  buffer_load_dwordx4 v230, s[20:23], s37 offen offset:3072 lds
  v_exp_f32 v197, v197
  v_mfma_f32_16x16x32_bf16 v[200:203], a[140:143], a[44:47], v[200:203]
  s_add_u32 s37, s37, 4096
  v_exp_f32 v198, v198
  v_mfma_f32_16x16x32_bf16 v[204:207], a[144:147], a[32:35], v[252:255]
  s_mov_b32 m0, 24576
  ds_read_b64_tr_b16 a[160:161], v226 offset:40960
  ds_read_b64_tr_b16 a[162:163], v226 offset:45056
  v_mfma_f32_16x16x32_bf16 v[204:207], a[148:151], a[36:39], v[204:207]
  buffer_load_dwordx4 v241, s[24:27], s38 offen offset:0 lds
  v_exp_f32 v199, v199
  v_mfma_f32_16x16x32_bf16 v[204:207], a[152:155], a[40:43], v[204:207]
  v_cvt_pk_bf16_f32 v210, v196, v197
  v_cvt_pk_bf16_f32 v211, v198, v199
  v_mfma_f32_16x16x32_bf16 v[204:207], a[156:159], a[44:47], v[204:207]
  buffer_load_dwordx4 v241, s[24:27], s38 offen offset:1024 lds
  v_mfma_f32_16x16x32_bf16 v[32:35], v[208:211], a[192:195], v[32:35]
  ds_read_b64_tr_b16 a[164:165], v237 offset:40960
  ds_read_b64_tr_b16 a[166:167], v237 offset:45056
  v_mul_f32 v200, s36, v200
  v_mul_f32 v201, s36, v201
  v_mfma_f32_16x16x32_bf16 v[36:39], v[208:211], a[196:199], v[36:39]
  buffer_load_dwordx4 v241, s[24:27], s38 offen offset:2048 lds
  v_exp_f32 v200, v200
  v_mfma_f32_16x16x32_bf16 v[40:43], v[208:211], a[200:203], v[40:43]
  v_mul_f32 v202, s36, v202
  v_mul_f32 v203, s36, v203
  v_mfma_f32_16x16x32_bf16 v[44:47], v[208:211], a[204:207], v[44:47]
  buffer_load_dwordx4 v241, s[24:27], s38 offen offset:3072 lds
  v_exp_f32 v201, v201
  v_mfma_f32_16x16x32_bf16 v[48:51], v[208:211], a[208:211], v[48:51]
  s_add_u32 s38, s38, 4096
  ds_read_b64_tr_b16 a[168:169], v234 offset:40960
  ds_read_b64_tr_b16 a[170:171], v234 offset:45056
  v_mfma_f32_16x16x32_bf16 v[52:55], v[208:211], a[212:215], v[52:55]
  s_mov_b32 m0, 28672
  v_exp_f32 v202, v202
  v_mfma_f32_16x16x32_bf16 v[56:59], v[208:211], a[216:219], v[56:59]
  buffer_load_dwordx4 v241, s[24:27], s38 offen offset:0 lds
  v_cvt_pk_bf16_f32 v212, v200, v201
  v_mul_f32 v204, s36, v204
  v_mfma_f32_16x16x32_bf16 v[60:63], v[208:211], a[220:223], v[60:63]
  v_exp_f32 v203, v203
  v_mfma_f32_16x16x32_bf16 a[228:231], a[248:251], v[208:211], a[228:231]
  buffer_load_dwordx4 v241, s[24:27], s38 offen offset:1024 lds
  v_mul_f32 v205, s36, v205
  v_mul_f32 v206, s36, v206
  v_mfma_f32_16x16x32_bf16 v[192:195], a[128:131], a[48:51], v[252:255]
  v_exp_f32 v204, v204
  v_mfma_f32_16x16x32_bf16 v[192:195], a[132:135], a[52:55], v[192:195]
  buffer_load_dwordx4 v241, s[24:27], s38 offen offset:2048 lds
  v_cvt_pk_bf16_f32 v213, v202, v203
  v_mul_f32 v207, s36, v207
  v_mfma_f32_16x16x32_bf16 v[192:195], a[136:139], a[56:59], v[192:195]
  v_exp_f32 v205, v205
  v_mfma_f32_16x16x32_bf16 v[192:195], a[140:143], a[60:63], v[192:195]
  buffer_load_dwordx4 v241, s[24:27], s38 offen offset:3072 lds
  v_exp_f32 v206, v206
  v_mfma_f32_16x16x32_bf16 v[196:199], a[144:147], a[48:51], v[252:255]
  s_add_u32 s38, s38, 4096
  ds_read_b64_tr_b16 a[172:173], v228 offset:40960
  ds_read_b64_tr_b16 a[174:175], v228 offset:45056
  v_mfma_f32_16x16x32_bf16 v[196:199], a[148:151], a[52:55], v[196:199]
  s_add_u32 s72, s53, s73
  v_exp_f32 v207, v207
  v_mfma_f32_16x16x32_bf16 v[196:199], a[152:155], a[56:59], v[196:199]
  s_add_u32 s72, s72, 425984
  v_cvt_pk_bf16_f32 v214, v204, v205
  v_cvt_pk_bf16_f32 v215, v206, v207
  v_mfma_f32_16x16x32_bf16 v[196:199], a[156:159], a[60:63], v[196:199]
  s_nop 0
  v_mfma_f32_16x16x32_bf16 v[64:67], v[212:215], a[192:195], v[64:67]
  ds_read_b64_tr_b16 a[176:177], v226 offset:40968
  ds_read_b64_tr_b16 a[178:179], v226 offset:45064
  v_mul_f32 v192, s36, v192
  v_mul_f32 v193, s36, v193
  v_mfma_f32_16x16x32_bf16 v[68:71], v[212:215], a[196:199], v[68:71]
  v_exp_f32 v192, v192
  v_mfma_f32_16x16x32_bf16 v[72:75], v[212:215], a[200:203], v[72:75]
  v_mul_f32 v194, s36, v194
  v_mul_f32 v195, s36, v195
  v_mfma_f32_16x16x32_bf16 v[76:79], v[212:215], a[204:207], v[76:79]
  v_exp_f32 v193, v193
  v_mfma_f32_16x16x32_bf16 v[80:83], v[212:215], a[208:211], v[80:83]
  ds_read_b64_tr_b16 a[180:181], v237 offset:40968
  ds_read_b64_tr_b16 a[182:183], v237 offset:45064
  v_mfma_f32_16x16x32_bf16 v[84:87], v[212:215], a[212:215], v[84:87]
  v_exp_f32 v194, v194
  v_mfma_f32_16x16x32_bf16 v[88:91], v[212:215], a[216:219], v[88:91]
  v_cvt_pk_bf16_f32 v208, v192, v193
  v_mul_f32 v196, s36, v196
  v_mfma_f32_16x16x32_bf16 v[92:95], v[212:215], a[220:223], v[92:95]
  v_exp_f32 v195, v195
  v_mfma_f32_16x16x32_bf16 a[232:235], a[248:251], v[212:215], a[232:235]
  v_mul_f32 v197, s36, v197
  v_mul_f32 v198, s36, v198
  v_mfma_f32_16x16x32_bf16 v[200:203], a[128:131], a[64:67], v[252:255]
  v_exp_f32 v196, v196
  v_mfma_f32_16x16x32_bf16 v[200:203], a[132:135], a[68:71], v[200:203]
  v_cvt_pk_bf16_f32 v209, v194, v195
  v_mul_f32 v199, s36, v199
  v_mfma_f32_16x16x32_bf16 v[200:203], a[136:139], a[72:75], v[200:203]
  v_exp_f32 v197, v197
  v_mfma_f32_16x16x32_bf16 v[200:203], a[140:143], a[76:79], v[200:203]
  v_exp_f32 v198, v198
  v_mfma_f32_16x16x32_bf16 v[204:207], a[144:147], a[64:67], v[252:255]
  ds_read_b64_tr_b16 a[184:185], v234 offset:40968
  ds_read_b64_tr_b16 a[186:187], v234 offset:45064
  v_mfma_f32_16x16x32_bf16 v[204:207], a[148:151], a[68:71], v[204:207]
  v_exp_f32 v199, v199
  v_mfma_f32_16x16x32_bf16 v[204:207], a[152:155], a[72:75], v[204:207]
  v_cvt_pk_bf16_f32 v210, v196, v197
  v_cvt_pk_bf16_f32 v211, v198, v199
  v_mfma_f32_16x16x32_bf16 v[204:207], a[156:159], a[76:79], v[204:207]
  s_waitcnt vmcnt(35)
  ds_add_u32 v245, v243
  v_mfma_f32_16x16x32_bf16 v[96:99], v[208:211], a[192:195], v[96:99]
  v_mul_f32 v200, s36, v200
  v_mul_f32 v201, s36, v201
  v_mfma_f32_16x16x32_bf16 v[100:103], v[208:211], a[196:199], v[100:103]
  v_exp_f32 v200, v200
  v_mfma_f32_16x16x32_bf16 v[104:107], v[208:211], a[200:203], v[104:107]
  v_mul_f32 v202, s36, v202
  v_mul_f32 v203, s36, v203
  v_mfma_f32_16x16x32_bf16 v[108:111], v[208:211], a[204:207], v[108:111]
  v_exp_f32 v201, v201
  v_mfma_f32_16x16x32_bf16 v[112:115], v[208:211], a[208:211], v[112:115]
  ds_read_b64_tr_b16 a[188:189], v228 offset:40968
  ds_read_b64_tr_b16 a[190:191], v228 offset:45064
  v_mfma_f32_16x16x32_bf16 v[116:119], v[208:211], a[212:215], v[116:119]
  v_exp_f32 v202, v202
  v_mfma_f32_16x16x32_bf16 v[120:123], v[208:211], a[216:219], v[120:123]
  s_waitcnt lgkmcnt(15)
  v_cvt_pk_bf16_f32 v212, v200, v201
  v_mul_f32 v204, s36, v204
  v_mfma_f32_16x16x32_bf16 v[124:127], v[208:211], a[220:223], v[124:127]
  v_exp_f32 v203, v203
  v_mfma_f32_16x16x32_bf16 a[236:239], a[248:251], v[208:211], a[236:239]
  s_cmp_eq_u32 s45, 3
  v_mul_f32 v205, s36, v205
  v_mul_f32 v206, s36, v206
  s_cbranch_scc1 L_C5
L_B5:
  v_mfma_f32_16x16x32_bf16 v[192:195], a[96:99], a[0:3], v[252:255]
  v_exp_f32 v204, v204
  v_mfma_f32_16x16x32_bf16 v[192:195], a[100:103], a[4:7], v[192:195]
  v_cvt_pk_bf16_f32 v213, v202, v203
  v_mul_f32 v207, s36, v207
  v_mfma_f32_16x16x32_bf16 v[192:195], a[104:107], a[8:11], v[192:195]
  v_exp_f32 v205, v205
  v_mfma_f32_16x16x32_bf16 v[192:195], a[108:111], a[12:15], v[192:195]
  v_exp_f32 v206, v206
  v_mfma_f32_16x16x32_bf16 v[196:199], a[112:115], a[0:3], v[252:255]
  ds_read_b128 a[128:131], v224 offset:49152
  ds_read_b128 a[132:135], v224 offset:49408
  v_mfma_f32_16x16x32_bf16 v[196:199], a[116:119], a[4:7], v[196:199]
  v_exp_f32 v207, v207
  v_mfma_f32_16x16x32_bf16 v[196:199], a[120:123], a[8:11], v[196:199]
  v_cvt_pk_bf16_f32 v214, v204, v205
  v_cvt_pk_bf16_f32 v215, v206, v207
  v_mfma_f32_16x16x32_bf16 v[196:199], a[124:127], a[12:15], v[196:199]
  ds_read_b64_tr_b16 v[216:217], v231 offset:0
  ds_read_b64_tr_b16 v[218:219], v231 offset:8
  ds_read_b64_tr_b16 v[220:221], v231 offset:1024
  ds_read_b64_tr_b16 v[222:223], v231 offset:1032
  ds_read_b32 v244, v242
  v_mfma_f32_16x16x32_bf16 v[128:131], v[212:215], a[192:195], v[128:131]
  v_mul_f32 v192, s36, v192
  v_mul_f32 v193, s36, v193
  v_mfma_f32_16x16x32_bf16 v[132:135], v[212:215], a[196:199], v[132:135]
  v_exp_f32 v192, v192
  v_mfma_f32_16x16x32_bf16 v[136:139], v[212:215], a[200:203], v[136:139]
  v_mul_f32 v194, s36, v194
  v_mul_f32 v195, s36, v195
  v_mfma_f32_16x16x32_bf16 v[140:143], v[212:215], a[204:207], v[140:143]
  v_exp_f32 v193, v193
  v_mfma_f32_16x16x32_bf16 v[144:147], v[212:215], a[208:211], v[144:147]
  ds_read_b128 a[136:139], v224 offset:49664
  ds_read_b128 a[140:143], v224 offset:49920
  v_mfma_f32_16x16x32_bf16 v[148:151], v[212:215], a[212:215], v[148:151]
  s_waitcnt lgkmcnt(2)
  v_exp_f32 v194, v194
  v_cmp_gt_u32 vcc, s58, v244
  v_mfma_f32_16x16x32_bf16 v[152:155], v[212:215], a[216:219], v[152:155]
  v_cvt_pk_bf16_f32 v208, v192, v193
  v_mul_f32 v196, s36, v196
  v_mfma_f32_16x16x32_bf16 v[156:159], v[212:215], a[220:223], v[156:159]
  s_cbranch_vccnz L_s5_B2
L_r5_B2:
  v_exp_f32 v195, v195
  v_mfma_f32_16x16x32_bf16 a[240:243], a[248:251], v[212:215], a[240:243]
  s_add_u32 s58, s58, 1
  v_mul_f32 v197, s36, v197
  v_mul_f32 v198, s36, v198
  v_mfma_f32_16x16x32_bf16 v[200:203], a[96:99], a[16:19], v[252:255]
  buffer_store_dwordx4 v[216:219], v232, s[28:31], s42 offen offset:0 nt
  v_exp_f32 v196, v196
  v_mfma_f32_16x16x32_bf16 v[200:203], a[100:103], a[20:23], v[200:203]
  s_waitcnt vmcnt(50)
  v_cvt_pk_bf16_f32 v209, v194, v195
  v_mul_f32 v199, s36, v199
  v_mfma_f32_16x16x32_bf16 v[200:203], a[104:107], a[24:27], v[200:203]
  buffer_store_dwordx4 v[220:223], v232, s[28:31], s42 offen offset:256 nt
  v_exp_f32 v197, v197
  v_mfma_f32_16x16x32_bf16 v[200:203], a[108:111], a[28:31], v[200:203]
  v_exp_f32 v198, v198
  v_mfma_f32_16x16x32_bf16 v[204:207], a[112:115], a[16:19], v[252:255]
  s_mov_b32 m0, s43
  ds_read_b128 a[144:147], v224 offset:53248
  ds_read_b128 a[148:151], v224 offset:53504
  v_mfma_f32_16x16x32_bf16 v[204:207], a[116:119], a[20:23], v[204:207]
  buffer_load_dwordx4 v229, s[16:19], s41 offen offset:0 nt lds
  v_exp_f32 v199, v199
  v_mfma_f32_16x16x32_bf16 v[204:207], a[120:123], a[24:27], v[204:207]
  s_add_u32 s43, s43, 2048
  v_cvt_pk_bf16_f32 v210, v196, v197
  v_cvt_pk_bf16_f32 v211, v198, v199
  v_mfma_f32_16x16x32_bf16 v[204:207], a[124:127], a[28:31], v[204:207]
  buffer_load_dwordx4 v229, s[16:19], s41 offen offset:1024 nt lds
  v_mfma_f32_16x16x32_bf16 v[0:3], v[208:211], a[160:163], v[0:3]
  s_add_u32 s41, s41, 24576
  v_mul_f32 v200, s36, v200
  v_mul_f32 v201, s36, v201
  v_mfma_f32_16x16x32_bf16 v[4:7], v[208:211], a[164:167], v[4:7]
  s_add_u32 m0, m0, 24576
  v_exp_f32 v200, v200
  v_mfma_f32_16x16x32_bf16 v[8:11], v[208:211], a[168:171], v[8:11]
  buffer_load_dwordx4 v229, s[16:19], s41 offen offset:0 nt lds
  v_mul_f32 v202, s36, v202
  v_mul_f32 v203, s36, v203
  v_mfma_f32_16x16x32_bf16 v[12:15], v[208:211], a[172:175], v[12:15]
  v_exp_f32 v201, v201
  v_mfma_f32_16x16x32_bf16 v[16:19], v[208:211], a[176:179], v[16:19]
  ds_read_b128 a[152:155], v224 offset:53760
  ds_read_b128 a[156:159], v224 offset:54016
  v_mfma_f32_16x16x32_bf16 v[20:23], v[208:211], a[180:183], v[20:23]
  buffer_load_dwordx4 v229, s[16:19], s41 offen offset:1024 nt lds
  v_exp_f32 v202, v202
  v_mfma_f32_16x16x32_bf16 v[24:27], v[208:211], a[184:187], v[24:27]
  s_add_u32 s41, s41, 24576
  v_cvt_pk_bf16_f32 v212, v200, v201
  v_mul_f32 v204, s36, v204
  v_mfma_f32_16x16x32_bf16 v[28:31], v[208:211], a[188:191], v[28:31]
  s_add_u32 m0, m0, 24576
  v_exp_f32 v203, v203
  v_mfma_f32_16x16x32_bf16 a[224:227], a[248:251], v[208:211], a[224:227]
  buffer_load_dwordx4 v229, s[16:19], s41 offen offset:0 nt lds
  v_mul_f32 v205, s36, v205
  v_mul_f32 v206, s36, v206
  v_mfma_f32_16x16x32_bf16 v[192:195], a[96:99], a[32:35], v[252:255]
  s_add_u32 s48, m0, 24576
  v_exp_f32 v204, v204
  v_mfma_f32_16x16x32_bf16 v[192:195], a[100:103], a[36:39], v[192:195]
  buffer_load_dwordx4 v229, s[16:19], s41 offen offset:1024 nt lds
  v_cvt_pk_bf16_f32 v213, v202, v203
  v_mul_f32 v207, s36, v207
  v_mfma_f32_16x16x32_bf16 v[192:195], a[104:107], a[40:43], v[192:195]
  s_add_u32 s41, s41, 24576
  v_exp_f32 v205, v205
  v_mfma_f32_16x16x32_bf16 v[192:195], a[108:111], a[44:47], v[192:195]
  v_exp_f32 v206, v206
  v_mfma_f32_16x16x32_bf16 v[196:199], a[112:115], a[32:35], v[252:255]
  s_min_u32 m0, s48, 159744
  ds_read_b64_tr_b16 a[192:193], v226 offset:57344
  ds_read_b64_tr_b16 a[194:195], v226 offset:61440
  v_mfma_f32_16x16x32_bf16 v[196:199], a[116:119], a[36:39], v[196:199]
  buffer_load_dwordx4 v229, s[16:19], s41 offen offset:0 nt lds
  v_exp_f32 v207, v207
  v_mfma_f32_16x16x32_bf16 v[196:199], a[120:123], a[40:43], v[196:199]
  v_cvt_pk_bf16_f32 v214, v204, v205
  v_cvt_pk_bf16_f32 v215, v206, v207
  v_mfma_f32_16x16x32_bf16 v[196:199], a[124:127], a[44:47], v[196:199]
  buffer_load_dwordx4 v229, s[16:19], s41 offen offset:1024 nt lds
  v_mfma_f32_16x16x32_bf16 v[32:35], v[212:215], a[160:163], v[32:35]
  s_add_u32 s41, s41, 0xfffee800
  ds_read_b64_tr_b16 a[196:197], v237 offset:57344
  ds_read_b64_tr_b16 a[198:199], v237 offset:61440
  v_mul_f32 v192, s36, v192
  v_mul_f32 v193, s36, v193
  v_mfma_f32_16x16x32_bf16 v[36:39], v[212:215], a[164:167], v[36:39]
  s_mov_b32 m0, 32768
  v_exp_f32 v192, v192
  v_mfma_f32_16x16x32_bf16 v[40:43], v[212:215], a[168:171], v[40:43]
  buffer_load_dwordx4 v229, s[20:23], s37 offen offset:0 lds
  v_mul_f32 v194, s36, v194
  v_mul_f32 v195, s36, v195
  v_mfma_f32_16x16x32_bf16 v[44:47], v[212:215], a[172:175], v[44:47]
  v_exp_f32 v193, v193
  v_mfma_f32_16x16x32_bf16 v[48:51], v[212:215], a[176:179], v[48:51]
  ds_read_b64_tr_b16 a[200:201], v234 offset:57344
  ds_read_b64_tr_b16 a[202:203], v234 offset:61440
  v_mfma_f32_16x16x32_bf16 v[52:55], v[212:215], a[180:183], v[52:55]
  buffer_load_dwordx4 v229, s[20:23], s37 offen offset:1024 lds
  v_exp_f32 v194, v194
  v_mfma_f32_16x16x32_bf16 v[56:59], v[212:215], a[184:187], v[56:59]
  v_cvt_pk_bf16_f32 v208, v192, v193
  v_mul_f32 v196, s36, v196
  v_mfma_f32_16x16x32_bf16 v[60:63], v[212:215], a[188:191], v[60:63]
  buffer_load_dwordx4 v230, s[20:23], s37 offen offset:2048 lds
  v_exp_f32 v195, v195
  v_mfma_f32_16x16x32_bf16 a[228:231], a[248:251], v[212:215], a[228:231]
  s_waitcnt vmcnt(50)
  v_mul_f32 v197, s36, v197
  v_mul_f32 v198, s36, v198
  v_mfma_f32_16x16x32_bf16 v[200:203], a[96:99], a[48:51], v[252:255]
  buffer_load_dwordx4 v230, s[20:23], s37 offen offset:3072 lds
  v_exp_f32 v196, v196
  v_mfma_f32_16x16x32_bf16 v[200:203], a[100:103], a[52:55], v[200:203]
  s_add_u32 s37, s37, 4096
  v_cvt_pk_bf16_f32 v209, v194, v195
  v_mul_f32 v199, s36, v199
  v_mfma_f32_16x16x32_bf16 v[200:203], a[104:107], a[56:59], v[200:203]
  s_mov_b32 m0, 36864
  v_exp_f32 v197, v197
  v_mfma_f32_16x16x32_bf16 v[200:203], a[108:111], a[60:63], v[200:203]
  buffer_load_dwordx4 v229, s[20:23], s37 offen offset:0 lds
  v_exp_f32 v198, v198
  v_mfma_f32_16x16x32_bf16 v[204:207], a[112:115], a[48:51], v[252:255]
  ds_read_b64_tr_b16 a[204:205], v228 offset:57344
  ds_read_b64_tr_b16 a[206:207], v228 offset:61440
  v_mfma_f32_16x16x32_bf16 v[204:207], a[116:119], a[52:55], v[204:207]
  buffer_load_dwordx4 v229, s[20:23], s37 offen offset:1024 lds
  v_exp_f32 v199, v199
  v_mfma_f32_16x16x32_bf16 v[204:207], a[120:123], a[56:59], v[204:207]
  v_cvt_pk_bf16_f32 v210, v196, v197
  v_cvt_pk_bf16_f32 v211, v198, v199
  v_mfma_f32_16x16x32_bf16 v[204:207], a[124:127], a[60:63], v[204:207]
  buffer_load_dwordx4 v230, s[20:23], s37 offen offset:2048 lds
  v_mfma_f32_16x16x32_bf16 v[64:67], v[208:211], a[160:163], v[64:67]
  ds_read_b64_tr_b16 a[208:209], v226 offset:57352
  ds_read_b64_tr_b16 a[210:211], v226 offset:61448
  v_mul_f32 v200, s36, v200
  v_mul_f32 v201, s36, v201
  v_mfma_f32_16x16x32_bf16 v[68:71], v[208:211], a[164:167], v[68:71]
  buffer_load_dwordx4 v230, s[20:23], s37 offen offset:3072 lds
  v_exp_f32 v200, v200
  v_mfma_f32_16x16x32_bf16 v[72:75], v[208:211], a[168:171], v[72:75]
  s_add_u32 s37, s37, 4096
  v_mul_f32 v202, s36, v202
  v_mul_f32 v203, s36, v203
  v_mfma_f32_16x16x32_bf16 v[76:79], v[208:211], a[172:175], v[76:79]
  v_exp_f32 v201, v201
  v_mfma_f32_16x16x32_bf16 v[80:83], v[208:211], a[176:179], v[80:83]
  s_mov_b32 m0, 40960
  ds_read_b64_tr_b16 a[212:213], v237 offset:57352
  ds_read_b64_tr_b16 a[214:215], v237 offset:61448
  v_mfma_f32_16x16x32_bf16 v[84:87], v[208:211], a[180:183], v[84:87]
  buffer_load_dwordx4 v241, s[24:27], s38 offen offset:0 lds
  v_exp_f32 v202, v202
  v_mfma_f32_16x16x32_bf16 v[88:91], v[208:211], a[184:187], v[88:91]
  v_cvt_pk_bf16_f32 v212, v200, v201
  v_mul_f32 v204, s36, v204
  v_mfma_f32_16x16x32_bf16 v[92:95], v[208:211], a[188:191], v[92:95]
  buffer_load_dwordx4 v241, s[24:27], s38 offen offset:1024 lds
  v_exp_f32 v203, v203
  v_mfma_f32_16x16x32_bf16 a[232:235], a[248:251], v[208:211], a[232:235]
  v_mul_f32 v205, s36, v205
  v_mul_f32 v206, s36, v206
  v_mfma_f32_16x16x32_bf16 v[192:195], a[96:99], a[64:67], v[252:255]
  buffer_load_dwordx4 v241, s[24:27], s38 offen offset:2048 lds
  v_exp_f32 v204, v204
  v_mfma_f32_16x16x32_bf16 v[192:195], a[100:103], a[68:71], v[192:195]
  v_cvt_pk_bf16_f32 v213, v202, v203
  v_mul_f32 v207, s36, v207
  v_mfma_f32_16x16x32_bf16 v[192:195], a[104:107], a[72:75], v[192:195]
  buffer_load_dwordx4 v241, s[24:27], s38 offen offset:3072 lds
  v_exp_f32 v205, v205
  v_mfma_f32_16x16x32_bf16 v[192:195], a[108:111], a[76:79], v[192:195]
  s_add_u32 s38, s38, 4096
  v_exp_f32 v206, v206
  v_mfma_f32_16x16x32_bf16 v[196:199], a[112:115], a[64:67], v[252:255]
  s_mov_b32 m0, 45056
  ds_read_b64_tr_b16 a[216:217], v234 offset:57352
  ds_read_b64_tr_b16 a[218:219], v234 offset:61448
  v_mfma_f32_16x16x32_bf16 v[196:199], a[116:119], a[68:71], v[196:199]
  buffer_load_dwordx4 v241, s[24:27], s38 offen offset:0 lds
  v_exp_f32 v207, v207
  v_mfma_f32_16x16x32_bf16 v[196:199], a[120:123], a[72:75], v[196:199]
  v_cvt_pk_bf16_f32 v214, v204, v205
  v_cvt_pk_bf16_f32 v215, v206, v207
  v_mfma_f32_16x16x32_bf16 v[196:199], a[124:127], a[76:79], v[196:199]
  s_waitcnt vmcnt(39)
  ds_add_u32 v245, v243
  v_mfma_f32_16x16x32_bf16 v[96:99], v[212:215], a[160:163], v[96:99]
  buffer_load_dwordx4 v241, s[24:27], s38 offen offset:1024 lds
  v_mul_f32 v192, s36, v192
  v_mul_f32 v193, s36, v193
  v_mfma_f32_16x16x32_bf16 v[100:103], v[212:215], a[164:167], v[100:103]
  v_exp_f32 v192, v192
  v_mfma_f32_16x16x32_bf16 v[104:107], v[212:215], a[168:171], v[104:107]
  buffer_load_dwordx4 v241, s[24:27], s38 offen offset:2048 lds
  v_mul_f32 v194, s36, v194
  v_mul_f32 v195, s36, v195
  v_mfma_f32_16x16x32_bf16 v[108:111], v[212:215], a[172:175], v[108:111]
  v_exp_f32 v193, v193
  v_mfma_f32_16x16x32_bf16 v[112:115], v[212:215], a[176:179], v[112:115]
  ds_read_b64_tr_b16 a[220:221], v228 offset:57352
  ds_read_b64_tr_b16 a[222:223], v228 offset:61448
  v_mfma_f32_16x16x32_bf16 v[116:119], v[212:215], a[180:183], v[116:119]
  v_exp_f32 v194, v194
  v_mfma_f32_16x16x32_bf16 v[120:123], v[212:215], a[184:187], v[120:123]
  s_waitcnt lgkmcnt(15)
  buffer_load_dwordx4 v241, s[24:27], s38 offen offset:3072 lds
  v_cvt_pk_bf16_f32 v208, v192, v193
  v_mul_f32 v196, s36, v196
  v_mfma_f32_16x16x32_bf16 v[124:127], v[212:215], a[188:191], v[124:127]
  s_add_u32 s38, s38, 4096
  v_exp_f32 v195, v195
  v_mfma_f32_16x16x32_bf16 a[236:239], a[248:251], v[212:215], a[236:239]
  global_load_dword v236, v[246:247], off
  v_mul_f32 v197, s36, v197
  v_mul_f32 v198, s36, v198
  v_mfma_f32_16x16x32_bf16 v[200:203], a[128:131], a[0:3], v[252:255]
  v_exp_f32 v196, v196
  v_mfma_f32_16x16x32_bf16 v[200:203], a[132:135], a[4:7], v[200:203]
  v_cvt_pk_bf16_f32 v209, v194, v195
  v_mul_f32 v199, s36, v199
  v_mfma_f32_16x16x32_bf16 v[200:203], a[136:139], a[8:11], v[200:203]
  v_exp_f32 v197, v197
  v_mfma_f32_16x16x32_bf16 v[200:203], a[140:143], a[12:15], v[200:203]
  v_exp_f32 v198, v198
  v_mfma_f32_16x16x32_bf16 v[204:207], a[144:147], a[0:3], v[252:255]
  ds_read_b128 a[96:99], v224 offset:0
  ds_read_b128 a[100:103], v224 offset:256
  v_mfma_f32_16x16x32_bf16 v[204:207], a[148:151], a[4:7], v[204:207]
  v_exp_f32 v199, v199
  v_mfma_f32_16x16x32_bf16 v[204:207], a[152:155], a[8:11], v[204:207]
  v_cvt_pk_bf16_f32 v210, v196, v197
  v_cvt_pk_bf16_f32 v211, v198, v199
  v_mfma_f32_16x16x32_bf16 v[204:207], a[156:159], a[12:15], v[204:207]
  ds_read_b64_tr_b16 v[216:217], v231 offset:2048
  ds_read_b64_tr_b16 v[218:219], v231 offset:2056
  ds_read_b64_tr_b16 v[220:221], v231 offset:3072
  ds_read_b64_tr_b16 v[222:223], v231 offset:3080
  ds_read_b32 v244, v242
  v_mfma_f32_16x16x32_bf16 v[128:131], v[208:211], a[160:163], v[128:131]
  v_mul_f32 v200, s36, v200
  v_mul_f32 v201, s36, v201
  v_mfma_f32_16x16x32_bf16 v[132:135], v[208:211], a[164:167], v[132:135]
  v_exp_f32 v200, v200
  v_mfma_f32_16x16x32_bf16 v[136:139], v[208:211], a[168:171], v[136:139]
  v_mul_f32 v202, s36, v202
  v_mul_f32 v203, s36, v203
  v_mfma_f32_16x16x32_bf16 v[140:143], v[208:211], a[172:175], v[140:143]
  v_exp_f32 v201, v201
  v_mfma_f32_16x16x32_bf16 v[144:147], v[208:211], a[176:179], v[144:147]
  ds_read_b128 a[104:107], v224 offset:512
  ds_read_b128 a[108:111], v224 offset:768
  v_mfma_f32_16x16x32_bf16 v[148:151], v[208:211], a[180:183], v[148:151]
  s_waitcnt lgkmcnt(2)
  v_exp_f32 v202, v202
  v_cmp_gt_u32 vcc, s58, v244
  v_mfma_f32_16x16x32_bf16 v[152:155], v[208:211], a[184:187], v[152:155]
  v_cvt_pk_bf16_f32 v212, v200, v201
  v_mul_f32 v204, s36, v204
  v_mfma_f32_16x16x32_bf16 v[156:159], v[208:211], a[188:191], v[156:159]
  s_cbranch_vccnz L_s5_B3
L_r5_B3:
  v_exp_f32 v203, v203
  v_mfma_f32_16x16x32_bf16 a[240:243], a[248:251], v[208:211], a[240:243]
  s_add_u32 s58, s58, 1
  v_mul_f32 v205, s36, v205
  v_mul_f32 v206, s36, v206
  v_mfma_f32_16x16x32_bf16 v[192:195], a[128:131], a[16:19], v[252:255]
  buffer_store_dwordx4 v[216:219], v232, s[28:31], s42 offen offset:512 nt
  v_exp_f32 v204, v204
  v_mfma_f32_16x16x32_bf16 v[192:195], a[132:135], a[20:23], v[192:195]
  s_waitcnt vmcnt(50)
  v_cvt_pk_bf16_f32 v213, v202, v203
  v_mul_f32 v207, s36, v207
  v_mfma_f32_16x16x32_bf16 v[192:195], a[136:139], a[24:27], v[192:195]
  buffer_store_dwordx4 v[220:223], v232, s[28:31], s42 offen offset:768 nt
  v_exp_f32 v205, v205
  v_mfma_f32_16x16x32_bf16 v[192:195], a[140:143], a[28:31], v[192:195]
  s_add_u32 s42, s42, 4096
  v_exp_f32 v206, v206
  v_mfma_f32_16x16x32_bf16 v[196:199], a[144:147], a[16:19], v[252:255]
  s_mov_b32 m0, s43
  ds_read_b128 a[112:115], v224 offset:4096
  ds_read_b128 a[116:119], v224 offset:4352
  v_mfma_f32_16x16x32_bf16 v[196:199], a[148:151], a[20:23], v[196:199]
  buffer_load_dwordx4 v230, s[16:19], s41 offen offset:0 nt lds
  v_exp_f32 v207, v207
  v_mfma_f32_16x16x32_bf16 v[196:199], a[152:155], a[24:27], v[196:199]
  s_add_u32 s43, s43, 2048
  v_cvt_pk_bf16_f32 v214, v204, v205
  v_cvt_pk_bf16_f32 v215, v206, v207
  v_mfma_f32_16x16x32_bf16 v[196:199], a[156:159], a[28:31], v[196:199]
  buffer_load_dwordx4 v230, s[16:19], s41 offen offset:1024 nt lds
  v_mfma_f32_16x16x32_bf16 v[0:3], v[212:215], a[192:195], v[0:3]
  s_add_u32 s41, s41, 24576
  v_mul_f32 v192, s36, v192
  v_mul_f32 v193, s36, v193
  v_mfma_f32_16x16x32_bf16 v[4:7], v[212:215], a[196:199], v[4:7]
  s_add_u32 m0, m0, 24576
  v_exp_f32 v192, v192
  v_mfma_f32_16x16x32_bf16 v[8:11], v[212:215], a[200:203], v[8:11]
  buffer_load_dwordx4 v230, s[16:19], s41 offen offset:0 nt lds
  v_mul_f32 v194, s36, v194
  v_mul_f32 v195, s36, v195
  v_mfma_f32_16x16x32_bf16 v[12:15], v[212:215], a[204:207], v[12:15]
  v_exp_f32 v193, v193
  v_mfma_f32_16x16x32_bf16 v[16:19], v[212:215], a[208:211], v[16:19]
  ds_read_b128 a[120:123], v224 offset:4608
  ds_read_b128 a[124:127], v224 offset:4864
  v_mfma_f32_16x16x32_bf16 v[20:23], v[212:215], a[212:215], v[20:23]
  buffer_load_dwordx4 v230, s[16:19], s41 offen offset:1024 nt lds
  v_exp_f32 v194, v194
  v_mfma_f32_16x16x32_bf16 v[24:27], v[212:215], a[216:219], v[24:27]
  s_add_u32 s41, s41, 24576
  v_cvt_pk_bf16_f32 v208, v192, v193
  v_mul_f32 v196, s36, v196
  v_mfma_f32_16x16x32_bf16 v[28:31], v[212:215], a[220:223], v[28:31]
  s_add_u32 m0, m0, 24576
  v_exp_f32 v195, v195
  v_mfma_f32_16x16x32_bf16 a[224:227], a[248:251], v[212:215], a[224:227]
  buffer_load_dwordx4 v230, s[16:19], s41 offen offset:0 nt lds
  v_mul_f32 v197, s36, v197
  v_mul_f32 v198, s36, v198
  v_mfma_f32_16x16x32_bf16 v[200:203], a[128:131], a[32:35], v[252:255]
  s_add_u32 s48, m0, 24576
  v_exp_f32 v196, v196
  v_mfma_f32_16x16x32_bf16 v[200:203], a[132:135], a[36:39], v[200:203]
  buffer_load_dwordx4 v230, s[16:19], s41 offen offset:1024 nt lds
  v_cvt_pk_bf16_f32 v209, v194, v195
  v_mul_f32 v199, s36, v199
  v_mfma_f32_16x16x32_bf16 v[200:203], a[136:139], a[40:43], v[200:203]
  s_add_u32 s41, s41, 24576
  v_exp_f32 v197, v197
  v_mfma_f32_16x16x32_bf16 v[200:203], a[140:143], a[44:47], v[200:203]
  v_exp_f32 v198, v198
  v_mfma_f32_16x16x32_bf16 v[204:207], a[144:147], a[32:35], v[252:255]
  s_min_u32 m0, s48, 159744
  ds_read_b64_tr_b16 a[160:161], v226 offset:8192
  ds_read_b64_tr_b16 a[162:163], v226 offset:12288
  v_mfma_f32_16x16x32_bf16 v[204:207], a[148:151], a[36:39], v[204:207]
  buffer_load_dwordx4 v230, s[16:19], s41 offen offset:0 nt lds
  v_exp_f32 v199, v199
  v_mfma_f32_16x16x32_bf16 v[204:207], a[152:155], a[40:43], v[204:207]
  v_cvt_pk_bf16_f32 v210, v196, v197
  v_cvt_pk_bf16_f32 v211, v198, v199
  v_mfma_f32_16x16x32_bf16 v[204:207], a[156:159], a[44:47], v[204:207]
  buffer_load_dwordx4 v230, s[16:19], s41 offen offset:1024 nt lds
  v_mfma_f32_16x16x32_bf16 v[32:35], v[208:211], a[192:195], v[32:35]
  s_add_u32 s41, s41, 0xfffee800
  ds_read_b64_tr_b16 a[164:165], v237 offset:8192
  ds_read_b64_tr_b16 a[166:167], v237 offset:12288
  v_mul_f32 v200, s36, v200
  v_mul_f32 v201, s36, v201
  v_mfma_f32_16x16x32_bf16 v[36:39], v[208:211], a[196:199], v[36:39]
  s_mov_b32 m0, 49152
  v_exp_f32 v200, v200
  v_mfma_f32_16x16x32_bf16 v[40:43], v[208:211], a[200:203], v[40:43]
  buffer_load_dwordx4 v229, s[20:23], s37 offen offset:0 lds
  v_mul_f32 v202, s36, v202
  v_mul_f32 v203, s36, v203
  v_mfma_f32_16x16x32_bf16 v[44:47], v[208:211], a[204:207], v[44:47]
  v_exp_f32 v201, v201
  v_mfma_f32_16x16x32_bf16 v[48:51], v[208:211], a[208:211], v[48:51]
  ds_read_b64_tr_b16 a[168:169], v234 offset:8192
  ds_read_b64_tr_b16 a[170:171], v234 offset:12288
  v_mfma_f32_16x16x32_bf16 v[52:55], v[208:211], a[212:215], v[52:55]
  buffer_load_dwordx4 v229, s[20:23], s37 offen offset:1024 lds
  v_exp_f32 v202, v202
  v_mfma_f32_16x16x32_bf16 v[56:59], v[208:211], a[216:219], v[56:59]
  v_cvt_pk_bf16_f32 v212, v200, v201
  v_mul_f32 v204, s36, v204
  v_mfma_f32_16x16x32_bf16 v[60:63], v[208:211], a[220:223], v[60:63]
  buffer_load_dwordx4 v230, s[20:23], s37 offen offset:2048 lds
  v_exp_f32 v203, v203
  v_mfma_f32_16x16x32_bf16 a[228:231], a[248:251], v[208:211], a[228:231]
  s_waitcnt vmcnt(50)
  v_mul_f32 v205, s36, v205
  v_mul_f32 v206, s36, v206
  v_mfma_f32_16x16x32_bf16 v[192:195], a[128:131], a[48:51], v[252:255]
  buffer_load_dwordx4 v230, s[20:23], s37 offen offset:3072 lds
  v_exp_f32 v204, v204
  v_mfma_f32_16x16x32_bf16 v[192:195], a[132:135], a[52:55], v[192:195]
  s_add_u32 s37, s37, 4096
  v_cvt_pk_bf16_f32 v213, v202, v203
  v_mul_f32 v207, s36, v207
  v_mfma_f32_16x16x32_bf16 v[192:195], a[136:139], a[56:59], v[192:195]
  s_mov_b32 m0, 53248
  v_exp_f32 v205, v205
  v_mfma_f32_16x16x32_bf16 v[192:195], a[140:143], a[60:63], v[192:195]
  buffer_load_dwordx4 v229, s[20:23], s37 offen offset:0 lds
  v_exp_f32 v206, v206
  v_mfma_f32_16x16x32_bf16 v[196:199], a[144:147], a[48:51], v[252:255]
  ds_read_b64_tr_b16 a[172:173], v228 offset:8192
  ds_read_b64_tr_b16 a[174:175], v228 offset:12288
  v_mfma_f32_16x16x32_bf16 v[196:199], a[148:151], a[52:55], v[196:199]
  buffer_load_dwordx4 v229, s[20:23], s37 offen offset:1024 lds
  v_exp_f32 v207, v207
  v_mfma_f32_16x16x32_bf16 v[196:199], a[152:155], a[56:59], v[196:199]
  v_cvt_pk_bf16_f32 v214, v204, v205
  v_cvt_pk_bf16_f32 v215, v206, v207
  v_mfma_f32_16x16x32_bf16 v[196:199], a[156:159], a[60:63], v[196:199]
  buffer_load_dwordx4 v230, s[20:23], s37 offen offset:2048 lds
  v_mfma_f32_16x16x32_bf16 v[64:67], v[212:215], a[192:195], v[64:67]
  ds_read_b64_tr_b16 a[176:177], v226 offset:8200
  ds_read_b64_tr_b16 a[178:179], v226 offset:12296
  v_mul_f32 v192, s36, v192
  v_mul_f32 v193, s36, v193
  v_mfma_f32_16x16x32_bf16 v[68:71], v[212:215], a[196:199], v[68:71]
  buffer_load_dwordx4 v230, s[20:23], s37 offen offset:3072 lds
  v_exp_f32 v192, v192
  v_mfma_f32_16x16x32_bf16 v[72:75], v[212:215], a[200:203], v[72:75]
  s_add_u32 s37, s37, 4096
  v_mul_f32 v194, s36, v194
  v_mul_f32 v195, s36, v195
  v_mfma_f32_16x16x32_bf16 v[76:79], v[212:215], a[204:207], v[76:79]
  v_exp_f32 v193, v193
  v_mfma_f32_16x16x32_bf16 v[80:83], v[212:215], a[208:211], v[80:83]
  s_mov_b32 m0, 57344
  ds_read_b64_tr_b16 a[180:181], v237 offset:8200
  ds_read_b64_tr_b16 a[182:183], v237 offset:12296
  v_mfma_f32_16x16x32_bf16 v[84:87], v[212:215], a[212:215], v[84:87]
  buffer_load_dwordx4 v241, s[24:27], s38 offen offset:0 lds
  v_exp_f32 v194, v194
  v_mfma_f32_16x16x32_bf16 v[88:91], v[212:215], a[216:219], v[88:91]
  v_cvt_pk_bf16_f32 v208, v192, v193
  v_mul_f32 v196, s36, v196
  v_mfma_f32_16x16x32_bf16 v[92:95], v[212:215], a[220:223], v[92:95]
  buffer_load_dwordx4 v241, s[24:27], s38 offen offset:1024 lds
  v_exp_f32 v195, v195
  v_mfma_f32_16x16x32_bf16 a[232:235], a[248:251], v[212:215], a[232:235]
  v_mul_f32 v197, s36, v197
  v_mul_f32 v198, s36, v198
  v_mfma_f32_16x16x32_bf16 v[200:203], a[128:131], a[64:67], v[252:255]
  buffer_load_dwordx4 v241, s[24:27], s38 offen offset:2048 lds
  v_exp_f32 v196, v196
  v_mfma_f32_16x16x32_bf16 v[200:203], a[132:135], a[68:71], v[200:203]
  v_cvt_pk_bf16_f32 v209, v194, v195
  v_mul_f32 v199, s36, v199
  v_mfma_f32_16x16x32_bf16 v[200:203], a[136:139], a[72:75], v[200:203]
  buffer_load_dwordx4 v241, s[24:27], s38 offen offset:3072 lds
  v_exp_f32 v197, v197
  v_mfma_f32_16x16x32_bf16 v[200:203], a[140:143], a[76:79], v[200:203]
  s_add_u32 s38, s38, 4096
  v_exp_f32 v198, v198
  v_mfma_f32_16x16x32_bf16 v[204:207], a[144:147], a[64:67], v[252:255]
  s_mov_b32 m0, 61440
  ds_read_b64_tr_b16 a[184:185], v234 offset:8200
  ds_read_b64_tr_b16 a[186:187], v234 offset:12296
  v_mfma_f32_16x16x32_bf16 v[204:207], a[148:151], a[68:71], v[204:207]
  buffer_load_dwordx4 v241, s[24:27], s38 offen offset:0 lds
  v_exp_f32 v199, v199
  v_mfma_f32_16x16x32_bf16 v[204:207], a[152:155], a[72:75], v[204:207]
  v_cvt_pk_bf16_f32 v210, v196, v197
  v_cvt_pk_bf16_f32 v211, v198, v199
  v_mfma_f32_16x16x32_bf16 v[204:207], a[156:159], a[76:79], v[204:207]
  s_waitcnt vmcnt(50)
  ds_add_u32 v245, v243
  v_mfma_f32_16x16x32_bf16 v[96:99], v[208:211], a[192:195], v[96:99]
  buffer_load_dwordx4 v241, s[24:27], s38 offen offset:1024 lds
  v_mul_f32 v200, s36, v200
  v_mul_f32 v201, s36, v201
  v_mfma_f32_16x16x32_bf16 v[100:103], v[208:211], a[196:199], v[100:103]
  v_exp_f32 v200, v200
  v_mfma_f32_16x16x32_bf16 v[104:107], v[208:211], a[200:203], v[104:107]
  buffer_load_dwordx4 v241, s[24:27], s38 offen offset:2048 lds
  v_mul_f32 v202, s36, v202
  v_mul_f32 v203, s36, v203
  v_mfma_f32_16x16x32_bf16 v[108:111], v[208:211], a[204:207], v[108:111]
  v_exp_f32 v201, v201
  v_mfma_f32_16x16x32_bf16 v[112:115], v[208:211], a[208:211], v[112:115]
  ds_read_b64_tr_b16 a[188:189], v228 offset:8200
  ds_read_b64_tr_b16 a[190:191], v228 offset:12296
  v_mfma_f32_16x16x32_bf16 v[116:119], v[208:211], a[212:215], v[116:119]
  v_exp_f32 v202, v202
  v_mfma_f32_16x16x32_bf16 v[120:123], v[208:211], a[216:219], v[120:123]
  s_waitcnt lgkmcnt(15)
  buffer_load_dwordx4 v241, s[24:27], s38 offen offset:3072 lds
  v_cvt_pk_bf16_f32 v212, v200, v201
  v_mul_f32 v204, s36, v204
  v_mfma_f32_16x16x32_bf16 v[124:127], v[208:211], a[220:223], v[124:127]
  s_add_u32 s38, s38, 4096
  v_exp_f32 v203, v203
  v_mfma_f32_16x16x32_bf16 a[236:239], a[248:251], v[208:211], a[236:239]
  v_mul_f32 v205, s36, v205
  v_mul_f32 v206, s36, v206
  v_mfma_f32_16x16x32_bf16 v[192:195], a[96:99], a[0:3], v[252:255]
  v_exp_f32 v204, v204
  v_mfma_f32_16x16x32_bf16 v[192:195], a[100:103], a[4:7], v[192:195]
  v_cvt_pk_bf16_f32 v213, v202, v203
  v_mul_f32 v207, s36, v207
  v_mfma_f32_16x16x32_bf16 v[192:195], a[104:107], a[8:11], v[192:195]
  v_exp_f32 v205, v205
  v_mfma_f32_16x16x32_bf16 v[192:195], a[108:111], a[12:15], v[192:195]
  v_exp_f32 v206, v206
  v_mfma_f32_16x16x32_bf16 v[196:199], a[112:115], a[0:3], v[252:255]
  ds_read_b128 a[128:131], v224 offset:16384
  ds_read_b128 a[132:135], v224 offset:16640
  v_mfma_f32_16x16x32_bf16 v[196:199], a[116:119], a[4:7], v[196:199]
  v_exp_f32 v207, v207
  v_mfma_f32_16x16x32_bf16 v[196:199], a[120:123], a[8:11], v[196:199]
  v_cvt_pk_bf16_f32 v214, v204, v205
  v_cvt_pk_bf16_f32 v215, v206, v207
  v_mfma_f32_16x16x32_bf16 v[196:199], a[124:127], a[12:15], v[196:199]
  ds_read_b64_tr_b16 v[216:217], v231 offset:4096
  ds_read_b64_tr_b16 v[218:219], v231 offset:4104
  ds_read_b64_tr_b16 v[220:221], v231 offset:5120
  ds_read_b64_tr_b16 v[222:223], v231 offset:5128
  ds_read_b32 v244, v242
  v_mfma_f32_16x16x32_bf16 v[128:131], v[212:215], a[192:195], v[128:131]
  v_mul_f32 v192, s36, v192
  v_mul_f32 v193, s36, v193
  v_mfma_f32_16x16x32_bf16 v[132:135], v[212:215], a[196:199], v[132:135]
  v_exp_f32 v192, v192
  v_mfma_f32_16x16x32_bf16 v[136:139], v[212:215], a[200:203], v[136:139]
  v_mul_f32 v194, s36, v194
  v_mul_f32 v195, s36, v195
  v_mfma_f32_16x16x32_bf16 v[140:143], v[212:215], a[204:207], v[140:143]
  v_exp_f32 v193, v193
  v_mfma_f32_16x16x32_bf16 v[144:147], v[212:215], a[208:211], v[144:147]
  ds_read_b128 a[136:139], v224 offset:16896
  ds_read_b128 a[140:143], v224 offset:17152
  v_mfma_f32_16x16x32_bf16 v[148:151], v[212:215], a[212:215], v[148:151]
  s_waitcnt lgkmcnt(2)
  v_exp_f32 v194, v194
  v_cmp_gt_u32 vcc, s58, v244
  v_mfma_f32_16x16x32_bf16 v[152:155], v[212:215], a[216:219], v[152:155]
  v_cvt_pk_bf16_f32 v208, v192, v193
  v_mul_f32 v196, s36, v196
  v_mfma_f32_16x16x32_bf16 v[156:159], v[212:215], a[220:223], v[156:159]
  s_cbranch_vccnz L_s5_B4
L_r5_B4:
  v_exp_f32 v195, v195
  v_mfma_f32_16x16x32_bf16 a[240:243], a[248:251], v[212:215], a[240:243]
  s_add_u32 s58, s58, 1
  v_mul_f32 v197, s36, v197
  v_mul_f32 v198, s36, v198
  v_mfma_f32_16x16x32_bf16 v[200:203], a[96:99], a[16:19], v[252:255]
  buffer_store_dwordx4 v[216:219], v232, s[28:31], s42 offen offset:0 nt
  v_exp_f32 v196, v196
  v_mfma_f32_16x16x32_bf16 v[200:203], a[100:103], a[20:23], v[200:203]
  s_waitcnt vmcnt(50)
  v_cvt_pk_bf16_f32 v209, v194, v195
  v_mul_f32 v199, s36, v199
  v_mfma_f32_16x16x32_bf16 v[200:203], a[104:107], a[24:27], v[200:203]
  buffer_store_dwordx4 v[220:223], v232, s[28:31], s42 offen offset:256 nt
  v_exp_f32 v197, v197
  v_mfma_f32_16x16x32_bf16 v[200:203], a[108:111], a[28:31], v[200:203]
  v_exp_f32 v198, v198
  v_mfma_f32_16x16x32_bf16 v[204:207], a[112:115], a[16:19], v[252:255]
  s_mov_b32 m0, s43
  ds_read_b128 a[144:147], v224 offset:20480
  ds_read_b128 a[148:151], v224 offset:20736
  v_mfma_f32_16x16x32_bf16 v[204:207], a[116:119], a[20:23], v[204:207]
  buffer_load_dwordx4 v229, s[16:19], s41 offen offset:0 nt lds
  v_exp_f32 v199, v199
  v_mfma_f32_16x16x32_bf16 v[204:207], a[120:123], a[24:27], v[204:207]
  s_add_u32 s43, s43, 2048
  v_cvt_pk_bf16_f32 v210, v196, v197
  v_cvt_pk_bf16_f32 v211, v198, v199
  v_mfma_f32_16x16x32_bf16 v[204:207], a[124:127], a[28:31], v[204:207]
  buffer_load_dwordx4 v229, s[16:19], s41 offen offset:1024 nt lds
  v_mfma_f32_16x16x32_bf16 v[0:3], v[208:211], a[160:163], v[0:3]
  s_add_u32 s41, s41, 24576
  v_mul_f32 v200, s36, v200
  v_mul_f32 v201, s36, v201
  v_mfma_f32_16x16x32_bf16 v[4:7], v[208:211], a[164:167], v[4:7]
  s_add_u32 m0, m0, 24576
  v_exp_f32 v200, v200
  v_mfma_f32_16x16x32_bf16 v[8:11], v[208:211], a[168:171], v[8:11]
  buffer_load_dwordx4 v229, s[16:19], s41 offen offset:0 nt lds
  v_mul_f32 v202, s36, v202
  v_mul_f32 v203, s36, v203
  v_mfma_f32_16x16x32_bf16 v[12:15], v[208:211], a[172:175], v[12:15]
  v_exp_f32 v201, v201
  v_mfma_f32_16x16x32_bf16 v[16:19], v[208:211], a[176:179], v[16:19]
  ds_read_b128 a[152:155], v224 offset:20992
  ds_read_b128 a[156:159], v224 offset:21248
  v_mfma_f32_16x16x32_bf16 v[20:23], v[208:211], a[180:183], v[20:23]
  buffer_load_dwordx4 v229, s[16:19], s41 offen offset:1024 nt lds
  v_exp_f32 v202, v202
  v_mfma_f32_16x16x32_bf16 v[24:27], v[208:211], a[184:187], v[24:27]
  s_add_u32 s41, s41, 24576
  v_cvt_pk_bf16_f32 v212, v200, v201
  v_mul_f32 v204, s36, v204
  v_mfma_f32_16x16x32_bf16 v[28:31], v[208:211], a[188:191], v[28:31]
  s_add_u32 m0, m0, 24576
  v_exp_f32 v203, v203
  v_mfma_f32_16x16x32_bf16 a[224:227], a[248:251], v[208:211], a[224:227]
  buffer_load_dwordx4 v229, s[16:19], s41 offen offset:0 nt lds
  v_mul_f32 v205, s36, v205
  v_mul_f32 v206, s36, v206
  v_mfma_f32_16x16x32_bf16 v[192:195], a[96:99], a[32:35], v[252:255]
  s_add_u32 s48, m0, 24576
  v_exp_f32 v204, v204
  v_mfma_f32_16x16x32_bf16 v[192:195], a[100:103], a[36:39], v[192:195]
  buffer_load_dwordx4 v229, s[16:19], s41 offen offset:1024 nt lds
  v_cvt_pk_bf16_f32 v213, v202, v203
  v_mul_f32 v207, s36, v207
  v_mfma_f32_16x16x32_bf16 v[192:195], a[104:107], a[40:43], v[192:195]
  s_add_u32 s41, s41, 24576
  v_exp_f32 v205, v205
  v_mfma_f32_16x16x32_bf16 v[192:195], a[108:111], a[44:47], v[192:195]
  v_exp_f32 v206, v206
  v_mfma_f32_16x16x32_bf16 v[196:199], a[112:115], a[32:35], v[252:255]
  s_min_u32 m0, s48, 159744
  ds_read_b64_tr_b16 a[192:193], v226 offset:24576
  ds_read_b64_tr_b16 a[194:195], v226 offset:28672
  v_mfma_f32_16x16x32_bf16 v[196:199], a[116:119], a[36:39], v[196:199]
  buffer_load_dwordx4 v229, s[16:19], s41 offen offset:0 nt lds
  v_exp_f32 v207, v207
  v_mfma_f32_16x16x32_bf16 v[196:199], a[120:123], a[40:43], v[196:199]
  v_cvt_pk_bf16_f32 v214, v204, v205
  v_cvt_pk_bf16_f32 v215, v206, v207
  v_mfma_f32_16x16x32_bf16 v[196:199], a[124:127], a[44:47], v[196:199]
  buffer_load_dwordx4 v229, s[16:19], s41 offen offset:1024 nt lds
  v_mfma_f32_16x16x32_bf16 v[32:35], v[212:215], a[160:163], v[32:35]
  s_add_u32 s41, s41, 0xfffee800
  ds_read_b64_tr_b16 a[196:197], v237 offset:24576
  ds_read_b64_tr_b16 a[198:199], v237 offset:28672
  v_mul_f32 v192, s36, v192
  v_mul_f32 v193, s36, v193
  v_mfma_f32_16x16x32_bf16 v[36:39], v[212:215], a[164:167], v[36:39]
  s_mov_b32 m0, 0
  v_exp_f32 v192, v192
  v_mfma_f32_16x16x32_bf16 v[40:43], v[212:215], a[168:171], v[40:43]
  buffer_load_dwordx4 v229, s[20:23], s37 offen offset:0 lds
  v_mul_f32 v194, s36, v194
  v_mul_f32 v195, s36, v195
  v_mfma_f32_16x16x32_bf16 v[44:47], v[212:215], a[172:175], v[44:47]
  v_exp_f32 v193, v193
  v_mfma_f32_16x16x32_bf16 v[48:51], v[212:215], a[176:179], v[48:51]
  ds_read_b64_tr_b16 a[200:201], v234 offset:24576
  ds_read_b64_tr_b16 a[202:203], v234 offset:28672
  v_mfma_f32_16x16x32_bf16 v[52:55], v[212:215], a[180:183], v[52:55]
  buffer_load_dwordx4 v229, s[20:23], s37 offen offset:1024 lds
  v_exp_f32 v194, v194
  v_mfma_f32_16x16x32_bf16 v[56:59], v[212:215], a[184:187], v[56:59]
  v_cvt_pk_bf16_f32 v208, v192, v193
  v_mul_f32 v196, s36, v196
  v_mfma_f32_16x16x32_bf16 v[60:63], v[212:215], a[188:191], v[60:63]
  buffer_load_dwordx4 v230, s[20:23], s37 offen offset:2048 lds
  v_exp_f32 v195, v195
  v_mfma_f32_16x16x32_bf16 a[228:231], a[248:251], v[212:215], a[228:231]
  s_waitcnt vmcnt(50)
  v_mul_f32 v197, s36, v197
  v_mul_f32 v198, s36, v198
  v_mfma_f32_16x16x32_bf16 v[200:203], a[96:99], a[48:51], v[252:255]
  buffer_load_dwordx4 v230, s[20:23], s37 offen offset:3072 lds
  v_exp_f32 v196, v196
  v_mfma_f32_16x16x32_bf16 v[200:203], a[100:103], a[52:55], v[200:203]
  s_add_u32 s37, s37, 4096
  v_cvt_pk_bf16_f32 v209, v194, v195
  v_mul_f32 v199, s36, v199
  v_mfma_f32_16x16x32_bf16 v[200:203], a[104:107], a[56:59], v[200:203]
  s_mov_b32 m0, 4096
  v_exp_f32 v197, v197
  v_mfma_f32_16x16x32_bf16 v[200:203], a[108:111], a[60:63], v[200:203]
  buffer_load_dwordx4 v229, s[20:23], s37 offen offset:0 lds
  v_exp_f32 v198, v198
  v_mfma_f32_16x16x32_bf16 v[204:207], a[112:115], a[48:51], v[252:255]
  ds_read_b64_tr_b16 a[204:205], v228 offset:24576
  ds_read_b64_tr_b16 a[206:207], v228 offset:28672
  v_mfma_f32_16x16x32_bf16 v[204:207], a[116:119], a[52:55], v[204:207]
  buffer_load_dwordx4 v229, s[20:23], s37 offen offset:1024 lds
  v_exp_f32 v199, v199
  v_mfma_f32_16x16x32_bf16 v[204:207], a[120:123], a[56:59], v[204:207]
  v_cvt_pk_bf16_f32 v210, v196, v197
  v_cvt_pk_bf16_f32 v211, v198, v199
  v_mfma_f32_16x16x32_bf16 v[204:207], a[124:127], a[60:63], v[204:207]
  buffer_load_dwordx4 v230, s[20:23], s37 offen offset:2048 lds
  v_mfma_f32_16x16x32_bf16 v[64:67], v[208:211], a[160:163], v[64:67]
  ds_read_b64_tr_b16 a[208:209], v226 offset:24584
  ds_read_b64_tr_b16 a[210:211], v226 offset:28680
  v_mul_f32 v200, s36, v200
  v_mul_f32 v201, s36, v201
  v_mfma_f32_16x16x32_bf16 v[68:71], v[208:211], a[164:167], v[68:71]
  buffer_load_dwordx4 v230, s[20:23], s37 offen offset:3072 lds
  v_exp_f32 v200, v200
  v_mfma_f32_16x16x32_bf16 v[72:75], v[208:211], a[168:171], v[72:75]
  s_add_u32 s37, s37, 4096
  v_mul_f32 v202, s36, v202
  v_mul_f32 v203, s36, v203
  v_mfma_f32_16x16x32_bf16 v[76:79], v[208:211], a[172:175], v[76:79]
  v_exp_f32 v201, v201
  v_mfma_f32_16x16x32_bf16 v[80:83], v[208:211], a[176:179], v[80:83]
  s_mov_b32 m0, 8192
  ds_read_b64_tr_b16 a[212:213], v237 offset:24584
  ds_read_b64_tr_b16 a[214:215], v237 offset:28680
  v_mfma_f32_16x16x32_bf16 v[84:87], v[208:211], a[180:183], v[84:87]
  buffer_load_dwordx4 v241, s[24:27], s38 offen offset:0 lds
  v_exp_f32 v202, v202
  v_mfma_f32_16x16x32_bf16 v[88:91], v[208:211], a[184:187], v[88:91]
  v_cvt_pk_bf16_f32 v212, v200, v201
  v_mul_f32 v204, s36, v204
  v_mfma_f32_16x16x32_bf16 v[92:95], v[208:211], a[188:191], v[92:95]
  buffer_load_dwordx4 v241, s[24:27], s38 offen offset:1024 lds
  v_exp_f32 v203, v203
  v_mfma_f32_16x16x32_bf16 a[232:235], a[248:251], v[208:211], a[232:235]
  v_mul_f32 v205, s36, v205
  v_mul_f32 v206, s36, v206
  v_mfma_f32_16x16x32_bf16 v[192:195], a[96:99], a[64:67], v[252:255]
  buffer_load_dwordx4 v241, s[24:27], s38 offen offset:2048 lds
  v_exp_f32 v204, v204
  v_mfma_f32_16x16x32_bf16 v[192:195], a[100:103], a[68:71], v[192:195]
  v_cvt_pk_bf16_f32 v213, v202, v203
  v_mul_f32 v207, s36, v207
  v_mfma_f32_16x16x32_bf16 v[192:195], a[104:107], a[72:75], v[192:195]
  buffer_load_dwordx4 v241, s[24:27], s38 offen offset:3072 lds
  v_exp_f32 v205, v205
  v_mfma_f32_16x16x32_bf16 v[192:195], a[108:111], a[76:79], v[192:195]
  s_add_u32 s38, s38, 4096
  v_exp_f32 v206, v206
  v_mfma_f32_16x16x32_bf16 v[196:199], a[112:115], a[64:67], v[252:255]
  s_mov_b32 m0, 12288
  ds_read_b64_tr_b16 a[216:217], v234 offset:24584
  ds_read_b64_tr_b16 a[218:219], v234 offset:28680
  v_mfma_f32_16x16x32_bf16 v[196:199], a[116:119], a[68:71], v[196:199]
  buffer_load_dwordx4 v241, s[24:27], s38 offen offset:0 lds
  v_exp_f32 v207, v207
  v_mfma_f32_16x16x32_bf16 v[196:199], a[120:123], a[72:75], v[196:199]
  v_cvt_pk_bf16_f32 v214, v204, v205
  v_cvt_pk_bf16_f32 v215, v206, v207
  v_mfma_f32_16x16x32_bf16 v[196:199], a[124:127], a[76:79], v[196:199]
  s_waitcnt vmcnt(50)
  ds_add_u32 v245, v243
  v_mfma_f32_16x16x32_bf16 v[96:99], v[212:215], a[160:163], v[96:99]
  buffer_load_dwordx4 v241, s[24:27], s38 offen offset:1024 lds
  v_mul_f32 v192, s36, v192
  v_mul_f32 v193, s36, v193
  v_mfma_f32_16x16x32_bf16 v[100:103], v[212:215], a[164:167], v[100:103]
  v_exp_f32 v192, v192
  v_mfma_f32_16x16x32_bf16 v[104:107], v[212:215], a[168:171], v[104:107]
  buffer_load_dwordx4 v241, s[24:27], s38 offen offset:2048 lds
  v_mul_f32 v194, s36, v194
  v_mul_f32 v195, s36, v195
  v_mfma_f32_16x16x32_bf16 v[108:111], v[212:215], a[172:175], v[108:111]
  v_exp_f32 v193, v193
  v_mfma_f32_16x16x32_bf16 v[112:115], v[212:215], a[176:179], v[112:115]
  ds_read_b64_tr_b16 a[220:221], v228 offset:24584
  ds_read_b64_tr_b16 a[222:223], v228 offset:28680
  v_mfma_f32_16x16x32_bf16 v[116:119], v[212:215], a[180:183], v[116:119]
  v_exp_f32 v194, v194
  v_mfma_f32_16x16x32_bf16 v[120:123], v[212:215], a[184:187], v[120:123]
  s_waitcnt lgkmcnt(15)
  buffer_load_dwordx4 v241, s[24:27], s38 offen offset:3072 lds
  v_cvt_pk_bf16_f32 v208, v192, v193
  v_mul_f32 v196, s36, v196
  v_mfma_f32_16x16x32_bf16 v[124:127], v[212:215], a[188:191], v[124:127]
  s_add_u32 s38, s38, 4096
  v_exp_f32 v195, v195
  v_mfma_f32_16x16x32_bf16 a[236:239], a[248:251], v[212:215], a[236:239]
  v_mul_f32 v197, s36, v197
  v_mul_f32 v198, s36, v198
  v_mfma_f32_16x16x32_bf16 v[200:203], a[128:131], a[0:3], v[252:255]
  v_exp_f32 v196, v196
  v_mfma_f32_16x16x32_bf16 v[200:203], a[132:135], a[4:7], v[200:203]
  v_cvt_pk_bf16_f32 v209, v194, v195
  v_mul_f32 v199, s36, v199
  v_mfma_f32_16x16x32_bf16 v[200:203], a[136:139], a[8:11], v[200:203]
  v_exp_f32 v197, v197
  v_mfma_f32_16x16x32_bf16 v[200:203], a[140:143], a[12:15], v[200:203]
  v_exp_f32 v198, v198
  v_mfma_f32_16x16x32_bf16 v[204:207], a[144:147], a[0:3], v[252:255]
  ds_read_b128 a[96:99], v224 offset:32768
  ds_read_b128 a[100:103], v224 offset:33024
  v_mfma_f32_16x16x32_bf16 v[204:207], a[148:151], a[4:7], v[204:207]
  v_exp_f32 v199, v199
  v_mfma_f32_16x16x32_bf16 v[204:207], a[152:155], a[8:11], v[204:207]
  v_cvt_pk_bf16_f32 v210, v196, v197
  v_cvt_pk_bf16_f32 v211, v198, v199
  v_mfma_f32_16x16x32_bf16 v[204:207], a[156:159], a[12:15], v[204:207]
  ds_read_b64_tr_b16 v[216:217], v231 offset:6144
  ds_read_b64_tr_b16 v[218:219], v231 offset:6152
  ds_read_b64_tr_b16 v[220:221], v231 offset:7168
  ds_read_b64_tr_b16 v[222:223], v231 offset:7176
  ds_read_b32 v244, v242
  v_mfma_f32_16x16x32_bf16 v[128:131], v[208:211], a[160:163], v[128:131]
  v_mul_f32 v200, s36, v200
  v_mul_f32 v201, s36, v201
  v_mfma_f32_16x16x32_bf16 v[132:135], v[208:211], a[164:167], v[132:135]
  v_exp_f32 v200, v200
  v_mfma_f32_16x16x32_bf16 v[136:139], v[208:211], a[168:171], v[136:139]
  v_mul_f32 v202, s36, v202
  v_mul_f32 v203, s36, v203
  v_mfma_f32_16x16x32_bf16 v[140:143], v[208:211], a[172:175], v[140:143]
  v_exp_f32 v201, v201
  v_mfma_f32_16x16x32_bf16 v[144:147], v[208:211], a[176:179], v[144:147]
  ds_read_b128 a[104:107], v224 offset:33280
  ds_read_b128 a[108:111], v224 offset:33536
  v_mfma_f32_16x16x32_bf16 v[148:151], v[208:211], a[180:183], v[148:151]
  s_waitcnt lgkmcnt(2)
  v_exp_f32 v202, v202
  v_cmp_gt_u32 vcc, s58, v244
  v_mfma_f32_16x16x32_bf16 v[152:155], v[208:211], a[184:187], v[152:155]
  v_cvt_pk_bf16_f32 v212, v200, v201
  v_mul_f32 v204, s36, v204
  v_mfma_f32_16x16x32_bf16 v[156:159], v[208:211], a[188:191], v[156:159]
  s_cbranch_vccnz L_s5_B5
L_r5_B5:
  v_exp_f32 v203, v203
  v_mfma_f32_16x16x32_bf16 a[240:243], a[248:251], v[208:211], a[240:243]
  s_add_u32 s58, s58, 1
  v_mul_f32 v205, s36, v205
  v_mul_f32 v206, s36, v206
  v_mfma_f32_16x16x32_bf16 v[192:195], a[128:131], a[16:19], v[252:255]
  buffer_store_dwordx4 v[216:219], v232, s[28:31], s42 offen offset:512 nt
  v_exp_f32 v204, v204
  v_mfma_f32_16x16x32_bf16 v[192:195], a[132:135], a[20:23], v[192:195]
  s_waitcnt vmcnt(50)
  v_cvt_pk_bf16_f32 v213, v202, v203
  v_mul_f32 v207, s36, v207
  v_mfma_f32_16x16x32_bf16 v[192:195], a[136:139], a[24:27], v[192:195]
  buffer_store_dwordx4 v[220:223], v232, s[28:31], s42 offen offset:768 nt
  v_exp_f32 v205, v205
  v_mfma_f32_16x16x32_bf16 v[192:195], a[140:143], a[28:31], v[192:195]
  s_add_u32 s42, s42, 4096
  v_exp_f32 v206, v206
  v_mfma_f32_16x16x32_bf16 v[196:199], a[144:147], a[16:19], v[252:255]
  s_mov_b32 m0, s43
  ds_read_b128 a[112:115], v224 offset:36864
  ds_read_b128 a[116:119], v224 offset:37120
  v_mfma_f32_16x16x32_bf16 v[196:199], a[148:151], a[20:23], v[196:199]
  buffer_load_dwordx4 v230, s[16:19], s41 offen offset:0 nt lds
  v_exp_f32 v207, v207
  v_mfma_f32_16x16x32_bf16 v[196:199], a[152:155], a[24:27], v[196:199]
  s_add_u32 s43, s43, 2048
  v_cvt_pk_bf16_f32 v214, v204, v205
  v_cvt_pk_bf16_f32 v215, v206, v207
  v_mfma_f32_16x16x32_bf16 v[196:199], a[156:159], a[28:31], v[196:199]
  buffer_load_dwordx4 v230, s[16:19], s41 offen offset:1024 nt lds
  v_mfma_f32_16x16x32_bf16 v[0:3], v[212:215], a[192:195], v[0:3]
  s_add_u32 s41, s41, 24576
  v_mul_f32 v192, s36, v192
  v_mul_f32 v193, s36, v193
  v_mfma_f32_16x16x32_bf16 v[4:7], v[212:215], a[196:199], v[4:7]
  s_add_u32 m0, m0, 24576
  v_exp_f32 v192, v192
  v_mfma_f32_16x16x32_bf16 v[8:11], v[212:215], a[200:203], v[8:11]
  buffer_load_dwordx4 v230, s[16:19], s41 offen offset:0 nt lds
  v_mul_f32 v194, s36, v194
  v_mul_f32 v195, s36, v195
  v_mfma_f32_16x16x32_bf16 v[12:15], v[212:215], a[204:207], v[12:15]
  v_exp_f32 v193, v193
  v_mfma_f32_16x16x32_bf16 v[16:19], v[212:215], a[208:211], v[16:19]
  ds_read_b128 a[120:123], v224 offset:37376
  ds_read_b128 a[124:127], v224 offset:37632
  v_mfma_f32_16x16x32_bf16 v[20:23], v[212:215], a[212:215], v[20:23]
  buffer_load_dwordx4 v230, s[16:19], s41 offen offset:1024 nt lds
  v_exp_f32 v194, v194
  v_mfma_f32_16x16x32_bf16 v[24:27], v[212:215], a[216:219], v[24:27]
  s_add_u32 s41, s41, 24576
  v_cvt_pk_bf16_f32 v208, v192, v193
  v_mul_f32 v196, s36, v196
  v_mfma_f32_16x16x32_bf16 v[28:31], v[212:215], a[220:223], v[28:31]
  s_add_u32 m0, m0, 24576
  v_exp_f32 v195, v195
  v_mfma_f32_16x16x32_bf16 a[224:227], a[248:251], v[212:215], a[224:227]
  buffer_load_dwordx4 v230, s[16:19], s41 offen offset:0 nt lds
  v_mul_f32 v197, s36, v197
  v_mul_f32 v198, s36, v198
  v_mfma_f32_16x16x32_bf16 v[200:203], a[128:131], a[32:35], v[252:255]
  s_add_u32 s48, m0, 24576
  v_exp_f32 v196, v196
  v_mfma_f32_16x16x32_bf16 v[200:203], a[132:135], a[36:39], v[200:203]
  buffer_load_dwordx4 v230, s[16:19], s41 offen offset:1024 nt lds
  v_cvt_pk_bf16_f32 v209, v194, v195
  v_mul_f32 v199, s36, v199
  v_mfma_f32_16x16x32_bf16 v[200:203], a[136:139], a[40:43], v[200:203]
  s_add_u32 s41, s41, 24576
  v_exp_f32 v197, v197
  v_mfma_f32_16x16x32_bf16 v[200:203], a[140:143], a[44:47], v[200:203]
  v_exp_f32 v198, v198
  v_mfma_f32_16x16x32_bf16 v[204:207], a[144:147], a[32:35], v[252:255]
  s_min_u32 m0, s48, 159744
  ds_read_b64_tr_b16 a[160:161], v226 offset:40960
  ds_read_b64_tr_b16 a[162:163], v226 offset:45056
  v_mfma_f32_16x16x32_bf16 v[204:207], a[148:151], a[36:39], v[204:207]
  buffer_load_dwordx4 v230, s[16:19], s41 offen offset:0 nt lds
  v_exp_f32 v199, v199
  v_mfma_f32_16x16x32_bf16 v[204:207], a[152:155], a[40:43], v[204:207]
  v_cvt_pk_bf16_f32 v210, v196, v197
  v_cvt_pk_bf16_f32 v211, v198, v199
  v_mfma_f32_16x16x32_bf16 v[204:207], a[156:159], a[44:47], v[204:207]
  buffer_load_dwordx4 v230, s[16:19], s41 offen offset:1024 nt lds
  v_add_u32 v231, 0x2000, v231
  v_mfma_f32_16x16x32_bf16 v[32:35], v[208:211], a[192:195], v[32:35]
  s_add_u32 s41, s41, 0xfffee800
  ds_read_b64_tr_b16 a[164:165], v237 offset:40960
  ds_read_b64_tr_b16 a[166:167], v237 offset:45056
  v_mul_f32 v200, s36, v200
  v_mul_f32 v201, s36, v201
  v_mfma_f32_16x16x32_bf16 v[36:39], v[208:211], a[196:199], v[36:39]
  s_mov_b32 m0, 16384
  v_exp_f32 v200, v200
  v_mfma_f32_16x16x32_bf16 v[40:43], v[208:211], a[200:203], v[40:43]
  buffer_load_dwordx4 v229, s[20:23], s37 offen offset:0 lds
  v_mul_f32 v202, s36, v202
  v_mul_f32 v203, s36, v203
  v_mfma_f32_16x16x32_bf16 v[44:47], v[208:211], a[204:207], v[44:47]
  v_exp_f32 v201, v201
  v_mfma_f32_16x16x32_bf16 v[48:51], v[208:211], a[208:211], v[48:51]
  ds_read_b64_tr_b16 a[168:169], v234 offset:40960
  ds_read_b64_tr_b16 a[170:171], v234 offset:45056
  v_mfma_f32_16x16x32_bf16 v[52:55], v[208:211], a[212:215], v[52:55]
  buffer_load_dwordx4 v229, s[20:23], s37 offen offset:1024 lds
  v_exp_f32 v202, v202
  v_mfma_f32_16x16x32_bf16 v[56:59], v[208:211], a[216:219], v[56:59]
  v_cvt_pk_bf16_f32 v212, v200, v201
  v_mul_f32 v204, s36, v204
  v_mfma_f32_16x16x32_bf16 v[60:63], v[208:211], a[220:223], v[60:63]
  buffer_load_dwordx4 v230, s[20:23], s37 offen offset:2048 lds
  v_exp_f32 v203, v203
  v_mfma_f32_16x16x32_bf16 a[228:231], a[248:251], v[208:211], a[228:231]
  s_waitcnt vmcnt(50)
  v_mul_f32 v205, s36, v205
  v_mul_f32 v206, s36, v206
  v_mfma_f32_16x16x32_bf16 v[192:195], a[128:131], a[48:51], v[252:255]
  buffer_load_dwordx4 v230, s[20:23], s37 offen offset:3072 lds
  v_exp_f32 v204, v204
  v_mfma_f32_16x16x32_bf16 v[192:195], a[132:135], a[52:55], v[192:195]
  s_add_u32 s37, s37, 4096
  v_cvt_pk_bf16_f32 v213, v202, v203
  v_mul_f32 v207, s36, v207
  v_mfma_f32_16x16x32_bf16 v[192:195], a[136:139], a[56:59], v[192:195]
  s_mov_b32 m0, 20480
  v_exp_f32 v205, v205
  v_mfma_f32_16x16x32_bf16 v[192:195], a[140:143], a[60:63], v[192:195]
  buffer_load_dwordx4 v229, s[20:23], s37 offen offset:0 lds
  v_exp_f32 v206, v206
  v_mfma_f32_16x16x32_bf16 v[196:199], a[144:147], a[48:51], v[252:255]
  ds_read_b64_tr_b16 a[172:173], v228 offset:40960
  ds_read_b64_tr_b16 a[174:175], v228 offset:45056
  v_mfma_f32_16x16x32_bf16 v[196:199], a[148:151], a[52:55], v[196:199]
  buffer_load_dwordx4 v229, s[20:23], s37 offen offset:1024 lds
  v_exp_f32 v207, v207
  v_mfma_f32_16x16x32_bf16 v[196:199], a[152:155], a[56:59], v[196:199]
  v_cvt_pk_bf16_f32 v214, v204, v205
  v_cvt_pk_bf16_f32 v215, v206, v207
  v_mfma_f32_16x16x32_bf16 v[196:199], a[156:159], a[60:63], v[196:199]
  buffer_load_dwordx4 v230, s[20:23], s37 offen offset:2048 lds
  v_mfma_f32_16x16x32_bf16 v[64:67], v[212:215], a[192:195], v[64:67]
  ds_read_b64_tr_b16 a[176:177], v226 offset:40968
  ds_read_b64_tr_b16 a[178:179], v226 offset:45064
  v_mul_f32 v192, s36, v192
  v_mul_f32 v193, s36, v193
  v_mfma_f32_16x16x32_bf16 v[68:71], v[212:215], a[196:199], v[68:71]
  buffer_load_dwordx4 v230, s[20:23], s37 offen offset:3072 lds
  v_exp_f32 v192, v192
  v_mfma_f32_16x16x32_bf16 v[72:75], v[212:215], a[200:203], v[72:75]
  s_add_u32 s37, s37, 4096
  v_mul_f32 v194, s36, v194
  v_mul_f32 v195, s36, v195
  v_mfma_f32_16x16x32_bf16 v[76:79], v[212:215], a[204:207], v[76:79]
  v_exp_f32 v193, v193
  v_mfma_f32_16x16x32_bf16 v[80:83], v[212:215], a[208:211], v[80:83]
  s_mov_b32 m0, 24576
  ds_read_b64_tr_b16 a[180:181], v237 offset:40968
  ds_read_b64_tr_b16 a[182:183], v237 offset:45064
  v_mfma_f32_16x16x32_bf16 v[84:87], v[212:215], a[212:215], v[84:87]
  buffer_load_dwordx4 v241, s[24:27], s38 offen offset:0 lds
  v_exp_f32 v194, v194
  v_mfma_f32_16x16x32_bf16 v[88:91], v[212:215], a[216:219], v[88:91]
  v_cvt_pk_bf16_f32 v208, v192, v193
  v_mul_f32 v196, s36, v196
  v_mfma_f32_16x16x32_bf16 v[92:95], v[212:215], a[220:223], v[92:95]
  buffer_load_dwordx4 v241, s[24:27], s38 offen offset:1024 lds
  v_exp_f32 v195, v195
  v_mfma_f32_16x16x32_bf16 a[232:235], a[248:251], v[212:215], a[232:235]
  v_mul_f32 v197, s36, v197
  v_mul_f32 v198, s36, v198
  v_mfma_f32_16x16x32_bf16 v[200:203], a[128:131], a[64:67], v[252:255]
  buffer_load_dwordx4 v241, s[24:27], s38 offen offset:2048 lds
  v_exp_f32 v196, v196
  v_mfma_f32_16x16x32_bf16 v[200:203], a[132:135], a[68:71], v[200:203]
  v_cvt_pk_bf16_f32 v209, v194, v195
  v_mul_f32 v199, s36, v199
  v_mfma_f32_16x16x32_bf16 v[200:203], a[136:139], a[72:75], v[200:203]
  buffer_load_dwordx4 v241, s[24:27], s38 offen offset:3072 lds
  v_exp_f32 v197, v197
  v_mfma_f32_16x16x32_bf16 v[200:203], a[140:143], a[76:79], v[200:203]
  s_add_u32 s38, s38, 4096
  v_exp_f32 v198, v198
  v_mfma_f32_16x16x32_bf16 v[204:207], a[144:147], a[64:67], v[252:255]
  s_mov_b32 m0, 28672
  ds_read_b64_tr_b16 a[184:185], v234 offset:40968
  ds_read_b64_tr_b16 a[186:187], v234 offset:45064
  v_mfma_f32_16x16x32_bf16 v[204:207], a[148:151], a[68:71], v[204:207]
  buffer_load_dwordx4 v241, s[24:27], s38 offen offset:0 lds
  v_exp_f32 v199, v199
  v_mfma_f32_16x16x32_bf16 v[204:207], a[152:155], a[72:75], v[204:207]
  v_cvt_pk_bf16_f32 v210, v196, v197
  v_cvt_pk_bf16_f32 v211, v198, v199
  v_mfma_f32_16x16x32_bf16 v[204:207], a[156:159], a[76:79], v[204:207]
  s_waitcnt vmcnt(49)
  ds_add_u32 v245, v243
  v_mfma_f32_16x16x32_bf16 v[96:99], v[208:211], a[192:195], v[96:99]
  buffer_load_dwordx4 v241, s[24:27], s38 offen offset:1024 lds
  v_mul_f32 v200, s36, v200
  v_mul_f32 v201, s36, v201
  v_mfma_f32_16x16x32_bf16 v[100:103], v[208:211], a[196:199], v[100:103]
  v_exp_f32 v200, v200
  v_mfma_f32_16x16x32_bf16 v[104:107], v[208:211], a[200:203], v[104:107]
  buffer_load_dwordx4 v241, s[24:27], s38 offen offset:2048 lds
  v_mul_f32 v202, s36, v202
  v_mul_f32 v203, s36, v203
  v_mfma_f32_16x16x32_bf16 v[108:111], v[208:211], a[204:207], v[108:111]
  s_add_u32 s44, s44, 1
  v_exp_f32 v201, v201
  v_mfma_f32_16x16x32_bf16 v[112:115], v[208:211], a[208:211], v[112:115]
  ds_read_b64_tr_b16 a[188:189], v228 offset:40968
  ds_read_b64_tr_b16 a[190:191], v228 offset:45064
  v_mfma_f32_16x16x32_bf16 v[116:119], v[208:211], a[212:215], v[116:119]
  v_exp_f32 v202, v202
  v_mfma_f32_16x16x32_bf16 v[120:123], v[208:211], a[216:219], v[120:123]
  s_waitcnt lgkmcnt(15)
  buffer_load_dwordx4 v241, s[24:27], s38 offen offset:3072 lds
  v_cvt_pk_bf16_f32 v212, v200, v201
  v_mul_f32 v204, s36, v204
  v_mfma_f32_16x16x32_bf16 v[124:127], v[208:211], a[220:223], v[124:127]
  s_add_u32 s38, s38, 4096
  v_exp_f32 v203, v203
  v_mfma_f32_16x16x32_bf16 a[236:239], a[248:251], v[208:211], a[236:239]
  s_cmp_lt_u32 s44, 3
  v_mul_f32 v205, s36, v205
  v_mul_f32 v206, s36, v206
  s_cbranch_scc1 L_B5
L_E5:
  v_mfma_f32_16x16x32_bf16 v[192:195], a[96:99], a[0:3], v[252:255]
  s_add_u32 s72, s38, s73
  v_exp_f32 v204, v204
  v_mfma_f32_16x16x32_bf16 v[192:195], a[100:103], a[4:7], v[192:195]
  v_cvt_pk_bf16_f32 v213, v202, v203
  v_mul_f32 v207, s36, v207
  v_mfma_f32_16x16x32_bf16 v[192:195], a[104:107], a[8:11], v[192:195]
  v_exp_f32 v205, v205
  v_mfma_f32_16x16x32_bf16 v[192:195], a[108:111], a[12:15], v[192:195]
  v_exp_f32 v206, v206
  v_mfma_f32_16x16x32_bf16 v[196:199], a[112:115], a[0:3], v[252:255]
  ds_read_b128 a[128:131], v224 offset:49152
  ds_read_b128 a[132:135], v224 offset:49408
  v_mfma_f32_16x16x32_bf16 v[196:199], a[116:119], a[4:7], v[196:199]
  v_exp_f32 v207, v207
  v_mfma_f32_16x16x32_bf16 v[196:199], a[120:123], a[8:11], v[196:199]
  v_cvt_pk_bf16_f32 v214, v204, v205
  v_cvt_pk_bf16_f32 v215, v206, v207
  v_mfma_f32_16x16x32_bf16 v[196:199], a[124:127], a[12:15], v[196:199]
  ds_read_b32 v244, v242
  v_mfma_f32_16x16x32_bf16 v[128:131], v[212:215], a[192:195], v[128:131]
  v_mul_f32 v192, s36, v192
  v_mul_f32 v193, s36, v193
  v_mfma_f32_16x16x32_bf16 v[132:135], v[212:215], a[196:199], v[132:135]
  v_exp_f32 v192, v192
  v_mfma_f32_16x16x32_bf16 v[136:139], v[212:215], a[200:203], v[136:139]
  v_mul_f32 v194, s36, v194
  v_mul_f32 v195, s36, v195
  v_mfma_f32_16x16x32_bf16 v[140:143], v[212:215], a[204:207], v[140:143]
  v_exp_f32 v193, v193
  v_mfma_f32_16x16x32_bf16 v[144:147], v[212:215], a[208:211], v[144:147]
  ds_read_b128 a[136:139], v224 offset:49664
  ds_read_b128 a[140:143], v224 offset:49920
  v_mfma_f32_16x16x32_bf16 v[148:151], v[212:215], a[212:215], v[148:151]
  s_waitcnt lgkmcnt(2)
  v_exp_f32 v194, v194
  v_cmp_gt_u32 vcc, s58, v244
  v_mfma_f32_16x16x32_bf16 v[152:155], v[212:215], a[216:219], v[152:155]
  v_cvt_pk_bf16_f32 v208, v192, v193
  v_mul_f32 v196, s36, v196
  v_mfma_f32_16x16x32_bf16 v[156:159], v[212:215], a[220:223], v[156:159]
  s_cbranch_vccnz L_s5_1414
L_r5_1414:
  v_exp_f32 v195, v195
  v_mfma_f32_16x16x32_bf16 a[240:243], a[248:251], v[212:215], a[240:243]
  s_add_u32 s58, s58, 1
  v_mul_f32 v197, s36, v197
  v_mul_f32 v198, s36, v198
  v_mfma_f32_16x16x32_bf16 v[200:203], a[96:99], a[16:19], v[252:255]
  buffer_load_dword v236, v235, s[24:27], s72 offen
  v_exp_f32 v196, v196
  v_mfma_f32_16x16x32_bf16 v[200:203], a[100:103], a[20:23], v[200:203]
  s_add_u32 s72, s72, 16384
  v_cvt_pk_bf16_f32 v209, v194, v195
  v_mul_f32 v199, s36, v199
  v_mfma_f32_16x16x32_bf16 v[200:203], a[104:107], a[24:27], v[200:203]
  s_mov_b32 m0, 32768
  s_waitcnt vmcnt(50)
  v_exp_f32 v197, v197
  v_mfma_f32_16x16x32_bf16 v[200:203], a[108:111], a[28:31], v[200:203]
  buffer_load_dwordx4 v229, s[20:23], s37 offen offset:0 lds
  v_exp_f32 v198, v198
  v_mfma_f32_16x16x32_bf16 v[204:207], a[112:115], a[16:19], v[252:255]
  ds_read_b128 a[144:147], v224 offset:53248
  ds_read_b128 a[148:151], v224 offset:53504
  v_mfma_f32_16x16x32_bf16 v[204:207], a[116:119], a[20:23], v[204:207]
  buffer_load_dwordx4 v229, s[20:23], s37 offen offset:1024 lds
  v_exp_f32 v199, v199
  v_mfma_f32_16x16x32_bf16 v[204:207], a[120:123], a[24:27], v[204:207]
  v_cvt_pk_bf16_f32 v210, v196, v197
  v_cvt_pk_bf16_f32 v211, v198, v199
  v_mfma_f32_16x16x32_bf16 v[204:207], a[124:127], a[28:31], v[204:207]
  buffer_load_dwordx4 v230, s[20:23], s37 offen offset:2048 lds
  v_mfma_f32_16x16x32_bf16 v[0:3], v[208:211], a[160:163], v[0:3]
  v_mul_f32 v200, s36, v200
  v_mul_f32 v201, s36, v201
  v_mfma_f32_16x16x32_bf16 v[4:7], v[208:211], a[164:167], v[4:7]
  buffer_load_dwordx4 v230, s[20:23], s37 offen offset:3072 lds
  v_exp_f32 v200, v200
  v_mfma_f32_16x16x32_bf16 v[8:11], v[208:211], a[168:171], v[8:11]
  s_add_u32 s37, s37, 4096
  v_mul_f32 v202, s36, v202
  v_mul_f32 v203, s36, v203
  v_mfma_f32_16x16x32_bf16 v[12:15], v[208:211], a[172:175], v[12:15]
  v_exp_f32 v201, v201
  v_mfma_f32_16x16x32_bf16 v[16:19], v[208:211], a[176:179], v[16:19]
  s_mov_b32 m0, 36864
  ds_read_b128 a[152:155], v224 offset:53760
  ds_read_b128 a[156:159], v224 offset:54016
  v_mfma_f32_16x16x32_bf16 v[20:23], v[208:211], a[180:183], v[20:23]
  buffer_load_dwordx4 v229, s[20:23], s37 offen offset:0 lds
  v_exp_f32 v202, v202
  v_mfma_f32_16x16x32_bf16 v[24:27], v[208:211], a[184:187], v[24:27]
  v_cvt_pk_bf16_f32 v212, v200, v201
  v_mul_f32 v204, s36, v204
  v_mfma_f32_16x16x32_bf16 v[28:31], v[208:211], a[188:191], v[28:31]
  buffer_load_dwordx4 v229, s[20:23], s37 offen offset:1024 lds
  v_exp_f32 v203, v203
  v_mfma_f32_16x16x32_bf16 a[224:227], a[248:251], v[208:211], a[224:227]
  v_mul_f32 v205, s36, v205
  v_mul_f32 v206, s36, v206
  v_mfma_f32_16x16x32_bf16 v[192:195], a[96:99], a[32:35], v[252:255]
  buffer_load_dwordx4 v230, s[20:23], s37 offen offset:2048 lds
  v_exp_f32 v204, v204
  v_mfma_f32_16x16x32_bf16 v[192:195], a[100:103], a[36:39], v[192:195]
  v_cvt_pk_bf16_f32 v213, v202, v203
  v_mul_f32 v207, s36, v207
  v_mfma_f32_16x16x32_bf16 v[192:195], a[104:107], a[40:43], v[192:195]
  buffer_load_dwordx4 v230, s[20:23], s37 offen offset:3072 lds
  v_exp_f32 v205, v205
  v_mfma_f32_16x16x32_bf16 v[192:195], a[108:111], a[44:47], v[192:195]
  s_add_u32 s37, s37, 4096
  v_exp_f32 v206, v206
  v_mfma_f32_16x16x32_bf16 v[196:199], a[112:115], a[32:35], v[252:255]
  s_mov_b32 m0, 40960
  ds_read_b64_tr_b16 a[192:193], v226 offset:57344
  ds_read_b64_tr_b16 a[194:195], v226 offset:61440
  v_mfma_f32_16x16x32_bf16 v[196:199], a[116:119], a[36:39], v[196:199]
  buffer_load_dwordx4 v241, s[24:27], s38 offen offset:0 lds
  v_exp_f32 v207, v207
  v_mfma_f32_16x16x32_bf16 v[196:199], a[120:123], a[40:43], v[196:199]
  v_cvt_pk_bf16_f32 v214, v204, v205
  v_cvt_pk_bf16_f32 v215, v206, v207
  v_mfma_f32_16x16x32_bf16 v[196:199], a[124:127], a[44:47], v[196:199]
  buffer_load_dwordx4 v241, s[24:27], s38 offen offset:1024 lds
  v_add_u32 v231, 0xffffa000, v231
  v_mfma_f32_16x16x32_bf16 v[32:35], v[212:215], a[160:163], v[32:35]
  ds_read_b64_tr_b16 a[196:197], v237 offset:57344
  ds_read_b64_tr_b16 a[198:199], v237 offset:61440
  v_mul_f32 v192, s36, v192
  v_mul_f32 v193, s36, v193
  v_mfma_f32_16x16x32_bf16 v[36:39], v[212:215], a[164:167], v[36:39]
  buffer_load_dwordx4 v241, s[24:27], s38 offen offset:2048 lds
  v_exp_f32 v192, v192
  v_mfma_f32_16x16x32_bf16 v[40:43], v[212:215], a[168:171], v[40:43]
  v_mul_f32 v194, s36, v194
  v_mul_f32 v195, s36, v195
  v_mfma_f32_16x16x32_bf16 v[44:47], v[212:215], a[172:175], v[44:47]
  buffer_load_dwordx4 v241, s[24:27], s38 offen offset:3072 lds
  v_exp_f32 v193, v193
  v_mfma_f32_16x16x32_bf16 v[48:51], v[212:215], a[176:179], v[48:51]
  s_add_u32 s38, s38, 4096
  ds_read_b64_tr_b16 a[200:201], v234 offset:57344
  ds_read_b64_tr_b16 a[202:203], v234 offset:61440
  v_mfma_f32_16x16x32_bf16 v[52:55], v[212:215], a[180:183], v[52:55]
  s_mov_b32 m0, 45056
  s_waitcnt vmcnt(50)
  v_exp_f32 v194, v194
  v_mfma_f32_16x16x32_bf16 v[56:59], v[212:215], a[184:187], v[56:59]
  buffer_load_dwordx4 v241, s[24:27], s38 offen offset:0 lds
  v_cvt_pk_bf16_f32 v208, v192, v193
  v_mul_f32 v196, s36, v196
  v_mfma_f32_16x16x32_bf16 v[60:63], v[212:215], a[188:191], v[60:63]
  v_exp_f32 v195, v195
  v_mfma_f32_16x16x32_bf16 a[228:231], a[248:251], v[212:215], a[228:231]
  buffer_load_dwordx4 v241, s[24:27], s38 offen offset:1024 lds
  v_mul_f32 v197, s36, v197
  v_mul_f32 v198, s36, v198
  v_mfma_f32_16x16x32_bf16 v[200:203], a[96:99], a[48:51], v[252:255]
  v_exp_f32 v196, v196
  v_mfma_f32_16x16x32_bf16 v[200:203], a[100:103], a[52:55], v[200:203]
  buffer_load_dwordx4 v241, s[24:27], s38 offen offset:2048 lds
  v_cvt_pk_bf16_f32 v209, v194, v195
  v_mul_f32 v199, s36, v199
  v_mfma_f32_16x16x32_bf16 v[200:203], a[104:107], a[56:59], v[200:203]
  v_exp_f32 v197, v197
  v_mfma_f32_16x16x32_bf16 v[200:203], a[108:111], a[60:63], v[200:203]
  buffer_load_dwordx4 v241, s[24:27], s38 offen offset:3072 lds
  v_exp_f32 v198, v198
  v_mfma_f32_16x16x32_bf16 v[204:207], a[112:115], a[48:51], v[252:255]
  s_add_u32 s38, s38, 4096
  ds_read_b64_tr_b16 a[204:205], v228 offset:57344
  ds_read_b64_tr_b16 a[206:207], v228 offset:61440
  v_mfma_f32_16x16x32_bf16 v[204:207], a[116:119], a[52:55], v[204:207]
  v_exp_f32 v199, v199
  v_mfma_f32_16x16x32_bf16 v[204:207], a[120:123], a[56:59], v[204:207]
  v_cvt_pk_bf16_f32 v210, v196, v197
  v_cvt_pk_bf16_f32 v211, v198, v199
  v_mfma_f32_16x16x32_bf16 v[204:207], a[124:127], a[60:63], v[204:207]
  s_nop 0
  v_mfma_f32_16x16x32_bf16 v[64:67], v[208:211], a[160:163], v[64:67]
  ds_read_b64_tr_b16 a[208:209], v226 offset:57352
  ds_read_b64_tr_b16 a[210:211], v226 offset:61448
  v_mul_f32 v200, s36, v200
  v_mul_f32 v201, s36, v201
  v_mfma_f32_16x16x32_bf16 v[68:71], v[208:211], a[164:167], v[68:71]
  v_exp_f32 v200, v200
  v_mfma_f32_16x16x32_bf16 v[72:75], v[208:211], a[168:171], v[72:75]
  v_mul_f32 v202, s36, v202
  v_mul_f32 v203, s36, v203
  v_mfma_f32_16x16x32_bf16 v[76:79], v[208:211], a[172:175], v[76:79]
  v_exp_f32 v201, v201
  v_mfma_f32_16x16x32_bf16 v[80:83], v[208:211], a[176:179], v[80:83]
  ds_read_b64_tr_b16 a[212:213], v237 offset:57352
  ds_read_b64_tr_b16 a[214:215], v237 offset:61448
  v_mfma_f32_16x16x32_bf16 v[84:87], v[208:211], a[180:183], v[84:87]
  v_exp_f32 v202, v202
  v_mfma_f32_16x16x32_bf16 v[88:91], v[208:211], a[184:187], v[88:91]
  v_cvt_pk_bf16_f32 v212, v200, v201
  v_mul_f32 v204, s36, v204
  v_mfma_f32_16x16x32_bf16 v[92:95], v[208:211], a[188:191], v[92:95]
  v_exp_f32 v203, v203
  v_mfma_f32_16x16x32_bf16 a[232:235], a[248:251], v[208:211], a[232:235]
  v_mul_f32 v205, s36, v205
  v_mul_f32 v206, s36, v206
  v_mfma_f32_16x16x32_bf16 v[192:195], a[96:99], a[64:67], v[252:255]
  v_exp_f32 v204, v204
  v_mfma_f32_16x16x32_bf16 v[192:195], a[100:103], a[68:71], v[192:195]
  v_cvt_pk_bf16_f32 v213, v202, v203
  v_mul_f32 v207, s36, v207
  v_mfma_f32_16x16x32_bf16 v[192:195], a[104:107], a[72:75], v[192:195]
  v_exp_f32 v205, v205
  v_mfma_f32_16x16x32_bf16 v[192:195], a[108:111], a[76:79], v[192:195]
  v_exp_f32 v206, v206
  v_mfma_f32_16x16x32_bf16 v[196:199], a[112:115], a[64:67], v[252:255]
  ds_read_b64_tr_b16 a[216:217], v234 offset:57352
  ds_read_b64_tr_b16 a[218:219], v234 offset:61448
  v_mfma_f32_16x16x32_bf16 v[196:199], a[116:119], a[68:71], v[196:199]
  v_exp_f32 v207, v207
  v_mfma_f32_16x16x32_bf16 v[196:199], a[120:123], a[72:75], v[196:199]
  v_cvt_pk_bf16_f32 v214, v204, v205
  v_cvt_pk_bf16_f32 v215, v206, v207
  v_mfma_f32_16x16x32_bf16 v[196:199], a[124:127], a[76:79], v[196:199]
  s_waitcnt vmcnt(17)
  ds_add_u32 v245, v243
  v_mfma_f32_16x16x32_bf16 v[96:99], v[212:215], a[160:163], v[96:99]
  v_mul_f32 v192, s36, v192
  v_mul_f32 v193, s36, v193
  v_mfma_f32_16x16x32_bf16 v[100:103], v[212:215], a[164:167], v[100:103]
  v_exp_f32 v192, v192
  v_mfma_f32_16x16x32_bf16 v[104:107], v[212:215], a[168:171], v[104:107]
  v_mul_f32 v194, s36, v194
  v_mul_f32 v195, s36, v195
  v_mfma_f32_16x16x32_bf16 v[108:111], v[212:215], a[172:175], v[108:111]
  s_add_u32 s45, s45, 1
  v_exp_f32 v193, v193
  v_mfma_f32_16x16x32_bf16 v[112:115], v[212:215], a[176:179], v[112:115]
  ds_read_b64_tr_b16 a[220:221], v228 offset:57352
  ds_read_b64_tr_b16 a[222:223], v228 offset:61448
  v_mfma_f32_16x16x32_bf16 v[116:119], v[212:215], a[180:183], v[116:119]
  v_exp_f32 v194, v194
  v_mfma_f32_16x16x32_bf16 v[120:123], v[212:215], a[184:187], v[120:123]
  s_waitcnt lgkmcnt(15)
  v_cvt_pk_bf16_f32 v208, v192, v193
  v_mul_f32 v196, s36, v196
  v_mfma_f32_16x16x32_bf16 v[124:127], v[212:215], a[188:191], v[124:127]
  v_exp_f32 v195, v195
  v_mfma_f32_16x16x32_bf16 a[236:239], a[248:251], v[212:215], a[236:239]
  s_cmp_lt_u32 s45, 4
  v_mul_f32 v197, s36, v197
  v_mul_f32 v198, s36, v198
  s_cbranch_scc1 L_A5
  v_mfma_f32_16x16x32_bf16 v[200:203], a[128:131], a[0:3], v[252:255]
  s_add_u32 s42, s51, 565248
  v_exp_f32 v196, v196
  v_mfma_f32_16x16x32_bf16 v[200:203], a[132:135], a[4:7], v[200:203]
  s_add_u32 s30, s42, 20480
  v_cvt_pk_bf16_f32 v209, v194, v195
  v_mul_f32 v199, s36, v199
  v_mfma_f32_16x16x32_bf16 v[200:203], a[136:139], a[8:11], v[200:203]
  v_exp_f32 v197, v197
  v_mfma_f32_16x16x32_bf16 v[200:203], a[140:143], a[12:15], v[200:203]
  v_exp_f32 v198, v198
  v_mfma_f32_16x16x32_bf16 v[204:207], a[144:147], a[0:3], v[252:255]
  v_mfma_f32_16x16x32_bf16 v[204:207], a[148:151], a[4:7], v[204:207]
  v_exp_f32 v199, v199
  v_mfma_f32_16x16x32_bf16 v[204:207], a[152:155], a[8:11], v[204:207]
  v_cvt_pk_bf16_f32 v210, v196, v197
  v_cvt_pk_bf16_f32 v211, v198, v199
  v_mfma_f32_16x16x32_bf16 v[204:207], a[156:159], a[12:15], v[204:207]
  s_nop 0
  v_mfma_f32_16x16x32_bf16 v[128:131], v[208:211], a[160:163], v[128:131]
  v_mul_f32 v200, s36, v200
  v_mul_f32 v201, s36, v201
  v_mfma_f32_16x16x32_bf16 v[132:135], v[208:211], a[164:167], v[132:135]
  v_exp_f32 v200, v200
  v_mfma_f32_16x16x32_bf16 v[136:139], v[208:211], a[168:171], v[136:139]
  v_mul_f32 v202, s36, v202
  v_mul_f32 v203, s36, v203
  v_mfma_f32_16x16x32_bf16 v[140:143], v[208:211], a[172:175], v[140:143]
  v_exp_f32 v201, v201
  v_mfma_f32_16x16x32_bf16 v[144:147], v[208:211], a[176:179], v[144:147]
  v_mfma_f32_16x16x32_bf16 v[148:151], v[208:211], a[180:183], v[148:151]
  v_exp_f32 v202, v202
  v_mfma_f32_16x16x32_bf16 v[152:155], v[208:211], a[184:187], v[152:155]
  v_cvt_pk_bf16_f32 v212, v200, v201
  v_mul_f32 v204, s36, v204
  v_mfma_f32_16x16x32_bf16 v[156:159], v[208:211], a[188:191], v[156:159]
  v_exp_f32 v203, v203
  v_mfma_f32_16x16x32_bf16 a[240:243], a[248:251], v[208:211], a[240:243]
  v_mul_f32 v205, s36, v205
  v_mul_f32 v206, s36, v206
  v_mfma_f32_16x16x32_bf16 v[192:195], a[128:131], a[16:19], v[252:255]
  v_exp_f32 v204, v204
  v_mfma_f32_16x16x32_bf16 v[192:195], a[132:135], a[20:23], v[192:195]
  v_cvt_pk_bf16_f32 v213, v202, v203
  v_mul_f32 v207, s36, v207
  v_mfma_f32_16x16x32_bf16 v[192:195], a[136:139], a[24:27], v[192:195]
  v_exp_f32 v205, v205
  v_mfma_f32_16x16x32_bf16 v[192:195], a[140:143], a[28:31], v[192:195]
  v_exp_f32 v206, v206
  v_mfma_f32_16x16x32_bf16 v[196:199], a[144:147], a[16:19], v[252:255]
  v_mfma_f32_16x16x32_bf16 v[196:199], a[148:151], a[20:23], v[196:199]
  v_exp_f32 v207, v207
  v_mfma_f32_16x16x32_bf16 v[196:199], a[152:155], a[24:27], v[196:199]
  v_cvt_pk_bf16_f32 v214, v204, v205
  v_cvt_pk_bf16_f32 v215, v206, v207
  v_mfma_f32_16x16x32_bf16 v[196:199], a[156:159], a[28:31], v[196:199]
  s_waitcnt lgkmcnt(0)
  v_mfma_f32_16x16x32_bf16 v[0:3], v[212:215], a[192:195], v[0:3]
  v_mul_f32 v192, s36, v192
  v_mul_f32 v193, s36, v193
  v_mfma_f32_16x16x32_bf16 v[4:7], v[212:215], a[196:199], v[4:7]
  v_exp_f32 v192, v192
  v_mfma_f32_16x16x32_bf16 v[8:11], v[212:215], a[200:203], v[8:11]
  v_mul_f32 v194, s36, v194
  v_mul_f32 v195, s36, v195
  v_mfma_f32_16x16x32_bf16 v[12:15], v[212:215], a[204:207], v[12:15]
  v_exp_f32 v193, v193
  v_mfma_f32_16x16x32_bf16 v[16:19], v[212:215], a[208:211], v[16:19]
  v_mfma_f32_16x16x32_bf16 v[20:23], v[212:215], a[212:215], v[20:23]
  v_exp_f32 v194, v194
  v_mfma_f32_16x16x32_bf16 v[24:27], v[212:215], a[216:219], v[24:27]
  v_cvt_pk_bf16_f32 v208, v192, v193
  v_mul_f32 v196, s36, v196
  v_mfma_f32_16x16x32_bf16 v[28:31], v[212:215], a[220:223], v[28:31]
  v_exp_f32 v195, v195
  v_mfma_f32_16x16x32_bf16 a[224:227], a[248:251], v[212:215], a[224:227]
  v_mul_f32 v197, s36, v197
  v_mul_f32 v198, s36, v198
  v_mfma_f32_16x16x32_bf16 v[200:203], a[128:131], a[32:35], v[252:255]
  v_exp_f32 v196, v196
  v_mfma_f32_16x16x32_bf16 v[200:203], a[132:135], a[36:39], v[200:203]
  v_cvt_pk_bf16_f32 v209, v194, v195
  v_mul_f32 v199, s36, v199
  v_mfma_f32_16x16x32_bf16 v[200:203], a[136:139], a[40:43], v[200:203]
  v_exp_f32 v197, v197
  v_accvgpr_read_b32 v238, a224
  v_rcp_f32 v216, v238
  v_add_u32 v238, 0xd5800000, v238
  ds_write_b32 v250, v216 offset:0
  ds_read_b128 v[216:219], v251 offset:0
  v_mfma_f32_16x16x32_bf16 v[200:203], a[140:143], a[44:47], v[200:203]
  v_exp_f32 v198, v198
  v_mfma_f32_16x16x32_bf16 v[204:207], a[144:147], a[32:35], v[252:255]
  v_mfma_f32_16x16x32_bf16 v[204:207], a[148:151], a[36:39], v[204:207]
  v_exp_f32 v199, v199
  v_mfma_f32_16x16x32_bf16 v[204:207], a[152:155], a[40:43], v[204:207]
  v_cvt_pk_bf16_f32 v210, v196, v197
  v_cvt_pk_bf16_f32 v211, v198, v199
  v_mfma_f32_16x16x32_bf16 v[204:207], a[156:159], a[44:47], v[204:207]
  s_nop 0
  v_mfma_f32_16x16x32_bf16 v[32:35], v[208:211], a[192:195], v[32:35]
  s_waitcnt lgkmcnt(0)
  v_mul_f32 v200, s36, v200
  v_mul_f32 v201, s36, v201
  v_cmp_le_u32 vcc, 0x34000000, v238
  v_pk_mul_f32 v[0:1], v[0:1], v[216:217]
  v_pk_mul_f32 v[2:3], v[2:3], v[218:219]
  v_pk_mul_f32 v[4:5], v[4:5], v[216:217]
  v_pk_mul_f32 v[6:7], v[6:7], v[218:219]
  v_pk_mul_f32 v[8:9], v[8:9], v[216:217]
  v_pk_mul_f32 v[10:11], v[10:11], v[218:219]
  v_pk_mul_f32 v[12:13], v[12:13], v[216:217]
  v_pk_mul_f32 v[14:15], v[14:15], v[218:219]
  v_cvt_pk_bf16_f32 v0, v0, v4
  v_cvt_pk_bf16_f32 v4, v1, v5
  v_cvt_pk_bf16_f32 v1, v8, v12
  v_cvt_pk_bf16_f32 v5, v9, v13
  v_cvt_pk_bf16_f32 v8, v2, v6
  v_cvt_pk_bf16_f32 v12, v3, v7
  v_pk_mul_f32 v[16:17], v[16:17], v[216:217]
  v_pk_mul_f32 v[20:21], v[20:21], v[216:217]
  v_pk_mul_f32 v[24:25], v[24:25], v[216:217]
  v_pk_mul_f32 v[28:29], v[28:29], v[216:217]
  v_cvt_pk_bf16_f32 v2, v16, v20
  v_cvt_pk_bf16_f32 v3, v24, v28
  ds_write_b128 v233, v[0:3] offset:0
  v_cvt_pk_bf16_f32 v6, v17, v21
  v_cvt_pk_bf16_f32 v7, v25, v29
  v_cvt_pk_bf16_f32 v9, v10, v14
  v_cvt_pk_bf16_f32 v13, v11, v15
  v_pk_mul_f32 v[18:19], v[18:19], v[218:219]
  ds_write_b128 v233, v[4:7] offset:1024
  v_pk_mul_f32 v[22:23], v[22:23], v[218:219]
  v_pk_mul_f32 v[26:27], v[26:27], v[218:219]
  v_pk_mul_f32 v[30:31], v[30:31], v[218:219]
  v_cvt_pk_bf16_f32 v10, v18, v22
  v_cvt_pk_bf16_f32 v11, v26, v30
  ds_write_b128 v233, v[8:11] offset:2048
  v_cvt_pk_bf16_f32 v14, v19, v23
  v_cvt_pk_bf16_f32 v15, v27, v31
  ds_write_b128 v233, v[12:15] offset:3072
  s_and_b32 vcc_lo, vcc_lo, 0xffff
  s_addc_u32 s46, s46, s46
  v_mfma_f32_16x16x32_bf16 v[36:39], v[208:211], a[196:199], v[36:39]
  v_exp_f32 v200, v200
  v_mfma_f32_16x16x32_bf16 v[40:43], v[208:211], a[200:203], v[40:43]
  v_mul_f32 v202, s36, v202
  v_mul_f32 v203, s36, v203
  v_mfma_f32_16x16x32_bf16 v[44:47], v[208:211], a[204:207], v[44:47]
  v_exp_f32 v201, v201
  v_mfma_f32_16x16x32_bf16 v[48:51], v[208:211], a[208:211], v[48:51]
  v_mfma_f32_16x16x32_bf16 v[52:55], v[208:211], a[212:215], v[52:55]
  v_exp_f32 v202, v202
  v_mfma_f32_16x16x32_bf16 v[56:59], v[208:211], a[216:219], v[56:59]
  v_cvt_pk_bf16_f32 v212, v200, v201
  v_mul_f32 v204, s36, v204
  v_mfma_f32_16x16x32_bf16 v[60:63], v[208:211], a[220:223], v[60:63]
  v_exp_f32 v203, v203
  v_mfma_f32_16x16x32_bf16 a[228:231], a[248:251], v[208:211], a[228:231]
  v_mul_f32 v205, s36, v205
  v_mul_f32 v206, s36, v206
  v_mfma_f32_16x16x32_bf16 v[192:195], a[128:131], a[48:51], v[252:255]
  ds_read_b64_tr_b16 a[0:1], v231 offset:0
  ds_read_b64_tr_b16 a[2:3], v231 offset:8
  ds_read_b64_tr_b16 a[4:5], v231 offset:1024
  ds_read_b64_tr_b16 a[6:7], v231 offset:1032
  ds_read_b64_tr_b16 a[8:9], v231 offset:2048
  ds_read_b64_tr_b16 a[10:11], v231 offset:2056
  ds_read_b64_tr_b16 a[12:13], v231 offset:3072
  ds_read_b64_tr_b16 a[14:15], v231 offset:3080
  v_exp_f32 v204, v204
  v_mfma_f32_16x16x32_bf16 v[192:195], a[132:135], a[52:55], v[192:195]
  v_cvt_pk_bf16_f32 v213, v202, v203
  v_mul_f32 v207, s36, v207
  v_mfma_f32_16x16x32_bf16 v[192:195], a[136:139], a[56:59], v[192:195]
  v_exp_f32 v205, v205
  v_accvgpr_read_b32 v238, a228
  v_rcp_f32 v216, v238
  v_add_u32 v238, 0xd5800000, v238
  ds_write_b32 v250, v216 offset:4096
  ds_read_b128 v[216:219], v251 offset:4096
  v_mfma_f32_16x16x32_bf16 v[192:195], a[140:143], a[60:63], v[192:195]
  v_exp_f32 v206, v206
  v_mfma_f32_16x16x32_bf16 v[196:199], a[144:147], a[48:51], v[252:255]
  v_mfma_f32_16x16x32_bf16 v[196:199], a[148:151], a[52:55], v[196:199]
  v_exp_f32 v207, v207
  v_mfma_f32_16x16x32_bf16 v[196:199], a[152:155], a[56:59], v[196:199]
  v_cvt_pk_bf16_f32 v214, v204, v205
  v_cvt_pk_bf16_f32 v215, v206, v207
  v_mfma_f32_16x16x32_bf16 v[196:199], a[156:159], a[60:63], v[196:199]
  s_waitcnt lgkmcnt(2)
  buffer_store_dwordx4 a[0:3], v232, s[28:31], s42 offen offset:0 nt
  v_mfma_f32_16x16x32_bf16 v[64:67], v[212:215], a[192:195], v[64:67]
  s_waitcnt lgkmcnt(0)
  v_mul_f32 v192, s36, v192
  v_mul_f32 v193, s36, v193
  v_cmp_le_u32 vcc, 0x34000000, v238
  v_pk_mul_f32 v[32:33], v[32:33], v[216:217]
  v_pk_mul_f32 v[36:37], v[36:37], v[216:217]
  v_pk_mul_f32 v[40:41], v[40:41], v[216:217]
  v_pk_mul_f32 v[44:45], v[44:45], v[216:217]
  v_pk_mul_f32 v[48:49], v[48:49], v[216:217]
  v_pk_mul_f32 v[52:53], v[52:53], v[216:217]
  v_pk_mul_f32 v[56:57], v[56:57], v[216:217]
  v_pk_mul_f32 v[60:61], v[60:61], v[216:217]
  v_cvt_pk_bf16_f32 v0, v32, v36
  v_cvt_pk_bf16_f32 v1, v40, v44
  v_cvt_pk_bf16_f32 v2, v48, v52
  v_cvt_pk_bf16_f32 v3, v56, v60
  ds_write_b128 v233, v[0:3] offset:4096
  v_cvt_pk_bf16_f32 v4, v33, v37
  v_cvt_pk_bf16_f32 v5, v41, v45
  v_cvt_pk_bf16_f32 v6, v49, v53
  v_cvt_pk_bf16_f32 v7, v57, v61
  v_pk_mul_f32 v[34:35], v[34:35], v[218:219]
  v_pk_mul_f32 v[38:39], v[38:39], v[218:219]
  v_pk_mul_f32 v[42:43], v[42:43], v[218:219]
  v_pk_mul_f32 v[46:47], v[46:47], v[218:219]
  ds_write_b128 v233, v[4:7] offset:5120
  v_pk_mul_f32 v[50:51], v[50:51], v[218:219]
  v_pk_mul_f32 v[54:55], v[54:55], v[218:219]
  v_pk_mul_f32 v[58:59], v[58:59], v[218:219]
  v_pk_mul_f32 v[62:63], v[62:63], v[218:219]
  v_cvt_pk_bf16_f32 v8, v34, v38
  v_cvt_pk_bf16_f32 v9, v42, v46
  v_cvt_pk_bf16_f32 v10, v50, v54
  v_cvt_pk_bf16_f32 v11, v58, v62
  ds_write_b128 v233, v[8:11] offset:6144
  v_cvt_pk_bf16_f32 v12, v35, v39
  v_cvt_pk_bf16_f32 v13, v43, v47
  v_cvt_pk_bf16_f32 v14, v51, v55
  v_cvt_pk_bf16_f32 v15, v59, v63
  ds_write_b128 v233, v[12:15] offset:7168
  s_and_b32 vcc_lo, vcc_lo, 0xffff
  s_addc_u32 s46, s46, s46
  v_mfma_f32_16x16x32_bf16 v[68:71], v[212:215], a[196:199], v[68:71]
  v_exp_f32 v192, v192
  v_mfma_f32_16x16x32_bf16 v[72:75], v[212:215], a[200:203], v[72:75]
  buffer_store_dwordx4 a[4:7], v232, s[28:31], s42 offen offset:256 nt
  v_mul_f32 v194, s36, v194
  v_mul_f32 v195, s36, v195
  v_mfma_f32_16x16x32_bf16 v[76:79], v[212:215], a[204:207], v[76:79]
  v_exp_f32 v193, v193
  v_mfma_f32_16x16x32_bf16 v[80:83], v[212:215], a[208:211], v[80:83]
  buffer_store_dwordx4 a[8:11], v232, s[28:31], s42 offen offset:512 nt
  v_mfma_f32_16x16x32_bf16 v[84:87], v[212:215], a[212:215], v[84:87]
  v_exp_f32 v194, v194
  v_mfma_f32_16x16x32_bf16 v[88:91], v[212:215], a[216:219], v[88:91]
  v_cvt_pk_bf16_f32 v208, v192, v193
  v_mul_f32 v196, s36, v196
  v_mfma_f32_16x16x32_bf16 v[92:95], v[212:215], a[220:223], v[92:95]
  v_exp_f32 v195, v195
  v_mfma_f32_16x16x32_bf16 a[232:235], a[248:251], v[212:215], a[232:235]
  buffer_store_dwordx4 a[12:15], v232, s[28:31], s42 offen offset:768 nt
  v_mul_f32 v197, s36, v197
  v_mul_f32 v198, s36, v198
  s_add_u32 s42, s42, 4096
  v_mfma_f32_16x16x32_bf16 v[200:203], a[128:131], a[64:67], v[252:255]
  ds_read_b64_tr_b16 a[16:17], v231 offset:4096
  ds_read_b64_tr_b16 a[18:19], v231 offset:4104
  ds_read_b64_tr_b16 a[20:21], v231 offset:5120
  ds_read_b64_tr_b16 a[22:23], v231 offset:5128
  ds_read_b64_tr_b16 a[24:25], v231 offset:6144
  ds_read_b64_tr_b16 a[26:27], v231 offset:6152
  ds_read_b64_tr_b16 a[28:29], v231 offset:7168
  ds_read_b64_tr_b16 a[30:31], v231 offset:7176
  v_exp_f32 v196, v196
  v_mfma_f32_16x16x32_bf16 v[200:203], a[132:135], a[68:71], v[200:203]
  v_cvt_pk_bf16_f32 v209, v194, v195
  v_mul_f32 v199, s36, v199
  v_mfma_f32_16x16x32_bf16 v[200:203], a[136:139], a[72:75], v[200:203]
  v_exp_f32 v197, v197
  v_accvgpr_read_b32 v238, a232
  v_rcp_f32 v216, v238
  v_add_u32 v238, 0xd5800000, v238
  ds_write_b32 v250, v216 offset:8192
  ds_read_b128 v[216:219], v251 offset:8192
  v_mfma_f32_16x16x32_bf16 v[200:203], a[140:143], a[76:79], v[200:203]
  v_exp_f32 v198, v198
  v_mfma_f32_16x16x32_bf16 v[204:207], a[144:147], a[64:67], v[252:255]
  v_mfma_f32_16x16x32_bf16 v[204:207], a[148:151], a[68:71], v[204:207]
  v_exp_f32 v199, v199
  v_mfma_f32_16x16x32_bf16 v[204:207], a[152:155], a[72:75], v[204:207]
  v_cvt_pk_bf16_f32 v210, v196, v197
  v_cvt_pk_bf16_f32 v211, v198, v199
  v_mfma_f32_16x16x32_bf16 v[204:207], a[156:159], a[76:79], v[204:207]
  s_waitcnt lgkmcnt(2)
  buffer_store_dwordx4 a[16:19], v232, s[28:31], s42 offen offset:0 nt
  v_mfma_f32_16x16x32_bf16 v[96:99], v[208:211], a[192:195], v[96:99]
  s_waitcnt lgkmcnt(0)
  v_mul_f32 v200, s36, v200
  v_mul_f32 v201, s36, v201
  v_cmp_le_u32 vcc, 0x34000000, v238
  v_pk_mul_f32 v[64:65], v[64:65], v[216:217]
  v_pk_mul_f32 v[68:69], v[68:69], v[216:217]
  v_pk_mul_f32 v[72:73], v[72:73], v[216:217]
  v_pk_mul_f32 v[76:77], v[76:77], v[216:217]
  v_pk_mul_f32 v[80:81], v[80:81], v[216:217]
  v_pk_mul_f32 v[84:85], v[84:85], v[216:217]
  v_pk_mul_f32 v[88:89], v[88:89], v[216:217]
  v_pk_mul_f32 v[92:93], v[92:93], v[216:217]
  v_cvt_pk_bf16_f32 v32, v64, v68
  v_cvt_pk_bf16_f32 v33, v72, v76
  v_cvt_pk_bf16_f32 v34, v80, v84
  v_cvt_pk_bf16_f32 v35, v88, v92
  ds_write_b128 v233, v[32:35] offset:8192
  v_cvt_pk_bf16_f32 v36, v65, v69
  v_cvt_pk_bf16_f32 v37, v73, v77
  v_cvt_pk_bf16_f32 v38, v81, v85
  v_cvt_pk_bf16_f32 v39, v89, v93
  v_pk_mul_f32 v[66:67], v[66:67], v[218:219]
  v_pk_mul_f32 v[70:71], v[70:71], v[218:219]
  v_pk_mul_f32 v[74:75], v[74:75], v[218:219]
  v_pk_mul_f32 v[78:79], v[78:79], v[218:219]
  ds_write_b128 v233, v[36:39] offset:9216
  v_pk_mul_f32 v[82:83], v[82:83], v[218:219]
  v_pk_mul_f32 v[86:87], v[86:87], v[218:219]
  v_pk_mul_f32 v[90:91], v[90:91], v[218:219]
  v_pk_mul_f32 v[94:95], v[94:95], v[218:219]
  v_cvt_pk_bf16_f32 v40, v66, v70
  v_cvt_pk_bf16_f32 v41, v74, v78
  v_cvt_pk_bf16_f32 v42, v82, v86
  v_cvt_pk_bf16_f32 v43, v90, v94
  ds_write_b128 v233, v[40:43] offset:10240
  v_cvt_pk_bf16_f32 v44, v67, v71
  v_cvt_pk_bf16_f32 v45, v75, v79
  v_cvt_pk_bf16_f32 v46, v83, v87
  v_cvt_pk_bf16_f32 v47, v91, v95
  ds_write_b128 v233, v[44:47] offset:11264
  s_and_b32 vcc_lo, vcc_lo, 0xffff
  s_addc_u32 s46, s46, s46
  v_mfma_f32_16x16x32_bf16 v[100:103], v[208:211], a[196:199], v[100:103]
  v_exp_f32 v200, v200
  v_mfma_f32_16x16x32_bf16 v[104:107], v[208:211], a[200:203], v[104:107]
  buffer_store_dwordx4 a[20:23], v232, s[28:31], s42 offen offset:256 nt
  v_mul_f32 v202, s36, v202
  v_mul_f32 v203, s36, v203
  v_mfma_f32_16x16x32_bf16 v[108:111], v[208:211], a[204:207], v[108:111]
  v_exp_f32 v201, v201
  v_mfma_f32_16x16x32_bf16 v[112:115], v[208:211], a[208:211], v[112:115]
  buffer_store_dwordx4 a[24:27], v232, s[28:31], s42 offen offset:512 nt
  v_mfma_f32_16x16x32_bf16 v[116:119], v[208:211], a[212:215], v[116:119]
  v_exp_f32 v202, v202
  v_mfma_f32_16x16x32_bf16 v[120:123], v[208:211], a[216:219], v[120:123]
  v_cvt_pk_bf16_f32 v212, v200, v201
  v_mul_f32 v204, s36, v204
  v_mfma_f32_16x16x32_bf16 v[124:127], v[208:211], a[220:223], v[124:127]
  v_exp_f32 v203, v203
  v_mfma_f32_16x16x32_bf16 a[236:239], a[248:251], v[208:211], a[236:239]
  buffer_store_dwordx4 a[28:31], v232, s[28:31], s42 offen offset:768 nt
  v_mul_f32 v205, s36, v205
  v_mul_f32 v206, s36, v206
  s_add_u32 s42, s42, 4096
  ds_read_b64_tr_b16 a[32:33], v231 offset:8192
  ds_read_b64_tr_b16 a[34:35], v231 offset:8200
  ds_read_b64_tr_b16 a[36:37], v231 offset:9216
  ds_read_b64_tr_b16 a[38:39], v231 offset:9224
  ds_read_b64_tr_b16 a[40:41], v231 offset:10240
  ds_read_b64_tr_b16 a[42:43], v231 offset:10248
  ds_read_b64_tr_b16 a[44:45], v231 offset:11264
  ds_read_b64_tr_b16 a[46:47], v231 offset:11272
  v_exp_f32 v204, v204
  s_nop 0
  v_cvt_pk_bf16_f32 v213, v202, v203
  v_mul_f32 v207, s36, v207
  s_nop 0
  v_exp_f32 v205, v205
  s_nop 0
  v_exp_f32 v206, v206
  s_nop 0
  s_nop 0
  v_exp_f32 v207, v207
  s_nop 0
  v_cvt_pk_bf16_f32 v214, v204, v205
  v_cvt_pk_bf16_f32 v215, v206, v207
  s_nop 0
  s_waitcnt lgkmcnt(0)
  v_mfma_f32_16x16x32_bf16 a[240:243], a[248:251], v[212:215], a[240:243]
  v_accvgpr_read_b32 v238, a236
  v_rcp_f32 v216, v238
  v_add_u32 v238, 0xd5800000, v238
  ds_write_b32 v250, v216 offset:12288
  ds_read_b128 v[216:219], v251 offset:12288
  v_mfma_f32_16x16x32_bf16 v[128:131], v[212:215], a[192:195], v[128:131]
  buffer_store_dwordx4 a[32:35], v232, s[28:31], s42 offen offset:0 nt
  v_mfma_f32_16x16x32_bf16 v[132:135], v[212:215], a[196:199], v[132:135]
  v_mfma_f32_16x16x32_bf16 v[136:139], v[212:215], a[200:203], v[136:139]
  buffer_store_dwordx4 a[36:39], v232, s[28:31], s42 offen offset:256 nt
  v_mfma_f32_16x16x32_bf16 v[140:143], v[212:215], a[204:207], v[140:143]
  v_mfma_f32_16x16x32_bf16 v[144:147], v[212:215], a[208:211], v[144:147]
  buffer_store_dwordx4 a[40:43], v232, s[28:31], s42 offen offset:512 nt
  v_mfma_f32_16x16x32_bf16 v[148:151], v[212:215], a[212:215], v[148:151]
  v_mfma_f32_16x16x32_bf16 v[152:155], v[212:215], a[216:219], v[152:155]
  buffer_store_dwordx4 a[44:47], v232, s[28:31], s42 offen offset:768 nt
  v_mfma_f32_16x16x32_bf16 v[156:159], v[212:215], a[220:223], v[156:159]
  s_add_u32 s42, s42, 4096
  s_waitcnt lgkmcnt(0)
  v_cmp_le_u32 vcc, 0x34000000, v238
  v_pk_mul_f32 v[96:97], v[96:97], v[216:217]
  v_pk_mul_f32 v[100:101], v[100:101], v[216:217]
  v_pk_mul_f32 v[104:105], v[104:105], v[216:217]
  v_pk_mul_f32 v[108:109], v[108:109], v[216:217]
  v_pk_mul_f32 v[112:113], v[112:113], v[216:217]
  v_pk_mul_f32 v[116:117], v[116:117], v[216:217]
  v_pk_mul_f32 v[120:121], v[120:121], v[216:217]
  v_pk_mul_f32 v[124:125], v[124:125], v[216:217]
  v_cvt_pk_bf16_f32 v64, v96, v100
  v_cvt_pk_bf16_f32 v65, v104, v108
  v_cvt_pk_bf16_f32 v66, v112, v116
  v_cvt_pk_bf16_f32 v67, v120, v124
  ds_write_b128 v233, v[64:67] offset:12288
  v_cvt_pk_bf16_f32 v68, v97, v101
  v_cvt_pk_bf16_f32 v69, v105, v109
  v_cvt_pk_bf16_f32 v70, v113, v117
  v_cvt_pk_bf16_f32 v71, v121, v125
  v_pk_mul_f32 v[98:99], v[98:99], v[218:219]
  v_pk_mul_f32 v[102:103], v[102:103], v[218:219]
  v_pk_mul_f32 v[106:107], v[106:107], v[218:219]
  v_pk_mul_f32 v[110:111], v[110:111], v[218:219]
  ds_write_b128 v233, v[68:71] offset:13312
  v_pk_mul_f32 v[114:115], v[114:115], v[218:219]
  v_pk_mul_f32 v[118:119], v[118:119], v[218:219]
  v_pk_mul_f32 v[122:123], v[122:123], v[218:219]
  v_pk_mul_f32 v[126:127], v[126:127], v[218:219]
  v_accvgpr_read_b32 v238, a240
  v_rcp_f32 v216, v238
  v_add_u32 v238, 0xd5800000, v238
  ds_write_b32 v250, v216 offset:16384
  ds_read_b128 v[216:219], v251 offset:16384
  v_cvt_pk_bf16_f32 v72, v98, v102
  v_cvt_pk_bf16_f32 v73, v106, v110
  v_cvt_pk_bf16_f32 v74, v114, v118
  v_cvt_pk_bf16_f32 v75, v122, v126
  ds_write_b128 v233, v[72:75] offset:14336
  v_cvt_pk_bf16_f32 v76, v99, v103
  v_cvt_pk_bf16_f32 v77, v107, v111
  v_cvt_pk_bf16_f32 v78, v115, v119
  v_cvt_pk_bf16_f32 v79, v123, v127
  ds_write_b128 v233, v[76:79] offset:15360
  s_and_b32 vcc_lo, vcc_lo, 0xffff
  s_addc_u32 s46, s46, s46
  ds_read_b64_tr_b16 a[48:49], v231 offset:12288
  ds_read_b64_tr_b16 a[50:51], v231 offset:12296
  ds_read_b64_tr_b16 a[52:53], v231 offset:13312
  ds_read_b64_tr_b16 a[54:55], v231 offset:13320
  ds_read_b64_tr_b16 a[56:57], v231 offset:14336
  ds_read_b64_tr_b16 a[58:59], v231 offset:14344
  ds_read_b64_tr_b16 a[60:61], v231 offset:15360
  ds_read_b64_tr_b16 a[62:63], v231 offset:15368
  s_waitcnt lgkmcnt(10)
  v_cmp_le_u32 vcc, 0x34000000, v238
  v_pk_mul_f32 v[128:129], v[128:129], v[216:217]
  v_pk_mul_f32 v[132:133], v[132:133], v[216:217]
  v_pk_mul_f32 v[136:137], v[136:137], v[216:217]
  v_pk_mul_f32 v[140:141], v[140:141], v[216:217]
  v_pk_mul_f32 v[144:145], v[144:145], v[216:217]
  v_pk_mul_f32 v[148:149], v[148:149], v[216:217]
  v_pk_mul_f32 v[152:153], v[152:153], v[216:217]
  v_pk_mul_f32 v[156:157], v[156:157], v[216:217]
  s_waitcnt lgkmcnt(0)
  buffer_store_dwordx4 a[48:51], v232, s[28:31], s42 offen offset:0 nt
  v_cvt_pk_bf16_f32 v96, v128, v132
  v_cvt_pk_bf16_f32 v97, v136, v140
  v_cvt_pk_bf16_f32 v98, v144, v148
  v_cvt_pk_bf16_f32 v99, v152, v156
  buffer_store_dwordx4 a[52:55], v232, s[28:31], s42 offen offset:256 nt
  ds_write_b128 v233, v[96:99] offset:16384
  v_cvt_pk_bf16_f32 v100, v129, v133
  v_cvt_pk_bf16_f32 v101, v137, v141
  v_cvt_pk_bf16_f32 v102, v145, v149
  buffer_store_dwordx4 a[56:59], v232, s[28:31], s42 offen offset:512 nt
  v_cvt_pk_bf16_f32 v103, v153, v157
  v_pk_mul_f32 v[130:131], v[130:131], v[218:219]
  v_pk_mul_f32 v[134:135], v[134:135], v[218:219]
  v_pk_mul_f32 v[138:139], v[138:139], v[218:219]
  buffer_store_dwordx4 a[60:63], v232, s[28:31], s42 offen offset:768 nt
  v_pk_mul_f32 v[142:143], v[142:143], v[218:219]
  ds_write_b128 v233, v[100:103] offset:17408
  v_pk_mul_f32 v[146:147], v[146:147], v[218:219]
  v_pk_mul_f32 v[150:151], v[150:151], v[218:219]
  v_pk_mul_f32 v[154:155], v[154:155], v[218:219]
  v_pk_mul_f32 v[158:159], v[158:159], v[218:219]
  v_cvt_pk_bf16_f32 v104, v130, v134
  v_cvt_pk_bf16_f32 v105, v138, v142
  v_cvt_pk_bf16_f32 v106, v146, v150
  v_cvt_pk_bf16_f32 v107, v154, v158
  ds_write_b128 v233, v[104:107] offset:18432
  v_cvt_pk_bf16_f32 v108, v131, v135
  v_cvt_pk_bf16_f32 v109, v139, v143
  v_cvt_pk_bf16_f32 v110, v147, v151
  v_cvt_pk_bf16_f32 v111, v155, v159
  ds_write_b128 v233, v[108:111] offset:19456
  ds_read_b64_tr_b16 a[64:65], v231 offset:16384
  ds_read_b64_tr_b16 a[66:67], v231 offset:16392
  ds_read_b64_tr_b16 a[68:69], v231 offset:17408
  ds_read_b64_tr_b16 a[70:71], v231 offset:17416
  ds_read_b64_tr_b16 a[72:73], v231 offset:18432
  ds_read_b64_tr_b16 a[74:75], v231 offset:18440
  ds_read_b64_tr_b16 a[76:77], v231 offset:19456
  ds_read_b64_tr_b16 a[78:79], v231 offset:19464
  s_and_b32 vcc_lo, vcc_lo, 0xffff
  s_addc_u32 s46, s46, s46
  s_add_u32 s42, s42, 4096
  s_brev_b32 s46, s46
  s_lshr_b32 s46, s46, 12
  s_mov_b32 s56, 5
  s_waitcnt lgkmcnt(6)
  buffer_store_dwordx4 a[64:67], v232, s[28:31], s42 offen offset:0 nt
  s_waitcnt lgkmcnt(4)
  buffer_store_dwordx4 a[68:71], v232, s[28:31], s42 offen offset:256 nt
  s_waitcnt lgkmcnt(2)
  buffer_store_dwordx4 a[72:75], v232, s[28:31], s42 offen offset:512 nt
  s_waitcnt lgkmcnt(0)
  buffer_store_dwordx4 a[76:79], v232, s[28:31], s42 offen offset:768 nt
  s_waitcnt vmcnt(20)
  s_branch L_tail
.p2align 6
L_C5:
  v_mfma_f32_16x16x32_bf16 v[192:195], a[96:99], a[0:3], v[252:255]
  v_exp_f32 v204, v204
  v_mfma_f32_16x16x32_bf16 v[192:195], a[100:103], a[4:7], v[192:195]
  v_cvt_pk_bf16_f32 v213, v202, v203
  v_mul_f32 v207, s36, v207
  v_mfma_f32_16x16x32_bf16 v[192:195], a[104:107], a[8:11], v[192:195]
  v_exp_f32 v205, v205
  v_mfma_f32_16x16x32_bf16 v[192:195], a[108:111], a[12:15], v[192:195]
  v_exp_f32 v206, v206
  v_mfma_f32_16x16x32_bf16 v[196:199], a[112:115], a[0:3], v[252:255]
  ds_read_b128 a[128:131], v224 offset:49152
  ds_read_b128 a[132:135], v224 offset:49408
  v_mfma_f32_16x16x32_bf16 v[196:199], a[116:119], a[4:7], v[196:199]
  v_exp_f32 v207, v207
  v_mfma_f32_16x16x32_bf16 v[196:199], a[120:123], a[8:11], v[196:199]
  v_cvt_pk_bf16_f32 v214, v204, v205
  v_cvt_pk_bf16_f32 v215, v206, v207
  v_mfma_f32_16x16x32_bf16 v[196:199], a[124:127], a[12:15], v[196:199]
  ds_read_b64_tr_b16 v[216:217], v231 offset:0
  ds_read_b64_tr_b16 v[218:219], v231 offset:8
  ds_read_b64_tr_b16 v[220:221], v231 offset:1024
  ds_read_b64_tr_b16 v[222:223], v231 offset:1032
  ds_read_b64_tr_b16 a[244:245], v231 offset:2048
  ds_read_b64_tr_b16 a[246:247], v231 offset:2056
  ds_read_b32 v244, v242
  v_mfma_f32_16x16x32_bf16 v[128:131], v[212:215], a[192:195], v[128:131]
  v_mul_f32 v192, s36, v192
  v_mul_f32 v193, s36, v193
  v_mfma_f32_16x16x32_bf16 v[132:135], v[212:215], a[196:199], v[132:135]
  v_exp_f32 v192, v192
  v_mfma_f32_16x16x32_bf16 v[136:139], v[212:215], a[200:203], v[136:139]
  v_mul_f32 v194, s36, v194
  v_mul_f32 v195, s36, v195
  v_mfma_f32_16x16x32_bf16 v[140:143], v[212:215], a[204:207], v[140:143]
  v_exp_f32 v193, v193
  v_mfma_f32_16x16x32_bf16 v[144:147], v[212:215], a[208:211], v[144:147]
  ds_read_b128 a[136:139], v224 offset:49664
  ds_read_b128 a[140:143], v224 offset:49920
  v_mfma_f32_16x16x32_bf16 v[148:151], v[212:215], a[212:215], v[148:151]
  s_waitcnt lgkmcnt(2)
  v_exp_f32 v194, v194
  v_cmp_gt_u32 vcc, s58, v244
  v_mfma_f32_16x16x32_bf16 v[152:155], v[212:215], a[216:219], v[152:155]
  v_cvt_pk_bf16_f32 v208, v192, v193
  v_mul_f32 v196, s36, v196
  v_mfma_f32_16x16x32_bf16 v[156:159], v[212:215], a[220:223], v[156:159]
  s_cbranch_vccnz L_s5_C2
L_r5_C2:
  v_exp_f32 v195, v195
  v_mfma_f32_16x16x32_bf16 a[240:243], a[248:251], v[212:215], a[240:243]
  s_add_u32 s58, s58, 1
  v_mul_f32 v197, s36, v197
  v_mul_f32 v198, s36, v198
  v_mfma_f32_16x16x32_bf16 v[200:203], a[96:99], a[16:19], v[252:255]
  buffer_store_dwordx4 v[216:219], v232, s[28:31], s42 offen offset:0 nt
  v_exp_f32 v196, v196
  v_mfma_f32_16x16x32_bf16 v[200:203], a[100:103], a[20:23], v[200:203]
  v_cvt_pk_bf16_f32 v209, v194, v195
  v_mul_f32 v199, s36, v199
  v_mfma_f32_16x16x32_bf16 v[200:203], a[104:107], a[24:27], v[200:203]
  buffer_store_dwordx4 v[220:223], v232, s[28:31], s42 offen offset:256 nt
  v_exp_f32 v197, v197
  v_mfma_f32_16x16x32_bf16 v[200:203], a[108:111], a[28:31], v[200:203]
  v_exp_f32 v198, v198
  v_mfma_f32_16x16x32_bf16 v[204:207], a[112:115], a[16:19], v[252:255]
  ds_read_b128 a[144:147], v224 offset:53248
  ds_read_b128 a[148:151], v224 offset:53504
  v_mfma_f32_16x16x32_bf16 v[204:207], a[116:119], a[20:23], v[204:207]
  buffer_store_dwordx4 a[244:247], v232, s[28:31], s42 offen offset:512 nt
  v_exp_f32 v199, v199
  v_mfma_f32_16x16x32_bf16 v[204:207], a[120:123], a[24:27], v[204:207]
  s_mov_b32 m0, 32768
  v_cvt_pk_bf16_f32 v210, v196, v197
  v_cvt_pk_bf16_f32 v211, v198, v199
  v_mfma_f32_16x16x32_bf16 v[204:207], a[124:127], a[28:31], v[204:207]
  buffer_load_dwordx4 v229, s[20:23], s37 offen offset:0 lds
  v_mfma_f32_16x16x32_bf16 v[0:3], v[208:211], a[160:163], v[0:3]
  v_mul_f32 v200, s36, v200
  v_mul_f32 v201, s36, v201
  v_mfma_f32_16x16x32_bf16 v[4:7], v[208:211], a[164:167], v[4:7]
  buffer_load_dwordx4 v229, s[20:23], s37 offen offset:1024 lds
  v_exp_f32 v200, v200
  v_mfma_f32_16x16x32_bf16 v[8:11], v[208:211], a[168:171], v[8:11]
  v_mul_f32 v202, s36, v202
  v_mul_f32 v203, s36, v203
  v_mfma_f32_16x16x32_bf16 v[12:15], v[208:211], a[172:175], v[12:15]
  buffer_load_dwordx4 v230, s[20:23], s37 offen offset:2048 lds
  v_exp_f32 v201, v201
  v_mfma_f32_16x16x32_bf16 v[16:19], v[208:211], a[176:179], v[16:19]
  ds_read_b128 a[152:155], v224 offset:53760
  ds_read_b128 a[156:159], v224 offset:54016
  v_mfma_f32_16x16x32_bf16 v[20:23], v[208:211], a[180:183], v[20:23]
  buffer_load_dwordx4 v230, s[20:23], s37 offen offset:3072 lds
  v_exp_f32 v202, v202
  v_mfma_f32_16x16x32_bf16 v[24:27], v[208:211], a[184:187], v[24:27]
  s_add_u32 s37, s37, 4096
  v_cvt_pk_bf16_f32 v212, v200, v201
  v_mul_f32 v204, s36, v204
  v_mfma_f32_16x16x32_bf16 v[28:31], v[208:211], a[188:191], v[28:31]
  s_mov_b32 m0, 36864
  v_exp_f32 v203, v203
  v_mfma_f32_16x16x32_bf16 a[224:227], a[248:251], v[208:211], a[224:227]
  buffer_load_dwordx4 v229, s[20:23], s37 offen offset:0 lds
  v_mul_f32 v205, s36, v205
  v_mul_f32 v206, s36, v206
  v_mfma_f32_16x16x32_bf16 v[192:195], a[96:99], a[32:35], v[252:255]
  v_exp_f32 v204, v204
  v_mfma_f32_16x16x32_bf16 v[192:195], a[100:103], a[36:39], v[192:195]
  buffer_load_dwordx4 v229, s[20:23], s37 offen offset:1024 lds
  v_cvt_pk_bf16_f32 v213, v202, v203
  v_mul_f32 v207, s36, v207
  v_mfma_f32_16x16x32_bf16 v[192:195], a[104:107], a[40:43], v[192:195]
  v_exp_f32 v205, v205
  v_mfma_f32_16x16x32_bf16 v[192:195], a[108:111], a[44:47], v[192:195]
  buffer_load_dwordx4 v230, s[20:23], s37 offen offset:2048 lds
  v_exp_f32 v206, v206
  v_mfma_f32_16x16x32_bf16 v[196:199], a[112:115], a[32:35], v[252:255]
  ds_read_b64_tr_b16 a[192:193], v226 offset:57344
  ds_read_b64_tr_b16 a[194:195], v226 offset:61440
  v_mfma_f32_16x16x32_bf16 v[196:199], a[116:119], a[36:39], v[196:199]
  buffer_load_dwordx4 v230, s[20:23], s37 offen offset:3072 lds
  v_exp_f32 v207, v207
  v_mfma_f32_16x16x32_bf16 v[196:199], a[120:123], a[40:43], v[196:199]
  s_add_u32 s37, s37, 4096
  v_cvt_pk_bf16_f32 v214, v204, v205
  v_cvt_pk_bf16_f32 v215, v206, v207
  v_mfma_f32_16x16x32_bf16 v[196:199], a[124:127], a[44:47], v[196:199]
  s_nop 0
  v_mfma_f32_16x16x32_bf16 v[32:35], v[212:215], a[160:163], v[32:35]
  s_mov_b32 m0, 40960
  ds_read_b64_tr_b16 a[196:197], v237 offset:57344
  ds_read_b64_tr_b16 a[198:199], v237 offset:61440
  v_mul_f32 v192, s36, v192
  v_mul_f32 v193, s36, v193
  v_mfma_f32_16x16x32_bf16 v[36:39], v[212:215], a[164:167], v[36:39]
  buffer_load_dwordx4 v241, s[24:27], s38 offen offset:0 lds
  v_exp_f32 v192, v192
  v_mfma_f32_16x16x32_bf16 v[40:43], v[212:215], a[168:171], v[40:43]
  v_mul_f32 v194, s36, v194
  v_mul_f32 v195, s36, v195
  v_mfma_f32_16x16x32_bf16 v[44:47], v[212:215], a[172:175], v[44:47]
  buffer_load_dwordx4 v241, s[24:27], s38 offen offset:1024 lds
  v_exp_f32 v193, v193
  v_mfma_f32_16x16x32_bf16 v[48:51], v[212:215], a[176:179], v[48:51]
  ds_read_b64_tr_b16 a[200:201], v234 offset:57344
  ds_read_b64_tr_b16 a[202:203], v234 offset:61440
  v_mfma_f32_16x16x32_bf16 v[52:55], v[212:215], a[180:183], v[52:55]
  buffer_load_dwordx4 v241, s[24:27], s38 offen offset:2048 lds
  v_exp_f32 v194, v194
  v_mfma_f32_16x16x32_bf16 v[56:59], v[212:215], a[184:187], v[56:59]
  v_cvt_pk_bf16_f32 v208, v192, v193
  v_mul_f32 v196, s36, v196
  v_mfma_f32_16x16x32_bf16 v[60:63], v[212:215], a[188:191], v[60:63]
  buffer_load_dwordx4 v241, s[24:27], s38 offen offset:3072 lds
  v_exp_f32 v195, v195
  v_mfma_f32_16x16x32_bf16 a[228:231], a[248:251], v[212:215], a[228:231]
  s_add_u32 s38, s38, 4096
  v_mul_f32 v197, s36, v197
  v_mul_f32 v198, s36, v198
  v_mfma_f32_16x16x32_bf16 v[200:203], a[96:99], a[48:51], v[252:255]
  s_mov_b32 m0, 45056
  v_exp_f32 v196, v196
  v_mfma_f32_16x16x32_bf16 v[200:203], a[100:103], a[52:55], v[200:203]
  buffer_load_dwordx4 v241, s[24:27], s38 offen offset:0 lds
  v_cvt_pk_bf16_f32 v209, v194, v195
  v_mul_f32 v199, s36, v199
  v_mfma_f32_16x16x32_bf16 v[200:203], a[104:107], a[56:59], v[200:203]
  v_exp_f32 v197, v197
  v_mfma_f32_16x16x32_bf16 v[200:203], a[108:111], a[60:63], v[200:203]
  buffer_load_dwordx4 v241, s[24:27], s38 offen offset:1024 lds
  v_exp_f32 v198, v198
  v_mfma_f32_16x16x32_bf16 v[204:207], a[112:115], a[48:51], v[252:255]
  ds_read_b64_tr_b16 a[204:205], v228 offset:57344
  ds_read_b64_tr_b16 a[206:207], v228 offset:61440
  v_mfma_f32_16x16x32_bf16 v[204:207], a[116:119], a[52:55], v[204:207]
  buffer_load_dwordx4 v241, s[24:27], s38 offen offset:2048 lds
  v_exp_f32 v199, v199
  v_mfma_f32_16x16x32_bf16 v[204:207], a[120:123], a[56:59], v[204:207]
  v_cvt_pk_bf16_f32 v210, v196, v197
  v_cvt_pk_bf16_f32 v211, v198, v199
  v_mfma_f32_16x16x32_bf16 v[204:207], a[124:127], a[60:63], v[204:207]
  buffer_load_dwordx4 v241, s[24:27], s38 offen offset:3072 lds
  v_mfma_f32_16x16x32_bf16 v[64:67], v[208:211], a[160:163], v[64:67]
  s_add_u32 s38, s38, 4096
  ds_read_b64_tr_b16 a[208:209], v226 offset:57352
  ds_read_b64_tr_b16 a[210:211], v226 offset:61448
  v_mul_f32 v200, s36, v200
  v_mul_f32 v201, s36, v201
  v_mfma_f32_16x16x32_bf16 v[68:71], v[208:211], a[164:167], v[68:71]
  buffer_load_dword v236, v235, s[20:23], s72 offen
  v_exp_f32 v200, v200
  v_mfma_f32_16x16x32_bf16 v[72:75], v[208:211], a[168:171], v[72:75]
  s_add_u32 s72, s72, 16384
  v_mul_f32 v202, s36, v202
  v_mul_f32 v203, s36, v203
  v_mfma_f32_16x16x32_bf16 v[76:79], v[208:211], a[172:175], v[76:79]
  global_load_dword v236, v[246:247], off
  v_exp_f32 v201, v201
  v_mfma_f32_16x16x32_bf16 v[80:83], v[208:211], a[176:179], v[80:83]
  ds_read_b64_tr_b16 a[212:213], v237 offset:57352
  ds_read_b64_tr_b16 a[214:215], v237 offset:61448
  v_mfma_f32_16x16x32_bf16 v[84:87], v[208:211], a[180:183], v[84:87]
  v_exp_f32 v202, v202
  v_mfma_f32_16x16x32_bf16 v[88:91], v[208:211], a[184:187], v[88:91]
  v_cvt_pk_bf16_f32 v212, v200, v201
  v_mul_f32 v204, s36, v204
  v_mfma_f32_16x16x32_bf16 v[92:95], v[208:211], a[188:191], v[92:95]
  v_exp_f32 v203, v203
  v_mfma_f32_16x16x32_bf16 a[232:235], a[248:251], v[208:211], a[232:235]
  v_mul_f32 v205, s36, v205
  v_mul_f32 v206, s36, v206
  v_mfma_f32_16x16x32_bf16 v[192:195], a[96:99], a[64:67], v[252:255]
  v_exp_f32 v204, v204
  v_mfma_f32_16x16x32_bf16 v[192:195], a[100:103], a[68:71], v[192:195]
  v_cvt_pk_bf16_f32 v213, v202, v203
  v_mul_f32 v207, s36, v207
  v_mfma_f32_16x16x32_bf16 v[192:195], a[104:107], a[72:75], v[192:195]
  v_exp_f32 v205, v205
  v_mfma_f32_16x16x32_bf16 v[192:195], a[108:111], a[76:79], v[192:195]
  v_exp_f32 v206, v206
  v_mfma_f32_16x16x32_bf16 v[196:199], a[112:115], a[64:67], v[252:255]
  ds_read_b64_tr_b16 a[216:217], v234 offset:57352
  ds_read_b64_tr_b16 a[218:219], v234 offset:61448
  v_mfma_f32_16x16x32_bf16 v[196:199], a[116:119], a[68:71], v[196:199]
  v_exp_f32 v207, v207
  v_mfma_f32_16x16x32_bf16 v[196:199], a[120:123], a[72:75], v[196:199]
  v_cvt_pk_bf16_f32 v214, v204, v205
  v_cvt_pk_bf16_f32 v215, v206, v207
  v_mfma_f32_16x16x32_bf16 v[196:199], a[124:127], a[76:79], v[196:199]
  s_waitcnt vmcnt(38)
  ds_add_u32 v245, v243
  v_mfma_f32_16x16x32_bf16 v[96:99], v[212:215], a[160:163], v[96:99]
  v_mul_f32 v192, s36, v192
  v_mul_f32 v193, s36, v193
  v_mfma_f32_16x16x32_bf16 v[100:103], v[212:215], a[164:167], v[100:103]
  v_exp_f32 v192, v192
  v_mfma_f32_16x16x32_bf16 v[104:107], v[212:215], a[168:171], v[104:107]
  v_mul_f32 v194, s36, v194
  v_mul_f32 v195, s36, v195
  v_mfma_f32_16x16x32_bf16 v[108:111], v[212:215], a[172:175], v[108:111]
  v_exp_f32 v193, v193
  v_mfma_f32_16x16x32_bf16 v[112:115], v[212:215], a[176:179], v[112:115]
  ds_read_b64_tr_b16 a[220:221], v228 offset:57352
  ds_read_b64_tr_b16 a[222:223], v228 offset:61448
  v_mfma_f32_16x16x32_bf16 v[116:119], v[212:215], a[180:183], v[116:119]
  v_exp_f32 v194, v194
  v_mfma_f32_16x16x32_bf16 v[120:123], v[212:215], a[184:187], v[120:123]
  s_waitcnt lgkmcnt(15)
  v_cvt_pk_bf16_f32 v208, v192, v193
  v_mul_f32 v196, s36, v196
  v_mfma_f32_16x16x32_bf16 v[124:127], v[212:215], a[188:191], v[124:127]
  v_exp_f32 v195, v195
  v_mfma_f32_16x16x32_bf16 a[236:239], a[248:251], v[212:215], a[236:239]
  v_mul_f32 v197, s36, v197
  v_mul_f32 v198, s36, v198
  v_mfma_f32_16x16x32_bf16 v[200:203], a[128:131], a[0:3], v[252:255]
  v_exp_f32 v196, v196
  v_mfma_f32_16x16x32_bf16 v[200:203], a[132:135], a[4:7], v[200:203]
  v_cvt_pk_bf16_f32 v209, v194, v195
  v_mul_f32 v199, s36, v199
  v_mfma_f32_16x16x32_bf16 v[200:203], a[136:139], a[8:11], v[200:203]
  v_exp_f32 v197, v197
  v_mfma_f32_16x16x32_bf16 v[200:203], a[140:143], a[12:15], v[200:203]
  v_exp_f32 v198, v198
  v_mfma_f32_16x16x32_bf16 v[204:207], a[144:147], a[0:3], v[252:255]
  ds_read_b128 a[96:99], v224 offset:0
  ds_read_b128 a[100:103], v224 offset:256
  v_mfma_f32_16x16x32_bf16 v[204:207], a[148:151], a[4:7], v[204:207]
  v_exp_f32 v199, v199
  v_mfma_f32_16x16x32_bf16 v[204:207], a[152:155], a[8:11], v[204:207]
  v_cvt_pk_bf16_f32 v210, v196, v197
  v_cvt_pk_bf16_f32 v211, v198, v199
  v_mfma_f32_16x16x32_bf16 v[204:207], a[156:159], a[12:15], v[204:207]
  ds_read_b64_tr_b16 v[216:217], v231 offset:3072
  ds_read_b64_tr_b16 v[218:219], v231 offset:3080
  ds_read_b64_tr_b16 v[220:221], v231 offset:4096
  ds_read_b64_tr_b16 v[222:223], v231 offset:4104
  ds_read_b64_tr_b16 a[244:245], v231 offset:5120
  ds_read_b64_tr_b16 a[246:247], v231 offset:5128
  ds_read_b32 v244, v242
  v_mfma_f32_16x16x32_bf16 v[128:131], v[208:211], a[160:163], v[128:131]
  v_mul_f32 v200, s36, v200
  v_mul_f32 v201, s36, v201
  v_mfma_f32_16x16x32_bf16 v[132:135], v[208:211], a[164:167], v[132:135]
  v_exp_f32 v200, v200
  v_mfma_f32_16x16x32_bf16 v[136:139], v[208:211], a[168:171], v[136:139]
  v_mul_f32 v202, s36, v202
  v_mul_f32 v203, s36, v203
  v_mfma_f32_16x16x32_bf16 v[140:143], v[208:211], a[172:175], v[140:143]
  v_exp_f32 v201, v201
  v_mfma_f32_16x16x32_bf16 v[144:147], v[208:211], a[176:179], v[144:147]
  ds_read_b128 a[104:107], v224 offset:512
  ds_read_b128 a[108:111], v224 offset:768
  v_mfma_f32_16x16x32_bf16 v[148:151], v[208:211], a[180:183], v[148:151]
  s_waitcnt lgkmcnt(2)
  v_exp_f32 v202, v202
  v_cmp_gt_u32 vcc, s58, v244
  v_mfma_f32_16x16x32_bf16 v[152:155], v[208:211], a[184:187], v[152:155]
  v_cvt_pk_bf16_f32 v212, v200, v201
  v_mul_f32 v204, s36, v204
  v_mfma_f32_16x16x32_bf16 v[156:159], v[208:211], a[188:191], v[156:159]
  s_cbranch_vccnz L_s5_C3
L_r5_C3:
  v_exp_f32 v203, v203
  v_mfma_f32_16x16x32_bf16 a[240:243], a[248:251], v[208:211], a[240:243]
  s_add_u32 s58, s58, 1
  v_mul_f32 v205, s36, v205
  v_mul_f32 v206, s36, v206
  v_mfma_f32_16x16x32_bf16 v[192:195], a[128:131], a[16:19], v[252:255]
  buffer_store_dwordx4 v[216:219], v232, s[28:31], s42 offen offset:768 nt
  v_exp_f32 v204, v204
  v_mfma_f32_16x16x32_bf16 v[192:195], a[132:135], a[20:23], v[192:195]
  s_add_u32 s42, s42, 4096
  v_cvt_pk_bf16_f32 v213, v202, v203
  v_mul_f32 v207, s36, v207
  v_mfma_f32_16x16x32_bf16 v[192:195], a[136:139], a[24:27], v[192:195]
  buffer_store_dwordx4 v[220:223], v232, s[28:31], s42 offen offset:0 nt
  v_exp_f32 v205, v205
  v_mfma_f32_16x16x32_bf16 v[192:195], a[140:143], a[28:31], v[192:195]
  v_exp_f32 v206, v206
  v_mfma_f32_16x16x32_bf16 v[196:199], a[144:147], a[16:19], v[252:255]
  ds_read_b128 a[112:115], v224 offset:4096
  ds_read_b128 a[116:119], v224 offset:4352
  v_mfma_f32_16x16x32_bf16 v[196:199], a[148:151], a[20:23], v[196:199]
  buffer_store_dwordx4 a[244:247], v232, s[28:31], s42 offen offset:256 nt
  v_exp_f32 v207, v207
  v_mfma_f32_16x16x32_bf16 v[196:199], a[152:155], a[24:27], v[196:199]
  s_mov_b32 m0, 49152
  v_cvt_pk_bf16_f32 v214, v204, v205
  v_cvt_pk_bf16_f32 v215, v206, v207
  v_mfma_f32_16x16x32_bf16 v[196:199], a[156:159], a[28:31], v[196:199]
  buffer_load_dwordx4 v229, s[20:23], s37 offen offset:0 lds
  v_mfma_f32_16x16x32_bf16 v[0:3], v[212:215], a[192:195], v[0:3]
  v_mul_f32 v192, s36, v192
  v_mul_f32 v193, s36, v193
  v_mfma_f32_16x16x32_bf16 v[4:7], v[212:215], a[196:199], v[4:7]
  buffer_load_dwordx4 v229, s[20:23], s37 offen offset:1024 lds
  v_exp_f32 v192, v192
  v_mfma_f32_16x16x32_bf16 v[8:11], v[212:215], a[200:203], v[8:11]
  v_mul_f32 v194, s36, v194
  v_mul_f32 v195, s36, v195
  v_mfma_f32_16x16x32_bf16 v[12:15], v[212:215], a[204:207], v[12:15]
  buffer_load_dwordx4 v230, s[20:23], s37 offen offset:2048 lds
  v_exp_f32 v193, v193
  v_mfma_f32_16x16x32_bf16 v[16:19], v[212:215], a[208:211], v[16:19]
  ds_read_b128 a[120:123], v224 offset:4608
  ds_read_b128 a[124:127], v224 offset:4864
  v_mfma_f32_16x16x32_bf16 v[20:23], v[212:215], a[212:215], v[20:23]
  buffer_load_dwordx4 v230, s[20:23], s37 offen offset:3072 lds
  v_exp_f32 v194, v194
  v_mfma_f32_16x16x32_bf16 v[24:27], v[212:215], a[216:219], v[24:27]
  s_add_u32 s37, s37, 4096
  v_cvt_pk_bf16_f32 v208, v192, v193
  v_mul_f32 v196, s36, v196
  v_mfma_f32_16x16x32_bf16 v[28:31], v[212:215], a[220:223], v[28:31]
  s_mov_b32 m0, 53248
  v_exp_f32 v195, v195
  v_mfma_f32_16x16x32_bf16 a[224:227], a[248:251], v[212:215], a[224:227]
  buffer_load_dwordx4 v229, s[20:23], s37 offen offset:0 lds
  v_mul_f32 v197, s36, v197
  v_mul_f32 v198, s36, v198
  v_mfma_f32_16x16x32_bf16 v[200:203], a[128:131], a[32:35], v[252:255]
  v_exp_f32 v196, v196
  v_mfma_f32_16x16x32_bf16 v[200:203], a[132:135], a[36:39], v[200:203]
  buffer_load_dwordx4 v229, s[20:23], s37 offen offset:1024 lds
  v_cvt_pk_bf16_f32 v209, v194, v195
  v_mul_f32 v199, s36, v199
  v_mfma_f32_16x16x32_bf16 v[200:203], a[136:139], a[40:43], v[200:203]
  v_exp_f32 v197, v197
  v_mfma_f32_16x16x32_bf16 v[200:203], a[140:143], a[44:47], v[200:203]
  buffer_load_dwordx4 v230, s[20:23], s37 offen offset:2048 lds
  v_exp_f32 v198, v198
  v_mfma_f32_16x16x32_bf16 v[204:207], a[144:147], a[32:35], v[252:255]
  ds_read_b64_tr_b16 a[160:161], v226 offset:8192
  ds_read_b64_tr_b16 a[162:163], v226 offset:12288
  v_mfma_f32_16x16x32_bf16 v[204:207], a[148:151], a[36:39], v[204:207]
  buffer_load_dwordx4 v230, s[20:23], s37 offen offset:3072 lds
  v_exp_f32 v199, v199
  v_mfma_f32_16x16x32_bf16 v[204:207], a[152:155], a[40:43], v[204:207]
  s_add_u32 s37, s37, 4096
  v_cvt_pk_bf16_f32 v210, v196, v197
  v_cvt_pk_bf16_f32 v211, v198, v199
  v_mfma_f32_16x16x32_bf16 v[204:207], a[156:159], a[44:47], v[204:207]
  s_nop 0
  v_mfma_f32_16x16x32_bf16 v[32:35], v[208:211], a[192:195], v[32:35]
  s_mov_b32 m0, 57344
  ds_read_b64_tr_b16 a[164:165], v237 offset:8192
  ds_read_b64_tr_b16 a[166:167], v237 offset:12288
  v_mul_f32 v200, s36, v200
  v_mul_f32 v201, s36, v201
  v_mfma_f32_16x16x32_bf16 v[36:39], v[208:211], a[196:199], v[36:39]
  buffer_load_dwordx4 v241, s[24:27], s38 offen offset:0 lds
  v_exp_f32 v200, v200
  v_mfma_f32_16x16x32_bf16 v[40:43], v[208:211], a[200:203], v[40:43]
  v_mul_f32 v202, s36, v202
  v_mul_f32 v203, s36, v203
  v_mfma_f32_16x16x32_bf16 v[44:47], v[208:211], a[204:207], v[44:47]
  buffer_load_dwordx4 v241, s[24:27], s38 offen offset:1024 lds
  v_exp_f32 v201, v201
  v_mfma_f32_16x16x32_bf16 v[48:51], v[208:211], a[208:211], v[48:51]
  ds_read_b64_tr_b16 a[168:169], v234 offset:8192
  ds_read_b64_tr_b16 a[170:171], v234 offset:12288
  v_mfma_f32_16x16x32_bf16 v[52:55], v[208:211], a[212:215], v[52:55]
  buffer_load_dwordx4 v241, s[24:27], s38 offen offset:2048 lds
  v_exp_f32 v202, v202
  v_mfma_f32_16x16x32_bf16 v[56:59], v[208:211], a[216:219], v[56:59]
  v_cvt_pk_bf16_f32 v212, v200, v201
  v_mul_f32 v204, s36, v204
  v_mfma_f32_16x16x32_bf16 v[60:63], v[208:211], a[220:223], v[60:63]
  buffer_load_dwordx4 v241, s[24:27], s38 offen offset:3072 lds
  v_exp_f32 v203, v203
  v_mfma_f32_16x16x32_bf16 a[228:231], a[248:251], v[208:211], a[228:231]
  s_add_u32 s38, s38, 4096
  v_mul_f32 v205, s36, v205
  v_mul_f32 v206, s36, v206
  v_mfma_f32_16x16x32_bf16 v[192:195], a[128:131], a[48:51], v[252:255]
  s_mov_b32 m0, 61440
  v_exp_f32 v204, v204
  v_mfma_f32_16x16x32_bf16 v[192:195], a[132:135], a[52:55], v[192:195]
  buffer_load_dwordx4 v241, s[24:27], s38 offen offset:0 lds
  v_cvt_pk_bf16_f32 v213, v202, v203
  v_mul_f32 v207, s36, v207
  v_mfma_f32_16x16x32_bf16 v[192:195], a[136:139], a[56:59], v[192:195]
  v_exp_f32 v205, v205
  v_mfma_f32_16x16x32_bf16 v[192:195], a[140:143], a[60:63], v[192:195]
  buffer_load_dwordx4 v241, s[24:27], s38 offen offset:1024 lds
  v_exp_f32 v206, v206
  v_mfma_f32_16x16x32_bf16 v[196:199], a[144:147], a[48:51], v[252:255]
  ds_read_b64_tr_b16 a[172:173], v228 offset:8192
  ds_read_b64_tr_b16 a[174:175], v228 offset:12288
  v_mfma_f32_16x16x32_bf16 v[196:199], a[148:151], a[52:55], v[196:199]
  buffer_load_dwordx4 v241, s[24:27], s38 offen offset:2048 lds
  v_exp_f32 v207, v207
  v_mfma_f32_16x16x32_bf16 v[196:199], a[152:155], a[56:59], v[196:199]
  v_cvt_pk_bf16_f32 v214, v204, v205
  v_cvt_pk_bf16_f32 v215, v206, v207
  v_mfma_f32_16x16x32_bf16 v[196:199], a[156:159], a[60:63], v[196:199]
  buffer_load_dwordx4 v241, s[24:27], s38 offen offset:3072 lds
  v_mfma_f32_16x16x32_bf16 v[64:67], v[212:215], a[192:195], v[64:67]
  s_add_u32 s38, s38, 4096
  ds_read_b64_tr_b16 a[176:177], v226 offset:8200
  ds_read_b64_tr_b16 a[178:179], v226 offset:12296
  v_mul_f32 v192, s36, v192
  v_mul_f32 v193, s36, v193
  v_mfma_f32_16x16x32_bf16 v[68:71], v[212:215], a[196:199], v[68:71]
  buffer_load_dword v236, v235, s[20:23], s72 offen
  v_exp_f32 v192, v192
  v_mfma_f32_16x16x32_bf16 v[72:75], v[212:215], a[200:203], v[72:75]
  s_add_u32 s72, s72, 16384
  v_mul_f32 v194, s36, v194
  v_mul_f32 v195, s36, v195
  v_mfma_f32_16x16x32_bf16 v[76:79], v[212:215], a[204:207], v[76:79]
  v_exp_f32 v193, v193
  v_mfma_f32_16x16x32_bf16 v[80:83], v[212:215], a[208:211], v[80:83]
  ds_read_b64_tr_b16 a[180:181], v237 offset:8200
  ds_read_b64_tr_b16 a[182:183], v237 offset:12296
  v_mfma_f32_16x16x32_bf16 v[84:87], v[212:215], a[212:215], v[84:87]
  v_exp_f32 v194, v194
  v_mfma_f32_16x16x32_bf16 v[88:91], v[212:215], a[216:219], v[88:91]
  v_cvt_pk_bf16_f32 v208, v192, v193
  v_mul_f32 v196, s36, v196
  v_mfma_f32_16x16x32_bf16 v[92:95], v[212:215], a[220:223], v[92:95]
  v_exp_f32 v195, v195
  v_mfma_f32_16x16x32_bf16 a[232:235], a[248:251], v[212:215], a[232:235]
  v_mul_f32 v197, s36, v197
  v_mul_f32 v198, s36, v198
  v_mfma_f32_16x16x32_bf16 v[200:203], a[128:131], a[64:67], v[252:255]
  v_exp_f32 v196, v196
  v_mfma_f32_16x16x32_bf16 v[200:203], a[132:135], a[68:71], v[200:203]
  v_cvt_pk_bf16_f32 v209, v194, v195
  v_mul_f32 v199, s36, v199
  v_mfma_f32_16x16x32_bf16 v[200:203], a[136:139], a[72:75], v[200:203]
  v_exp_f32 v197, v197
  v_mfma_f32_16x16x32_bf16 v[200:203], a[140:143], a[76:79], v[200:203]
  v_exp_f32 v198, v198
  v_mfma_f32_16x16x32_bf16 v[204:207], a[144:147], a[64:67], v[252:255]
  ds_read_b64_tr_b16 a[184:185], v234 offset:8200
  ds_read_b64_tr_b16 a[186:187], v234 offset:12296
  v_mfma_f32_16x16x32_bf16 v[204:207], a[148:151], a[68:71], v[204:207]
  v_exp_f32 v199, v199
  v_mfma_f32_16x16x32_bf16 v[204:207], a[152:155], a[72:75], v[204:207]
  v_cvt_pk_bf16_f32 v210, v196, v197
  v_cvt_pk_bf16_f32 v211, v198, v199
  v_mfma_f32_16x16x32_bf16 v[204:207], a[156:159], a[76:79], v[204:207]
  s_waitcnt vmcnt(41)
  ds_add_u32 v245, v243
  v_mfma_f32_16x16x32_bf16 v[96:99], v[208:211], a[192:195], v[96:99]
  v_mul_f32 v200, s36, v200
  v_mul_f32 v201, s36, v201
  v_mfma_f32_16x16x32_bf16 v[100:103], v[208:211], a[196:199], v[100:103]
  v_exp_f32 v200, v200
  v_mfma_f32_16x16x32_bf16 v[104:107], v[208:211], a[200:203], v[104:107]
  v_mul_f32 v202, s36, v202
  v_mul_f32 v203, s36, v203
  v_mfma_f32_16x16x32_bf16 v[108:111], v[208:211], a[204:207], v[108:111]
  v_exp_f32 v201, v201
  v_mfma_f32_16x16x32_bf16 v[112:115], v[208:211], a[208:211], v[112:115]
  ds_read_b64_tr_b16 a[188:189], v228 offset:8200
  ds_read_b64_tr_b16 a[190:191], v228 offset:12296
  v_mfma_f32_16x16x32_bf16 v[116:119], v[208:211], a[212:215], v[116:119]
  v_exp_f32 v202, v202
  v_mfma_f32_16x16x32_bf16 v[120:123], v[208:211], a[216:219], v[120:123]
  s_waitcnt lgkmcnt(15)
  v_cvt_pk_bf16_f32 v212, v200, v201
  v_mul_f32 v204, s36, v204
  v_mfma_f32_16x16x32_bf16 v[124:127], v[208:211], a[220:223], v[124:127]
  v_exp_f32 v203, v203
  v_mfma_f32_16x16x32_bf16 a[236:239], a[248:251], v[208:211], a[236:239]
  v_mul_f32 v205, s36, v205
  v_mul_f32 v206, s36, v206
  v_mfma_f32_16x16x32_bf16 v[192:195], a[96:99], a[0:3], v[252:255]
  v_exp_f32 v204, v204
  v_mfma_f32_16x16x32_bf16 v[192:195], a[100:103], a[4:7], v[192:195]
  v_cvt_pk_bf16_f32 v213, v202, v203
  v_mul_f32 v207, s36, v207
  v_mfma_f32_16x16x32_bf16 v[192:195], a[104:107], a[8:11], v[192:195]
  v_exp_f32 v205, v205
  v_mfma_f32_16x16x32_bf16 v[192:195], a[108:111], a[12:15], v[192:195]
  v_exp_f32 v206, v206
  v_mfma_f32_16x16x32_bf16 v[196:199], a[112:115], a[0:3], v[252:255]
  ds_read_b128 a[128:131], v224 offset:16384
  ds_read_b128 a[132:135], v224 offset:16640
  v_mfma_f32_16x16x32_bf16 v[196:199], a[116:119], a[4:7], v[196:199]
  v_exp_f32 v207, v207
  v_mfma_f32_16x16x32_bf16 v[196:199], a[120:123], a[8:11], v[196:199]
  v_cvt_pk_bf16_f32 v214, v204, v205
  v_cvt_pk_bf16_f32 v215, v206, v207
  v_mfma_f32_16x16x32_bf16 v[196:199], a[124:127], a[12:15], v[196:199]
  ds_read_b64_tr_b16 v[216:217], v231 offset:6144
  ds_read_b64_tr_b16 v[218:219], v231 offset:6152
  ds_read_b64_tr_b16 v[220:221], v231 offset:7168
  ds_read_b64_tr_b16 v[222:223], v231 offset:7176
  ds_read_b64_tr_b16 a[244:245], v231 offset:8192
  ds_read_b64_tr_b16 a[246:247], v231 offset:8200
  ds_read_b32 v244, v242
  v_mfma_f32_16x16x32_bf16 v[128:131], v[212:215], a[192:195], v[128:131]
  v_mul_f32 v192, s36, v192
  v_mul_f32 v193, s36, v193
  v_mfma_f32_16x16x32_bf16 v[132:135], v[212:215], a[196:199], v[132:135]
  v_exp_f32 v192, v192
  v_mfma_f32_16x16x32_bf16 v[136:139], v[212:215], a[200:203], v[136:139]
  v_mul_f32 v194, s36, v194
  v_mul_f32 v195, s36, v195
  v_mfma_f32_16x16x32_bf16 v[140:143], v[212:215], a[204:207], v[140:143]
  v_exp_f32 v193, v193
  v_mfma_f32_16x16x32_bf16 v[144:147], v[212:215], a[208:211], v[144:147]
  ds_read_b128 a[136:139], v224 offset:16896
  ds_read_b128 a[140:143], v224 offset:17152
  v_mfma_f32_16x16x32_bf16 v[148:151], v[212:215], a[212:215], v[148:151]
  s_waitcnt lgkmcnt(2)
  v_exp_f32 v194, v194
  v_cmp_gt_u32 vcc, s58, v244
  v_mfma_f32_16x16x32_bf16 v[152:155], v[212:215], a[216:219], v[152:155]
  v_cvt_pk_bf16_f32 v208, v192, v193
  v_mul_f32 v196, s36, v196
  v_mfma_f32_16x16x32_bf16 v[156:159], v[212:215], a[220:223], v[156:159]
  s_cbranch_vccnz L_s5_C4
L_r5_C4:
  v_exp_f32 v195, v195
  v_mfma_f32_16x16x32_bf16 a[240:243], a[248:251], v[212:215], a[240:243]
  s_add_u32 s58, s58, 1
  v_mul_f32 v197, s36, v197
  v_mul_f32 v198, s36, v198
  v_mfma_f32_16x16x32_bf16 v[200:203], a[96:99], a[16:19], v[252:255]
  buffer_store_dwordx4 v[216:219], v232, s[28:31], s42 offen offset:512 nt
  v_exp_f32 v196, v196
  v_mfma_f32_16x16x32_bf16 v[200:203], a[100:103], a[20:23], v[200:203]
  v_cvt_pk_bf16_f32 v209, v194, v195
  v_mul_f32 v199, s36, v199
  v_mfma_f32_16x16x32_bf16 v[200:203], a[104:107], a[24:27], v[200:203]
  buffer_store_dwordx4 v[220:223], v232, s[28:31], s42 offen offset:768 nt
  v_exp_f32 v197, v197
  v_mfma_f32_16x16x32_bf16 v[200:203], a[108:111], a[28:31], v[200:203]
  s_add_u32 s42, s42, 4096
  v_exp_f32 v198, v198
  v_mfma_f32_16x16x32_bf16 v[204:207], a[112:115], a[16:19], v[252:255]
  ds_read_b128 a[144:147], v224 offset:20480
  ds_read_b128 a[148:151], v224 offset:20736
  v_mfma_f32_16x16x32_bf16 v[204:207], a[116:119], a[20:23], v[204:207]
  buffer_store_dwordx4 a[244:247], v232, s[28:31], s42 offen offset:0 nt
  v_exp_f32 v199, v199
  v_mfma_f32_16x16x32_bf16 v[204:207], a[120:123], a[24:27], v[204:207]
  s_mov_b32 m0, 0
  v_cvt_pk_bf16_f32 v210, v196, v197
  v_cvt_pk_bf16_f32 v211, v198, v199
  v_mfma_f32_16x16x32_bf16 v[204:207], a[124:127], a[28:31], v[204:207]
  buffer_load_dwordx4 v229, s[20:23], s37 offen offset:0 lds
  v_mfma_f32_16x16x32_bf16 v[0:3], v[208:211], a[160:163], v[0:3]
  v_mul_f32 v200, s36, v200
  v_mul_f32 v201, s36, v201
  v_mfma_f32_16x16x32_bf16 v[4:7], v[208:211], a[164:167], v[4:7]
  buffer_load_dwordx4 v229, s[20:23], s37 offen offset:1024 lds
  v_exp_f32 v200, v200
  v_mfma_f32_16x16x32_bf16 v[8:11], v[208:211], a[168:171], v[8:11]
  v_mul_f32 v202, s36, v202
  v_mul_f32 v203, s36, v203
  v_mfma_f32_16x16x32_bf16 v[12:15], v[208:211], a[172:175], v[12:15]
  buffer_load_dwordx4 v230, s[20:23], s37 offen offset:2048 lds
  v_exp_f32 v201, v201
  v_mfma_f32_16x16x32_bf16 v[16:19], v[208:211], a[176:179], v[16:19]
  ds_read_b128 a[152:155], v224 offset:20992
  ds_read_b128 a[156:159], v224 offset:21248
  v_mfma_f32_16x16x32_bf16 v[20:23], v[208:211], a[180:183], v[20:23]
  buffer_load_dwordx4 v230, s[20:23], s37 offen offset:3072 lds
  v_exp_f32 v202, v202
  v_mfma_f32_16x16x32_bf16 v[24:27], v[208:211], a[184:187], v[24:27]
  s_add_u32 s37, s37, 4096
  v_cvt_pk_bf16_f32 v212, v200, v201
  v_mul_f32 v204, s36, v204
  v_mfma_f32_16x16x32_bf16 v[28:31], v[208:211], a[188:191], v[28:31]
  s_mov_b32 m0, 4096
  v_exp_f32 v203, v203
  v_mfma_f32_16x16x32_bf16 a[224:227], a[248:251], v[208:211], a[224:227]
  buffer_load_dwordx4 v229, s[20:23], s37 offen offset:0 lds
  v_mul_f32 v205, s36, v205
  v_mul_f32 v206, s36, v206
  v_mfma_f32_16x16x32_bf16 v[192:195], a[96:99], a[32:35], v[252:255]
  v_exp_f32 v204, v204
  v_mfma_f32_16x16x32_bf16 v[192:195], a[100:103], a[36:39], v[192:195]
  buffer_load_dwordx4 v229, s[20:23], s37 offen offset:1024 lds
  v_cvt_pk_bf16_f32 v213, v202, v203
  v_mul_f32 v207, s36, v207
  v_mfma_f32_16x16x32_bf16 v[192:195], a[104:107], a[40:43], v[192:195]
  v_exp_f32 v205, v205
  v_mfma_f32_16x16x32_bf16 v[192:195], a[108:111], a[44:47], v[192:195]
  buffer_load_dwordx4 v230, s[20:23], s37 offen offset:2048 lds
  v_exp_f32 v206, v206
  v_mfma_f32_16x16x32_bf16 v[196:199], a[112:115], a[32:35], v[252:255]
  ds_read_b64_tr_b16 a[192:193], v226 offset:24576
  ds_read_b64_tr_b16 a[194:195], v226 offset:28672
  v_mfma_f32_16x16x32_bf16 v[196:199], a[116:119], a[36:39], v[196:199]
  buffer_load_dwordx4 v230, s[20:23], s37 offen offset:3072 lds
  v_exp_f32 v207, v207
  v_mfma_f32_16x16x32_bf16 v[196:199], a[120:123], a[40:43], v[196:199]
  s_add_u32 s37, s37, 4096
  v_cvt_pk_bf16_f32 v214, v204, v205
  v_cvt_pk_bf16_f32 v215, v206, v207
  v_mfma_f32_16x16x32_bf16 v[196:199], a[124:127], a[44:47], v[196:199]
  s_nop 0
  v_mfma_f32_16x16x32_bf16 v[32:35], v[212:215], a[160:163], v[32:35]
  s_mov_b32 m0, 8192
  ds_read_b64_tr_b16 a[196:197], v237 offset:24576
  ds_read_b64_tr_b16 a[198:199], v237 offset:28672
  v_mul_f32 v192, s36, v192
  v_mul_f32 v193, s36, v193
  v_mfma_f32_16x16x32_bf16 v[36:39], v[212:215], a[164:167], v[36:39]
  buffer_load_dwordx4 v241, s[24:27], s38 offen offset:0 lds
  v_exp_f32 v192, v192
  v_mfma_f32_16x16x32_bf16 v[40:43], v[212:215], a[168:171], v[40:43]
  v_mul_f32 v194, s36, v194
  v_mul_f32 v195, s36, v195
  v_mfma_f32_16x16x32_bf16 v[44:47], v[212:215], a[172:175], v[44:47]
  buffer_load_dwordx4 v241, s[24:27], s38 offen offset:1024 lds
  v_exp_f32 v193, v193
  v_mfma_f32_16x16x32_bf16 v[48:51], v[212:215], a[176:179], v[48:51]
  ds_read_b64_tr_b16 a[200:201], v234 offset:24576
  ds_read_b64_tr_b16 a[202:203], v234 offset:28672
  v_mfma_f32_16x16x32_bf16 v[52:55], v[212:215], a[180:183], v[52:55]
  buffer_load_dwordx4 v241, s[24:27], s38 offen offset:2048 lds
  v_exp_f32 v194, v194
  v_mfma_f32_16x16x32_bf16 v[56:59], v[212:215], a[184:187], v[56:59]
  v_cvt_pk_bf16_f32 v208, v192, v193
  v_mul_f32 v196, s36, v196
  v_mfma_f32_16x16x32_bf16 v[60:63], v[212:215], a[188:191], v[60:63]
  buffer_load_dwordx4 v241, s[24:27], s38 offen offset:3072 lds
  v_exp_f32 v195, v195
  v_mfma_f32_16x16x32_bf16 a[228:231], a[248:251], v[212:215], a[228:231]
  s_add_u32 s38, s38, 4096
  v_mul_f32 v197, s36, v197
  v_mul_f32 v198, s36, v198
  v_mfma_f32_16x16x32_bf16 v[200:203], a[96:99], a[48:51], v[252:255]
  s_mov_b32 m0, 12288
  v_exp_f32 v196, v196
  v_mfma_f32_16x16x32_bf16 v[200:203], a[100:103], a[52:55], v[200:203]
  buffer_load_dwordx4 v241, s[24:27], s38 offen offset:0 lds
  v_cvt_pk_bf16_f32 v209, v194, v195
  v_mul_f32 v199, s36, v199
  v_mfma_f32_16x16x32_bf16 v[200:203], a[104:107], a[56:59], v[200:203]
  v_exp_f32 v197, v197
  v_mfma_f32_16x16x32_bf16 v[200:203], a[108:111], a[60:63], v[200:203]
  buffer_load_dwordx4 v241, s[24:27], s38 offen offset:1024 lds
  v_exp_f32 v198, v198
  v_mfma_f32_16x16x32_bf16 v[204:207], a[112:115], a[48:51], v[252:255]
  ds_read_b64_tr_b16 a[204:205], v228 offset:24576
  ds_read_b64_tr_b16 a[206:207], v228 offset:28672
  v_mfma_f32_16x16x32_bf16 v[204:207], a[116:119], a[52:55], v[204:207]
  buffer_load_dwordx4 v241, s[24:27], s38 offen offset:2048 lds
  v_exp_f32 v199, v199
  v_mfma_f32_16x16x32_bf16 v[204:207], a[120:123], a[56:59], v[204:207]
  v_cvt_pk_bf16_f32 v210, v196, v197
  v_cvt_pk_bf16_f32 v211, v198, v199
  v_mfma_f32_16x16x32_bf16 v[204:207], a[124:127], a[60:63], v[204:207]
  buffer_load_dwordx4 v241, s[24:27], s38 offen offset:3072 lds
  v_mfma_f32_16x16x32_bf16 v[64:67], v[208:211], a[160:163], v[64:67]
  s_add_u32 s38, s38, 4096
  ds_read_b64_tr_b16 a[208:209], v226 offset:24584
  ds_read_b64_tr_b16 a[210:211], v226 offset:28680
  v_mul_f32 v200, s36, v200
  v_mul_f32 v201, s36, v201
  v_mfma_f32_16x16x32_bf16 v[68:71], v[208:211], a[164:167], v[68:71]
  buffer_load_dword v236, v235, s[20:23], s72 offen
  v_exp_f32 v200, v200
  v_mfma_f32_16x16x32_bf16 v[72:75], v[208:211], a[168:171], v[72:75]
  s_add_u32 s72, s72, 16384
  v_mul_f32 v202, s36, v202
  v_mul_f32 v203, s36, v203
  v_mfma_f32_16x16x32_bf16 v[76:79], v[208:211], a[172:175], v[76:79]
  v_exp_f32 v201, v201
  v_mfma_f32_16x16x32_bf16 v[80:83], v[208:211], a[176:179], v[80:83]
  ds_read_b64_tr_b16 a[212:213], v237 offset:24584
  ds_read_b64_tr_b16 a[214:215], v237 offset:28680
  v_mfma_f32_16x16x32_bf16 v[84:87], v[208:211], a[180:183], v[84:87]
  v_exp_f32 v202, v202
  v_mfma_f32_16x16x32_bf16 v[88:91], v[208:211], a[184:187], v[88:91]
  v_cvt_pk_bf16_f32 v212, v200, v201
  v_mul_f32 v204, s36, v204
  v_mfma_f32_16x16x32_bf16 v[92:95], v[208:211], a[188:191], v[92:95]
  v_exp_f32 v203, v203
  v_mfma_f32_16x16x32_bf16 a[232:235], a[248:251], v[208:211], a[232:235]
  v_mul_f32 v205, s36, v205
  v_mul_f32 v206, s36, v206
  v_mfma_f32_16x16x32_bf16 v[192:195], a[96:99], a[64:67], v[252:255]
  v_exp_f32 v204, v204
  v_mfma_f32_16x16x32_bf16 v[192:195], a[100:103], a[68:71], v[192:195]
  v_cvt_pk_bf16_f32 v213, v202, v203
  v_mul_f32 v207, s36, v207
  v_mfma_f32_16x16x32_bf16 v[192:195], a[104:107], a[72:75], v[192:195]
  v_exp_f32 v205, v205
  v_mfma_f32_16x16x32_bf16 v[192:195], a[108:111], a[76:79], v[192:195]
  v_exp_f32 v206, v206
  v_mfma_f32_16x16x32_bf16 v[196:199], a[112:115], a[64:67], v[252:255]
  ds_read_b64_tr_b16 a[216:217], v234 offset:24584
  ds_read_b64_tr_b16 a[218:219], v234 offset:28680
  v_mfma_f32_16x16x32_bf16 v[196:199], a[116:119], a[68:71], v[196:199]
  v_exp_f32 v207, v207
  v_mfma_f32_16x16x32_bf16 v[196:199], a[120:123], a[72:75], v[196:199]
  v_cvt_pk_bf16_f32 v214, v204, v205
  v_cvt_pk_bf16_f32 v215, v206, v207
  v_mfma_f32_16x16x32_bf16 v[196:199], a[124:127], a[76:79], v[196:199]
  s_waitcnt vmcnt(42)
  ds_add_u32 v245, v243
  v_mfma_f32_16x16x32_bf16 v[96:99], v[212:215], a[160:163], v[96:99]
  v_mul_f32 v192, s36, v192
  v_mul_f32 v193, s36, v193
  v_mfma_f32_16x16x32_bf16 v[100:103], v[212:215], a[164:167], v[100:103]
  v_exp_f32 v192, v192
  v_mfma_f32_16x16x32_bf16 v[104:107], v[212:215], a[168:171], v[104:107]
  v_mul_f32 v194, s36, v194
  v_mul_f32 v195, s36, v195
  v_mfma_f32_16x16x32_bf16 v[108:111], v[212:215], a[172:175], v[108:111]
  v_exp_f32 v193, v193
  v_mfma_f32_16x16x32_bf16 v[112:115], v[212:215], a[176:179], v[112:115]
  ds_read_b64_tr_b16 a[220:221], v228 offset:24584
  ds_read_b64_tr_b16 a[222:223], v228 offset:28680
  v_mfma_f32_16x16x32_bf16 v[116:119], v[212:215], a[180:183], v[116:119]
  v_exp_f32 v194, v194
  v_mfma_f32_16x16x32_bf16 v[120:123], v[212:215], a[184:187], v[120:123]
  s_waitcnt lgkmcnt(15)
  v_cvt_pk_bf16_f32 v208, v192, v193
  v_mul_f32 v196, s36, v196
  v_mfma_f32_16x16x32_bf16 v[124:127], v[212:215], a[188:191], v[124:127]
  v_exp_f32 v195, v195
  v_mfma_f32_16x16x32_bf16 a[236:239], a[248:251], v[212:215], a[236:239]
  v_mul_f32 v197, s36, v197
  v_mul_f32 v198, s36, v198
  v_mfma_f32_16x16x32_bf16 v[200:203], a[128:131], a[0:3], v[252:255]
  v_exp_f32 v196, v196
  v_mfma_f32_16x16x32_bf16 v[200:203], a[132:135], a[4:7], v[200:203]
  v_cvt_pk_bf16_f32 v209, v194, v195
  v_mul_f32 v199, s36, v199
  v_mfma_f32_16x16x32_bf16 v[200:203], a[136:139], a[8:11], v[200:203]
  v_exp_f32 v197, v197
  v_mfma_f32_16x16x32_bf16 v[200:203], a[140:143], a[12:15], v[200:203]
  v_exp_f32 v198, v198
  v_mfma_f32_16x16x32_bf16 v[204:207], a[144:147], a[0:3], v[252:255]
  ds_read_b128 a[96:99], v224 offset:32768
  ds_read_b128 a[100:103], v224 offset:33024
  v_mfma_f32_16x16x32_bf16 v[204:207], a[148:151], a[4:7], v[204:207]
  v_exp_f32 v199, v199
  v_mfma_f32_16x16x32_bf16 v[204:207], a[152:155], a[8:11], v[204:207]
  v_cvt_pk_bf16_f32 v210, v196, v197
  v_cvt_pk_bf16_f32 v211, v198, v199
  v_mfma_f32_16x16x32_bf16 v[204:207], a[156:159], a[12:15], v[204:207]
  ds_read_b64_tr_b16 v[216:217], v231 offset:9216
  ds_read_b64_tr_b16 v[218:219], v231 offset:9224
  ds_read_b64_tr_b16 v[220:221], v231 offset:10240
  ds_read_b64_tr_b16 v[222:223], v231 offset:10248
  ds_read_b64_tr_b16 a[244:245], v231 offset:11264
  ds_read_b64_tr_b16 a[246:247], v231 offset:11272
  ds_read_b32 v244, v242
  v_mfma_f32_16x16x32_bf16 v[128:131], v[208:211], a[160:163], v[128:131]
  v_mul_f32 v200, s36, v200
  v_mul_f32 v201, s36, v201
  v_mfma_f32_16x16x32_bf16 v[132:135], v[208:211], a[164:167], v[132:135]
  v_exp_f32 v200, v200
  v_mfma_f32_16x16x32_bf16 v[136:139], v[208:211], a[168:171], v[136:139]
  v_mul_f32 v202, s36, v202
  v_mul_f32 v203, s36, v203
  v_mfma_f32_16x16x32_bf16 v[140:143], v[208:211], a[172:175], v[140:143]
  v_exp_f32 v201, v201
  v_mfma_f32_16x16x32_bf16 v[144:147], v[208:211], a[176:179], v[144:147]
  ds_read_b128 a[104:107], v224 offset:33280
  ds_read_b128 a[108:111], v224 offset:33536
  v_mfma_f32_16x16x32_bf16 v[148:151], v[208:211], a[180:183], v[148:151]
  s_waitcnt lgkmcnt(2)
  v_exp_f32 v202, v202
  v_cmp_gt_u32 vcc, s58, v244
  v_mfma_f32_16x16x32_bf16 v[152:155], v[208:211], a[184:187], v[152:155]
  v_cvt_pk_bf16_f32 v212, v200, v201
  v_mul_f32 v204, s36, v204
  v_mfma_f32_16x16x32_bf16 v[156:159], v[208:211], a[188:191], v[156:159]
  s_cbranch_vccnz L_s5_C5
L_r5_C5:
  v_exp_f32 v203, v203
  v_mfma_f32_16x16x32_bf16 a[240:243], a[248:251], v[208:211], a[240:243]
  s_add_u32 s58, s58, 1
  v_mul_f32 v205, s36, v205
  v_mul_f32 v206, s36, v206
  v_mfma_f32_16x16x32_bf16 v[192:195], a[128:131], a[16:19], v[252:255]
  buffer_store_dwordx4 v[216:219], v232, s[28:31], s42 offen offset:256 nt
  v_exp_f32 v204, v204
  v_mfma_f32_16x16x32_bf16 v[192:195], a[132:135], a[20:23], v[192:195]
  v_cvt_pk_bf16_f32 v213, v202, v203
  v_mul_f32 v207, s36, v207
  v_mfma_f32_16x16x32_bf16 v[192:195], a[136:139], a[24:27], v[192:195]
  buffer_store_dwordx4 v[220:223], v232, s[28:31], s42 offen offset:512 nt
  v_exp_f32 v205, v205
  v_mfma_f32_16x16x32_bf16 v[192:195], a[140:143], a[28:31], v[192:195]
  v_exp_f32 v206, v206
  v_mfma_f32_16x16x32_bf16 v[196:199], a[144:147], a[16:19], v[252:255]
  ds_read_b128 a[112:115], v224 offset:36864
  ds_read_b128 a[116:119], v224 offset:37120
  v_mfma_f32_16x16x32_bf16 v[196:199], a[148:151], a[20:23], v[196:199]
  buffer_store_dwordx4 a[244:247], v232, s[28:31], s42 offen offset:768 nt
  v_exp_f32 v207, v207
  v_mfma_f32_16x16x32_bf16 v[196:199], a[152:155], a[24:27], v[196:199]
  s_add_u32 s42, s42, 4096
  v_cvt_pk_bf16_f32 v214, v204, v205
  v_cvt_pk_bf16_f32 v215, v206, v207
  v_mfma_f32_16x16x32_bf16 v[196:199], a[156:159], a[28:31], v[196:199]
  s_mov_b32 m0, 16384
  v_mfma_f32_16x16x32_bf16 v[0:3], v[212:215], a[192:195], v[0:3]
  buffer_load_dwordx4 v229, s[20:23], s37 offen offset:0 lds
  v_mul_f32 v192, s36, v192
  v_mul_f32 v193, s36, v193
  v_mfma_f32_16x16x32_bf16 v[4:7], v[212:215], a[196:199], v[4:7]
  v_exp_f32 v192, v192
  v_mfma_f32_16x16x32_bf16 v[8:11], v[212:215], a[200:203], v[8:11]
  buffer_load_dwordx4 v229, s[20:23], s37 offen offset:1024 lds
  v_mul_f32 v194, s36, v194
  v_mul_f32 v195, s36, v195
  v_mfma_f32_16x16x32_bf16 v[12:15], v[212:215], a[204:207], v[12:15]
  v_exp_f32 v193, v193
  v_mfma_f32_16x16x32_bf16 v[16:19], v[212:215], a[208:211], v[16:19]
  ds_read_b128 a[120:123], v224 offset:37376
  ds_read_b128 a[124:127], v224 offset:37632
  v_mfma_f32_16x16x32_bf16 v[20:23], v[212:215], a[212:215], v[20:23]
  buffer_load_dwordx4 v230, s[20:23], s37 offen offset:2048 lds
  v_exp_f32 v194, v194
  v_mfma_f32_16x16x32_bf16 v[24:27], v[212:215], a[216:219], v[24:27]
  v_cvt_pk_bf16_f32 v208, v192, v193
  v_mul_f32 v196, s36, v196
  v_mfma_f32_16x16x32_bf16 v[28:31], v[212:215], a[220:223], v[28:31]
  buffer_load_dwordx4 v230, s[20:23], s37 offen offset:3072 lds
  v_exp_f32 v195, v195
  v_mfma_f32_16x16x32_bf16 a[224:227], a[248:251], v[212:215], a[224:227]
  s_add_u32 s37, s37, 4096
  v_mul_f32 v197, s36, v197
  v_mul_f32 v198, s36, v198
  v_mfma_f32_16x16x32_bf16 v[200:203], a[128:131], a[32:35], v[252:255]
  s_mov_b32 m0, 20480
  v_exp_f32 v196, v196
  v_mfma_f32_16x16x32_bf16 v[200:203], a[132:135], a[36:39], v[200:203]
  buffer_load_dwordx4 v229, s[20:23], s37 offen offset:0 lds
  v_cvt_pk_bf16_f32 v209, v194, v195
  v_mul_f32 v199, s36, v199
  v_mfma_f32_16x16x32_bf16 v[200:203], a[136:139], a[40:43], v[200:203]
  v_exp_f32 v197, v197
  v_mfma_f32_16x16x32_bf16 v[200:203], a[140:143], a[44:47], v[200:203]
  buffer_load_dwordx4 v229, s[20:23], s37 offen offset:1024 lds
  v_exp_f32 v198, v198
  v_mfma_f32_16x16x32_bf16 v[204:207], a[144:147], a[32:35], v[252:255]
  ds_read_b64_tr_b16 a[160:161], v226 offset:40960
  ds_read_b64_tr_b16 a[162:163], v226 offset:45056
  v_mfma_f32_16x16x32_bf16 v[204:207], a[148:151], a[36:39], v[204:207]
  buffer_load_dwordx4 v230, s[20:23], s37 offen offset:2048 lds
  v_exp_f32 v199, v199
  v_mfma_f32_16x16x32_bf16 v[204:207], a[152:155], a[40:43], v[204:207]
  v_cvt_pk_bf16_f32 v210, v196, v197
  v_cvt_pk_bf16_f32 v211, v198, v199
  v_mfma_f32_16x16x32_bf16 v[204:207], a[156:159], a[44:47], v[204:207]
  buffer_load_dwordx4 v230, s[20:23], s37 offen offset:3072 lds
  v_add_u32 v231, 0x3000, v231
  v_mfma_f32_16x16x32_bf16 v[32:35], v[208:211], a[192:195], v[32:35]
  s_add_u32 s37, s37, 4096
  ds_read_b64_tr_b16 a[164:165], v237 offset:40960
  ds_read_b64_tr_b16 a[166:167], v237 offset:45056
  v_mul_f32 v200, s36, v200
  v_mul_f32 v201, s36, v201
  v_mfma_f32_16x16x32_bf16 v[36:39], v[208:211], a[196:199], v[36:39]
  s_mov_b32 m0, 24576
  v_exp_f32 v200, v200
  v_mfma_f32_16x16x32_bf16 v[40:43], v[208:211], a[200:203], v[40:43]
  buffer_load_dwordx4 v241, s[24:27], s38 offen offset:0 lds
  v_mul_f32 v202, s36, v202
  v_mul_f32 v203, s36, v203
  v_mfma_f32_16x16x32_bf16 v[44:47], v[208:211], a[204:207], v[44:47]
  v_exp_f32 v201, v201
  v_mfma_f32_16x16x32_bf16 v[48:51], v[208:211], a[208:211], v[48:51]
  ds_read_b64_tr_b16 a[168:169], v234 offset:40960
  ds_read_b64_tr_b16 a[170:171], v234 offset:45056
  v_mfma_f32_16x16x32_bf16 v[52:55], v[208:211], a[212:215], v[52:55]
  buffer_load_dwordx4 v241, s[24:27], s38 offen offset:1024 lds
  v_exp_f32 v202, v202
  v_mfma_f32_16x16x32_bf16 v[56:59], v[208:211], a[216:219], v[56:59]
  v_cvt_pk_bf16_f32 v212, v200, v201
  v_mul_f32 v204, s36, v204
  v_mfma_f32_16x16x32_bf16 v[60:63], v[208:211], a[220:223], v[60:63]
  buffer_load_dwordx4 v241, s[24:27], s38 offen offset:2048 lds
  v_exp_f32 v203, v203
  v_mfma_f32_16x16x32_bf16 a[228:231], a[248:251], v[208:211], a[228:231]
  v_mul_f32 v205, s36, v205
  v_mul_f32 v206, s36, v206
  v_mfma_f32_16x16x32_bf16 v[192:195], a[128:131], a[48:51], v[252:255]
  buffer_load_dwordx4 v241, s[24:27], s38 offen offset:3072 lds
  v_exp_f32 v204, v204
  v_mfma_f32_16x16x32_bf16 v[192:195], a[132:135], a[52:55], v[192:195]
  s_add_u32 s38, s38, 4096
  v_cvt_pk_bf16_f32 v213, v202, v203
  v_mul_f32 v207, s36, v207
  v_mfma_f32_16x16x32_bf16 v[192:195], a[136:139], a[56:59], v[192:195]
  s_mov_b32 m0, 28672
  v_exp_f32 v205, v205
  v_mfma_f32_16x16x32_bf16 v[192:195], a[140:143], a[60:63], v[192:195]
  buffer_load_dwordx4 v241, s[24:27], s38 offen offset:0 lds
  v_exp_f32 v206, v206
  v_mfma_f32_16x16x32_bf16 v[196:199], a[144:147], a[48:51], v[252:255]
  ds_read_b64_tr_b16 a[172:173], v228 offset:40960
  ds_read_b64_tr_b16 a[174:175], v228 offset:45056
  v_mfma_f32_16x16x32_bf16 v[196:199], a[148:151], a[52:55], v[196:199]
  buffer_load_dwordx4 v241, s[24:27], s38 offen offset:1024 lds
  v_exp_f32 v207, v207
  v_mfma_f32_16x16x32_bf16 v[196:199], a[152:155], a[56:59], v[196:199]
  v_cvt_pk_bf16_f32 v214, v204, v205
  v_cvt_pk_bf16_f32 v215, v206, v207
  v_mfma_f32_16x16x32_bf16 v[196:199], a[156:159], a[60:63], v[196:199]
  buffer_load_dwordx4 v241, s[24:27], s38 offen offset:2048 lds
  v_mfma_f32_16x16x32_bf16 v[64:67], v[212:215], a[192:195], v[64:67]
  ds_read_b64_tr_b16 a[176:177], v226 offset:40968
  ds_read_b64_tr_b16 a[178:179], v226 offset:45064
  v_mul_f32 v192, s36, v192
  v_mul_f32 v193, s36, v193
  v_mfma_f32_16x16x32_bf16 v[68:71], v[212:215], a[196:199], v[68:71]
  buffer_load_dwordx4 v241, s[24:27], s38 offen offset:3072 lds
  v_exp_f32 v192, v192
  v_mfma_f32_16x16x32_bf16 v[72:75], v[212:215], a[200:203], v[72:75]
  s_add_u32 s38, s38, 4096
  v_mul_f32 v194, s36, v194
  v_mul_f32 v195, s36, v195
  v_mfma_f32_16x16x32_bf16 v[76:79], v[212:215], a[204:207], v[76:79]
  buffer_load_dword v236, v235, s[20:23], s72 offen
  v_exp_f32 v193, v193
  v_mfma_f32_16x16x32_bf16 v[80:83], v[212:215], a[208:211], v[80:83]
  s_add_u32 s72, s72, 16384
  ds_read_b64_tr_b16 a[180:181], v237 offset:40968
  ds_read_b64_tr_b16 a[182:183], v237 offset:45064
  v_mfma_f32_16x16x32_bf16 v[84:87], v[212:215], a[212:215], v[84:87]
  v_exp_f32 v194, v194
  v_mfma_f32_16x16x32_bf16 v[88:91], v[212:215], a[216:219], v[88:91]
  v_cvt_pk_bf16_f32 v208, v192, v193
  v_mul_f32 v196, s36, v196
  v_mfma_f32_16x16x32_bf16 v[92:95], v[212:215], a[220:223], v[92:95]
  v_exp_f32 v195, v195
  v_mfma_f32_16x16x32_bf16 a[232:235], a[248:251], v[212:215], a[232:235]
  v_mul_f32 v197, s36, v197
  v_mul_f32 v198, s36, v198
  v_mfma_f32_16x16x32_bf16 v[200:203], a[128:131], a[64:67], v[252:255]
  v_exp_f32 v196, v196
  v_mfma_f32_16x16x32_bf16 v[200:203], a[132:135], a[68:71], v[200:203]
  v_cvt_pk_bf16_f32 v209, v194, v195
  v_mul_f32 v199, s36, v199
  v_mfma_f32_16x16x32_bf16 v[200:203], a[136:139], a[72:75], v[200:203]
  v_exp_f32 v197, v197
  v_mfma_f32_16x16x32_bf16 v[200:203], a[140:143], a[76:79], v[200:203]
  v_exp_f32 v198, v198
  v_mfma_f32_16x16x32_bf16 v[204:207], a[144:147], a[64:67], v[252:255]
  ds_read_b64_tr_b16 a[184:185], v234 offset:40968
  ds_read_b64_tr_b16 a[186:187], v234 offset:45064
  v_mfma_f32_16x16x32_bf16 v[204:207], a[148:151], a[68:71], v[204:207]
  v_exp_f32 v199, v199
  v_mfma_f32_16x16x32_bf16 v[204:207], a[152:155], a[72:75], v[204:207]
  v_cvt_pk_bf16_f32 v210, v196, v197
  v_cvt_pk_bf16_f32 v211, v198, v199
  v_mfma_f32_16x16x32_bf16 v[204:207], a[156:159], a[76:79], v[204:207]
  s_waitcnt vmcnt(41)
  ds_add_u32 v245, v243
  v_mfma_f32_16x16x32_bf16 v[96:99], v[208:211], a[192:195], v[96:99]
  v_mul_f32 v200, s36, v200
  v_mul_f32 v201, s36, v201
  v_mfma_f32_16x16x32_bf16 v[100:103], v[208:211], a[196:199], v[100:103]
  v_exp_f32 v200, v200
  v_mfma_f32_16x16x32_bf16 v[104:107], v[208:211], a[200:203], v[104:107]
  v_mul_f32 v202, s36, v202
  v_mul_f32 v203, s36, v203
  v_mfma_f32_16x16x32_bf16 v[108:111], v[208:211], a[204:207], v[108:111]
  s_add_u32 s44, s44, 1
  v_exp_f32 v201, v201
  v_mfma_f32_16x16x32_bf16 v[112:115], v[208:211], a[208:211], v[112:115]
  ds_read_b64_tr_b16 a[188:189], v228 offset:40968
  ds_read_b64_tr_b16 a[190:191], v228 offset:45064
  v_mfma_f32_16x16x32_bf16 v[116:119], v[208:211], a[212:215], v[116:119]
  v_exp_f32 v202, v202
  v_mfma_f32_16x16x32_bf16 v[120:123], v[208:211], a[216:219], v[120:123]
  s_waitcnt lgkmcnt(15)
  v_cvt_pk_bf16_f32 v212, v200, v201
  v_mul_f32 v204, s36, v204
  v_mfma_f32_16x16x32_bf16 v[124:127], v[208:211], a[220:223], v[124:127]
  v_exp_f32 v203, v203
  v_mfma_f32_16x16x32_bf16 a[236:239], a[248:251], v[208:211], a[236:239]
  s_cmp_lt_u32 s44, 2
  v_mul_f32 v205, s36, v205
  v_mul_f32 v206, s36, v206
  s_cbranch_scc1 L_C5
L_D5:
  v_mfma_f32_16x16x32_bf16 v[192:195], a[96:99], a[0:3], v[252:255]
  v_exp_f32 v204, v204
  v_mfma_f32_16x16x32_bf16 v[192:195], a[100:103], a[4:7], v[192:195]
  v_cvt_pk_bf16_f32 v213, v202, v203
  v_mul_f32 v207, s36, v207
  v_mfma_f32_16x16x32_bf16 v[192:195], a[104:107], a[8:11], v[192:195]
  v_exp_f32 v205, v205
  v_mfma_f32_16x16x32_bf16 v[192:195], a[108:111], a[12:15], v[192:195]
  v_exp_f32 v206, v206
  v_mfma_f32_16x16x32_bf16 v[196:199], a[112:115], a[0:3], v[252:255]
  ds_read_b128 a[128:131], v224 offset:49152
  ds_read_b128 a[132:135], v224 offset:49408
  v_mfma_f32_16x16x32_bf16 v[196:199], a[116:119], a[4:7], v[196:199]
  v_exp_f32 v207, v207
  v_mfma_f32_16x16x32_bf16 v[196:199], a[120:123], a[8:11], v[196:199]
  v_cvt_pk_bf16_f32 v214, v204, v205
  v_cvt_pk_bf16_f32 v215, v206, v207
  v_mfma_f32_16x16x32_bf16 v[196:199], a[124:127], a[12:15], v[196:199]
  ds_read_b32 v244, v242
  v_mfma_f32_16x16x32_bf16 v[128:131], v[212:215], a[192:195], v[128:131]
  v_mul_f32 v192, s36, v192
  v_mul_f32 v193, s36, v193
  v_mfma_f32_16x16x32_bf16 v[132:135], v[212:215], a[196:199], v[132:135]
  v_exp_f32 v192, v192
  v_mfma_f32_16x16x32_bf16 v[136:139], v[212:215], a[200:203], v[136:139]
  v_mul_f32 v194, s36, v194
  v_mul_f32 v195, s36, v195
  v_mfma_f32_16x16x32_bf16 v[140:143], v[212:215], a[204:207], v[140:143]
  v_exp_f32 v193, v193
  v_mfma_f32_16x16x32_bf16 v[144:147], v[212:215], a[208:211], v[144:147]
  ds_read_b128 a[136:139], v224 offset:49664
  ds_read_b128 a[140:143], v224 offset:49920
  v_mfma_f32_16x16x32_bf16 v[148:151], v[212:215], a[212:215], v[148:151]
  s_waitcnt lgkmcnt(2)
  v_exp_f32 v194, v194
  v_cmp_gt_u32 vcc, s58, v244
  v_mfma_f32_16x16x32_bf16 v[152:155], v[212:215], a[216:219], v[152:155]
  v_cvt_pk_bf16_f32 v208, v192, v193
  v_mul_f32 v196, s36, v196
  v_mfma_f32_16x16x32_bf16 v[156:159], v[212:215], a[220:223], v[156:159]
  s_cbranch_vccnz L_s5_D10
L_r5_D10:
  v_exp_f32 v195, v195
  v_mfma_f32_16x16x32_bf16 a[240:243], a[248:251], v[212:215], a[240:243]
  s_add_u32 s58, s58, 1
  v_mul_f32 v197, s36, v197
  v_mul_f32 v198, s36, v198
  v_mfma_f32_16x16x32_bf16 v[200:203], a[96:99], a[16:19], v[252:255]
  s_mov_b32 m0, 32768
  v_exp_f32 v196, v196
  v_mfma_f32_16x16x32_bf16 v[200:203], a[100:103], a[20:23], v[200:203]
  buffer_load_dwordx4 v229, s[20:23], s37 offen offset:0 lds
  v_cvt_pk_bf16_f32 v209, v194, v195
  v_mul_f32 v199, s36, v199
  v_mfma_f32_16x16x32_bf16 v[200:203], a[104:107], a[24:27], v[200:203]
  v_exp_f32 v197, v197
  v_mfma_f32_16x16x32_bf16 v[200:203], a[108:111], a[28:31], v[200:203]
  buffer_load_dwordx4 v229, s[20:23], s37 offen offset:1024 lds
  v_exp_f32 v198, v198
  v_mfma_f32_16x16x32_bf16 v[204:207], a[112:115], a[16:19], v[252:255]
  ds_read_b128 a[144:147], v224 offset:53248
  ds_read_b128 a[148:151], v224 offset:53504
  v_mfma_f32_16x16x32_bf16 v[204:207], a[116:119], a[20:23], v[204:207]
  buffer_load_dwordx4 v230, s[20:23], s37 offen offset:2048 lds
  v_exp_f32 v199, v199
  v_mfma_f32_16x16x32_bf16 v[204:207], a[120:123], a[24:27], v[204:207]
  v_cvt_pk_bf16_f32 v210, v196, v197
  v_cvt_pk_bf16_f32 v211, v198, v199
  v_mfma_f32_16x16x32_bf16 v[204:207], a[124:127], a[28:31], v[204:207]
  buffer_load_dwordx4 v230, s[20:23], s37 offen offset:3072 lds
  v_mfma_f32_16x16x32_bf16 v[0:3], v[208:211], a[160:163], v[0:3]
  s_add_u32 s37, s37, 4096
  v_mul_f32 v200, s36, v200
  v_mul_f32 v201, s36, v201
  v_mfma_f32_16x16x32_bf16 v[4:7], v[208:211], a[164:167], v[4:7]
  s_mov_b32 m0, 36864
  v_exp_f32 v200, v200
  v_mfma_f32_16x16x32_bf16 v[8:11], v[208:211], a[168:171], v[8:11]
  buffer_load_dwordx4 v229, s[20:23], s37 offen offset:0 lds
  v_mul_f32 v202, s36, v202
  v_mul_f32 v203, s36, v203
  v_mfma_f32_16x16x32_bf16 v[12:15], v[208:211], a[172:175], v[12:15]
  v_exp_f32 v201, v201
  v_mfma_f32_16x16x32_bf16 v[16:19], v[208:211], a[176:179], v[16:19]
  ds_read_b128 a[152:155], v224 offset:53760
  ds_read_b128 a[156:159], v224 offset:54016
  v_mfma_f32_16x16x32_bf16 v[20:23], v[208:211], a[180:183], v[20:23]
  buffer_load_dwordx4 v229, s[20:23], s37 offen offset:1024 lds
  v_exp_f32 v202, v202
  v_mfma_f32_16x16x32_bf16 v[24:27], v[208:211], a[184:187], v[24:27]
  v_cvt_pk_bf16_f32 v212, v200, v201
  v_mul_f32 v204, s36, v204
  v_mfma_f32_16x16x32_bf16 v[28:31], v[208:211], a[188:191], v[28:31]
  buffer_load_dwordx4 v230, s[20:23], s37 offen offset:2048 lds
  v_exp_f32 v203, v203
  v_mfma_f32_16x16x32_bf16 a[224:227], a[248:251], v[208:211], a[224:227]
  v_mul_f32 v205, s36, v205
  v_mul_f32 v206, s36, v206
  v_mfma_f32_16x16x32_bf16 v[192:195], a[96:99], a[32:35], v[252:255]
  buffer_load_dwordx4 v230, s[20:23], s37 offen offset:3072 lds
  v_exp_f32 v204, v204
  v_mfma_f32_16x16x32_bf16 v[192:195], a[100:103], a[36:39], v[192:195]
  s_add_u32 s37, s37, 4096
  v_cvt_pk_bf16_f32 v213, v202, v203
  v_mul_f32 v207, s36, v207
  v_mfma_f32_16x16x32_bf16 v[192:195], a[104:107], a[40:43], v[192:195]
  s_mov_b32 m0, 40960
  v_exp_f32 v205, v205
  v_mfma_f32_16x16x32_bf16 v[192:195], a[108:111], a[44:47], v[192:195]
  buffer_load_dwordx4 v241, s[24:27], s38 offen offset:0 lds
  v_exp_f32 v206, v206
  v_mfma_f32_16x16x32_bf16 v[196:199], a[112:115], a[32:35], v[252:255]
  ds_read_b64_tr_b16 a[192:193], v226 offset:57344
  ds_read_b64_tr_b16 a[194:195], v226 offset:61440
  v_mfma_f32_16x16x32_bf16 v[196:199], a[116:119], a[36:39], v[196:199]
  buffer_load_dwordx4 v241, s[24:27], s38 offen offset:1024 lds
  v_exp_f32 v207, v207
  v_mfma_f32_16x16x32_bf16 v[196:199], a[120:123], a[40:43], v[196:199]
  v_cvt_pk_bf16_f32 v214, v204, v205
  v_cvt_pk_bf16_f32 v215, v206, v207
  v_mfma_f32_16x16x32_bf16 v[196:199], a[124:127], a[44:47], v[196:199]
  buffer_load_dwordx4 v241, s[24:27], s38 offen offset:2048 lds
  v_mfma_f32_16x16x32_bf16 v[32:35], v[212:215], a[160:163], v[32:35]
  ds_read_b64_tr_b16 a[196:197], v237 offset:57344
  ds_read_b64_tr_b16 a[198:199], v237 offset:61440
  v_mul_f32 v192, s36, v192
  v_mul_f32 v193, s36, v193
  v_mfma_f32_16x16x32_bf16 v[36:39], v[212:215], a[164:167], v[36:39]
  buffer_load_dwordx4 v241, s[24:27], s38 offen offset:3072 lds
  v_exp_f32 v192, v192
  v_mfma_f32_16x16x32_bf16 v[40:43], v[212:215], a[168:171], v[40:43]
  s_add_u32 s38, s38, 4096
  v_mul_f32 v194, s36, v194
  v_mul_f32 v195, s36, v195
  v_mfma_f32_16x16x32_bf16 v[44:47], v[212:215], a[172:175], v[44:47]
  v_exp_f32 v193, v193
  v_mfma_f32_16x16x32_bf16 v[48:51], v[212:215], a[176:179], v[48:51]
  s_mov_b32 m0, 45056
  ds_read_b64_tr_b16 a[200:201], v234 offset:57344
  ds_read_b64_tr_b16 a[202:203], v234 offset:61440
  v_mfma_f32_16x16x32_bf16 v[52:55], v[212:215], a[180:183], v[52:55]
  buffer_load_dwordx4 v241, s[24:27], s38 offen offset:0 lds
  v_exp_f32 v194, v194
  v_mfma_f32_16x16x32_bf16 v[56:59], v[212:215], a[184:187], v[56:59]
  v_cvt_pk_bf16_f32 v208, v192, v193
  v_mul_f32 v196, s36, v196
  v_mfma_f32_16x16x32_bf16 v[60:63], v[212:215], a[188:191], v[60:63]
  buffer_load_dwordx4 v241, s[24:27], s38 offen offset:1024 lds
  v_exp_f32 v195, v195
  v_mfma_f32_16x16x32_bf16 a[228:231], a[248:251], v[212:215], a[228:231]
  v_mul_f32 v197, s36, v197
  v_mul_f32 v198, s36, v198
  v_mfma_f32_16x16x32_bf16 v[200:203], a[96:99], a[48:51], v[252:255]
  buffer_load_dwordx4 v241, s[24:27], s38 offen offset:2048 lds
  v_exp_f32 v196, v196
  v_mfma_f32_16x16x32_bf16 v[200:203], a[100:103], a[52:55], v[200:203]
  v_cvt_pk_bf16_f32 v209, v194, v195
  v_mul_f32 v199, s36, v199
  v_mfma_f32_16x16x32_bf16 v[200:203], a[104:107], a[56:59], v[200:203]
  buffer_load_dwordx4 v241, s[24:27], s38 offen offset:3072 lds
  v_exp_f32 v197, v197
  v_mfma_f32_16x16x32_bf16 v[200:203], a[108:111], a[60:63], v[200:203]
  s_add_u32 s38, s38, 4096
  v_exp_f32 v198, v198
  v_mfma_f32_16x16x32_bf16 v[204:207], a[112:115], a[48:51], v[252:255]
  ds_read_b64_tr_b16 a[204:205], v228 offset:57344
  ds_read_b64_tr_b16 a[206:207], v228 offset:61440
  v_mfma_f32_16x16x32_bf16 v[204:207], a[116:119], a[52:55], v[204:207]
  global_load_dword v236, v[246:247], off
  v_exp_f32 v199, v199
  v_mfma_f32_16x16x32_bf16 v[204:207], a[120:123], a[56:59], v[204:207]
  v_cvt_pk_bf16_f32 v210, v196, v197
  v_cvt_pk_bf16_f32 v211, v198, v199
  v_mfma_f32_16x16x32_bf16 v[204:207], a[124:127], a[60:63], v[204:207]
  s_nop 0
  v_mfma_f32_16x16x32_bf16 v[64:67], v[208:211], a[160:163], v[64:67]
  ds_read_b64_tr_b16 a[208:209], v226 offset:57352
  ds_read_b64_tr_b16 a[210:211], v226 offset:61448
  v_mul_f32 v200, s36, v200
  v_mul_f32 v201, s36, v201
  v_mfma_f32_16x16x32_bf16 v[68:71], v[208:211], a[164:167], v[68:71]
  v_exp_f32 v200, v200
  v_mfma_f32_16x16x32_bf16 v[72:75], v[208:211], a[168:171], v[72:75]
  v_mul_f32 v202, s36, v202
  v_mul_f32 v203, s36, v203
  v_mfma_f32_16x16x32_bf16 v[76:79], v[208:211], a[172:175], v[76:79]
  v_exp_f32 v201, v201
  v_mfma_f32_16x16x32_bf16 v[80:83], v[208:211], a[176:179], v[80:83]
  ds_read_b64_tr_b16 a[212:213], v237 offset:57352
  ds_read_b64_tr_b16 a[214:215], v237 offset:61448
  v_mfma_f32_16x16x32_bf16 v[84:87], v[208:211], a[180:183], v[84:87]
  v_exp_f32 v202, v202
  v_mfma_f32_16x16x32_bf16 v[88:91], v[208:211], a[184:187], v[88:91]
  v_cvt_pk_bf16_f32 v212, v200, v201
  v_mul_f32 v204, s36, v204
  v_mfma_f32_16x16x32_bf16 v[92:95], v[208:211], a[188:191], v[92:95]
  v_exp_f32 v203, v203
  v_mfma_f32_16x16x32_bf16 a[232:235], a[248:251], v[208:211], a[232:235]
  v_mul_f32 v205, s36, v205
  v_mul_f32 v206, s36, v206
  v_mfma_f32_16x16x32_bf16 v[192:195], a[96:99], a[64:67], v[252:255]
  v_exp_f32 v204, v204
  v_mfma_f32_16x16x32_bf16 v[192:195], a[100:103], a[68:71], v[192:195]
  v_cvt_pk_bf16_f32 v213, v202, v203
  v_mul_f32 v207, s36, v207
  v_mfma_f32_16x16x32_bf16 v[192:195], a[104:107], a[72:75], v[192:195]
  v_exp_f32 v205, v205
  v_mfma_f32_16x16x32_bf16 v[192:195], a[108:111], a[76:79], v[192:195]
  v_exp_f32 v206, v206
  v_mfma_f32_16x16x32_bf16 v[196:199], a[112:115], a[64:67], v[252:255]
  ds_read_b64_tr_b16 a[216:217], v234 offset:57352
  ds_read_b64_tr_b16 a[218:219], v234 offset:61448
  v_mfma_f32_16x16x32_bf16 v[196:199], a[116:119], a[68:71], v[196:199]
  v_exp_f32 v207, v207
  v_mfma_f32_16x16x32_bf16 v[196:199], a[120:123], a[72:75], v[196:199]
  v_cvt_pk_bf16_f32 v214, v204, v205
  v_cvt_pk_bf16_f32 v215, v206, v207
  v_mfma_f32_16x16x32_bf16 v[196:199], a[124:127], a[76:79], v[196:199]
  s_waitcnt vmcnt(38)
  ds_add_u32 v245, v243
  v_mfma_f32_16x16x32_bf16 v[96:99], v[212:215], a[160:163], v[96:99]
  v_mul_f32 v192, s36, v192
  v_mul_f32 v193, s36, v193
  v_mfma_f32_16x16x32_bf16 v[100:103], v[212:215], a[164:167], v[100:103]
  v_exp_f32 v192, v192
  v_mfma_f32_16x16x32_bf16 v[104:107], v[212:215], a[168:171], v[104:107]
  v_mul_f32 v194, s36, v194
  v_mul_f32 v195, s36, v195
  v_mfma_f32_16x16x32_bf16 v[108:111], v[212:215], a[172:175], v[108:111]
  v_exp_f32 v193, v193
  v_mfma_f32_16x16x32_bf16 v[112:115], v[212:215], a[176:179], v[112:115]
  ds_read_b64_tr_b16 a[220:221], v228 offset:57352
  ds_read_b64_tr_b16 a[222:223], v228 offset:61448
  v_mfma_f32_16x16x32_bf16 v[116:119], v[212:215], a[180:183], v[116:119]
  v_exp_f32 v194, v194
  v_mfma_f32_16x16x32_bf16 v[120:123], v[212:215], a[184:187], v[120:123]
  s_waitcnt lgkmcnt(15)
  v_cvt_pk_bf16_f32 v208, v192, v193
  v_mul_f32 v196, s36, v196
  v_mfma_f32_16x16x32_bf16 v[124:127], v[212:215], a[188:191], v[124:127]
  v_exp_f32 v195, v195
  v_mfma_f32_16x16x32_bf16 a[236:239], a[248:251], v[212:215], a[236:239]
  v_mul_f32 v197, s36, v197
  v_mul_f32 v198, s36, v198
  v_mfma_f32_16x16x32_bf16 v[200:203], a[128:131], a[0:3], v[252:255]
  v_exp_f32 v196, v196
  v_mfma_f32_16x16x32_bf16 v[200:203], a[132:135], a[4:7], v[200:203]
  v_cvt_pk_bf16_f32 v209, v194, v195
  v_mul_f32 v199, s36, v199
  v_mfma_f32_16x16x32_bf16 v[200:203], a[136:139], a[8:11], v[200:203]
  v_exp_f32 v197, v197
  v_mfma_f32_16x16x32_bf16 v[200:203], a[140:143], a[12:15], v[200:203]
  v_exp_f32 v198, v198
  v_mfma_f32_16x16x32_bf16 v[204:207], a[144:147], a[0:3], v[252:255]
  ds_read_b128 a[96:99], v224 offset:0
  ds_read_b128 a[100:103], v224 offset:256
  v_mfma_f32_16x16x32_bf16 v[204:207], a[148:151], a[4:7], v[204:207]
  v_exp_f32 v199, v199
  v_mfma_f32_16x16x32_bf16 v[204:207], a[152:155], a[8:11], v[204:207]
  v_cvt_pk_bf16_f32 v210, v196, v197
  v_cvt_pk_bf16_f32 v211, v198, v199
  v_mfma_f32_16x16x32_bf16 v[204:207], a[156:159], a[12:15], v[204:207]
  ds_read_b32 v244, v242
  v_mfma_f32_16x16x32_bf16 v[128:131], v[208:211], a[160:163], v[128:131]
  v_mul_f32 v200, s36, v200
  v_mul_f32 v201, s36, v201
  v_mfma_f32_16x16x32_bf16 v[132:135], v[208:211], a[164:167], v[132:135]
  v_exp_f32 v200, v200
  v_mfma_f32_16x16x32_bf16 v[136:139], v[208:211], a[168:171], v[136:139]
  v_mul_f32 v202, s36, v202
  v_mul_f32 v203, s36, v203
  v_mfma_f32_16x16x32_bf16 v[140:143], v[208:211], a[172:175], v[140:143]
  v_exp_f32 v201, v201
  v_mfma_f32_16x16x32_bf16 v[144:147], v[208:211], a[176:179], v[144:147]
  ds_read_b128 a[104:107], v224 offset:512
  ds_read_b128 a[108:111], v224 offset:768
  v_mfma_f32_16x16x32_bf16 v[148:151], v[208:211], a[180:183], v[148:151]
  s_waitcnt lgkmcnt(2)
  v_exp_f32 v202, v202
  v_cmp_gt_u32 vcc, s58, v244
  v_mfma_f32_16x16x32_bf16 v[152:155], v[208:211], a[184:187], v[152:155]
  v_cvt_pk_bf16_f32 v212, v200, v201
  v_mul_f32 v204, s36, v204
  v_mfma_f32_16x16x32_bf16 v[156:159], v[208:211], a[188:191], v[156:159]
  s_cbranch_vccnz L_s5_D11
L_r5_D11:
  v_exp_f32 v203, v203
  v_mfma_f32_16x16x32_bf16 a[240:243], a[248:251], v[208:211], a[240:243]
  s_add_u32 s58, s58, 1
  v_mul_f32 v205, s36, v205
  v_mul_f32 v206, s36, v206
  v_mfma_f32_16x16x32_bf16 v[192:195], a[128:131], a[16:19], v[252:255]
  s_mov_b32 m0, 49152
  v_exp_f32 v204, v204
  v_mfma_f32_16x16x32_bf16 v[192:195], a[132:135], a[20:23], v[192:195]
  buffer_load_dwordx4 v229, s[20:23], s37 offen offset:0 lds
  v_cvt_pk_bf16_f32 v213, v202, v203
  v_mul_f32 v207, s36, v207
  v_mfma_f32_16x16x32_bf16 v[192:195], a[136:139], a[24:27], v[192:195]
  v_exp_f32 v205, v205
  v_mfma_f32_16x16x32_bf16 v[192:195], a[140:143], a[28:31], v[192:195]
  buffer_load_dwordx4 v229, s[20:23], s37 offen offset:1024 lds
  v_exp_f32 v206, v206
  v_mfma_f32_16x16x32_bf16 v[196:199], a[144:147], a[16:19], v[252:255]
  ds_read_b128 a[112:115], v224 offset:4096
  ds_read_b128 a[116:119], v224 offset:4352
  v_mfma_f32_16x16x32_bf16 v[196:199], a[148:151], a[20:23], v[196:199]
  buffer_load_dwordx4 v230, s[20:23], s37 offen offset:2048 lds
  v_exp_f32 v207, v207
  v_mfma_f32_16x16x32_bf16 v[196:199], a[152:155], a[24:27], v[196:199]
  v_cvt_pk_bf16_f32 v214, v204, v205
  v_cvt_pk_bf16_f32 v215, v206, v207
  v_mfma_f32_16x16x32_bf16 v[196:199], a[156:159], a[28:31], v[196:199]
  buffer_load_dwordx4 v230, s[20:23], s37 offen offset:3072 lds
  v_mfma_f32_16x16x32_bf16 v[0:3], v[212:215], a[192:195], v[0:3]
  s_add_u32 s37, s37, 4096
  v_mul_f32 v192, s36, v192
  v_mul_f32 v193, s36, v193
  v_mfma_f32_16x16x32_bf16 v[4:7], v[212:215], a[196:199], v[4:7]
  s_mov_b32 m0, 53248
  v_exp_f32 v192, v192
  v_mfma_f32_16x16x32_bf16 v[8:11], v[212:215], a[200:203], v[8:11]
  buffer_load_dwordx4 v229, s[20:23], s37 offen offset:0 lds
  v_mul_f32 v194, s36, v194
  v_mul_f32 v195, s36, v195
  v_mfma_f32_16x16x32_bf16 v[12:15], v[212:215], a[204:207], v[12:15]
  v_exp_f32 v193, v193
  v_mfma_f32_16x16x32_bf16 v[16:19], v[212:215], a[208:211], v[16:19]
  ds_read_b128 a[120:123], v224 offset:4608
  ds_read_b128 a[124:127], v224 offset:4864
  v_mfma_f32_16x16x32_bf16 v[20:23], v[212:215], a[212:215], v[20:23]
  buffer_load_dwordx4 v229, s[20:23], s37 offen offset:1024 lds
  v_exp_f32 v194, v194
  v_mfma_f32_16x16x32_bf16 v[24:27], v[212:215], a[216:219], v[24:27]
  v_cvt_pk_bf16_f32 v208, v192, v193
  v_mul_f32 v196, s36, v196
  v_mfma_f32_16x16x32_bf16 v[28:31], v[212:215], a[220:223], v[28:31]
  buffer_load_dwordx4 v230, s[20:23], s37 offen offset:2048 lds
  v_exp_f32 v195, v195
  v_mfma_f32_16x16x32_bf16 a[224:227], a[248:251], v[212:215], a[224:227]
  v_mul_f32 v197, s36, v197
  v_mul_f32 v198, s36, v198
  v_mfma_f32_16x16x32_bf16 v[200:203], a[128:131], a[32:35], v[252:255]
  buffer_load_dwordx4 v230, s[20:23], s37 offen offset:3072 lds
  v_exp_f32 v196, v196
  v_mfma_f32_16x16x32_bf16 v[200:203], a[132:135], a[36:39], v[200:203]
  s_add_u32 s37, s37, 4096
  v_cvt_pk_bf16_f32 v209, v194, v195
  v_mul_f32 v199, s36, v199
  v_mfma_f32_16x16x32_bf16 v[200:203], a[136:139], a[40:43], v[200:203]
  s_mov_b32 m0, 57344
  v_exp_f32 v197, v197
  v_mfma_f32_16x16x32_bf16 v[200:203], a[140:143], a[44:47], v[200:203]
  buffer_load_dwordx4 v241, s[24:27], s38 offen offset:0 lds
  v_exp_f32 v198, v198
  v_mfma_f32_16x16x32_bf16 v[204:207], a[144:147], a[32:35], v[252:255]
  ds_read_b64_tr_b16 a[160:161], v226 offset:8192
  ds_read_b64_tr_b16 a[162:163], v226 offset:12288
  v_mfma_f32_16x16x32_bf16 v[204:207], a[148:151], a[36:39], v[204:207]
  buffer_load_dwordx4 v241, s[24:27], s38 offen offset:1024 lds
  v_exp_f32 v199, v199
  v_mfma_f32_16x16x32_bf16 v[204:207], a[152:155], a[40:43], v[204:207]
  v_cvt_pk_bf16_f32 v210, v196, v197
  v_cvt_pk_bf16_f32 v211, v198, v199
  v_mfma_f32_16x16x32_bf16 v[204:207], a[156:159], a[44:47], v[204:207]
  buffer_load_dwordx4 v241, s[24:27], s38 offen offset:2048 lds
  v_mfma_f32_16x16x32_bf16 v[32:35], v[208:211], a[192:195], v[32:35]
  ds_read_b64_tr_b16 a[164:165], v237 offset:8192
  ds_read_b64_tr_b16 a[166:167], v237 offset:12288
  v_mul_f32 v200, s36, v200
  v_mul_f32 v201, s36, v201
  v_mfma_f32_16x16x32_bf16 v[36:39], v[208:211], a[196:199], v[36:39]
  buffer_load_dwordx4 v241, s[24:27], s38 offen offset:3072 lds
  v_exp_f32 v200, v200
  v_mfma_f32_16x16x32_bf16 v[40:43], v[208:211], a[200:203], v[40:43]
  s_add_u32 s38, s38, 4096
  v_mul_f32 v202, s36, v202
  v_mul_f32 v203, s36, v203
  v_mfma_f32_16x16x32_bf16 v[44:47], v[208:211], a[204:207], v[44:47]
  v_exp_f32 v201, v201
  v_mfma_f32_16x16x32_bf16 v[48:51], v[208:211], a[208:211], v[48:51]
  s_mov_b32 m0, 61440
  ds_read_b64_tr_b16 a[168:169], v234 offset:8192
  ds_read_b64_tr_b16 a[170:171], v234 offset:12288
  v_mfma_f32_16x16x32_bf16 v[52:55], v[208:211], a[212:215], v[52:55]
  buffer_load_dwordx4 v241, s[24:27], s38 offen offset:0 lds
  v_exp_f32 v202, v202
  v_mfma_f32_16x16x32_bf16 v[56:59], v[208:211], a[216:219], v[56:59]
  v_cvt_pk_bf16_f32 v212, v200, v201
  v_mul_f32 v204, s36, v204
  v_mfma_f32_16x16x32_bf16 v[60:63], v[208:211], a[220:223], v[60:63]
  buffer_load_dwordx4 v241, s[24:27], s38 offen offset:1024 lds
  v_exp_f32 v203, v203
  v_mfma_f32_16x16x32_bf16 a[228:231], a[248:251], v[208:211], a[228:231]
  v_mul_f32 v205, s36, v205
  v_mul_f32 v206, s36, v206
  v_mfma_f32_16x16x32_bf16 v[192:195], a[128:131], a[48:51], v[252:255]
  buffer_load_dwordx4 v241, s[24:27], s38 offen offset:2048 lds
  v_exp_f32 v204, v204
  v_mfma_f32_16x16x32_bf16 v[192:195], a[132:135], a[52:55], v[192:195]
  v_cvt_pk_bf16_f32 v213, v202, v203
  v_mul_f32 v207, s36, v207
  v_mfma_f32_16x16x32_bf16 v[192:195], a[136:139], a[56:59], v[192:195]
  buffer_load_dwordx4 v241, s[24:27], s38 offen offset:3072 lds
  v_exp_f32 v205, v205
  v_mfma_f32_16x16x32_bf16 v[192:195], a[140:143], a[60:63], v[192:195]
  s_add_u32 s38, s38, 4096
  v_exp_f32 v206, v206
  v_mfma_f32_16x16x32_bf16 v[196:199], a[144:147], a[48:51], v[252:255]
  ds_read_b64_tr_b16 a[172:173], v228 offset:8192
  ds_read_b64_tr_b16 a[174:175], v228 offset:12288
  v_mfma_f32_16x16x32_bf16 v[196:199], a[148:151], a[52:55], v[196:199]
  v_exp_f32 v207, v207
  v_mfma_f32_16x16x32_bf16 v[196:199], a[152:155], a[56:59], v[196:199]
  v_cvt_pk_bf16_f32 v214, v204, v205
  v_cvt_pk_bf16_f32 v215, v206, v207
  v_mfma_f32_16x16x32_bf16 v[196:199], a[156:159], a[60:63], v[196:199]
  s_nop 0
  v_mfma_f32_16x16x32_bf16 v[64:67], v[212:215], a[192:195], v[64:67]
  ds_read_b64_tr_b16 a[176:177], v226 offset:8200
  ds_read_b64_tr_b16 a[178:179], v226 offset:12296
  v_mul_f32 v192, s36, v192
  v_mul_f32 v193, s36, v193
  v_mfma_f32_16x16x32_bf16 v[68:71], v[212:215], a[196:199], v[68:71]
  v_exp_f32 v192, v192
  v_mfma_f32_16x16x32_bf16 v[72:75], v[212:215], a[200:203], v[72:75]
  v_mul_f32 v194, s36, v194
  v_mul_f32 v195, s36, v195
  v_mfma_f32_16x16x32_bf16 v[76:79], v[212:215], a[204:207], v[76:79]
  v_exp_f32 v193, v193
  v_mfma_f32_16x16x32_bf16 v[80:83], v[212:215], a[208:211], v[80:83]
  ds_read_b64_tr_b16 a[180:181], v237 offset:8200
  ds_read_b64_tr_b16 a[182:183], v237 offset:12296
  v_mfma_f32_16x16x32_bf16 v[84:87], v[212:215], a[212:215], v[84:87]
  v_exp_f32 v194, v194
  v_mfma_f32_16x16x32_bf16 v[88:91], v[212:215], a[216:219], v[88:91]
  v_cvt_pk_bf16_f32 v208, v192, v193
  v_mul_f32 v196, s36, v196
  v_mfma_f32_16x16x32_bf16 v[92:95], v[212:215], a[220:223], v[92:95]
  v_exp_f32 v195, v195
  v_mfma_f32_16x16x32_bf16 a[232:235], a[248:251], v[212:215], a[232:235]
  v_mul_f32 v197, s36, v197
  v_mul_f32 v198, s36, v198
  v_mfma_f32_16x16x32_bf16 v[200:203], a[128:131], a[64:67], v[252:255]
  v_exp_f32 v196, v196
  v_mfma_f32_16x16x32_bf16 v[200:203], a[132:135], a[68:71], v[200:203]
  v_cvt_pk_bf16_f32 v209, v194, v195
  v_mul_f32 v199, s36, v199
  v_mfma_f32_16x16x32_bf16 v[200:203], a[136:139], a[72:75], v[200:203]
  v_exp_f32 v197, v197
  v_mfma_f32_16x16x32_bf16 v[200:203], a[140:143], a[76:79], v[200:203]
  v_exp_f32 v198, v198
  v_mfma_f32_16x16x32_bf16 v[204:207], a[144:147], a[64:67], v[252:255]
  ds_read_b64_tr_b16 a[184:185], v234 offset:8200
  ds_read_b64_tr_b16 a[186:187], v234 offset:12296
  v_mfma_f32_16x16x32_bf16 v[204:207], a[148:151], a[68:71], v[204:207]
  v_exp_f32 v199, v199
  v_mfma_f32_16x16x32_bf16 v[204:207], a[152:155], a[72:75], v[204:207]
  v_cvt_pk_bf16_f32 v210, v196, v197
  v_cvt_pk_bf16_f32 v211, v198, v199
  v_mfma_f32_16x16x32_bf16 v[204:207], a[156:159], a[76:79], v[204:207]
  s_waitcnt vmcnt(34)
  ds_add_u32 v245, v243
  v_mfma_f32_16x16x32_bf16 v[96:99], v[208:211], a[192:195], v[96:99]
  v_mul_f32 v200, s36, v200
  v_mul_f32 v201, s36, v201
  v_mfma_f32_16x16x32_bf16 v[100:103], v[208:211], a[196:199], v[100:103]
  v_exp_f32 v200, v200
  v_mfma_f32_16x16x32_bf16 v[104:107], v[208:211], a[200:203], v[104:107]
  v_mul_f32 v202, s36, v202
  v_mul_f32 v203, s36, v203
  v_mfma_f32_16x16x32_bf16 v[108:111], v[208:211], a[204:207], v[108:111]
  v_exp_f32 v201, v201
  v_mfma_f32_16x16x32_bf16 v[112:115], v[208:211], a[208:211], v[112:115]
  ds_read_b64_tr_b16 a[188:189], v228 offset:8200
  ds_read_b64_tr_b16 a[190:191], v228 offset:12296
  v_mfma_f32_16x16x32_bf16 v[116:119], v[208:211], a[212:215], v[116:119]
  v_exp_f32 v202, v202
  v_mfma_f32_16x16x32_bf16 v[120:123], v[208:211], a[216:219], v[120:123]
  s_waitcnt lgkmcnt(15)
  v_cvt_pk_bf16_f32 v212, v200, v201
  v_mul_f32 v204, s36, v204
  v_mfma_f32_16x16x32_bf16 v[124:127], v[208:211], a[220:223], v[124:127]
  v_exp_f32 v203, v203
  v_mfma_f32_16x16x32_bf16 a[236:239], a[248:251], v[208:211], a[236:239]
  v_mul_f32 v205, s36, v205
  v_mul_f32 v206, s36, v206
  v_mfma_f32_16x16x32_bf16 v[192:195], a[96:99], a[0:3], v[252:255]
  v_exp_f32 v204, v204
  v_mfma_f32_16x16x32_bf16 v[192:195], a[100:103], a[4:7], v[192:195]
  v_cvt_pk_bf16_f32 v213, v202, v203
  v_mul_f32 v207, s36, v207
  v_mfma_f32_16x16x32_bf16 v[192:195], a[104:107], a[8:11], v[192:195]
  v_exp_f32 v205, v205
  v_mfma_f32_16x16x32_bf16 v[192:195], a[108:111], a[12:15], v[192:195]
  v_exp_f32 v206, v206
  v_mfma_f32_16x16x32_bf16 v[196:199], a[112:115], a[0:3], v[252:255]
  ds_read_b128 a[128:131], v224 offset:16384
  ds_read_b128 a[132:135], v224 offset:16640
  v_mfma_f32_16x16x32_bf16 v[196:199], a[116:119], a[4:7], v[196:199]
  v_exp_f32 v207, v207
  v_mfma_f32_16x16x32_bf16 v[196:199], a[120:123], a[8:11], v[196:199]
  v_cvt_pk_bf16_f32 v214, v204, v205
  v_cvt_pk_bf16_f32 v215, v206, v207
  v_mfma_f32_16x16x32_bf16 v[196:199], a[124:127], a[12:15], v[196:199]
  ds_read_b32 v244, v242
  v_mfma_f32_16x16x32_bf16 v[128:131], v[212:215], a[192:195], v[128:131]
  v_mul_f32 v192, s36, v192
  v_mul_f32 v193, s36, v193
  v_mfma_f32_16x16x32_bf16 v[132:135], v[212:215], a[196:199], v[132:135]
  v_exp_f32 v192, v192
  v_mfma_f32_16x16x32_bf16 v[136:139], v[212:215], a[200:203], v[136:139]
  v_mul_f32 v194, s36, v194
  v_mul_f32 v195, s36, v195
  v_mfma_f32_16x16x32_bf16 v[140:143], v[212:215], a[204:207], v[140:143]
  v_exp_f32 v193, v193
  v_mfma_f32_16x16x32_bf16 v[144:147], v[212:215], a[208:211], v[144:147]
  ds_read_b128 a[136:139], v224 offset:16896
  ds_read_b128 a[140:143], v224 offset:17152
  v_mfma_f32_16x16x32_bf16 v[148:151], v[212:215], a[212:215], v[148:151]
  s_waitcnt lgkmcnt(2)
  v_exp_f32 v194, v194
  v_cmp_gt_u32 vcc, s58, v244
  v_mfma_f32_16x16x32_bf16 v[152:155], v[212:215], a[216:219], v[152:155]
  v_cvt_pk_bf16_f32 v208, v192, v193
  v_mul_f32 v196, s36, v196
  v_mfma_f32_16x16x32_bf16 v[156:159], v[212:215], a[220:223], v[156:159]
  s_cbranch_vccnz L_s5_D12
L_r5_D12:
  v_exp_f32 v195, v195
  v_mfma_f32_16x16x32_bf16 a[240:243], a[248:251], v[212:215], a[240:243]
  s_add_u32 s58, s58, 1
  v_mul_f32 v197, s36, v197
  v_mul_f32 v198, s36, v198
  v_mfma_f32_16x16x32_bf16 v[200:203], a[96:99], a[16:19], v[252:255]
  v_exp_f32 v196, v196
  v_mfma_f32_16x16x32_bf16 v[200:203], a[100:103], a[20:23], v[200:203]
  v_cvt_pk_bf16_f32 v209, v194, v195
  v_mul_f32 v199, s36, v199
  v_mfma_f32_16x16x32_bf16 v[200:203], a[104:107], a[24:27], v[200:203]
  v_exp_f32 v197, v197
  v_mfma_f32_16x16x32_bf16 v[200:203], a[108:111], a[28:31], v[200:203]
  v_exp_f32 v198, v198
  v_mfma_f32_16x16x32_bf16 v[204:207], a[112:115], a[16:19], v[252:255]
  ds_read_b128 a[144:147], v224 offset:20480
  ds_read_b128 a[148:151], v224 offset:20736
  v_mfma_f32_16x16x32_bf16 v[204:207], a[116:119], a[20:23], v[204:207]
  v_exp_f32 v199, v199
  v_mfma_f32_16x16x32_bf16 v[204:207], a[120:123], a[24:27], v[204:207]
  v_cvt_pk_bf16_f32 v210, v196, v197
  v_cvt_pk_bf16_f32 v211, v198, v199
  v_mfma_f32_16x16x32_bf16 v[204:207], a[124:127], a[28:31], v[204:207]
  s_nop 0
  v_mfma_f32_16x16x32_bf16 v[0:3], v[208:211], a[160:163], v[0:3]
  v_mul_f32 v200, s36, v200
  v_mul_f32 v201, s36, v201
  v_mfma_f32_16x16x32_bf16 v[4:7], v[208:211], a[164:167], v[4:7]
  v_exp_f32 v200, v200
  v_mfma_f32_16x16x32_bf16 v[8:11], v[208:211], a[168:171], v[8:11]
  v_mul_f32 v202, s36, v202
  v_mul_f32 v203, s36, v203
  v_mfma_f32_16x16x32_bf16 v[12:15], v[208:211], a[172:175], v[12:15]
  v_exp_f32 v201, v201
  v_mfma_f32_16x16x32_bf16 v[16:19], v[208:211], a[176:179], v[16:19]
  ds_read_b128 a[152:155], v224 offset:20992
  ds_read_b128 a[156:159], v224 offset:21248
  v_mfma_f32_16x16x32_bf16 v[20:23], v[208:211], a[180:183], v[20:23]
  v_exp_f32 v202, v202
  v_mfma_f32_16x16x32_bf16 v[24:27], v[208:211], a[184:187], v[24:27]
  v_cvt_pk_bf16_f32 v212, v200, v201
  v_mul_f32 v204, s36, v204
  v_mfma_f32_16x16x32_bf16 v[28:31], v[208:211], a[188:191], v[28:31]
  v_exp_f32 v203, v203
  v_mfma_f32_16x16x32_bf16 a[224:227], a[248:251], v[208:211], a[224:227]
  v_mul_f32 v205, s36, v205
  v_mul_f32 v206, s36, v206
  v_mfma_f32_16x16x32_bf16 v[192:195], a[96:99], a[32:35], v[252:255]
  v_exp_f32 v204, v204
  v_mfma_f32_16x16x32_bf16 v[192:195], a[100:103], a[36:39], v[192:195]
  v_cvt_pk_bf16_f32 v213, v202, v203
  v_mul_f32 v207, s36, v207
  v_mfma_f32_16x16x32_bf16 v[192:195], a[104:107], a[40:43], v[192:195]
  v_exp_f32 v205, v205
  v_mfma_f32_16x16x32_bf16 v[192:195], a[108:111], a[44:47], v[192:195]
  v_exp_f32 v206, v206
  v_mfma_f32_16x16x32_bf16 v[196:199], a[112:115], a[32:35], v[252:255]
  ds_read_b64_tr_b16 a[192:193], v226 offset:24576
  ds_read_b64_tr_b16 a[194:195], v226 offset:28672
  v_mfma_f32_16x16x32_bf16 v[196:199], a[116:119], a[36:39], v[196:199]
  v_exp_f32 v207, v207
  v_mfma_f32_16x16x32_bf16 v[196:199], a[120:123], a[40:43], v[196:199]
  v_cvt_pk_bf16_f32 v214, v204, v205
  v_cvt_pk_bf16_f32 v215, v206, v207
  v_mfma_f32_16x16x32_bf16 v[196:199], a[124:127], a[44:47], v[196:199]
  s_nop 0
  v_mfma_f32_16x16x32_bf16 v[32:35], v[212:215], a[160:163], v[32:35]
  ds_read_b64_tr_b16 a[196:197], v237 offset:24576
  ds_read_b64_tr_b16 a[198:199], v237 offset:28672
  v_mul_f32 v192, s36, v192
  v_mul_f32 v193, s36, v193
  v_mfma_f32_16x16x32_bf16 v[36:39], v[212:215], a[164:167], v[36:39]
  v_exp_f32 v192, v192
  v_mfma_f32_16x16x32_bf16 v[40:43], v[212:215], a[168:171], v[40:43]
  v_mul_f32 v194, s36, v194
  v_mul_f32 v195, s36, v195
  v_mfma_f32_16x16x32_bf16 v[44:47], v[212:215], a[172:175], v[44:47]
  v_exp_f32 v193, v193
  v_mfma_f32_16x16x32_bf16 v[48:51], v[212:215], a[176:179], v[48:51]
  ds_read_b64_tr_b16 a[200:201], v234 offset:24576
  ds_read_b64_tr_b16 a[202:203], v234 offset:28672
  v_mfma_f32_16x16x32_bf16 v[52:55], v[212:215], a[180:183], v[52:55]
  v_exp_f32 v194, v194
  v_mfma_f32_16x16x32_bf16 v[56:59], v[212:215], a[184:187], v[56:59]
  v_cvt_pk_bf16_f32 v208, v192, v193
  v_mul_f32 v196, s36, v196
  v_mfma_f32_16x16x32_bf16 v[60:63], v[212:215], a[188:191], v[60:63]
  v_exp_f32 v195, v195
  v_mfma_f32_16x16x32_bf16 a[228:231], a[248:251], v[212:215], a[228:231]
  v_mul_f32 v197, s36, v197
  v_mul_f32 v198, s36, v198
  v_mfma_f32_16x16x32_bf16 v[200:203], a[96:99], a[48:51], v[252:255]
  v_exp_f32 v196, v196
  v_mfma_f32_16x16x32_bf16 v[200:203], a[100:103], a[52:55], v[200:203]
  v_cvt_pk_bf16_f32 v209, v194, v195
  v_mul_f32 v199, s36, v199
  v_mfma_f32_16x16x32_bf16 v[200:203], a[104:107], a[56:59], v[200:203]
  v_exp_f32 v197, v197
  v_mfma_f32_16x16x32_bf16 v[200:203], a[108:111], a[60:63], v[200:203]
  v_exp_f32 v198, v198
  v_mfma_f32_16x16x32_bf16 v[204:207], a[112:115], a[48:51], v[252:255]
  ds_read_b64_tr_b16 a[204:205], v228 offset:24576
  ds_read_b64_tr_b16 a[206:207], v228 offset:28672
  v_mfma_f32_16x16x32_bf16 v[204:207], a[116:119], a[52:55], v[204:207]
  v_exp_f32 v199, v199
  v_mfma_f32_16x16x32_bf16 v[204:207], a[120:123], a[56:59], v[204:207]
  v_cvt_pk_bf16_f32 v210, v196, v197
  v_cvt_pk_bf16_f32 v211, v198, v199
  v_mfma_f32_16x16x32_bf16 v[204:207], a[124:127], a[60:63], v[204:207]
  s_nop 0
  v_mfma_f32_16x16x32_bf16 v[64:67], v[208:211], a[160:163], v[64:67]
  ds_read_b64_tr_b16 a[208:209], v226 offset:24584
  ds_read_b64_tr_b16 a[210:211], v226 offset:28680
  v_mul_f32 v200, s36, v200
  v_mul_f32 v201, s36, v201
  v_mfma_f32_16x16x32_bf16 v[68:71], v[208:211], a[164:167], v[68:71]
  v_exp_f32 v200, v200
  v_mfma_f32_16x16x32_bf16 v[72:75], v[208:211], a[168:171], v[72:75]
  v_mul_f32 v202, s36, v202
  v_mul_f32 v203, s36, v203
  v_mfma_f32_16x16x32_bf16 v[76:79], v[208:211], a[172:175], v[76:79]
  v_exp_f32 v201, v201
  v_mfma_f32_16x16x32_bf16 v[80:83], v[208:211], a[176:179], v[80:83]
  ds_read_b64_tr_b16 a[212:213], v237 offset:24584
  ds_read_b64_tr_b16 a[214:215], v237 offset:28680
  v_mfma_f32_16x16x32_bf16 v[84:87], v[208:211], a[180:183], v[84:87]
  v_exp_f32 v202, v202
  v_mfma_f32_16x16x32_bf16 v[88:91], v[208:211], a[184:187], v[88:91]
  v_cvt_pk_bf16_f32 v212, v200, v201
  v_mul_f32 v204, s36, v204
  v_mfma_f32_16x16x32_bf16 v[92:95], v[208:211], a[188:191], v[92:95]
  v_exp_f32 v203, v203
  v_mfma_f32_16x16x32_bf16 a[232:235], a[248:251], v[208:211], a[232:235]
  v_mul_f32 v205, s36, v205
  v_mul_f32 v206, s36, v206
  v_mfma_f32_16x16x32_bf16 v[192:195], a[96:99], a[64:67], v[252:255]
  v_exp_f32 v204, v204
  v_mfma_f32_16x16x32_bf16 v[192:195], a[100:103], a[68:71], v[192:195]
  v_cvt_pk_bf16_f32 v213, v202, v203
  v_mul_f32 v207, s36, v207
  v_mfma_f32_16x16x32_bf16 v[192:195], a[104:107], a[72:75], v[192:195]
  v_exp_f32 v205, v205
  v_mfma_f32_16x16x32_bf16 v[192:195], a[108:111], a[76:79], v[192:195]
  v_exp_f32 v206, v206
  v_mfma_f32_16x16x32_bf16 v[196:199], a[112:115], a[64:67], v[252:255]
  ds_read_b64_tr_b16 a[216:217], v234 offset:24584
  ds_read_b64_tr_b16 a[218:219], v234 offset:28680
  v_mfma_f32_16x16x32_bf16 v[196:199], a[116:119], a[68:71], v[196:199]
  v_exp_f32 v207, v207
  v_mfma_f32_16x16x32_bf16 v[196:199], a[120:123], a[72:75], v[196:199]
  v_cvt_pk_bf16_f32 v214, v204, v205
  v_cvt_pk_bf16_f32 v215, v206, v207
  v_mfma_f32_16x16x32_bf16 v[196:199], a[124:127], a[76:79], v[196:199]
  s_waitcnt vmcnt(17)
  ds_add_u32 v245, v243
  v_mfma_f32_16x16x32_bf16 v[96:99], v[212:215], a[160:163], v[96:99]
  v_mul_f32 v192, s36, v192
  v_mul_f32 v193, s36, v193
  v_mfma_f32_16x16x32_bf16 v[100:103], v[212:215], a[164:167], v[100:103]
  v_exp_f32 v192, v192
  v_mfma_f32_16x16x32_bf16 v[104:107], v[212:215], a[168:171], v[104:107]
  v_mul_f32 v194, s36, v194
  v_mul_f32 v195, s36, v195
  v_mfma_f32_16x16x32_bf16 v[108:111], v[212:215], a[172:175], v[108:111]
  v_exp_f32 v193, v193
  v_mfma_f32_16x16x32_bf16 v[112:115], v[212:215], a[176:179], v[112:115]
  ds_read_b64_tr_b16 a[220:221], v228 offset:24584
  ds_read_b64_tr_b16 a[222:223], v228 offset:28680
  v_mfma_f32_16x16x32_bf16 v[116:119], v[212:215], a[180:183], v[116:119]
  v_exp_f32 v194, v194
  v_mfma_f32_16x16x32_bf16 v[120:123], v[212:215], a[184:187], v[120:123]
  s_waitcnt lgkmcnt(15)
  v_cvt_pk_bf16_f32 v208, v192, v193
  v_mul_f32 v196, s36, v196
  v_mfma_f32_16x16x32_bf16 v[124:127], v[212:215], a[188:191], v[124:127]
  v_exp_f32 v195, v195
  v_mfma_f32_16x16x32_bf16 a[236:239], a[248:251], v[212:215], a[236:239]
  v_mul_f32 v197, s36, v197
  v_mul_f32 v198, s36, v198
  v_mfma_f32_16x16x32_bf16 v[200:203], a[128:131], a[0:3], v[252:255]
  v_exp_f32 v196, v196
  v_mfma_f32_16x16x32_bf16 v[200:203], a[132:135], a[4:7], v[200:203]
  v_cvt_pk_bf16_f32 v209, v194, v195
  v_mul_f32 v199, s36, v199
  v_mfma_f32_16x16x32_bf16 v[200:203], a[136:139], a[8:11], v[200:203]
  v_exp_f32 v197, v197
  v_mfma_f32_16x16x32_bf16 v[200:203], a[140:143], a[12:15], v[200:203]
  v_exp_f32 v198, v198
  v_mfma_f32_16x16x32_bf16 v[204:207], a[144:147], a[0:3], v[252:255]
  ds_read_b128 a[96:99], v224 offset:32768
  ds_read_b128 a[100:103], v224 offset:33024
  v_mfma_f32_16x16x32_bf16 v[204:207], a[148:151], a[4:7], v[204:207]
  v_exp_f32 v199, v199
  v_mfma_f32_16x16x32_bf16 v[204:207], a[152:155], a[8:11], v[204:207]
  v_cvt_pk_bf16_f32 v210, v196, v197
  v_cvt_pk_bf16_f32 v211, v198, v199
  v_mfma_f32_16x16x32_bf16 v[204:207], a[156:159], a[12:15], v[204:207]
  ds_read_b32 v244, v242
  v_mfma_f32_16x16x32_bf16 v[128:131], v[208:211], a[160:163], v[128:131]
  v_mul_f32 v200, s36, v200
  v_mul_f32 v201, s36, v201
  v_mfma_f32_16x16x32_bf16 v[132:135], v[208:211], a[164:167], v[132:135]
  v_exp_f32 v200, v200
  v_mfma_f32_16x16x32_bf16 v[136:139], v[208:211], a[168:171], v[136:139]
  v_mul_f32 v202, s36, v202
  v_mul_f32 v203, s36, v203
  v_mfma_f32_16x16x32_bf16 v[140:143], v[208:211], a[172:175], v[140:143]
  v_exp_f32 v201, v201
  v_mfma_f32_16x16x32_bf16 v[144:147], v[208:211], a[176:179], v[144:147]
  ds_read_b128 a[104:107], v224 offset:33280
  ds_read_b128 a[108:111], v224 offset:33536
  v_mfma_f32_16x16x32_bf16 v[148:151], v[208:211], a[180:183], v[148:151]
  s_waitcnt lgkmcnt(2)
  v_exp_f32 v202, v202
  v_cmp_gt_u32 vcc, s58, v244
  v_mfma_f32_16x16x32_bf16 v[152:155], v[208:211], a[184:187], v[152:155]
  v_cvt_pk_bf16_f32 v212, v200, v201
  v_mul_f32 v204, s36, v204
  v_mfma_f32_16x16x32_bf16 v[156:159], v[208:211], a[188:191], v[156:159]
  s_cbranch_vccnz L_s5_D13
L_r5_D13:
  v_exp_f32 v203, v203
  v_mfma_f32_16x16x32_bf16 a[240:243], a[248:251], v[208:211], a[240:243]
  s_add_u32 s58, s58, 1
  v_mul_f32 v205, s36, v205
  v_mul_f32 v206, s36, v206
  v_mfma_f32_16x16x32_bf16 v[192:195], a[128:131], a[16:19], v[252:255]
  v_exp_f32 v204, v204
  v_mfma_f32_16x16x32_bf16 v[192:195], a[132:135], a[20:23], v[192:195]
  v_cvt_pk_bf16_f32 v213, v202, v203
  v_mul_f32 v207, s36, v207
  v_mfma_f32_16x16x32_bf16 v[192:195], a[136:139], a[24:27], v[192:195]
  v_exp_f32 v205, v205
  v_mfma_f32_16x16x32_bf16 v[192:195], a[140:143], a[28:31], v[192:195]
  v_exp_f32 v206, v206
  v_mfma_f32_16x16x32_bf16 v[196:199], a[144:147], a[16:19], v[252:255]
  ds_read_b128 a[112:115], v224 offset:36864
  ds_read_b128 a[116:119], v224 offset:37120
  v_mfma_f32_16x16x32_bf16 v[196:199], a[148:151], a[20:23], v[196:199]
  v_exp_f32 v207, v207
  v_mfma_f32_16x16x32_bf16 v[196:199], a[152:155], a[24:27], v[196:199]
  v_cvt_pk_bf16_f32 v214, v204, v205
  v_cvt_pk_bf16_f32 v215, v206, v207
  v_mfma_f32_16x16x32_bf16 v[196:199], a[156:159], a[28:31], v[196:199]
  s_nop 0
  v_mfma_f32_16x16x32_bf16 v[0:3], v[212:215], a[192:195], v[0:3]
  v_mul_f32 v192, s36, v192
  v_mul_f32 v193, s36, v193
  v_mfma_f32_16x16x32_bf16 v[4:7], v[212:215], a[196:199], v[4:7]
  v_exp_f32 v192, v192
  v_mfma_f32_16x16x32_bf16 v[8:11], v[212:215], a[200:203], v[8:11]
  v_mul_f32 v194, s36, v194
  v_mul_f32 v195, s36, v195
  v_mfma_f32_16x16x32_bf16 v[12:15], v[212:215], a[204:207], v[12:15]
  v_exp_f32 v193, v193
  v_mfma_f32_16x16x32_bf16 v[16:19], v[212:215], a[208:211], v[16:19]
  ds_read_b128 a[120:123], v224 offset:37376
  ds_read_b128 a[124:127], v224 offset:37632
  v_mfma_f32_16x16x32_bf16 v[20:23], v[212:215], a[212:215], v[20:23]
  v_exp_f32 v194, v194
  v_mfma_f32_16x16x32_bf16 v[24:27], v[212:215], a[216:219], v[24:27]
  v_cvt_pk_bf16_f32 v208, v192, v193
  v_mul_f32 v196, s36, v196
  v_mfma_f32_16x16x32_bf16 v[28:31], v[212:215], a[220:223], v[28:31]
  v_exp_f32 v195, v195
  v_mfma_f32_16x16x32_bf16 a[224:227], a[248:251], v[212:215], a[224:227]
  v_mul_f32 v197, s36, v197
  v_mul_f32 v198, s36, v198
  v_mfma_f32_16x16x32_bf16 v[200:203], a[128:131], a[32:35], v[252:255]
  v_exp_f32 v196, v196
  v_mfma_f32_16x16x32_bf16 v[200:203], a[132:135], a[36:39], v[200:203]
  v_cvt_pk_bf16_f32 v209, v194, v195
  v_mul_f32 v199, s36, v199
  v_mfma_f32_16x16x32_bf16 v[200:203], a[136:139], a[40:43], v[200:203]
  v_exp_f32 v197, v197
  v_mfma_f32_16x16x32_bf16 v[200:203], a[140:143], a[44:47], v[200:203]
  v_exp_f32 v198, v198
  v_mfma_f32_16x16x32_bf16 v[204:207], a[144:147], a[32:35], v[252:255]
  ds_read_b64_tr_b16 a[160:161], v226 offset:40960
  ds_read_b64_tr_b16 a[162:163], v226 offset:45056
  v_mfma_f32_16x16x32_bf16 v[204:207], a[148:151], a[36:39], v[204:207]
  v_exp_f32 v199, v199
  v_mfma_f32_16x16x32_bf16 v[204:207], a[152:155], a[40:43], v[204:207]
  v_cvt_pk_bf16_f32 v210, v196, v197
  v_cvt_pk_bf16_f32 v211, v198, v199
  v_mfma_f32_16x16x32_bf16 v[204:207], a[156:159], a[44:47], v[204:207]
  s_nop 0
  v_mfma_f32_16x16x32_bf16 v[32:35], v[208:211], a[192:195], v[32:35]
  ds_read_b64_tr_b16 a[164:165], v237 offset:40960
  ds_read_b64_tr_b16 a[166:167], v237 offset:45056
  v_mul_f32 v200, s36, v200
  v_mul_f32 v201, s36, v201
  v_mfma_f32_16x16x32_bf16 v[36:39], v[208:211], a[196:199], v[36:39]
  v_exp_f32 v200, v200
  v_mfma_f32_16x16x32_bf16 v[40:43], v[208:211], a[200:203], v[40:43]
  v_mul_f32 v202, s36, v202
  v_mul_f32 v203, s36, v203
  v_mfma_f32_16x16x32_bf16 v[44:47], v[208:211], a[204:207], v[44:47]
  v_exp_f32 v201, v201
  v_mfma_f32_16x16x32_bf16 v[48:51], v[208:211], a[208:211], v[48:51]
  ds_read_b64_tr_b16 a[168:169], v234 offset:40960
  ds_read_b64_tr_b16 a[170:171], v234 offset:45056
  v_mfma_f32_16x16x32_bf16 v[52:55], v[208:211], a[212:215], v[52:55]
  v_exp_f32 v202, v202
  v_mfma_f32_16x16x32_bf16 v[56:59], v[208:211], a[216:219], v[56:59]
  v_cvt_pk_bf16_f32 v212, v200, v201
  v_mul_f32 v204, s36, v204
  v_mfma_f32_16x16x32_bf16 v[60:63], v[208:211], a[220:223], v[60:63]
  v_exp_f32 v203, v203
  v_mfma_f32_16x16x32_bf16 a[228:231], a[248:251], v[208:211], a[228:231]
  v_mul_f32 v205, s36, v205
  v_mul_f32 v206, s36, v206
  v_mfma_f32_16x16x32_bf16 v[192:195], a[128:131], a[48:51], v[252:255]
  v_exp_f32 v204, v204
  v_mfma_f32_16x16x32_bf16 v[192:195], a[132:135], a[52:55], v[192:195]
  v_cvt_pk_bf16_f32 v213, v202, v203
  v_mul_f32 v207, s36, v207
  v_mfma_f32_16x16x32_bf16 v[192:195], a[136:139], a[56:59], v[192:195]
  v_exp_f32 v205, v205
  v_mfma_f32_16x16x32_bf16 v[192:195], a[140:143], a[60:63], v[192:195]
  v_exp_f32 v206, v206
  v_mfma_f32_16x16x32_bf16 v[196:199], a[144:147], a[48:51], v[252:255]
  ds_read_b64_tr_b16 a[172:173], v228 offset:40960
  ds_read_b64_tr_b16 a[174:175], v228 offset:45056
  v_mfma_f32_16x16x32_bf16 v[196:199], a[148:151], a[52:55], v[196:199]
  v_exp_f32 v207, v207
  v_mfma_f32_16x16x32_bf16 v[196:199], a[152:155], a[56:59], v[196:199]
  v_cvt_pk_bf16_f32 v214, v204, v205
  v_cvt_pk_bf16_f32 v215, v206, v207
  v_mfma_f32_16x16x32_bf16 v[196:199], a[156:159], a[60:63], v[196:199]
  s_nop 0
  v_mfma_f32_16x16x32_bf16 v[64:67], v[212:215], a[192:195], v[64:67]
  ds_read_b64_tr_b16 a[176:177], v226 offset:40968
  ds_read_b64_tr_b16 a[178:179], v226 offset:45064
  v_mul_f32 v192, s36, v192
  v_mul_f32 v193, s36, v193
  v_mfma_f32_16x16x32_bf16 v[68:71], v[212:215], a[196:199], v[68:71]
  v_exp_f32 v192, v192
  v_mfma_f32_16x16x32_bf16 v[72:75], v[212:215], a[200:203], v[72:75]
  v_mul_f32 v194, s36, v194
  v_mul_f32 v195, s36, v195
  v_mfma_f32_16x16x32_bf16 v[76:79], v[212:215], a[204:207], v[76:79]
  v_exp_f32 v193, v193
  v_mfma_f32_16x16x32_bf16 v[80:83], v[212:215], a[208:211], v[80:83]
  ds_read_b64_tr_b16 a[180:181], v237 offset:40968
  ds_read_b64_tr_b16 a[182:183], v237 offset:45064
  v_mfma_f32_16x16x32_bf16 v[84:87], v[212:215], a[212:215], v[84:87]
  v_exp_f32 v194, v194
  v_mfma_f32_16x16x32_bf16 v[88:91], v[212:215], a[216:219], v[88:91]
  v_cvt_pk_bf16_f32 v208, v192, v193
  v_mul_f32 v196, s36, v196
  v_mfma_f32_16x16x32_bf16 v[92:95], v[212:215], a[220:223], v[92:95]
  v_exp_f32 v195, v195
  v_mfma_f32_16x16x32_bf16 a[232:235], a[248:251], v[212:215], a[232:235]
  v_mul_f32 v197, s36, v197
  v_mul_f32 v198, s36, v198
  v_mfma_f32_16x16x32_bf16 v[200:203], a[128:131], a[64:67], v[252:255]
  v_exp_f32 v196, v196
  v_mfma_f32_16x16x32_bf16 v[200:203], a[132:135], a[68:71], v[200:203]
  v_cvt_pk_bf16_f32 v209, v194, v195
  v_mul_f32 v199, s36, v199
  v_mfma_f32_16x16x32_bf16 v[200:203], a[136:139], a[72:75], v[200:203]
  v_exp_f32 v197, v197
  v_mfma_f32_16x16x32_bf16 v[200:203], a[140:143], a[76:79], v[200:203]
  v_exp_f32 v198, v198
  v_mfma_f32_16x16x32_bf16 v[204:207], a[144:147], a[64:67], v[252:255]
  ds_read_b64_tr_b16 a[184:185], v234 offset:40968
  ds_read_b64_tr_b16 a[186:187], v234 offset:45064
  v_mfma_f32_16x16x32_bf16 v[204:207], a[148:151], a[68:71], v[204:207]
  v_exp_f32 v199, v199
  v_mfma_f32_16x16x32_bf16 v[204:207], a[152:155], a[72:75], v[204:207]
  v_cvt_pk_bf16_f32 v210, v196, v197
  v_cvt_pk_bf16_f32 v211, v198, v199
  v_mfma_f32_16x16x32_bf16 v[204:207], a[156:159], a[76:79], v[204:207]
  s_waitcnt vmcnt(0)
  ds_add_u32 v245, v243
  v_mfma_f32_16x16x32_bf16 v[96:99], v[208:211], a[192:195], v[96:99]
  v_mul_f32 v200, s36, v200
  v_mul_f32 v201, s36, v201
  v_mfma_f32_16x16x32_bf16 v[100:103], v[208:211], a[196:199], v[100:103]
  v_exp_f32 v200, v200
  v_mfma_f32_16x16x32_bf16 v[104:107], v[208:211], a[200:203], v[104:107]
  v_mul_f32 v202, s36, v202
  v_mul_f32 v203, s36, v203
  v_mfma_f32_16x16x32_bf16 v[108:111], v[208:211], a[204:207], v[108:111]
  s_add_u32 s44, s44, 1
  v_exp_f32 v201, v201
  v_mfma_f32_16x16x32_bf16 v[112:115], v[208:211], a[208:211], v[112:115]
  ds_read_b64_tr_b16 a[188:189], v228 offset:40968
  ds_read_b64_tr_b16 a[190:191], v228 offset:45064
  v_mfma_f32_16x16x32_bf16 v[116:119], v[208:211], a[212:215], v[116:119]
  v_exp_f32 v202, v202
  v_mfma_f32_16x16x32_bf16 v[120:123], v[208:211], a[216:219], v[120:123]
  s_waitcnt lgkmcnt(15)
  v_cvt_pk_bf16_f32 v212, v200, v201
  v_mul_f32 v204, s36, v204
  v_mfma_f32_16x16x32_bf16 v[124:127], v[208:211], a[220:223], v[124:127]
  v_exp_f32 v203, v203
  v_mfma_f32_16x16x32_bf16 a[236:239], a[248:251], v[208:211], a[236:239]
  s_cmp_lt_u32 s44, 3
  v_mul_f32 v205, s36, v205
  v_mul_f32 v206, s36, v206
  s_cbranch_scc1 L_D5
  s_branch L_E5
L_s5_a:
  s_mov_b32 s59, 1048576
L_s5_a_l:
  ds_read_b32 v244, v242
  s_sub_u32 s59, s59, 1
  s_cbranch_scc1 L_s5_a_x
  s_waitcnt lgkmcnt(0)
  v_cmp_gt_u32 vcc, s58, v244
  s_nop 0
  s_cbranch_vccnz L_s5_a_l
L_s5_a_x:
  s_waitcnt lgkmcnt(0)
  s_branch L_r5_a
L_s5_1515:
  s_mov_b32 s59, 1048576
L_s5_1515_l:
  ds_read_b32 v244, v242
  s_sub_u32 s59, s59, 1
  s_cbranch_scc1 L_s5_1515_x
  s_waitcnt lgkmcnt(0)
  v_cmp_gt_u32 vcc, s58, v244
  s_nop 0
  s_cbranch_vccnz L_s5_1515_l
L_s5_1515_x:
  s_waitcnt lgkmcnt(0)
  s_branch L_r5_1515
L_s5_00:
  s_mov_b32 s59, 1048576
L_s5_00_l:
  ds_read_b32 v244, v242
  s_sub_u32 s59, s59, 1
  s_cbranch_scc1 L_s5_00_x
  s_waitcnt lgkmcnt(0)
  v_cmp_gt_u32 vcc, s58, v244
  s_nop 0
  s_cbranch_vccnz L_s5_00_l
L_s5_00_x:
  s_waitcnt lgkmcnt(0)
  s_branch L_r5_00
L_s5_11:
  s_mov_b32 s59, 1048576
L_s5_11_l:
  ds_read_b32 v244, v242
  s_sub_u32 s59, s59, 1
  s_cbranch_scc1 L_s5_11_x
  s_waitcnt lgkmcnt(0)
  v_cmp_gt_u32 vcc, s58, v244
  s_nop 0
  s_cbranch_vccnz L_s5_11_l
L_s5_11_x:
  s_waitcnt lgkmcnt(0)
  s_branch L_r5_11
L_s5_B2:
  s_mov_b32 s59, 1048576
L_s5_B2_l:
  ds_read_b32 v244, v242
  s_sub_u32 s59, s59, 1
  s_cbranch_scc1 L_s5_B2_x
  s_waitcnt lgkmcnt(0)
  v_cmp_gt_u32 vcc, s58, v244
  s_nop 0
  s_cbranch_vccnz L_s5_B2_l
L_s5_B2_x:
  s_waitcnt lgkmcnt(0)
  s_branch L_r5_B2
L_s5_B3:
  s_mov_b32 s59, 1048576
L_s5_B3_l:
  ds_read_b32 v244, v242
  s_sub_u32 s59, s59, 1
  s_cbranch_scc1 L_s5_B3_x
  s_waitcnt lgkmcnt(0)
  v_cmp_gt_u32 vcc, s58, v244
  s_nop 0
  s_cbranch_vccnz L_s5_B3_l
L_s5_B3_x:
  s_waitcnt lgkmcnt(0)
  s_branch L_r5_B3
L_s5_B4:
  s_mov_b32 s59, 1048576
L_s5_B4_l:
  ds_read_b32 v244, v242
  s_sub_u32 s59, s59, 1
  s_cbranch_scc1 L_s5_B4_x
  s_waitcnt lgkmcnt(0)
  v_cmp_gt_u32 vcc, s58, v244
  s_nop 0
  s_cbranch_vccnz L_s5_B4_l
L_s5_B4_x:
  s_waitcnt lgkmcnt(0)
  s_branch L_r5_B4
L_s5_B5:
  s_mov_b32 s59, 1048576
L_s5_B5_l:
  ds_read_b32 v244, v242
  s_sub_u32 s59, s59, 1
  s_cbranch_scc1 L_s5_B5_x
  s_waitcnt lgkmcnt(0)
  v_cmp_gt_u32 vcc, s58, v244
  s_nop 0
  s_cbranch_vccnz L_s5_B5_l
L_s5_B5_x:
  s_waitcnt lgkmcnt(0)
  s_branch L_r5_B5
L_s5_C2:
  s_mov_b32 s59, 1048576
L_s5_C2_l:
  ds_read_b32 v244, v242
  s_sub_u32 s59, s59, 1
  s_cbranch_scc1 L_s5_C2_x
  s_waitcnt lgkmcnt(0)
  v_cmp_gt_u32 vcc, s58, v244
  s_nop 0
  s_cbranch_vccnz L_s5_C2_l
L_s5_C2_x:
  s_waitcnt lgkmcnt(0)
  s_branch L_r5_C2
L_s5_C3:
  s_mov_b32 s59, 1048576
L_s5_C3_l:
  ds_read_b32 v244, v242
  s_sub_u32 s59, s59, 1
  s_cbranch_scc1 L_s5_C3_x
  s_waitcnt lgkmcnt(0)
  v_cmp_gt_u32 vcc, s58, v244
  s_nop 0
  s_cbranch_vccnz L_s5_C3_l
L_s5_C3_x:
  s_waitcnt lgkmcnt(0)
  s_branch L_r5_C3
L_s5_C4:
  s_mov_b32 s59, 1048576
L_s5_C4_l:
  ds_read_b32 v244, v242
  s_sub_u32 s59, s59, 1
  s_cbranch_scc1 L_s5_C4_x
  s_waitcnt lgkmcnt(0)
  v_cmp_gt_u32 vcc, s58, v244
  s_nop 0
  s_cbranch_vccnz L_s5_C4_l
L_s5_C4_x:
  s_waitcnt lgkmcnt(0)
  s_branch L_r5_C4
L_s5_C5:
  s_mov_b32 s59, 1048576
L_s5_C5_l:
  ds_read_b32 v244, v242
  s_sub_u32 s59, s59, 1
  s_cbranch_scc1 L_s5_C5_x
  s_waitcnt lgkmcnt(0)
  v_cmp_gt_u32 vcc, s58, v244
  s_nop 0
  s_cbranch_vccnz L_s5_C5_l
L_s5_C5_x:
  s_waitcnt lgkmcnt(0)
  s_branch L_r5_C5
L_s5_D10:
  s_mov_b32 s59, 1048576
L_s5_D10_l:
  ds_read_b32 v244, v242
  s_sub_u32 s59, s59, 1
  s_cbranch_scc1 L_s5_D10_x
  s_waitcnt lgkmcnt(0)
  v_cmp_gt_u32 vcc, s58, v244
  s_nop 0
  s_cbranch_vccnz L_s5_D10_l
L_s5_D10_x:
  s_waitcnt lgkmcnt(0)
  s_branch L_r5_D10
L_s5_D11:
  s_mov_b32 s59, 1048576
L_s5_D11_l:
  ds_read_b32 v244, v242
  s_sub_u32 s59, s59, 1
  s_cbranch_scc1 L_s5_D11_x
  s_waitcnt lgkmcnt(0)
  v_cmp_gt_u32 vcc, s58, v244
  s_nop 0
  s_cbranch_vccnz L_s5_D11_l
L_s5_D11_x:
  s_waitcnt lgkmcnt(0)
  s_branch L_r5_D11
L_s5_D12:
  s_mov_b32 s59, 1048576
L_s5_D12_l:
  ds_read_b32 v244, v242
  s_sub_u32 s59, s59, 1
  s_cbranch_scc1 L_s5_D12_x
  s_waitcnt lgkmcnt(0)
  v_cmp_gt_u32 vcc, s58, v244
  s_nop 0
  s_cbranch_vccnz L_s5_D12_l
L_s5_D12_x:
  s_waitcnt lgkmcnt(0)
  s_branch L_r5_D12
L_s5_D13:
  s_mov_b32 s59, 1048576
L_s5_D13_l:
  ds_read_b32 v244, v242
  s_sub_u32 s59, s59, 1
  s_cbranch_scc1 L_s5_D13_x
  s_waitcnt lgkmcnt(0)
  v_cmp_gt_u32 vcc, s58, v244
  s_nop 0
  s_cbranch_vccnz L_s5_D13_l
L_s5_D13_x:
  s_waitcnt lgkmcnt(0)
  s_branch L_r5_D13
L_s5_1414:
  s_mov_b32 s59, 1048576
L_s5_1414_l:
  ds_read_b32 v244, v242
  s_sub_u32 s59, s59, 1
  s_cbranch_scc1 L_s5_1414_x
  s_waitcnt lgkmcnt(0)
  v_cmp_gt_u32 vcc, s58, v244
  s_nop 0
  s_cbranch_vccnz L_s5_1414_l
L_s5_1414_x:
  s_waitcnt lgkmcnt(0)
  s_branch L_r5_1414
L_tail:
  s_nop 0
  s_cmp_eq_u32 s46, 0
  s_cbranch_scc1 L_done
  s_waitcnt vmcnt(0) lgkmcnt(0)
  s_mov_b32 s18, 96468992
  s_mov_b32 s30, 96468992
  v_bfe_u32 v250, v248, 2, 2
  v_lshrrev_b32 v251, 4, v248
  v_and_b32 v252, 3, v248
  v_and_b32 v253, 1, v251
  v_lshlrev_b32 v226, 10, v251
  v_lshl_add_u32 v226, v250, 6, v226
  v_lshlrev_b32 v253, 1, v253
  v_xor_b32 v253, v253, v252
  v_lshl_add_u32 v226, v253, 4, v226
  v_lshl_add_u32 v231, v248, 4, s50
  v_lshrrev_b32 v250, 3, v248
  v_and_b32 v253, 7, v248
  v_xor_b32 v254, v250, v253
  v_lshlrev_b32 v232, 8, v250
  v_lshl_add_u32 v232, v254, 4, v232
  v_and_b32 v250, 1, v250
  v_xor_b32 v254, v251, v253
  v_lshl_add_u32 v233, v250, 11, s50
  v_lshl_add_u32 v233, v253, 7, v233
  v_lshl_add_u32 v233, v254, 4, v233
  v_xor_b32 v234, 64, v233
  s_add_u32 s48, s50, 4096
  v_add_u32 v216, s48, v224
  v_add_u32 v217, s48, v226
  v_xor_b32 v254, 16, v248
  v_xor_b32 v255, 32, v248
  v_lshlrev_b32 v254, 2, v254
  v_lshlrev_b32 v255, 2, v255
  s_mov_b32 s44, 0
  s_mov_b32 s45, 0
L_fb_scan:
  s_bitcmp1_b32 s46, 0
  s_cbranch_scc0 L_fb_next
  s_mul_i32 s41, s44, 188416
  s_add_u32 s41, s41, s51
  s_lshl_b32 s48, s45, 12
  s_add_u32 s41, s41, s48
  s_lshl_b32 s55, s44, 17
  s_add_u32 s55, s55, s53
  s_mov_b32 m0, s50
  s_nop 0
  buffer_load_dwordx4 v229, s[16:19], s41 offen offset:0 lds
  buffer_load_dwordx4 v229, s[16:19], s41 offen offset:1024 lds
  buffer_load_dwordx4 v230, s[16:19], s41 offen offset:2048 lds
  buffer_load_dwordx4 v230, s[16:19], s41 offen offset:3072 lds
  v_mov_b32 v250, 0xff800000
  v_mov_b32 v251, 0
  v_mov_b32 v0, 0
  v_mov_b32 v1, 0
  v_mov_b32 v2, 0
  v_mov_b32 v3, 0
  v_mov_b32 v4, 0
  v_mov_b32 v5, 0
  v_mov_b32 v6, 0
  v_mov_b32 v7, 0
  v_mov_b32 v8, 0
  v_mov_b32 v9, 0
  v_mov_b32 v10, 0
  v_mov_b32 v11, 0
  v_mov_b32 v12, 0
  v_mov_b32 v13, 0
  v_mov_b32 v14, 0
  v_mov_b32 v15, 0
  v_mov_b32 v16, 0
  v_mov_b32 v17, 0
  v_mov_b32 v18, 0
  v_mov_b32 v19, 0
  v_mov_b32 v20, 0
  v_mov_b32 v21, 0
  v_mov_b32 v22, 0
  v_mov_b32 v23, 0
  v_mov_b32 v24, 0
  v_mov_b32 v25, 0
  v_mov_b32 v26, 0
  v_mov_b32 v27, 0
  v_mov_b32 v28, 0
  v_mov_b32 v29, 0
  v_mov_b32 v30, 0
  v_mov_b32 v31, 0
  s_waitcnt vmcnt(0)
  ds_read_b128 a[0:3], v225 offset:0
  ds_read_b128 a[4:7], v225 offset:256
  ds_read_b128 a[8:11], v225 offset:512
  ds_read_b128 a[12:15], v225 offset:768
  s_mov_b32 s54, 0
L_fb_tile:
  s_add_u32 m0, s50, 4096
  s_add_u32 s48, s55, 0
  buffer_load_dwordx4 v229, s[20:23], s48 offen offset:0 lds
  buffer_load_dwordx4 v229, s[20:23], s48 offen offset:1024 lds
  buffer_load_dwordx4 v230, s[20:23], s48 offen offset:2048 lds
  buffer_load_dwordx4 v230, s[20:23], s48 offen offset:3072 lds
  s_add_u32 m0, s50, 12288
  s_nop 0
  buffer_load_dwordx4 v229, s[24:27], s48 offen offset:0 lds
  buffer_load_dwordx4 v230, s[24:27], s48 offen offset:1024 lds
  buffer_load_dwordx4 v229, s[24:27], s48 offen offset:2048 lds
  buffer_load_dwordx4 v230, s[24:27], s48 offen offset:3072 lds
  s_add_u32 m0, s50, 8192
  s_add_u32 s48, s55, 4096
  buffer_load_dwordx4 v229, s[20:23], s48 offen offset:0 lds
  buffer_load_dwordx4 v229, s[20:23], s48 offen offset:1024 lds
  buffer_load_dwordx4 v230, s[20:23], s48 offen offset:2048 lds
  buffer_load_dwordx4 v230, s[20:23], s48 offen offset:3072 lds
  s_add_u32 m0, s50, 16384
  s_nop 0
  buffer_load_dwordx4 v229, s[24:27], s48 offen offset:0 lds
  buffer_load_dwordx4 v230, s[24:27], s48 offen offset:1024 lds
  buffer_load_dwordx4 v229, s[24:27], s48 offen offset:2048 lds
  buffer_load_dwordx4 v230, s[24:27], s48 offen offset:3072 lds
  s_add_u32 s55, s55, 8192
  s_waitcnt vmcnt(0)
  ds_read_b128 a[96:99], v216 offset:0
  ds_read_b128 a[100:103], v216 offset:256
  ds_read_b128 a[104:107], v216 offset:512
  ds_read_b128 a[108:111], v216 offset:768
  ds_read_b128 a[112:115], v216 offset:4096
  ds_read_b128 a[116:119], v216 offset:4352
  ds_read_b128 a[120:123], v216 offset:4608
  ds_read_b128 a[124:127], v216 offset:4864
  ds_read_b64_tr_b16 a[160:161], v217 offset:8192
  ds_read_b64_tr_b16 a[162:163], v217 offset:12288
  ds_read_b64_tr_b16 a[164:165], v217 offset:8200
  ds_read_b64_tr_b16 a[166:167], v217 offset:12296
  ds_read_b64_tr_b16 a[168:169], v217 offset:8448
  ds_read_b64_tr_b16 a[170:171], v217 offset:12544
  ds_read_b64_tr_b16 a[172:173], v217 offset:8456
  ds_read_b64_tr_b16 a[174:175], v217 offset:12552
  ds_read_b64_tr_b16 a[176:177], v217 offset:8704
  ds_read_b64_tr_b16 a[178:179], v217 offset:12800
  ds_read_b64_tr_b16 a[180:181], v217 offset:8712
  ds_read_b64_tr_b16 a[182:183], v217 offset:12808
  ds_read_b64_tr_b16 a[184:185], v217 offset:8960
  ds_read_b64_tr_b16 a[186:187], v217 offset:13056
  ds_read_b64_tr_b16 a[188:189], v217 offset:8968
  ds_read_b64_tr_b16 a[190:191], v217 offset:13064
  s_waitcnt lgkmcnt(0)
  v_mfma_f32_16x16x32_bf16 v[192:195], a[96:99], a[0:3], 0
  v_mfma_f32_16x16x32_bf16 v[192:195], a[100:103], a[4:7], v[192:195]
  v_mfma_f32_16x16x32_bf16 v[192:195], a[104:107], a[8:11], v[192:195]
  v_mfma_f32_16x16x32_bf16 v[192:195], a[108:111], a[12:15], v[192:195]
  v_mfma_f32_16x16x32_bf16 v[196:199], a[112:115], a[0:3], 0
  v_mfma_f32_16x16x32_bf16 v[196:199], a[116:119], a[4:7], v[196:199]
  v_mfma_f32_16x16x32_bf16 v[196:199], a[120:123], a[8:11], v[196:199]
  v_mfma_f32_16x16x32_bf16 v[196:199], a[124:127], a[12:15], v[196:199]
  s_nop 7
  s_nop 1
  v_max3_f32 v253, v192, v193, v194
  v_max3_f32 v253, v253, v195, v196
  v_max3_f32 v253, v253, v197, v198
  v_max3_f32 v253, v253, v199, v250
  ds_bpermute_b32 v252, v254, v253
  s_waitcnt lgkmcnt(0)
  v_max_f32 v253, v253, v252
  ds_bpermute_b32 v252, v255, v253
  s_waitcnt lgkmcnt(0)
  v_max_f32 v253, v253, v252
  v_sub_f32 v252, v250, v253
  v_mul_f32 v252, s36, v252
  v_exp_f32 v252, v252
  v_mov_b32 v250, v253
  v_sub_f32 v192, v192, v253
  v_sub_f32 v193, v193, v253
  v_sub_f32 v194, v194, v253
  v_sub_f32 v195, v195, v253
  v_sub_f32 v196, v196, v253
  v_sub_f32 v197, v197, v253
  v_sub_f32 v198, v198, v253
  v_sub_f32 v199, v199, v253
  v_mul_f32 v192, s36, v192
  v_mul_f32 v193, s36, v193
  v_mul_f32 v194, s36, v194
  v_mul_f32 v195, s36, v195
  v_mul_f32 v196, s36, v196
  v_mul_f32 v197, s36, v197
  v_mul_f32 v198, s36, v198
  v_mul_f32 v199, s36, v199
  v_exp_f32 v192, v192
  v_exp_f32 v193, v193
  v_exp_f32 v194, v194
  v_exp_f32 v195, v195
  v_exp_f32 v196, v196
  v_exp_f32 v197, v197
  v_exp_f32 v198, v198
  v_exp_f32 v199, v199
  v_mul_f32 v251, v251, v252
  v_mul_f32 v0, v252, v0
  v_mul_f32 v1, v252, v1
  v_mul_f32 v2, v252, v2
  v_mul_f32 v3, v252, v3
  v_mul_f32 v4, v252, v4
  v_mul_f32 v5, v252, v5
  v_mul_f32 v6, v252, v6
  v_mul_f32 v7, v252, v7
  v_mul_f32 v8, v252, v8
  v_mul_f32 v9, v252, v9
  v_mul_f32 v10, v252, v10
  v_mul_f32 v11, v252, v11
  v_mul_f32 v12, v252, v12
  v_mul_f32 v13, v252, v13
  v_mul_f32 v14, v252, v14
  v_mul_f32 v15, v252, v15
  v_mul_f32 v16, v252, v16
  v_mul_f32 v17, v252, v17
  v_mul_f32 v18, v252, v18
  v_mul_f32 v19, v252, v19
  v_mul_f32 v20, v252, v20
  v_mul_f32 v21, v252, v21
  v_mul_f32 v22, v252, v22
  v_mul_f32 v23, v252, v23
  v_mul_f32 v24, v252, v24
  v_mul_f32 v25, v252, v25
  v_mul_f32 v26, v252, v26
  v_mul_f32 v27, v252, v27
  v_mul_f32 v28, v252, v28
  v_mul_f32 v29, v252, v29
  v_mul_f32 v30, v252, v30
  v_mul_f32 v31, v252, v31
  v_add_f32 v251, v251, v192
  v_add_f32 v251, v251, v193
  v_add_f32 v251, v251, v194
  v_add_f32 v251, v251, v195
  v_add_f32 v251, v251, v196
  v_add_f32 v251, v251, v197
  v_add_f32 v251, v251, v198
  v_add_f32 v251, v251, v199
  v_cvt_pk_bf16_f32 v208, v192, v193
  v_cvt_pk_bf16_f32 v209, v194, v195
  v_cvt_pk_bf16_f32 v210, v196, v197
  v_cvt_pk_bf16_f32 v211, v198, v199
  s_nop 1
  v_mfma_f32_16x16x32_bf16 v[0:3], a[160:163], v[208:211], v[0:3]
  v_mfma_f32_16x16x32_bf16 v[4:7], a[164:167], v[208:211], v[4:7]
  v_mfma_f32_16x16x32_bf16 v[8:11], a[168:171], v[208:211], v[8:11]
  v_mfma_f32_16x16x32_bf16 v[12:15], a[172:175], v[208:211], v[12:15]
  v_mfma_f32_16x16x32_bf16 v[16:19], a[176:179], v[208:211], v[16:19]
  v_mfma_f32_16x16x32_bf16 v[20:23], a[180:183], v[208:211], v[20:23]
  v_mfma_f32_16x16x32_bf16 v[24:27], a[184:187], v[208:211], v[24:27]
  v_mfma_f32_16x16x32_bf16 v[28:31], a[188:191], v[208:211], v[28:31]
  s_add_u32 s54, s54, 1
  s_cmp_lt_u32 s54, 16
  s_nop 7
  s_cbranch_scc1 L_fb_tile
  ds_bpermute_b32 v252, v254, v251
  s_waitcnt lgkmcnt(0)
  v_add_f32 v251, v251, v252
  ds_bpermute_b32 v252, v255, v251
  s_waitcnt lgkmcnt(0)
  v_add_f32 v251, v251, v252
  v_rcp_f32 v240, v251
  s_nop 1
  v_pk_mul_f32 v[0:1], v[0:1], v[240:241] op_sel_hi:[1,0]
  v_pk_mul_f32 v[2:3], v[2:3], v[240:241] op_sel_hi:[1,0]
  v_pk_mul_f32 v[4:5], v[4:5], v[240:241] op_sel_hi:[1,0]
  v_pk_mul_f32 v[6:7], v[6:7], v[240:241] op_sel_hi:[1,0]
  v_cvt_pk_bf16_f32 v0, v0, v1
  v_cvt_pk_bf16_f32 v1, v2, v3
  v_cvt_pk_bf16_f32 v2, v4, v5
  v_cvt_pk_bf16_f32 v3, v6, v7
  ds_write_b128 v233, v[0:3] offset:0
  v_pk_mul_f32 v[8:9], v[8:9], v[240:241] op_sel_hi:[1,0]
  v_pk_mul_f32 v[10:11], v[10:11], v[240:241] op_sel_hi:[1,0]
  v_pk_mul_f32 v[12:13], v[12:13], v[240:241] op_sel_hi:[1,0]
  v_pk_mul_f32 v[14:15], v[14:15], v[240:241] op_sel_hi:[1,0]
  v_cvt_pk_bf16_f32 v8, v8, v9
  v_cvt_pk_bf16_f32 v9, v10, v11
  v_cvt_pk_bf16_f32 v10, v12, v13
  v_cvt_pk_bf16_f32 v11, v14, v15
  ds_write_b128 v234, v[8:11] offset:0
  v_pk_mul_f32 v[16:17], v[16:17], v[240:241] op_sel_hi:[1,0]
  v_pk_mul_f32 v[18:19], v[18:19], v[240:241] op_sel_hi:[1,0]
  v_pk_mul_f32 v[20:21], v[20:21], v[240:241] op_sel_hi:[1,0]
  v_pk_mul_f32 v[22:23], v[22:23], v[240:241] op_sel_hi:[1,0]
  v_cvt_pk_bf16_f32 v16, v16, v17
  v_cvt_pk_bf16_f32 v17, v18, v19
  v_cvt_pk_bf16_f32 v18, v20, v21
  v_cvt_pk_bf16_f32 v19, v22, v23
  ds_write_b128 v233, v[16:19] offset:1024
  v_pk_mul_f32 v[24:25], v[24:25], v[240:241] op_sel_hi:[1,0]
  v_pk_mul_f32 v[26:27], v[26:27], v[240:241] op_sel_hi:[1,0]
  v_pk_mul_f32 v[28:29], v[28:29], v[240:241] op_sel_hi:[1,0]
  v_pk_mul_f32 v[30:31], v[30:31], v[240:241] op_sel_hi:[1,0]
  v_cvt_pk_bf16_f32 v24, v24, v25
  v_cvt_pk_bf16_f32 v25, v26, v27
  v_cvt_pk_bf16_f32 v26, v28, v29
  v_cvt_pk_bf16_f32 v27, v30, v31
  ds_write_b128 v234, v[24:27] offset:1024
  ds_read_b128 a[0:3], v231 offset:0
  ds_read_b128 a[4:7], v231 offset:1024
  ds_read_b128 a[8:11], v231 offset:2048
  ds_read_b128 a[12:15], v231 offset:3072
  s_waitcnt lgkmcnt(0)
  buffer_store_dwordx4 a[0:3], v232, s[28:31], s41 offen offset:0
  buffer_store_dwordx4 a[4:7], v232, s[28:31], s41 offen offset:128
  buffer_store_dwordx4 a[8:11], v232, s[28:31], s41 offen offset:2048
  buffer_store_dwordx4 a[12:15], v232, s[28:31], s41 offen offset:2176
  s_waitcnt vmcnt(0)
L_fb_next:
  s_add_u32 s45, s45, 1
  s_cmp_eq_u32 s45, s56
  s_cselect_b32 s45, 0, s45
  s_addc_u32 s44, s44, 0
  s_lshr_b32 s46, s46, 1
  s_cbranch_scc1 L_fb_scan
L_done:
L_end:
  s_endpgm
.section .rodata,"a"
.p2align 6
.amdhsa_kernel standalone__gqa_softmax__near_ridge_kernel
  .amdhsa_next_free_vgpr 512
  .amdhsa_next_free_sgpr 102
  .amdhsa_accum_offset 256
  .amdhsa_group_segment_fixed_size 0
  .amdhsa_kernarg_size 48
  .amdhsa_user_sgpr_count 2
  .amdhsa_user_sgpr_kernarg_segment_ptr 1
  .amdhsa_system_sgpr_workgroup_id_x 1
.end_amdhsa_kernel
```
